```python
import torch

def _softmax(x, axis=-1):
    return torch.softmax(x, dim=axis)
def _gelu(x):
    return torch.nn.functional.gelu(x, approximate="tanh")
def _silu(x):
    return torch.nn.functional.silu(x)
def _sigmoid(x):
    return torch.sigmoid(x)
def _layernorm(x, axis=-1, eps=1e-5):
    m = x.mean(dim=axis, keepdim=True)
    v = x.var(dim=axis, keepdim=True, unbiased=False)
    return (x - m) / torch.sqrt(v + eps)
def _scatter_add(tgt, idx, src, axis=0):
    return tgt.clone().index_add_(axis, idx, src)
def _segment_sum(src, seg, n):
    out = torch.zeros((n,) + src.shape[1:], dtype=src.dtype)
    return out.index_add_(0, seg, src)
def _pad(x, pw):
    flat = tuple(v for pair in reversed(pw) for v in pair)
    return torch.nn.functional.pad(x, flat)

kernel_name = 'gated_mix__compressed_kv_cla__mixer_channel_mlp__prompt'

def setup_inputs():

    _w = (lambda a: (lambda t: t.to(torch.bfloat16) if t.is_floating_point() else t)(torch.as_tensor(a)))
    def _A_setup():
        B, H, Sq, Sk, D, M = 1, 32, 2048, 2048, 128, 512
        Dc = 4 * D
        return {
            "x": _w((lambda *s: torch.randn(*s, dtype=torch.bfloat16) * 0.05)(B, Sq, M)),
            "c_kv": _w((lambda *s: torch.randn(*s, dtype=torch.bfloat16) * 0.8)(B, Sk, Dc)),
            "w_q": _w((lambda *s: torch.randn(*s, dtype=torch.bfloat16) * 6.4)(M, H, D) * (M ** -0.5)),
            "w_uk": _w((lambda *s: torch.randn(*s, dtype=torch.bfloat16) * 6.4)(Dc, H, D) * (Dc ** -0.5)),
            "w_uv": _w((lambda *s: torch.randn(*s, dtype=torch.bfloat16) * 0.8)(Dc, H, D) * (Dc ** -0.5)),
            "w_o": _w((lambda *s: torch.randn(*s, dtype=torch.bfloat16) * 0.8)(H, D, M) * ((H * D) ** -0.5)),
        }
    _A_in = _A_setup()

    def _B_setup():
        B, S, D, F = 1, 2048, 512, 1376
        return {
            "x": _w((lambda *s: torch.randn(*s, dtype=torch.bfloat16) * 0.05)(B, S, D)),
            "w1": _w((lambda *s: torch.randn(*s, dtype=torch.bfloat16) * 3.2)(D, F) * (D ** -0.5)),
            "b1": _w((lambda *s: torch.randn(*s, dtype=torch.bfloat16) * 1.6)(F)),
            "w2": _w((lambda *s: torch.randn(*s, dtype=torch.bfloat16) * 0.05)(F, D) * (F ** -0.5)),
            "b2": _w((lambda *s: torch.randn(*s, dtype=torch.bfloat16) * 0.05)(D)),
        }
    _B_in = _B_setup()

    return {
        "A_x": _A_in["x"],
        "A_c_kv": _A_in["c_kv"],
        "A_w_q": _A_in["w_q"],
        "A_w_uk": _A_in["w_uk"],
        "A_w_uv": _A_in["w_uv"],
        "A_w_o": _A_in["w_o"],
        "B_x": _B_in["x"],
        "B_w1": _B_in["w1"],
        "B_b1": _B_in["b1"],
        "B_w2": _B_in["w2"],
        "B_b2": _B_in["b2"],
        "gate_w": _w((lambda *s: torch.randn(*s, dtype=torch.bfloat16) * 0.05)(512) * 16.0),
    }

def reference(A_x, A_c_kv, A_w_q, A_w_uk, A_w_uv, A_w_o, B_x, B_w1, B_b1, B_w2, B_b2, gate_w):
    def _A_ref(x, c_kv, w_q, w_uk, w_uv, w_o):
        B, Sq, M = x.shape[0], x.shape[1], x.shape[2]
        Sk = c_kv.shape[1]
        H, D = w_q.shape[1], w_q.shape[2]
        q = torch.einsum("bqm,mhd->bhqd", x, w_q)
        k = torch.einsum("bkc,chd->bhkd", c_kv, w_uk)
        v = torch.einsum("bkc,chd->bhkd", c_kv, w_uv)
        scores = torch.einsum("bhqd,bhkd->bhqk", q, k) * (D ** -0.5)
        off = Sk - Sq
        qi = torch.arange(Sq)[:, None]
        kj = torch.arange(Sk)[None, :]
        cmask = kj <= (qi + off)
        scores = torch.where(cmask[None, None], scores, -1e9)
        p = _softmax(scores, axis=-1)
        ctx = torch.einsum("bhqk,bhkd->bhqd", p, v)
        return torch.einsum("bhqd,hdm->bqm", ctx, w_o)

    def _B_ref(x, w1, b1, w2, b2):
        y = _layernorm(x, axis=-1)
        h = _gelu(torch.einsum("bsd,df->bsf", y, w1) + b1)
        return torch.einsum("bsf,fd->bsd", h, w2) + b2

    x = A_x
    g = _sigmoid((x * gate_w).sum(-1, keepdims=True))
    a = _A_ref(x, A_c_kv, A_w_q, A_w_uk, A_w_uv, A_w_o)
    b = _B_ref(x, B_w1, B_b1, B_w2, B_b2)
    return g * a + (1 - g) * b
```

```asm
; @launch grid=(256,1,1) block=(256,1,1) lds=163840
.amdgcn_target "amdgcn-amd-amdhsa--gfx950"
.text
.globl gated_mix__compressed_kv_cla__mixer_channel_mlp__prompt_kernel
.p2align 8
.type gated_mix__compressed_kv_cla__mixer_channel_mlp__prompt_kernel,@function
gated_mix__compressed_kv_cla__mixer_channel_mlp__prompt_kernel:
s_cmp_ge_u32 s2, 256
s_cbranch_scc1 L_k12_end
s_load_dwordx2 s[4:5], s[0:1], 8
s_load_dwordx2 s[8:9], s[0:1], 24
s_load_dwordx2 s[12:13], s[0:1], 32
s_load_dwordx2 s[16:17], s[0:1], 112
s_load_dwordx2 s[20:21], s[0:1], 0
s_load_dwordx2 s[24:25], s[0:1], 16
s_load_dwordx2 s[28:29], s[0:1], 56
s_load_dwordx2 s[56:57], s[0:1], 64
s_load_dwordx2 s[32:33], s[0:1], 104
s_load_dwordx2 s[60:61], s[0:1], 88
s_and_b32 s39, s2, 7
s_lshr_b32 s40, s2, 3
s_lshl_b32 s36, s39, 2
s_lshr_b32 s41, s40, 3
s_add_u32 s36, s36, s41
s_and_b32 s37, s40, 7
v_lshrrev_b32 v1, 6, v0
s_nop 0
v_readfirstlane_b32 s38, v1
v_and_b32 v1, 63, v0
s_mov_b32 s6, 0x200000
s_mov_b32 s7, 0x20000
s_mov_b32 s11, 0x20000
s_mov_b32 s15, 0x20000
s_mov_b32 s18, 0x10000000
s_mov_b32 s19, 0x20000
s_mov_b32 s34, 256
s_mov_b32 s35, 0x20000
s_mov_b32 s62, 1024
s_mov_b32 s63, 0x20000
s_lshl_b32 s45, s38, 12
s_lshl_b32 s46, s38, 11
s_lshl_b32 s3, s38, 14
s_lshl_b32 s39, s37, 8
s_lshl_b32 s40, s38, 6
s_add_u32 s39, s39, s40
s_lshl_b32 s53, s39, 10
v_lshrrev_b32 v50, 3, v1
v_lshlrev_b32 v50, 10, v50
v_lshrrev_b32 v51, 4, v1
v_and_b32 v52, 7, v1
v_xor_b32 v53, v52, v51
v_lshl_add_u32 v2, v53, 4, v50
v_xor_b32 v53, v52, v51
v_xor_b32 v53, 4, v53
v_lshl_add_u32 v3, v53, 4, v50
v_add_u32 v3, 7168, v3
v_xor_b32 v53, v52, v51
v_lshl_add_u32 v4, v53, 4, v50
v_add_u32 v4, 14336, v4
v_xor_b32 v53, v52, v51
v_xor_b32 v53, 4, v53
v_lshl_add_u32 v5, v53, 4, v50
v_add_u32 v5, 21504, v5
v_lshrrev_b32 v50, 4, v1
s_lshl_b32 s39, s38, 3
v_add_u32 v51, s39, v50
v_lshlrev_b32 v51, 13, v51
v_bfe_u32 v52, v1, 2, 2
v_xor_b32 v52, v52, v50
v_lshlrev_b32 v52, 6, v52
v_and_b32 v53, 3, v1
v_lshlrev_b32 v53, 4, v53
v_add3_u32 v6, v51, v52, v53
v_add_u32 v7, 31744, v6
s_lshl_b32 s39, s36, 8
s_sub_u32 s10, 0x400000, s39
s_sub_u32 s14, 0x400000, s39
s_waitcnt lgkmcnt(0)
s_add_u32 s8, s8, s39
s_addc_u32 s9, s9, 0
s_add_u32 s12, s12, s39
s_addc_u32 s13, s13, 0
s_add_u32 m0, s3, 0
s_add_u32 s43, s53, 0
buffer_load_dwordx4 v2, s[4:7], s43 offen offset:0 lds
buffer_load_dwordx4 v3, s[4:7], s43 offen offset:1024 lds
buffer_load_dwordx4 v4, s[4:7], s43 offen offset:2048 lds
buffer_load_dwordx4 v5, s[4:7], s43 offen offset:3072 lds
s_add_u32 m0, s3, 4096
s_add_u32 s43, s53, 32768
buffer_load_dwordx4 v2, s[4:7], s43 offen offset:0 lds
buffer_load_dwordx4 v3, s[4:7], s43 offen offset:1024 lds
buffer_load_dwordx4 v4, s[4:7], s43 offen offset:2048 lds
buffer_load_dwordx4 v5, s[4:7], s43 offen offset:3072 lds
s_add_u32 m0, s46, 65536
s_mov_b32 s44, 0
buffer_load_dwordx4 v6, s[8:11], s44 offen offset:0 lds
buffer_load_dwordx4 v7, s[8:11], s44 offen offset:1024 lds
s_add_u32 m0, s46, 73728
s_nop 0
buffer_load_dwordx4 v6, s[12:15], s44 offen offset:0 lds
buffer_load_dwordx4 v7, s[12:15], s44 offen offset:1024 lds
s_add_u32 m0, s46, 81920
s_mov_b32 s44, 262144
buffer_load_dwordx4 v6, s[8:11], s44 offen offset:0 lds
buffer_load_dwordx4 v7, s[8:11], s44 offen offset:1024 lds
s_add_u32 m0, s46, 90112
s_nop 0
buffer_load_dwordx4 v6, s[12:15], s44 offen offset:0 lds
buffer_load_dwordx4 v7, s[12:15], s44 offen offset:1024 lds
s_mov_b32 s22, 0x200000
s_mov_b32 s23, 0x20000
s_lshl_b32 s39, s36, 8
s_add_u32 s24, s24, s39
s_addc_u32 s25, s25, 0
s_sub_u32 s26, 0x400000, s39
s_mov_b32 s27, 0x20000
s_mov_b32 s30, 1409024
s_mov_b32 s31, 0x20000
s_mov_b32 s58, 2752
s_mov_b32 s59, 0x20000
s_lshl_b32 s48, s37, 7
s_lshl_b32 s39, s38, 5
s_sub_u32 s49, 1920, s48
s_add_u32 s48, s48, s39
s_add_u32 s49, s49, s39
s_lshr_b32 s50, s36, 1
s_add_u32 s50, s50, 32
s_min_u32 s50, s50, 42
s_and_b32 s51, s36, 1
s_or_b32 s39, s2, s38
s_cmp_lg_u32 s39, 0
s_cbranch_scc1 L_np_1
s_memrealtime s[64:65]
s_waitcnt lgkmcnt(0)
s_or_b32 s39, s64, 1
v_mov_b32 v50, s39
v_mov_b32 v51, 0
s_mov_b64 s[64:65], exec
s_mov_b64 exec, 1
buffer_store_dword v50, v51, s[32:35], 0 offen sc1
s_mov_b64 exec, s[64:65]
L_np_1:
v_and_b32 v50, 31, v1
v_lshrrev_b32 v51, 5, v1
v_bfe_u32 v52, v1, 1, 3
v_lshlrev_b32 v50, 7, v50
v_add_u32 v50, s3, v50
v_xor_b32 v51, v51, v52
v_xor_b32 v53, 0, v51
v_lshl_add_u32 v8, v53, 4, v50
v_xor_b32 v53, 2, v51
v_lshl_add_u32 v9, v53, 4, v50
v_xor_b32 v53, 4, v51
v_lshl_add_u32 v10, v53, 4, v50
v_xor_b32 v53, 6, v51
v_lshl_add_u32 v11, v53, 4, v50
v_bfe_u32 v50, v1, 2, 2
v_lshrrev_b32 v51, 5, v1
v_lshl_add_u32 v51, v51, 3, v50
v_bfe_u32 v52, v1, 4, 1
v_and_b32 v53, 3, v1
v_lshlrev_b32 v52, 5, v52
v_lshl_add_u32 v52, v53, 3, v52
v_lshl_add_u32 v53, v51, 8, v52
v_add_u32 v53, 65536, v53
v_xor_b32 v54, 0, v50
v_lshl_add_u32 v12, v54, 6, v53
v_xor_b32 v54, 1, v50
v_lshl_add_u32 v13, v54, 6, v53
v_xor_b32 v54, 2, v50
v_lshl_add_u32 v14, v54, 6, v53
v_xor_b32 v54, 3, v50
v_lshl_add_u32 v15, v54, 6, v53
v_mov_b32 v20, v2
v_mov_b32 v21, v3
v_mov_b32 v22, v4
v_mov_b32 v23, v5
v_mov_b32 v24, v6
v_mov_b32 v25, v7
v_mov_b32 v27, v8
v_mov_b32 v28, v9
v_mov_b32 v29, v10
v_mov_b32 v30, v11
v_mov_b32 v35, v12
v_mov_b32 v36, v13
v_mov_b32 v37, v14
v_mov_b32 v38, v15
s_lshl_b32 s39, s51, 12
v_add_u32 v31, s39, v27
v_add_u32 v32, s39, v28
v_add_u32 v33, s39, v29
v_add_u32 v34, s39, v30
s_lshl_b32 s54, s48, 10
s_lshl_b32 s55, s49, 10
v_lshl_add_u32 v39, v51, 6, v52
v_add_u32 v39, 73728, v39
s_cmp_lt_u32 s38, 2
s_cselect_b32 s39, s36, s50
s_lshl_b32 s39, s39, 6
s_and_b32 s40, s38, 1
s_mul_i32 s40, s40, 44032
s_add_u32 s39, s39, s40
s_mov_b32 s40, 2752
v_lshrrev_b32 v50, 2, v1
v_mul_lo_u32 v50, v50, s40
v_and_b32 v51, 3, v1
v_lshlrev_b32 v51, 4, v51
v_add3_u32 v26, v50, v51, s39
s_lshl_b32 s39, s36, 3
s_add_u32 s39, s39, s37
s_lshl_b32 s39, s39, 3
s_lshl_b32 s40, s38, 1
s_add_u32 s39, s39, s40
s_lshl_b32 s40, s39, 10
v_lshlrev_b32 v64, 4, v1
buffer_load_dwordx4 v[68:71], v64, s[20:23], s40 offen
buffer_load_dwordx4 v[72:75], v64, s[20:23], s40 offen offset:1024
buffer_load_dwordx4 v[76:79], v64, s[60:63], 0 offen
s_lshl_b32 s47, s39, 4
s_lshl_b32 s39, s37, 6
s_lshl_b32 s40, s38, 4
s_add_u32 s39, s39, s40
v_lshrrev_b32 v50, 2, v1
v_add_u32 v50, s39, v50
s_mov_b32 s40, 2752
v_mul_lo_u32 v50, v50, s40
v_and_b32 v51, 3, v1
v_lshl_add_u32 v50, v51, 4, v50
s_lshl_b32 s41, s36, 6
buffer_load_dwordx4 v[40:43], v50, s[28:31], s41 offen
s_lshl_b32 s41, s50, 6
buffer_load_dwordx4 v[44:47], v50, s[28:31], s41 offen
s_load_dwordx2 s[84:85], s[0:1], 16
s_load_dwordx2 s[86:87], s[0:1], 40
s_load_dwordx2 s[88:89], s[0:1], 72
s_load_dwordx2 s[90:91], s[0:1], 24
s_load_dwordx2 s[92:93], s[0:1], 32
v_lshlrev_b32 v49, 4, v1
s_lshl_b32 s76, s2, 2
s_add_u32 s76, s76, s38
s_waitcnt lgkmcnt(0)
s_waitcnt vmcnt(9)
s_barrier
ds_read_b128 a[128:131], v8 offset:0
ds_read_b128 a[132:135], v8 offset:4096
ds_read_b64_tr_b16 a[144:145], v12 offset:0
ds_read_b64_tr_b16 a[160:161], v12 offset:8192
ds_read_b64_tr_b16 a[148:149], v13 offset:0
ds_read_b64_tr_b16 a[164:165], v13 offset:8192
ds_read_b64_tr_b16 a[152:153], v14 offset:0
ds_read_b64_tr_b16 a[168:169], v14 offset:8192
ds_read_b64_tr_b16 a[156:157], v15 offset:0
ds_read_b64_tr_b16 a[172:173], v15 offset:8192
ds_read_b64_tr_b16 a[146:147], v12 offset:1024
ds_read_b64_tr_b16 a[162:163], v12 offset:9216
ds_read_b64_tr_b16 a[150:151], v13 offset:1024
ds_read_b64_tr_b16 a[166:167], v13 offset:9216
ds_read_b64_tr_b16 a[154:155], v14 offset:1024
ds_read_b64_tr_b16 a[170:171], v14 offset:9216
ds_read_b64_tr_b16 a[158:159], v15 offset:1024
ds_read_b64_tr_b16 a[174:175], v15 offset:9216
s_waitcnt lgkmcnt(7)
v_mfma_f32_32x32x16_bf16 a[0:15], a[144:147], a[128:131], 0
ds_read_b128 a[136:139], v9 offset:0
s_add_u32 m0, s46, 98304
s_mov_b32 s44, 524288
v_mfma_f32_32x32x16_bf16 a[16:31], a[144:147], a[132:135], 0
ds_read_b128 a[140:143], v9 offset:4096
ds_read_b64_tr_b16 a[144:145], v12 offset:4096
buffer_load_dwordx4 v6, s[8:11], s44 offen offset:0 lds
s_waitcnt lgkmcnt(9)
v_mfma_f32_32x32x16_bf16 v[128:143], a[128:131], a[160:163], 0
ds_read_b64_tr_b16 a[146:147], v12 offset:5120
buffer_load_dwordx4 v7, s[8:11], s44 offen offset:1024 lds
v_mfma_f32_32x32x16_bf16 v[192:207], a[132:135], a[160:163], 0
ds_read_b64_tr_b16 a[160:161], v12 offset:12288
s_add_u32 m0, s46, 106496
s_nop 0
s_waitcnt lgkmcnt(10)
v_mfma_f32_32x32x16_bf16 a[32:47], a[148:151], a[128:131], 0
ds_read_b64_tr_b16 a[162:163], v12 offset:13312
buffer_load_dwordx4 v6, s[12:15], s44 offen offset:0 lds
v_mfma_f32_32x32x16_bf16 a[48:63], a[148:151], a[132:135], 0
ds_read_b64_tr_b16 a[148:149], v13 offset:4096
buffer_load_dwordx4 v7, s[12:15], s44 offen offset:1024 lds
s_waitcnt lgkmcnt(11)
v_mfma_f32_32x32x16_bf16 v[144:159], a[128:131], a[164:167], 0
ds_read_b64_tr_b16 a[150:151], v13 offset:5120
v_mfma_f32_32x32x16_bf16 v[208:223], a[132:135], a[164:167], 0
ds_read_b64_tr_b16 a[164:165], v13 offset:12288
s_waitcnt lgkmcnt(12)
v_mfma_f32_32x32x16_bf16 a[64:79], a[152:155], a[128:131], 0
ds_read_b64_tr_b16 a[166:167], v13 offset:13312
v_mfma_f32_32x32x16_bf16 a[80:95], a[152:155], a[132:135], 0
ds_read_b64_tr_b16 a[152:153], v14 offset:4096
s_add_u32 m0, s3, 8192
s_add_u32 s43, s53, 128
s_waitcnt lgkmcnt(13)
v_mfma_f32_32x32x16_bf16 v[160:175], a[128:131], a[168:171], 0
ds_read_b64_tr_b16 a[154:155], v14 offset:5120
buffer_load_dwordx4 v2, s[4:7], s43 offen offset:0 lds
v_mfma_f32_32x32x16_bf16 v[224:239], a[132:135], a[168:171], 0
ds_read_b64_tr_b16 a[168:169], v14 offset:12288
buffer_load_dwordx4 v3, s[4:7], s43 offen offset:1024 lds
s_waitcnt lgkmcnt(14)
v_mfma_f32_32x32x16_bf16 a[96:111], a[156:159], a[128:131], 0
ds_read_b64_tr_b16 a[170:171], v14 offset:13312
buffer_load_dwordx4 v4, s[4:7], s43 offen offset:2048 lds
v_mfma_f32_32x32x16_bf16 a[112:127], a[156:159], a[132:135], 0
ds_read_b64_tr_b16 a[156:157], v15 offset:4096
buffer_load_dwordx4 v5, s[4:7], s43 offen offset:3072 lds
s_waitcnt lgkmcnt(15)
v_mfma_f32_32x32x16_bf16 v[176:191], a[128:131], a[172:175], 0
ds_read_b64_tr_b16 a[158:159], v15 offset:5120
s_add_u32 m0, s3, 12288
s_add_u32 s43, s53, 32896
v_mfma_f32_32x32x16_bf16 v[240:255], a[132:135], a[172:175], 0
ds_read_b64_tr_b16 a[172:173], v15 offset:12288
buffer_load_dwordx4 v2, s[4:7], s43 offen offset:0 lds
s_waitcnt lgkmcnt(13)
v_mfma_f32_32x32x16_bf16 a[0:15], a[144:147], a[136:139], a[0:15]
ds_read_b64_tr_b16 a[174:175], v15 offset:13312
s_waitcnt vmcnt(14)
s_barrier
ds_read_b128 a[128:131], v10 offset:0
buffer_load_dwordx4 v3, s[4:7], s43 offen offset:1024 lds
v_mfma_f32_32x32x16_bf16 a[16:31], a[144:147], a[140:143], a[16:31]
ds_read_b128 a[132:135], v10 offset:4096
ds_read_b64_tr_b16 a[144:145], v12 offset:16384
buffer_load_dwordx4 v4, s[4:7], s43 offen offset:2048 lds
s_waitcnt lgkmcnt(15)
v_mfma_f32_32x32x16_bf16 v[128:143], a[136:139], a[160:163], v[128:143]
ds_read_b64_tr_b16 a[146:147], v12 offset:17408
buffer_load_dwordx4 v5, s[4:7], s43 offen offset:3072 lds
v_mfma_f32_32x32x16_bf16 v[192:207], a[140:143], a[160:163], v[192:207]
ds_read_b64_tr_b16 a[160:161], v12 offset:24576
s_add_u32 m0, s46, 114688
s_mov_b32 s44, 786432
s_waitcnt lgkmcnt(15)
v_mfma_f32_32x32x16_bf16 a[32:47], a[148:151], a[136:139], a[32:47]
ds_read_b64_tr_b16 a[162:163], v12 offset:25600
buffer_load_dwordx4 v6, s[8:11], s44 offen offset:0 lds
v_mfma_f32_32x32x16_bf16 a[48:63], a[148:151], a[140:143], a[48:63]
ds_read_b64_tr_b16 a[148:149], v13 offset:16384
buffer_load_dwordx4 v7, s[8:11], s44 offen offset:1024 lds
s_waitcnt lgkmcnt(15)
v_mfma_f32_32x32x16_bf16 v[144:159], a[136:139], a[164:167], v[144:159]
ds_read_b64_tr_b16 a[150:151], v13 offset:17408
s_add_u32 m0, s46, 122880
s_nop 0
v_mfma_f32_32x32x16_bf16 v[208:223], a[140:143], a[164:167], v[208:223]
ds_read_b64_tr_b16 a[164:165], v13 offset:24576
buffer_load_dwordx4 v6, s[12:15], s44 offen offset:0 lds
s_waitcnt lgkmcnt(15)
v_mfma_f32_32x32x16_bf16 a[64:79], a[152:155], a[136:139], a[64:79]
ds_read_b64_tr_b16 a[166:167], v13 offset:25600
buffer_load_dwordx4 v7, s[12:15], s44 offen offset:1024 lds
v_mfma_f32_32x32x16_bf16 a[80:95], a[152:155], a[140:143], a[80:95]
ds_read_b64_tr_b16 a[152:153], v14 offset:16384
s_waitcnt lgkmcnt(15)
v_mfma_f32_32x32x16_bf16 v[160:175], a[136:139], a[168:171], v[160:175]
ds_read_b64_tr_b16 a[154:155], v14 offset:17408
v_mfma_f32_32x32x16_bf16 v[224:239], a[140:143], a[168:171], v[224:239]
ds_read_b64_tr_b16 a[168:169], v14 offset:24576
s_waitcnt lgkmcnt(15)
v_mfma_f32_32x32x16_bf16 a[96:111], a[156:159], a[136:139], a[96:111]
ds_read_b64_tr_b16 a[170:171], v14 offset:25600
v_mfma_f32_32x32x16_bf16 a[112:127], a[156:159], a[140:143], a[112:127]
ds_read_b64_tr_b16 a[156:157], v15 offset:16384
s_waitcnt lgkmcnt(15)
v_mfma_f32_32x32x16_bf16 v[176:191], a[136:139], a[172:175], v[176:191]
ds_read_b64_tr_b16 a[158:159], v15 offset:17408
v_mfma_f32_32x32x16_bf16 v[240:255], a[140:143], a[172:175], v[240:255]
ds_read_b64_tr_b16 a[172:173], v15 offset:24576
s_waitcnt lgkmcnt(13)
v_mfma_f32_32x32x16_bf16 a[0:15], a[144:147], a[128:131], a[0:15]
ds_read_b64_tr_b16 a[174:175], v15 offset:25600
ds_read_b128 a[136:139], v11 offset:0
v_mfma_f32_32x32x16_bf16 a[16:31], a[144:147], a[132:135], a[16:31]
ds_read_b128 a[140:143], v11 offset:4096
ds_read_b64_tr_b16 a[144:145], v12 offset:20480
s_waitcnt lgkmcnt(15)
v_mfma_f32_32x32x16_bf16 v[128:143], a[128:131], a[160:163], v[128:143]
ds_read_b64_tr_b16 a[146:147], v12 offset:21504
s_waitcnt vmcnt(18)
v_lshlrev_b32 v80, 16, v68
v_and_b32 v81, 0xffff0000, v68
v_lshlrev_b32 v82, 16, v69
v_mfma_f32_32x32x16_bf16 v[192:207], a[132:135], a[160:163], v[192:207]
ds_read_b64_tr_b16 a[160:161], v12 offset:28672
v_and_b32 v83, 0xffff0000, v69
v_lshlrev_b32 v84, 16, v70
v_and_b32 v85, 0xffff0000, v70
v_lshlrev_b32 v86, 16, v71
s_waitcnt lgkmcnt(15)
v_mfma_f32_32x32x16_bf16 a[32:47], a[148:151], a[128:131], a[32:47]
ds_read_b64_tr_b16 a[162:163], v12 offset:29696
v_and_b32 v87, 0xffff0000, v71
v_lshlrev_b32 v88, 16, v72
v_and_b32 v89, 0xffff0000, v72
v_lshlrev_b32 v90, 16, v73
v_mfma_f32_32x32x16_bf16 a[48:63], a[148:151], a[132:135], a[48:63]
ds_read_b64_tr_b16 a[148:149], v13 offset:20480
v_and_b32 v91, 0xffff0000, v73
v_lshlrev_b32 v92, 16, v74
v_and_b32 v93, 0xffff0000, v74
s_waitcnt lgkmcnt(15)
v_mfma_f32_32x32x16_bf16 v[144:159], a[128:131], a[164:167], v[144:159]
ds_read_b64_tr_b16 a[150:151], v13 offset:21504
v_lshlrev_b32 v94, 16, v75
v_and_b32 v95, 0xffff0000, v75
v_lshlrev_b32 v96, 16, v76
v_and_b32 v97, 0xffff0000, v76
v_mfma_f32_32x32x16_bf16 v[208:223], a[132:135], a[164:167], v[208:223]
ds_read_b64_tr_b16 a[164:165], v13 offset:28672
v_lshlrev_b32 v98, 16, v77
v_and_b32 v99, 0xffff0000, v77
v_lshlrev_b32 v100, 16, v78
v_and_b32 v101, 0xffff0000, v78
s_waitcnt lgkmcnt(15)
v_mfma_f32_32x32x16_bf16 a[64:79], a[152:155], a[128:131], a[64:79]
ds_read_b64_tr_b16 a[166:167], v13 offset:29696
v_lshlrev_b32 v102, 16, v79
v_and_b32 v103, 0xffff0000, v79
v_add_f32 v104, v80, v81
v_mul_f32 v106, v80, v96
v_mfma_f32_32x32x16_bf16 a[80:95], a[152:155], a[132:135], a[80:95]
ds_read_b64_tr_b16 a[152:153], v14 offset:20480
v_add_f32 v104, v104, v82
v_add_f32 v104, v104, v83
v_add_f32 v104, v104, v84
v_add_f32 v104, v104, v85
s_waitcnt lgkmcnt(15)
v_mfma_f32_32x32x16_bf16 v[160:175], a[128:131], a[168:171], v[160:175]
ds_read_b64_tr_b16 a[154:155], v14 offset:21504
v_add_f32 v104, v104, v86
v_add_f32 v104, v104, v87
v_fmac_f32 v106, v81, v97
v_fmac_f32 v106, v82, v98
v_mfma_f32_32x32x16_bf16 v[224:239], a[132:135], a[168:171], v[224:239]
ds_read_b64_tr_b16 a[168:169], v14 offset:28672
v_fmac_f32 v106, v83, v99
v_fmac_f32 v106, v84, v100
v_fmac_f32 v106, v85, v101
v_fmac_f32 v106, v86, v102
s_waitcnt lgkmcnt(15)
v_mfma_f32_32x32x16_bf16 a[96:111], a[156:159], a[128:131], a[96:111]
ds_read_b64_tr_b16 a[170:171], v14 offset:29696
v_fmac_f32 v106, v87, v103
v_add_f32 v105, v88, v89
v_mul_f32 v107, v88, v96
v_mfma_f32_32x32x16_bf16 a[112:127], a[156:159], a[132:135], a[112:127]
ds_read_b64_tr_b16 a[156:157], v15 offset:20480
v_add_f32 v105, v105, v90
v_add_f32 v105, v105, v91
v_add_f32 v105, v105, v92
v_add_f32 v105, v105, v93
s_waitcnt lgkmcnt(15)
v_mfma_f32_32x32x16_bf16 v[176:191], a[128:131], a[172:175], v[176:191]
ds_read_b64_tr_b16 a[158:159], v15 offset:21504
v_add_f32 v105, v105, v94
v_add_f32 v105, v105, v95
v_fmac_f32 v107, v89, v97
v_fmac_f32 v107, v90, v98
v_mfma_f32_32x32x16_bf16 v[240:255], a[132:135], a[172:175], v[240:255]
ds_read_b64_tr_b16 a[172:173], v15 offset:28672
v_fmac_f32 v107, v91, v99
v_fmac_f32 v107, v92, v100
v_fmac_f32 v107, v93, v101
v_fmac_f32 v107, v94, v102
s_waitcnt lgkmcnt(13)
v_mfma_f32_32x32x16_bf16 a[0:15], a[144:147], a[136:139], a[0:15]
ds_read_b64_tr_b16 a[174:175], v15 offset:29696
s_waitcnt vmcnt(12)
s_barrier
s_waitcnt vmcnt(4)
ds_read_b128 a[128:131], v8 offset:8192
v_fmac_f32 v107, v95, v103
v_mfma_f32_32x32x16_bf16 a[16:31], a[144:147], a[140:143], a[16:31]
ds_read_b128 a[132:135], v8 offset:12288
ds_read_b64_tr_b16 a[144:145], v12 offset:32768
s_add_u32 m0, s46, 65536
s_mov_b32 s44, 1048576
s_waitcnt lgkmcnt(15)
v_mfma_f32_32x32x16_bf16 v[128:143], a[136:139], a[160:163], v[128:143]
ds_read_b64_tr_b16 a[146:147], v12 offset:33792
s_nop 1
v_add_f32_dpp v104, v104, v104 row_ror:1 row_mask:0xf bank_mask:0xf
v_add_f32_dpp v105, v105, v105 row_ror:1 row_mask:0xf bank_mask:0xf
v_add_f32_dpp v106, v106, v106 row_ror:1 row_mask:0xf bank_mask:0xf
v_mfma_f32_32x32x16_bf16 v[192:207], a[140:143], a[160:163], v[192:207]
ds_read_b64_tr_b16 a[160:161], v12 offset:40960
buffer_load_dwordx4 v6, s[8:11], s44 offen offset:0 lds
v_add_f32_dpp v107, v107, v107 row_ror:1 row_mask:0xf bank_mask:0xf
s_nop 1
s_waitcnt lgkmcnt(15)
v_mfma_f32_32x32x16_bf16 a[32:47], a[148:151], a[136:139], a[32:47]
ds_read_b64_tr_b16 a[162:163], v12 offset:41984
v_add_f32_dpp v104, v104, v104 row_ror:2 row_mask:0xf bank_mask:0xf
v_add_f32_dpp v105, v105, v105 row_ror:2 row_mask:0xf bank_mask:0xf
v_add_f32_dpp v106, v106, v106 row_ror:2 row_mask:0xf bank_mask:0xf
v_add_f32_dpp v107, v107, v107 row_ror:2 row_mask:0xf bank_mask:0xf
v_mfma_f32_32x32x16_bf16 a[48:63], a[148:151], a[140:143], a[48:63]
ds_read_b64_tr_b16 a[148:149], v13 offset:32768
buffer_load_dwordx4 v7, s[8:11], s44 offen offset:1024 lds
s_nop 1
s_waitcnt lgkmcnt(15)
v_mfma_f32_32x32x16_bf16 v[144:159], a[136:139], a[164:167], v[144:159]
ds_read_b64_tr_b16 a[150:151], v13 offset:33792
v_add_f32_dpp v104, v104, v104 row_ror:4 row_mask:0xf bank_mask:0xf
v_add_f32_dpp v105, v105, v105 row_ror:4 row_mask:0xf bank_mask:0xf
v_add_f32_dpp v106, v106, v106 row_ror:4 row_mask:0xf bank_mask:0xf
v_add_f32_dpp v107, v107, v107 row_ror:4 row_mask:0xf bank_mask:0xf
v_mfma_f32_32x32x16_bf16 v[208:223], a[140:143], a[164:167], v[208:223]
ds_read_b64_tr_b16 a[164:165], v13 offset:40960
s_add_u32 m0, s46, 73728
s_nop 0
s_nop 1
s_waitcnt lgkmcnt(15)
v_mfma_f32_32x32x16_bf16 a[64:79], a[152:155], a[136:139], a[64:79]
ds_read_b64_tr_b16 a[166:167], v13 offset:41984
v_add_f32_dpp v104, v104, v104 row_ror:8 row_mask:0xf bank_mask:0xf
v_add_f32_dpp v105, v105, v105 row_ror:8 row_mask:0xf bank_mask:0xf
v_add_f32_dpp v106, v106, v106 row_ror:8 row_mask:0xf bank_mask:0xf
v_add_f32_dpp v107, v107, v107 row_ror:8 row_mask:0xf bank_mask:0xf
v_mfma_f32_32x32x16_bf16 a[80:95], a[152:155], a[140:143], a[80:95]
ds_read_b64_tr_b16 a[152:153], v14 offset:32768
buffer_load_dwordx4 v6, s[12:15], s44 offen offset:0 lds
s_nop 0
v_mov_b32 v108, v104
v_mov_b32 v109, v105
s_waitcnt lgkmcnt(15)
v_mfma_f32_32x32x16_bf16 v[160:175], a[136:139], a[168:171], v[160:175]
ds_read_b64_tr_b16 a[154:155], v14 offset:33792
v_mov_b32 v110, v106
v_mov_b32 v111, v107
s_nop 1
v_mfma_f32_32x32x16_bf16 v[224:239], a[140:143], a[168:171], v[224:239]
ds_read_b64_tr_b16 a[168:169], v14 offset:40960
buffer_load_dwordx4 v7, s[12:15], s44 offen offset:1024 lds
v_permlane16_swap_b32 v108, v104
v_permlane16_swap_b32 v109, v105
v_permlane16_swap_b32 v110, v106
s_waitcnt lgkmcnt(15)
v_mfma_f32_32x32x16_bf16 a[96:111], a[156:159], a[136:139], a[96:111]
ds_read_b64_tr_b16 a[170:171], v14 offset:41984
v_permlane16_swap_b32 v111, v107
s_nop 1
v_add_f32 v104, v104, v108
v_mfma_f32_32x32x16_bf16 a[112:127], a[156:159], a[140:143], a[112:127]
ds_read_b64_tr_b16 a[156:157], v15 offset:32768
v_add_f32 v105, v105, v109
v_add_f32 v106, v106, v110
v_add_f32 v107, v107, v111
s_waitcnt lgkmcnt(15)
v_mfma_f32_32x32x16_bf16 v[176:191], a[136:139], a[172:175], v[176:191]
ds_read_b64_tr_b16 a[158:159], v15 offset:33792
s_nop 0
v_mov_b32 v108, v104
v_mov_b32 v109, v105
v_mov_b32 v110, v106
v_mfma_f32_32x32x16_bf16 v[240:255], a[140:143], a[172:175], v[240:255]
ds_read_b64_tr_b16 a[172:173], v15 offset:40960
v_mov_b32 v111, v107
s_nop 1
v_permlane32_swap_b32 v108, v104
s_waitcnt lgkmcnt(13)
v_mfma_f32_32x32x16_bf16 a[0:15], a[144:147], a[128:131], a[0:15]
ds_read_b64_tr_b16 a[174:175], v15 offset:41984
ds_read_b128 a[136:139], v9 offset:8192
v_permlane32_swap_b32 v109, v105
v_permlane32_swap_b32 v110, v106
v_permlane32_swap_b32 v111, v107
v_mfma_f32_32x32x16_bf16 a[16:31], a[144:147], a[132:135], a[16:31]
ds_read_b128 a[140:143], v9 offset:12288
ds_read_b64_tr_b16 a[144:145], v12 offset:36864
s_add_u32 m0, s3, 0
s_add_u32 s43, s53, 256
s_nop 1
s_waitcnt lgkmcnt(15)
v_mfma_f32_32x32x16_bf16 v[128:143], a[128:131], a[160:163], v[128:143]
ds_read_b64_tr_b16 a[146:147], v12 offset:37888
v_add_f32 v104, v104, v108
v_add_f32 v105, v105, v109
v_add_f32 v106, v106, v110
v_mfma_f32_32x32x16_bf16 v[192:207], a[132:135], a[160:163], v[192:207]
ds_read_b64_tr_b16 a[160:161], v12 offset:45056
buffer_load_dwordx4 v2, s[4:7], s43 offen offset:0 lds
v_add_f32 v107, v107, v111
v_mul_f32 v104, 0x3b000000, v104
v_mul_f32 v105, 0x3b000000, v105
s_waitcnt lgkmcnt(15)
v_mfma_f32_32x32x16_bf16 a[32:47], a[148:151], a[128:131], a[32:47]
ds_read_b64_tr_b16 a[162:163], v12 offset:46080
v_sub_f32 v80, v80, v104
v_sub_f32 v81, v81, v104
v_sub_f32 v82, v82, v104
v_sub_f32 v83, v83, v104
v_mfma_f32_32x32x16_bf16 a[48:63], a[148:151], a[132:135], a[48:63]
ds_read_b64_tr_b16 a[148:149], v13 offset:36864
buffer_load_dwordx4 v3, s[4:7], s43 offen offset:1024 lds
v_sub_f32 v84, v84, v104
v_sub_f32 v85, v85, v104
v_sub_f32 v86, v86, v104
s_waitcnt lgkmcnt(15)
v_mfma_f32_32x32x16_bf16 v[144:159], a[128:131], a[164:167], v[144:159]
ds_read_b64_tr_b16 a[150:151], v13 offset:37888
v_sub_f32 v87, v87, v104
v_mul_f32 v112, v80, v80
v_fmac_f32 v112, v81, v81
s_mov_b32 s72, s84
s_mov_b32 s73, s85
s_mov_b32 s74, 4194304
v_mfma_f32_32x32x16_bf16 v[208:223], a[132:135], a[164:167], v[208:223]
ds_read_b64_tr_b16 a[164:165], v13 offset:45056
buffer_load_dwordx4 v4, s[4:7], s43 offen offset:2048 lds
v_fmac_f32 v112, v82, v82
v_fmac_f32 v112, v83, v83
v_fmac_f32 v112, v84, v84
s_mov_b32 s75, 0x20000
s_waitcnt lgkmcnt(15)
v_mfma_f32_32x32x16_bf16 a[64:79], a[152:155], a[128:131], a[64:79]
ds_read_b64_tr_b16 a[166:167], v13 offset:46080
v_fmac_f32 v112, v85, v85
v_fmac_f32 v112, v86, v86
v_fmac_f32 v112, v87, v87
v_sub_f32 v88, v88, v105
s_mul_i32 s77, s76, 4096
v_mfma_f32_32x32x16_bf16 a[80:95], a[152:155], a[132:135], a[80:95]
ds_read_b64_tr_b16 a[152:153], v14 offset:36864
buffer_load_dwordx4 v5, s[4:7], s43 offen offset:3072 lds
v_sub_f32 v89, v89, v105
v_sub_f32 v90, v90, v105
v_sub_f32 v91, v91, v105
s_waitcnt lgkmcnt(15)
v_mfma_f32_32x32x16_bf16 v[160:175], a[128:131], a[168:171], v[160:175]
ds_read_b64_tr_b16 a[154:155], v14 offset:37888
v_sub_f32 v92, v92, v105
v_sub_f32 v93, v93, v105
v_sub_f32 v94, v94, v105
v_sub_f32 v95, v95, v105
buffer_load_dwordx4 v[52:55], v49, s[72:75], s77 offen offset:0
v_mfma_f32_32x32x16_bf16 v[224:239], a[132:135], a[168:171], v[224:239]
ds_read_b64_tr_b16 a[168:169], v14 offset:45056
s_add_u32 m0, s3, 4096
s_add_u32 s43, s53, 33024
v_mul_f32 v113, v88, v88
v_fmac_f32 v113, v89, v89
buffer_load_dwordx4 v[52:55], v49, s[72:75], s77 offen offset:1024
s_waitcnt lgkmcnt(15)
v_mfma_f32_32x32x16_bf16 a[96:111], a[156:159], a[128:131], a[96:111]
ds_read_b64_tr_b16 a[170:171], v14 offset:46080
v_fmac_f32 v113, v90, v90
v_fmac_f32 v113, v91, v91
v_fmac_f32 v113, v92, v92
v_fmac_f32 v113, v93, v93
buffer_load_dwordx4 v[52:55], v49, s[72:75], s77 offen offset:2048
v_mfma_f32_32x32x16_bf16 a[112:127], a[156:159], a[132:135], a[112:127]
ds_read_b64_tr_b16 a[156:157], v15 offset:36864
buffer_load_dwordx4 v2, s[4:7], s43 offen offset:0 lds
v_fmac_f32 v113, v94, v94
v_fmac_f32 v113, v95, v95
buffer_load_dwordx4 v[52:55], v49, s[72:75], s77 offen offset:3072
s_mov_b32 s72, s28
s_mov_b32 s73, s29
s_waitcnt lgkmcnt(15)
v_mfma_f32_32x32x16_bf16 v[176:191], a[128:131], a[172:175], v[176:191]
ds_read_b64_tr_b16 a[158:159], v15 offset:37888
s_nop 1
v_add_f32_dpp v112, v112, v112 row_ror:1 row_mask:0xf bank_mask:0xf
v_add_f32_dpp v113, v113, v113 row_ror:1 row_mask:0xf bank_mask:0xf
v_mfma_f32_32x32x16_bf16 v[240:255], a[132:135], a[172:175], v[240:255]
ds_read_b64_tr_b16 a[172:173], v15 offset:45056
buffer_load_dwordx4 v3, s[4:7], s43 offen offset:1024 lds
s_nop 1
v_add_f32_dpp v112, v112, v112 row_ror:2 row_mask:0xf bank_mask:0xf
s_mov_b32 s74, 1409024
s_waitcnt lgkmcnt(13)
v_mfma_f32_32x32x16_bf16 a[0:15], a[144:147], a[136:139], a[0:15]
ds_read_b64_tr_b16 a[174:175], v15 offset:46080
s_waitcnt vmcnt(10)
s_barrier
ds_read_b128 a[128:131], v10 offset:8192
v_add_f32_dpp v113, v113, v113 row_ror:2 row_mask:0xf bank_mask:0xf
s_nop 1
s_mov_b32 s75, 0x20000
v_mfma_f32_32x32x16_bf16 a[16:31], a[144:147], a[140:143], a[16:31]
ds_read_b128 a[132:135], v10 offset:12288
ds_read_b64_tr_b16 a[144:145], v12 offset:49152
buffer_load_dwordx4 v4, s[4:7], s43 offen offset:2048 lds
v_add_f32_dpp v112, v112, v112 row_ror:4 row_mask:0xf bank_mask:0xf
s_mul_i32 s77, s76, 2048
buffer_load_dwordx4 v[52:55], v49, s[72:75], s77 offen offset:0
buffer_load_dwordx4 v[52:55], v49, s[72:75], s77 offen offset:1024
s_waitcnt lgkmcnt(15)
v_mfma_f32_32x32x16_bf16 v[128:143], a[136:139], a[160:163], v[128:143]
ds_read_b64_tr_b16 a[146:147], v12 offset:50176
v_add_f32_dpp v113, v113, v113 row_ror:4 row_mask:0xf bank_mask:0xf
s_nop 1
v_add_f32_dpp v112, v112, v112 row_ror:8 row_mask:0xf bank_mask:0xf
v_mfma_f32_32x32x16_bf16 v[192:207], a[140:143], a[160:163], v[192:207]
ds_read_b64_tr_b16 a[160:161], v12 offset:57344
buffer_load_dwordx4 v5, s[4:7], s43 offen offset:3072 lds
v_add_f32_dpp v113, v113, v113 row_ror:8 row_mask:0xf bank_mask:0xf
s_nop 0
v_mov_b32 v108, v112
s_waitcnt lgkmcnt(15)
v_mfma_f32_32x32x16_bf16 a[32:47], a[148:151], a[136:139], a[32:47]
ds_read_b64_tr_b16 a[162:163], v12 offset:58368
v_mov_b32 v109, v113
s_nop 1
v_permlane16_swap_b32 v108, v112
v_mfma_f32_32x32x16_bf16 a[48:63], a[148:151], a[140:143], a[48:63]
ds_read_b64_tr_b16 a[148:149], v13 offset:49152
s_add_u32 m0, s46, 81920
s_mov_b32 s44, 1310720
v_permlane16_swap_b32 v109, v113
s_waitcnt lgkmcnt(15)
v_mfma_f32_32x32x16_bf16 v[144:159], a[136:139], a[164:167], v[144:159]
ds_read_b64_tr_b16 a[150:151], v13 offset:50176
s_nop 1
v_add_f32 v112, v112, v108
v_add_f32 v113, v113, v109
s_nop 0
v_mfma_f32_32x32x16_bf16 v[208:223], a[140:143], a[164:167], v[208:223]
ds_read_b64_tr_b16 a[164:165], v13 offset:57344
buffer_load_dwordx4 v6, s[8:11], s44 offen offset:0 lds
v_mov_b32 v108, v112
v_mov_b32 v109, v113
s_waitcnt lgkmcnt(15)
v_mfma_f32_32x32x16_bf16 a[64:79], a[152:155], a[136:139], a[64:79]
ds_read_b64_tr_b16 a[166:167], v13 offset:58368
s_nop 1
v_permlane32_swap_b32 v108, v112
v_permlane32_swap_b32 v109, v113
v_mfma_f32_32x32x16_bf16 a[80:95], a[152:155], a[140:143], a[80:95]
ds_read_b64_tr_b16 a[152:153], v14 offset:49152
buffer_load_dwordx4 v7, s[8:11], s44 offen offset:1024 lds
s_nop 1
v_add_f32 v112, v112, v108
s_waitcnt lgkmcnt(15)
v_mfma_f32_32x32x16_bf16 v[160:175], a[136:139], a[168:171], v[160:175]
ds_read_b64_tr_b16 a[154:155], v14 offset:50176
v_add_f32 v113, v113, v109
v_mov_b32 v114, 0x3727c5ac
v_fmac_f32 v114, 0x3b000000, v112
v_rsq_f32 v116, v114
v_mfma_f32_32x32x16_bf16 v[224:239], a[140:143], a[168:171], v[224:239]
ds_read_b64_tr_b16 a[168:169], v14 offset:57344
s_add_u32 m0, s46, 90112
s_nop 0
v_mul_f32 v115, 0xbfb8aa3b, v106
s_waitcnt lgkmcnt(15)
v_mfma_f32_32x32x16_bf16 a[96:111], a[156:159], a[136:139], a[96:111]
ds_read_b64_tr_b16 a[170:171], v14 offset:58368
v_exp_f32 v115, v115
v_mul_f32 v117, v104, v116
v_add_f32 v115, 1.0, v115
v_mfma_f32_32x32x16_bf16 a[112:127], a[156:159], a[140:143], a[112:127]
ds_read_b64_tr_b16 a[156:157], v15 offset:49152
buffer_load_dwordx4 v6, s[12:15], s44 offen offset:0 lds
v_sub_f32 v117, 0, v117
v_rcp_f32 v118, v115
s_waitcnt lgkmcnt(15)
v_mfma_f32_32x32x16_bf16 v[176:191], a[136:139], a[172:175], v[176:191]
ds_read_b64_tr_b16 a[158:159], v15 offset:50176
v_mov_b32 v119, 0
v_mov_b32 v114, 0x3727c5ac
v_fmac_f32 v114, 0x3b000000, v113
v_mfma_f32_32x32x16_bf16 v[240:255], a[140:143], a[172:175], v[240:255]
ds_read_b64_tr_b16 a[172:173], v15 offset:57344
buffer_load_dwordx4 v7, s[12:15], s44 offen offset:1024 lds
v_rsq_f32 v120, v114
v_mul_f32 v115, 0xbfb8aa3b, v107
s_waitcnt lgkmcnt(13)
v_mfma_f32_32x32x16_bf16 a[0:15], a[144:147], a[128:131], a[0:15]
ds_read_b64_tr_b16 a[174:175], v15 offset:58368
ds_read_b128 a[136:139], v11 offset:8192
v_exp_f32 v115, v115
v_mul_f32 v121, v105, v120
v_mfma_f32_32x32x16_bf16 a[16:31], a[144:147], a[132:135], a[16:31]
ds_read_b128 a[140:143], v11 offset:12288
ds_read_b64_tr_b16 a[144:145], v12 offset:53248
v_add_f32 v115, 1.0, v115
v_sub_f32 v121, 0, v121
v_rcp_f32 v122, v115
s_waitcnt lgkmcnt(15)
v_mfma_f32_32x32x16_bf16 v[128:143], a[128:131], a[160:163], v[128:143]
ds_read_b64_tr_b16 a[146:147], v12 offset:54272
v_mov_b32 v123, 0
v_mov_b32 v64, 0x3800000
v_mfma_f32_32x32x16_bf16 v[192:207], a[132:135], a[160:163], v[192:207]
ds_read_b64_tr_b16 a[160:161], v12 offset:61440
s_mov_b64 s[64:65], exec
s_mov_b64 exec, 1
buffer_store_dwordx4 v[116:119], v64, s[16:19], s47 offen sc1
buffer_store_dwordx4 v[120:123], v64, s[16:19], s47 offen offset:16 sc1
s_mov_b64 exec, s[64:65]
s_waitcnt lgkmcnt(15)
v_mfma_f32_32x32x16_bf16 a[32:47], a[148:151], a[128:131], a[32:47]
ds_read_b64_tr_b16 a[162:163], v12 offset:62464
v_mfma_f32_32x32x16_bf16 a[48:63], a[148:151], a[132:135], a[48:63]
ds_read_b64_tr_b16 a[148:149], v13 offset:53248
s_waitcnt lgkmcnt(15)
v_mfma_f32_32x32x16_bf16 v[144:159], a[128:131], a[164:167], v[144:159]
ds_read_b64_tr_b16 a[150:151], v13 offset:54272
v_mfma_f32_32x32x16_bf16 v[208:223], a[132:135], a[164:167], v[208:223]
ds_read_b64_tr_b16 a[164:165], v13 offset:61440
s_waitcnt lgkmcnt(15)
v_mfma_f32_32x32x16_bf16 a[64:79], a[152:155], a[128:131], a[64:79]
ds_read_b64_tr_b16 a[166:167], v13 offset:62464
v_lshlrev_b32 v64, 16, v40
v_mfma_f32_32x32x16_bf16 a[80:95], a[152:155], a[132:135], a[80:95]
ds_read_b64_tr_b16 a[152:153], v14 offset:53248
v_and_b32 v65, 0xffff0000, v40
v_lshlrev_b32 v66, 16, v41
s_waitcnt lgkmcnt(15)
v_mfma_f32_32x32x16_bf16 v[160:175], a[128:131], a[168:171], v[160:175]
ds_read_b64_tr_b16 a[154:155], v14 offset:54272
v_and_b32 v67, 0xffff0000, v41
v_lshlrev_b32 v68, 16, v42
v_mfma_f32_32x32x16_bf16 v[224:239], a[132:135], a[168:171], v[224:239]
ds_read_b64_tr_b16 a[168:169], v14 offset:61440
v_and_b32 v69, 0xffff0000, v42
v_lshlrev_b32 v70, 16, v43
s_waitcnt lgkmcnt(15)
v_mfma_f32_32x32x16_bf16 a[96:111], a[156:159], a[128:131], a[96:111]
ds_read_b64_tr_b16 a[170:171], v14 offset:62464
v_and_b32 v71, 0xffff0000, v43
v_lshlrev_b32 v72, 16, v44
v_mfma_f32_32x32x16_bf16 a[112:127], a[156:159], a[132:135], a[112:127]
ds_read_b64_tr_b16 a[156:157], v15 offset:53248
v_and_b32 v73, 0xffff0000, v44
v_lshlrev_b32 v74, 16, v45
s_waitcnt lgkmcnt(15)
v_mfma_f32_32x32x16_bf16 v[176:191], a[128:131], a[172:175], v[176:191]
ds_read_b64_tr_b16 a[158:159], v15 offset:54272
v_and_b32 v75, 0xffff0000, v45
v_lshlrev_b32 v76, 16, v46
v_and_b32 v77, 0xffff0000, v46
v_mfma_f32_32x32x16_bf16 v[240:255], a[132:135], a[172:175], v[240:255]
ds_read_b64_tr_b16 a[172:173], v15 offset:61440
v_lshlrev_b32 v78, 16, v47
v_and_b32 v79, 0xffff0000, v47
s_waitcnt lgkmcnt(13)
v_mfma_f32_32x32x16_bf16 a[0:15], a[144:147], a[136:139], a[0:15]
ds_read_b64_tr_b16 a[174:175], v15 offset:62464
s_waitcnt vmcnt(14)
s_barrier
s_waitcnt vmcnt(6)
ds_read_b128 a[128:131], v8 offset:0
v_mfma_f32_32x32x16_bf16 a[16:31], a[144:147], a[140:143], a[16:31]
ds_read_b128 a[132:135], v8 offset:4096
ds_read_b64_tr_b16 a[144:145], v12 offset:0
s_add_u32 m0, s46, 98304
s_mov_b32 s44, 1572864
s_waitcnt lgkmcnt(15)
v_mfma_f32_32x32x16_bf16 v[128:143], a[136:139], a[160:163], v[128:143]
ds_read_b64_tr_b16 a[146:147], v12 offset:1024
s_nop 1
v_add_f32_dpp v64, v64, v64 row_ror:4 row_mask:0xf bank_mask:0xf
v_mfma_f32_32x32x16_bf16 v[192:207], a[140:143], a[160:163], v[192:207]
ds_read_b64_tr_b16 a[160:161], v12 offset:8192
buffer_load_dwordx4 v6, s[8:11], s44 offen offset:0 lds
v_add_f32_dpp v65, v65, v65 row_ror:4 row_mask:0xf bank_mask:0xf
s_waitcnt lgkmcnt(15)
v_mfma_f32_32x32x16_bf16 a[32:47], a[148:151], a[136:139], a[32:47]
ds_read_b64_tr_b16 a[162:163], v12 offset:9216
v_add_f32_dpp v66, v66, v66 row_ror:4 row_mask:0xf bank_mask:0xf
v_add_f32_dpp v67, v67, v67 row_ror:4 row_mask:0xf bank_mask:0xf
v_mfma_f32_32x32x16_bf16 a[48:63], a[148:151], a[140:143], a[48:63]
ds_read_b64_tr_b16 a[148:149], v13 offset:0
buffer_load_dwordx4 v7, s[8:11], s44 offen offset:1024 lds
v_add_f32_dpp v68, v68, v68 row_ror:4 row_mask:0xf bank_mask:0xf
v_add_f32_dpp v69, v69, v69 row_ror:4 row_mask:0xf bank_mask:0xf
s_waitcnt lgkmcnt(15)
v_mfma_f32_32x32x16_bf16 v[144:159], a[136:139], a[164:167], v[144:159]
ds_read_b64_tr_b16 a[150:151], v13 offset:1024
v_add_f32_dpp v70, v70, v70 row_ror:4 row_mask:0xf bank_mask:0xf
v_add_f32_dpp v71, v71, v71 row_ror:4 row_mask:0xf bank_mask:0xf
v_mfma_f32_32x32x16_bf16 v[208:223], a[140:143], a[164:167], v[208:223]
ds_read_b64_tr_b16 a[164:165], v13 offset:8192
s_add_u32 m0, s46, 106496
s_nop 0
v_add_f32_dpp v72, v72, v72 row_ror:4 row_mask:0xf bank_mask:0xf
s_waitcnt lgkmcnt(15)
v_mfma_f32_32x32x16_bf16 a[64:79], a[152:155], a[136:139], a[64:79]
ds_read_b64_tr_b16 a[166:167], v13 offset:9216
v_add_f32_dpp v73, v73, v73 row_ror:4 row_mask:0xf bank_mask:0xf
v_add_f32_dpp v74, v74, v74 row_ror:4 row_mask:0xf bank_mask:0xf
v_mfma_f32_32x32x16_bf16 a[80:95], a[152:155], a[140:143], a[80:95]
ds_read_b64_tr_b16 a[152:153], v14 offset:0
buffer_load_dwordx4 v6, s[12:15], s44 offen offset:0 lds
v_add_f32_dpp v75, v75, v75 row_ror:4 row_mask:0xf bank_mask:0xf
v_add_f32_dpp v76, v76, v76 row_ror:4 row_mask:0xf bank_mask:0xf
s_waitcnt lgkmcnt(15)
v_mfma_f32_32x32x16_bf16 v[160:175], a[136:139], a[168:171], v[160:175]
ds_read_b64_tr_b16 a[154:155], v14 offset:1024
v_add_f32_dpp v77, v77, v77 row_ror:4 row_mask:0xf bank_mask:0xf
v_add_f32_dpp v78, v78, v78 row_ror:4 row_mask:0xf bank_mask:0xf
v_mfma_f32_32x32x16_bf16 v[224:239], a[140:143], a[168:171], v[224:239]
ds_read_b64_tr_b16 a[168:169], v14 offset:8192
buffer_load_dwordx4 v7, s[12:15], s44 offen offset:1024 lds
v_add_f32_dpp v79, v79, v79 row_ror:4 row_mask:0xf bank_mask:0xf
s_waitcnt lgkmcnt(15)
v_mfma_f32_32x32x16_bf16 a[96:111], a[156:159], a[136:139], a[96:111]
ds_read_b64_tr_b16 a[170:171], v14 offset:9216
s_nop 1
v_mfma_f32_32x32x16_bf16 a[112:127], a[156:159], a[140:143], a[112:127]
ds_read_b64_tr_b16 a[156:157], v15 offset:0
v_add_f32_dpp v64, v64, v64 row_ror:8 row_mask:0xf bank_mask:0xf
v_add_f32_dpp v65, v65, v65 row_ror:8 row_mask:0xf bank_mask:0xf
s_waitcnt lgkmcnt(15)
v_mfma_f32_32x32x16_bf16 v[176:191], a[136:139], a[172:175], v[176:191]
ds_read_b64_tr_b16 a[158:159], v15 offset:1024
v_add_f32_dpp v66, v66, v66 row_ror:8 row_mask:0xf bank_mask:0xf
v_add_f32_dpp v67, v67, v67 row_ror:8 row_mask:0xf bank_mask:0xf
v_mfma_f32_32x32x16_bf16 v[240:255], a[140:143], a[172:175], v[240:255]
ds_read_b64_tr_b16 a[172:173], v15 offset:8192
v_add_f32_dpp v68, v68, v68 row_ror:8 row_mask:0xf bank_mask:0xf
v_add_f32_dpp v69, v69, v69 row_ror:8 row_mask:0xf bank_mask:0xf
v_add_f32_dpp v70, v70, v70 row_ror:8 row_mask:0xf bank_mask:0xf
s_waitcnt lgkmcnt(13)
v_mfma_f32_32x32x16_bf16 a[0:15], a[144:147], a[128:131], a[0:15]
ds_read_b64_tr_b16 a[174:175], v15 offset:9216
ds_read_b128 a[136:139], v9 offset:0
v_add_f32_dpp v71, v71, v71 row_ror:8 row_mask:0xf bank_mask:0xf
v_mfma_f32_32x32x16_bf16 a[16:31], a[144:147], a[132:135], a[16:31]
ds_read_b128 a[140:143], v9 offset:4096
ds_read_b64_tr_b16 a[144:145], v12 offset:4096
s_add_u32 m0, s3, 8192
s_add_u32 s43, s53, 384
v_add_f32_dpp v72, v72, v72 row_ror:8 row_mask:0xf bank_mask:0xf
s_waitcnt lgkmcnt(15)
v_mfma_f32_32x32x16_bf16 v[128:143], a[128:131], a[160:163], v[128:143]
ds_read_b64_tr_b16 a[146:147], v12 offset:5120
v_add_f32_dpp v73, v73, v73 row_ror:8 row_mask:0xf bank_mask:0xf
v_add_f32_dpp v74, v74, v74 row_ror:8 row_mask:0xf bank_mask:0xf
v_mfma_f32_32x32x16_bf16 v[192:207], a[132:135], a[160:163], v[192:207]
ds_read_b64_tr_b16 a[160:161], v12 offset:12288
buffer_load_dwordx4 v2, s[4:7], s43 offen offset:0 lds
v_add_f32_dpp v75, v75, v75 row_ror:8 row_mask:0xf bank_mask:0xf
s_waitcnt lgkmcnt(15)
v_mfma_f32_32x32x16_bf16 a[32:47], a[148:151], a[128:131], a[32:47]
ds_read_b64_tr_b16 a[162:163], v12 offset:13312
v_add_f32_dpp v76, v76, v76 row_ror:8 row_mask:0xf bank_mask:0xf
v_add_f32_dpp v77, v77, v77 row_ror:8 row_mask:0xf bank_mask:0xf
v_mfma_f32_32x32x16_bf16 a[48:63], a[148:151], a[132:135], a[48:63]
ds_read_b64_tr_b16 a[148:149], v13 offset:4096
buffer_load_dwordx4 v3, s[4:7], s43 offen offset:1024 lds
v_add_f32_dpp v78, v78, v78 row_ror:8 row_mask:0xf bank_mask:0xf
v_add_f32_dpp v79, v79, v79 row_ror:8 row_mask:0xf bank_mask:0xf
s_waitcnt lgkmcnt(15)
v_mfma_f32_32x32x16_bf16 v[144:159], a[128:131], a[164:167], v[144:159]
ds_read_b64_tr_b16 a[150:151], v13 offset:5120
s_nop 0
v_mov_b32 v80, v64
v_mfma_f32_32x32x16_bf16 v[208:223], a[132:135], a[164:167], v[208:223]
ds_read_b64_tr_b16 a[164:165], v13 offset:12288
buffer_load_dwordx4 v4, s[4:7], s43 offen offset:2048 lds
v_mov_b32 v81, v65
v_mov_b32 v82, v66
s_waitcnt lgkmcnt(15)
v_mfma_f32_32x32x16_bf16 a[64:79], a[152:155], a[128:131], a[64:79]
ds_read_b64_tr_b16 a[166:167], v13 offset:13312
v_mov_b32 v83, v67
v_mov_b32 v84, v68
v_mfma_f32_32x32x16_bf16 a[80:95], a[152:155], a[132:135], a[80:95]
ds_read_b64_tr_b16 a[152:153], v14 offset:4096
buffer_load_dwordx4 v5, s[4:7], s43 offen offset:3072 lds
v_mov_b32 v85, v69
s_waitcnt lgkmcnt(15)
v_mfma_f32_32x32x16_bf16 v[160:175], a[128:131], a[168:171], v[160:175]
ds_read_b64_tr_b16 a[154:155], v14 offset:5120
v_mov_b32 v86, v70
v_mov_b32 v87, v71
v_mfma_f32_32x32x16_bf16 v[224:239], a[132:135], a[168:171], v[224:239]
ds_read_b64_tr_b16 a[168:169], v14 offset:12288
s_add_u32 m0, s3, 12288
s_add_u32 s43, s53, 33152
v_mov_b32 v88, v72
s_waitcnt lgkmcnt(15)
v_mfma_f32_32x32x16_bf16 a[96:111], a[156:159], a[128:131], a[96:111]
ds_read_b64_tr_b16 a[170:171], v14 offset:13312
v_mov_b32 v89, v73
v_mov_b32 v90, v74
v_mfma_f32_32x32x16_bf16 a[112:127], a[156:159], a[132:135], a[112:127]
ds_read_b64_tr_b16 a[156:157], v15 offset:4096
buffer_load_dwordx4 v2, s[4:7], s43 offen offset:0 lds
v_mov_b32 v91, v75
v_mov_b32 v92, v76
s_waitcnt lgkmcnt(15)
v_mfma_f32_32x32x16_bf16 v[176:191], a[128:131], a[172:175], v[176:191]
ds_read_b64_tr_b16 a[158:159], v15 offset:5120
v_mov_b32 v93, v77
v_mov_b32 v94, v78
v_mfma_f32_32x32x16_bf16 v[240:255], a[132:135], a[172:175], v[240:255]
ds_read_b64_tr_b16 a[172:173], v15 offset:12288
buffer_load_dwordx4 v3, s[4:7], s43 offen offset:1024 lds
v_mov_b32 v95, v79
s_waitcnt lgkmcnt(13)
v_mfma_f32_32x32x16_bf16 a[0:15], a[144:147], a[136:139], a[0:15]
ds_read_b64_tr_b16 a[174:175], v15 offset:13312
s_waitcnt vmcnt(12)
s_barrier
ds_read_b128 a[128:131], v10 offset:0
s_nop 1
v_mfma_f32_32x32x16_bf16 a[16:31], a[144:147], a[140:143], a[16:31]
ds_read_b128 a[132:135], v10 offset:4096
ds_read_b64_tr_b16 a[144:145], v12 offset:16384
buffer_load_dwordx4 v4, s[4:7], s43 offen offset:2048 lds
v_permlane16_swap_b32 v80, v64
s_waitcnt lgkmcnt(15)
v_mfma_f32_32x32x16_bf16 v[128:143], a[136:139], a[160:163], v[128:143]
ds_read_b64_tr_b16 a[146:147], v12 offset:17408
v_permlane16_swap_b32 v81, v65
v_permlane16_swap_b32 v82, v66
v_mfma_f32_32x32x16_bf16 v[192:207], a[140:143], a[160:163], v[192:207]
ds_read_b64_tr_b16 a[160:161], v12 offset:24576
buffer_load_dwordx4 v5, s[4:7], s43 offen offset:3072 lds
v_permlane16_swap_b32 v83, v67
s_waitcnt lgkmcnt(15)
v_mfma_f32_32x32x16_bf16 a[32:47], a[148:151], a[136:139], a[32:47]
ds_read_b64_tr_b16 a[162:163], v12 offset:25600
v_permlane16_swap_b32 v84, v68
v_permlane16_swap_b32 v85, v69
v_mfma_f32_32x32x16_bf16 a[48:63], a[148:151], a[140:143], a[48:63]
ds_read_b64_tr_b16 a[148:149], v13 offset:16384
s_add_u32 m0, s46, 114688
s_mov_b32 s44, 1835008
v_permlane16_swap_b32 v86, v70
s_waitcnt lgkmcnt(15)
v_mfma_f32_32x32x16_bf16 v[144:159], a[136:139], a[164:167], v[144:159]
ds_read_b64_tr_b16 a[150:151], v13 offset:17408
v_permlane16_swap_b32 v87, v71
v_permlane16_swap_b32 v88, v72
v_mfma_f32_32x32x16_bf16 v[208:223], a[140:143], a[164:167], v[208:223]
ds_read_b64_tr_b16 a[164:165], v13 offset:24576
buffer_load_dwordx4 v6, s[8:11], s44 offen offset:0 lds
v_permlane16_swap_b32 v89, v73
v_permlane16_swap_b32 v90, v74
s_waitcnt lgkmcnt(15)
v_mfma_f32_32x32x16_bf16 a[64:79], a[152:155], a[136:139], a[64:79]
ds_read_b64_tr_b16 a[166:167], v13 offset:25600
v_permlane16_swap_b32 v91, v75
v_permlane16_swap_b32 v92, v76
v_mfma_f32_32x32x16_bf16 a[80:95], a[152:155], a[140:143], a[80:95]
ds_read_b64_tr_b16 a[152:153], v14 offset:16384
buffer_load_dwordx4 v7, s[8:11], s44 offen offset:1024 lds
v_permlane16_swap_b32 v93, v77
v_permlane16_swap_b32 v94, v78
s_waitcnt lgkmcnt(15)
v_mfma_f32_32x32x16_bf16 v[160:175], a[136:139], a[168:171], v[160:175]
ds_read_b64_tr_b16 a[154:155], v14 offset:17408
v_permlane16_swap_b32 v95, v79
v_mfma_f32_32x32x16_bf16 v[224:239], a[140:143], a[168:171], v[224:239]
ds_read_b64_tr_b16 a[168:169], v14 offset:24576
s_add_u32 m0, s46, 122880
s_nop 0
s_nop 1
s_waitcnt lgkmcnt(15)
v_mfma_f32_32x32x16_bf16 a[96:111], a[156:159], a[136:139], a[96:111]
ds_read_b64_tr_b16 a[170:171], v14 offset:25600
v_add_f32 v64, v64, v80
v_add_f32 v65, v65, v81
v_mfma_f32_32x32x16_bf16 a[112:127], a[156:159], a[140:143], a[112:127]
ds_read_b64_tr_b16 a[156:157], v15 offset:16384
buffer_load_dwordx4 v6, s[12:15], s44 offen offset:0 lds
v_add_f32 v66, v66, v82
s_waitcnt lgkmcnt(15)
v_mfma_f32_32x32x16_bf16 v[176:191], a[136:139], a[172:175], v[176:191]
ds_read_b64_tr_b16 a[158:159], v15 offset:17408
v_add_f32 v67, v67, v83
v_add_f32 v68, v68, v84
v_mfma_f32_32x32x16_bf16 v[240:255], a[140:143], a[172:175], v[240:255]
ds_read_b64_tr_b16 a[172:173], v15 offset:24576
buffer_load_dwordx4 v7, s[12:15], s44 offen offset:1024 lds
v_add_f32 v69, v69, v85
v_add_f32 v70, v70, v86
s_waitcnt lgkmcnt(13)
v_mfma_f32_32x32x16_bf16 a[0:15], a[144:147], a[128:131], a[0:15]
ds_read_b64_tr_b16 a[174:175], v15 offset:25600
ds_read_b128 a[136:139], v11 offset:0
v_add_f32 v71, v71, v87
v_mfma_f32_32x32x16_bf16 a[16:31], a[144:147], a[132:135], a[16:31]
ds_read_b128 a[140:143], v11 offset:4096
ds_read_b64_tr_b16 a[144:145], v12 offset:20480
v_add_f32 v72, v72, v88
v_add_f32 v73, v73, v89
s_waitcnt lgkmcnt(15)
v_mfma_f32_32x32x16_bf16 v[128:143], a[128:131], a[160:163], v[128:143]
ds_read_b64_tr_b16 a[146:147], v12 offset:21504
v_add_f32 v74, v74, v90
v_add_f32 v75, v75, v91
v_mfma_f32_32x32x16_bf16 v[192:207], a[132:135], a[160:163], v[192:207]
ds_read_b64_tr_b16 a[160:161], v12 offset:28672
v_add_f32 v76, v76, v92
v_add_f32 v77, v77, v93
s_waitcnt lgkmcnt(15)
v_mfma_f32_32x32x16_bf16 a[32:47], a[148:151], a[128:131], a[32:47]
ds_read_b64_tr_b16 a[162:163], v12 offset:29696
v_add_f32 v78, v78, v94
v_add_f32 v79, v79, v95
v_mfma_f32_32x32x16_bf16 a[48:63], a[148:151], a[132:135], a[48:63]
ds_read_b64_tr_b16 a[148:149], v13 offset:20480
s_nop 0
v_mov_b32 v80, v64
s_waitcnt lgkmcnt(15)
v_mfma_f32_32x32x16_bf16 v[144:159], a[128:131], a[164:167], v[144:159]
ds_read_b64_tr_b16 a[150:151], v13 offset:21504
v_mov_b32 v81, v65
v_mov_b32 v82, v66
v_mfma_f32_32x32x16_bf16 v[208:223], a[132:135], a[164:167], v[208:223]
ds_read_b64_tr_b16 a[164:165], v13 offset:28672
v_mov_b32 v83, v67
v_mov_b32 v84, v68
s_waitcnt lgkmcnt(15)
v_mfma_f32_32x32x16_bf16 a[64:79], a[152:155], a[128:131], a[64:79]
ds_read_b64_tr_b16 a[166:167], v13 offset:29696
v_mov_b32 v85, v69
v_mov_b32 v86, v70
v_mov_b32 v87, v71
v_mfma_f32_32x32x16_bf16 a[80:95], a[152:155], a[132:135], a[80:95]
ds_read_b64_tr_b16 a[152:153], v14 offset:20480
v_mov_b32 v88, v72
v_mov_b32 v89, v73
s_waitcnt lgkmcnt(15)
v_mfma_f32_32x32x16_bf16 v[160:175], a[128:131], a[168:171], v[160:175]
ds_read_b64_tr_b16 a[154:155], v14 offset:21504
v_mov_b32 v90, v74
v_mov_b32 v91, v75
v_mfma_f32_32x32x16_bf16 v[224:239], a[132:135], a[168:171], v[224:239]
ds_read_b64_tr_b16 a[168:169], v14 offset:28672
v_mov_b32 v92, v76
v_mov_b32 v93, v77
s_waitcnt lgkmcnt(15)
v_mfma_f32_32x32x16_bf16 a[96:111], a[156:159], a[128:131], a[96:111]
ds_read_b64_tr_b16 a[170:171], v14 offset:29696
v_mov_b32 v94, v78
v_mov_b32 v95, v79
v_mfma_f32_32x32x16_bf16 a[112:127], a[156:159], a[132:135], a[112:127]
ds_read_b64_tr_b16 a[156:157], v15 offset:20480
s_nop 1
s_waitcnt lgkmcnt(15)
v_mfma_f32_32x32x16_bf16 v[176:191], a[128:131], a[172:175], v[176:191]
ds_read_b64_tr_b16 a[158:159], v15 offset:21504
v_permlane32_swap_b32 v80, v64
v_permlane32_swap_b32 v81, v65
v_mfma_f32_32x32x16_bf16 v[240:255], a[132:135], a[172:175], v[240:255]
ds_read_b64_tr_b16 a[172:173], v15 offset:28672
v_permlane32_swap_b32 v82, v66
v_permlane32_swap_b32 v83, v67
s_waitcnt lgkmcnt(13)
v_mfma_f32_32x32x16_bf16 a[0:15], a[144:147], a[136:139], a[0:15]
ds_read_b64_tr_b16 a[174:175], v15 offset:29696
s_waitcnt vmcnt(12)
s_barrier
s_waitcnt vmcnt(4)
ds_read_b128 a[128:131], v8 offset:8192
v_permlane32_swap_b32 v84, v68
v_mfma_f32_32x32x16_bf16 a[16:31], a[144:147], a[140:143], a[16:31]
ds_read_b128 a[132:135], v8 offset:12288
ds_read_b64_tr_b16 a[144:145], v12 offset:32768
s_add_u32 m0, s46, 65536
s_mov_b32 s44, 2097152
s_waitcnt lgkmcnt(15)
v_mfma_f32_32x32x16_bf16 v[128:143], a[136:139], a[160:163], v[128:143]
ds_read_b64_tr_b16 a[146:147], v12 offset:33792
v_permlane32_swap_b32 v85, v69
v_permlane32_swap_b32 v86, v70
v_mfma_f32_32x32x16_bf16 v[192:207], a[140:143], a[160:163], v[192:207]
ds_read_b64_tr_b16 a[160:161], v12 offset:40960
buffer_load_dwordx4 v6, s[8:11], s44 offen offset:0 lds
v_permlane32_swap_b32 v87, v71
v_permlane32_swap_b32 v88, v72
s_waitcnt lgkmcnt(15)
v_mfma_f32_32x32x16_bf16 a[32:47], a[148:151], a[136:139], a[32:47]
ds_read_b64_tr_b16 a[162:163], v12 offset:41984
v_permlane32_swap_b32 v89, v73
v_permlane32_swap_b32 v90, v74
v_mfma_f32_32x32x16_bf16 a[48:63], a[148:151], a[140:143], a[48:63]
ds_read_b64_tr_b16 a[148:149], v13 offset:32768
buffer_load_dwordx4 v7, s[8:11], s44 offen offset:1024 lds
v_permlane32_swap_b32 v91, v75
s_waitcnt lgkmcnt(15)
v_mfma_f32_32x32x16_bf16 v[144:159], a[136:139], a[164:167], v[144:159]
ds_read_b64_tr_b16 a[150:151], v13 offset:33792
v_permlane32_swap_b32 v92, v76
v_permlane32_swap_b32 v93, v77
v_mfma_f32_32x32x16_bf16 v[208:223], a[140:143], a[164:167], v[208:223]
ds_read_b64_tr_b16 a[164:165], v13 offset:40960
s_add_u32 m0, s46, 73728
s_nop 0
v_permlane32_swap_b32 v94, v78
s_waitcnt lgkmcnt(15)
v_mfma_f32_32x32x16_bf16 a[64:79], a[152:155], a[136:139], a[64:79]
ds_read_b64_tr_b16 a[166:167], v13 offset:41984
v_permlane32_swap_b32 v95, v79
s_nop 1
v_mfma_f32_32x32x16_bf16 a[80:95], a[152:155], a[140:143], a[80:95]
ds_read_b64_tr_b16 a[152:153], v14 offset:32768
buffer_load_dwordx4 v6, s[12:15], s44 offen offset:0 lds
v_add_f32 v64, v64, v80
s_waitcnt lgkmcnt(15)
v_mfma_f32_32x32x16_bf16 v[160:175], a[136:139], a[168:171], v[160:175]
ds_read_b64_tr_b16 a[154:155], v14 offset:33792
v_add_f32 v65, v65, v81
v_add_f32 v66, v66, v82
v_mfma_f32_32x32x16_bf16 v[224:239], a[140:143], a[168:171], v[224:239]
ds_read_b64_tr_b16 a[168:169], v14 offset:40960
buffer_load_dwordx4 v7, s[12:15], s44 offen offset:1024 lds
v_add_f32 v67, v67, v83
v_add_f32 v68, v68, v84
s_waitcnt lgkmcnt(15)
v_mfma_f32_32x32x16_bf16 a[96:111], a[156:159], a[136:139], a[96:111]
ds_read_b64_tr_b16 a[170:171], v14 offset:41984
v_add_f32 v69, v69, v85
v_add_f32 v70, v70, v86
v_mfma_f32_32x32x16_bf16 a[112:127], a[156:159], a[140:143], a[112:127]
ds_read_b64_tr_b16 a[156:157], v15 offset:32768
v_add_f32 v71, v71, v87
v_add_f32 v72, v72, v88
s_waitcnt lgkmcnt(15)
v_mfma_f32_32x32x16_bf16 v[176:191], a[136:139], a[172:175], v[176:191]
ds_read_b64_tr_b16 a[158:159], v15 offset:33792
v_add_f32 v73, v73, v89
v_add_f32 v74, v74, v90
v_mfma_f32_32x32x16_bf16 v[240:255], a[140:143], a[172:175], v[240:255]
ds_read_b64_tr_b16 a[172:173], v15 offset:40960
v_add_f32 v75, v75, v91
v_add_f32 v76, v76, v92
s_waitcnt lgkmcnt(13)
v_mfma_f32_32x32x16_bf16 a[0:15], a[144:147], a[128:131], a[0:15]
ds_read_b64_tr_b16 a[174:175], v15 offset:41984
ds_read_b128 a[136:139], v9 offset:8192
v_add_f32 v77, v77, v93
v_add_f32 v78, v78, v94
v_mfma_f32_32x32x16_bf16 a[16:31], a[144:147], a[132:135], a[16:31]
ds_read_b128 a[140:143], v9 offset:12288
ds_read_b64_tr_b16 a[144:145], v12 offset:36864
s_add_u32 m0, s3, 0
s_add_u32 s43, s53, 512
s_waitcnt lgkmcnt(15)
v_mfma_f32_32x32x16_bf16 v[128:143], a[128:131], a[160:163], v[128:143]
ds_read_b64_tr_b16 a[146:147], v12 offset:37888
v_add_f32 v79, v79, v95
v_and_b32 v96, 3, v1
v_mfma_f32_32x32x16_bf16 v[192:207], a[132:135], a[160:163], v[192:207]
ds_read_b64_tr_b16 a[160:161], v12 offset:45056
buffer_load_dwordx4 v2, s[4:7], s43 offen offset:0 lds
v_lshlrev_b32 v96, 5, v96
s_lshl_b32 s62, s38, 8
s_waitcnt lgkmcnt(15)
v_mfma_f32_32x32x16_bf16 a[32:47], a[148:151], a[128:131], a[32:47]
ds_read_b64_tr_b16 a[162:163], v12 offset:46080
s_add_u32 s62, s62, 133120
v_add_u32 v96, s62, v96
v_mfma_f32_32x32x16_bf16 a[48:63], a[148:151], a[132:135], a[48:63]
ds_read_b64_tr_b16 a[148:149], v13 offset:36864
buffer_load_dwordx4 v3, s[4:7], s43 offen offset:1024 lds
ds_write_b128 v96, v[64:67] offset:0
s_waitcnt lgkmcnt(15)
v_mfma_f32_32x32x16_bf16 v[144:159], a[128:131], a[164:167], v[144:159]
ds_read_b64_tr_b16 a[150:151], v13 offset:37888
ds_write_b128 v96, v[68:71] offset:16
ds_write_b128 v96, v[72:75] offset:128
v_mfma_f32_32x32x16_bf16 v[208:223], a[132:135], a[164:167], v[208:223]
ds_read_b64_tr_b16 a[164:165], v13 offset:45056
buffer_load_dwordx4 v4, s[4:7], s43 offen offset:2048 lds
ds_write_b128 v96, v[76:79] offset:144
s_waitcnt lgkmcnt(0)
v_mfma_f32_32x32x16_bf16 a[64:79], a[152:155], a[128:131], a[64:79]
ds_read_b64_tr_b16 a[166:167], v13 offset:46080
v_mfma_f32_32x32x16_bf16 a[80:95], a[152:155], a[132:135], a[80:95]
ds_read_b64_tr_b16 a[152:153], v14 offset:36864
buffer_load_dwordx4 v5, s[4:7], s43 offen offset:3072 lds
v_mfma_f32_32x32x16_bf16 v[160:175], a[128:131], a[168:171], v[160:175]
ds_read_b64_tr_b16 a[154:155], v14 offset:37888
v_mfma_f32_32x32x16_bf16 v[224:239], a[132:135], a[168:171], v[224:239]
ds_read_b64_tr_b16 a[168:169], v14 offset:45056
s_add_u32 m0, s3, 4096
s_add_u32 s43, s53, 33280
v_mfma_f32_32x32x16_bf16 a[96:111], a[156:159], a[128:131], a[96:111]
ds_read_b64_tr_b16 a[170:171], v14 offset:46080
v_mfma_f32_32x32x16_bf16 a[112:127], a[156:159], a[132:135], a[112:127]
ds_read_b64_tr_b16 a[156:157], v15 offset:36864
buffer_load_dwordx4 v2, s[4:7], s43 offen offset:0 lds
v_mfma_f32_32x32x16_bf16 v[176:191], a[128:131], a[172:175], v[176:191]
ds_read_b64_tr_b16 a[158:159], v15 offset:37888
v_mfma_f32_32x32x16_bf16 v[240:255], a[132:135], a[172:175], v[240:255]
ds_read_b64_tr_b16 a[172:173], v15 offset:45056
buffer_load_dwordx4 v3, s[4:7], s43 offen offset:1024 lds
v_mfma_f32_32x32x16_bf16 a[0:15], a[144:147], a[136:139], a[0:15]
ds_read_b64_tr_b16 a[174:175], v15 offset:46080
s_waitcnt vmcnt(10)
s_barrier
ds_read_b128 a[128:131], v10 offset:8192
v_mfma_f32_32x32x16_bf16 a[16:31], a[144:147], a[140:143], a[16:31]
ds_read_b128 a[132:135], v10 offset:12288
ds_read_b64_tr_b16 a[144:145], v12 offset:49152
buffer_load_dwordx4 v4, s[4:7], s43 offen offset:2048 lds
v_mfma_f32_32x32x16_bf16 v[128:143], a[136:139], a[160:163], v[128:143]
ds_read_b64_tr_b16 a[146:147], v12 offset:50176
v_mfma_f32_32x32x16_bf16 v[192:207], a[140:143], a[160:163], v[192:207]
ds_read_b64_tr_b16 a[160:161], v12 offset:57344
buffer_load_dwordx4 v5, s[4:7], s43 offen offset:3072 lds
v_mfma_f32_32x32x16_bf16 a[32:47], a[148:151], a[136:139], a[32:47]
ds_read_b64_tr_b16 a[162:163], v12 offset:58368
v_mfma_f32_32x32x16_bf16 a[48:63], a[148:151], a[140:143], a[48:63]
ds_read_b64_tr_b16 a[148:149], v13 offset:49152
s_add_u32 m0, s46, 81920
s_mov_b32 s44, 2359296
s_waitcnt lgkmcnt(15)
v_mfma_f32_32x32x16_bf16 v[144:159], a[136:139], a[164:167], v[144:159]
ds_read_b64_tr_b16 a[150:151], v13 offset:50176
v_mfma_f32_32x32x16_bf16 v[208:223], a[140:143], a[164:167], v[208:223]
ds_read_b64_tr_b16 a[164:165], v13 offset:57344
buffer_load_dwordx4 v6, s[8:11], s44 offen offset:0 lds
s_waitcnt lgkmcnt(15)
v_mfma_f32_32x32x16_bf16 a[64:79], a[152:155], a[136:139], a[64:79]
ds_read_b64_tr_b16 a[166:167], v13 offset:58368
v_mfma_f32_32x32x16_bf16 a[80:95], a[152:155], a[140:143], a[80:95]
ds_read_b64_tr_b16 a[152:153], v14 offset:49152
buffer_load_dwordx4 v7, s[8:11], s44 offen offset:1024 lds
s_waitcnt lgkmcnt(15)
v_mfma_f32_32x32x16_bf16 v[160:175], a[136:139], a[168:171], v[160:175]
ds_read_b64_tr_b16 a[154:155], v14 offset:50176
v_mfma_f32_32x32x16_bf16 v[224:239], a[140:143], a[168:171], v[224:239]
ds_read_b64_tr_b16 a[168:169], v14 offset:57344
s_add_u32 m0, s46, 90112
s_nop 0
s_waitcnt lgkmcnt(15)
v_mfma_f32_32x32x16_bf16 a[96:111], a[156:159], a[136:139], a[96:111]
ds_read_b64_tr_b16 a[170:171], v14 offset:58368
v_mfma_f32_32x32x16_bf16 a[112:127], a[156:159], a[140:143], a[112:127]
ds_read_b64_tr_b16 a[156:157], v15 offset:49152
buffer_load_dwordx4 v6, s[12:15], s44 offen offset:0 lds
s_waitcnt lgkmcnt(15)
v_mfma_f32_32x32x16_bf16 v[176:191], a[136:139], a[172:175], v[176:191]
ds_read_b64_tr_b16 a[158:159], v15 offset:50176
v_mfma_f32_32x32x16_bf16 v[240:255], a[140:143], a[172:175], v[240:255]
ds_read_b64_tr_b16 a[172:173], v15 offset:57344
buffer_load_dwordx4 v7, s[12:15], s44 offen offset:1024 lds
s_waitcnt lgkmcnt(13)
v_mfma_f32_32x32x16_bf16 a[0:15], a[144:147], a[128:131], a[0:15]
ds_read_b64_tr_b16 a[174:175], v15 offset:58368
ds_read_b128 a[136:139], v11 offset:8192
v_mfma_f32_32x32x16_bf16 a[16:31], a[144:147], a[132:135], a[16:31]
ds_read_b128 a[140:143], v11 offset:12288
ds_read_b64_tr_b16 a[144:145], v12 offset:53248
s_waitcnt lgkmcnt(15)
v_mfma_f32_32x32x16_bf16 v[128:143], a[128:131], a[160:163], v[128:143]
ds_read_b64_tr_b16 a[146:147], v12 offset:54272
v_mfma_f32_32x32x16_bf16 v[192:207], a[132:135], a[160:163], v[192:207]
ds_read_b64_tr_b16 a[160:161], v12 offset:61440
s_waitcnt lgkmcnt(15)
v_mfma_f32_32x32x16_bf16 a[32:47], a[148:151], a[128:131], a[32:47]
ds_read_b64_tr_b16 a[162:163], v12 offset:62464
v_mfma_f32_32x32x16_bf16 a[48:63], a[148:151], a[132:135], a[48:63]
ds_read_b64_tr_b16 a[148:149], v13 offset:53248
s_waitcnt lgkmcnt(15)
v_mfma_f32_32x32x16_bf16 v[144:159], a[128:131], a[164:167], v[144:159]
ds_read_b64_tr_b16 a[150:151], v13 offset:54272
v_mfma_f32_32x32x16_bf16 v[208:223], a[132:135], a[164:167], v[208:223]
ds_read_b64_tr_b16 a[164:165], v13 offset:61440
s_waitcnt lgkmcnt(15)
v_mfma_f32_32x32x16_bf16 a[64:79], a[152:155], a[128:131], a[64:79]
ds_read_b64_tr_b16 a[166:167], v13 offset:62464
v_mfma_f32_32x32x16_bf16 a[80:95], a[152:155], a[132:135], a[80:95]
ds_read_b64_tr_b16 a[152:153], v14 offset:53248
s_waitcnt lgkmcnt(15)
v_mfma_f32_32x32x16_bf16 v[160:175], a[128:131], a[168:171], v[160:175]
ds_read_b64_tr_b16 a[154:155], v14 offset:54272
v_mfma_f32_32x32x16_bf16 v[224:239], a[132:135], a[168:171], v[224:239]
ds_read_b64_tr_b16 a[168:169], v14 offset:61440
s_waitcnt lgkmcnt(15)
v_mfma_f32_32x32x16_bf16 a[96:111], a[156:159], a[128:131], a[96:111]
ds_read_b64_tr_b16 a[170:171], v14 offset:62464
v_mfma_f32_32x32x16_bf16 a[112:127], a[156:159], a[132:135], a[112:127]
ds_read_b64_tr_b16 a[156:157], v15 offset:53248
s_waitcnt lgkmcnt(15)
v_mfma_f32_32x32x16_bf16 v[176:191], a[128:131], a[172:175], v[176:191]
ds_read_b64_tr_b16 a[158:159], v15 offset:54272
v_mfma_f32_32x32x16_bf16 v[240:255], a[132:135], a[172:175], v[240:255]
ds_read_b64_tr_b16 a[172:173], v15 offset:61440
s_waitcnt lgkmcnt(13)
v_mfma_f32_32x32x16_bf16 a[0:15], a[144:147], a[136:139], a[0:15]
ds_read_b64_tr_b16 a[174:175], v15 offset:62464
s_waitcnt vmcnt(12)
s_barrier
s_waitcnt vmcnt(4)
ds_read_b128 a[128:131], v8 offset:0
v_mfma_f32_32x32x16_bf16 a[16:31], a[144:147], a[140:143], a[16:31]
ds_read_b128 a[132:135], v8 offset:4096
ds_read_b64_tr_b16 a[144:145], v12 offset:0
s_add_u32 m0, s46, 98304
s_mov_b32 s44, 2621440
s_waitcnt lgkmcnt(15)
v_mfma_f32_32x32x16_bf16 v[128:143], a[136:139], a[160:163], v[128:143]
ds_read_b64_tr_b16 a[146:147], v12 offset:1024
v_mfma_f32_32x32x16_bf16 v[192:207], a[140:143], a[160:163], v[192:207]
ds_read_b64_tr_b16 a[160:161], v12 offset:8192
buffer_load_dwordx4 v6, s[8:11], s44 offen offset:0 lds
s_waitcnt lgkmcnt(15)
v_mfma_f32_32x32x16_bf16 a[32:47], a[148:151], a[136:139], a[32:47]
ds_read_b64_tr_b16 a[162:163], v12 offset:9216
s_cmp_lg_u32 s38, 0
s_cbranch_scc1 L_w0_2
v_lshlrev_b32 v96, 2, v1
v_add_u32 v97, 133120, v96
ds_read_b32 v98, v97 offset:0
ds_read_b32 v99, v97 offset:256
ds_read_b32 v100, v97 offset:512
ds_read_b32 v101, v97 offset:768
s_lshl_b32 s62, s36, 3
s_add_u32 s62, s62, s37
s_lshl_b32 s62, s62, 8
s_add_u32 s62, s62, 0x3a00000
s_waitcnt lgkmcnt(0)
v_add_f32 v98, v98, v99
v_add_f32 v100, v100, v101
v_add_f32 v98, v98, v100
buffer_store_dword v98, v96, s[16:19], s62 offen sc1
L_w0_2:
s_waitcnt lgkmcnt(0)
v_mfma_f32_32x32x16_bf16 a[48:63], a[148:151], a[140:143], a[48:63]
ds_read_b64_tr_b16 a[148:149], v13 offset:0
buffer_load_dwordx4 v7, s[8:11], s44 offen offset:1024 lds
v_mfma_f32_32x32x16_bf16 v[144:159], a[136:139], a[164:167], v[144:159]
ds_read_b64_tr_b16 a[150:151], v13 offset:1024
v_mfma_f32_32x32x16_bf16 v[208:223], a[140:143], a[164:167], v[208:223]
ds_read_b64_tr_b16 a[164:165], v13 offset:8192
s_add_u32 m0, s46, 106496
s_nop 0
v_mfma_f32_32x32x16_bf16 a[64:79], a[152:155], a[136:139], a[64:79]
ds_read_b64_tr_b16 a[166:167], v13 offset:9216
v_mfma_f32_32x32x16_bf16 a[80:95], a[152:155], a[140:143], a[80:95]
ds_read_b64_tr_b16 a[152:153], v14 offset:0
buffer_load_dwordx4 v6, s[12:15], s44 offen offset:0 lds
v_mfma_f32_32x32x16_bf16 v[160:175], a[136:139], a[168:171], v[160:175]
ds_read_b64_tr_b16 a[154:155], v14 offset:1024
v_mfma_f32_32x32x16_bf16 v[224:239], a[140:143], a[168:171], v[224:239]
ds_read_b64_tr_b16 a[168:169], v14 offset:8192
buffer_load_dwordx4 v7, s[12:15], s44 offen offset:1024 lds
v_mfma_f32_32x32x16_bf16 a[96:111], a[156:159], a[136:139], a[96:111]
ds_read_b64_tr_b16 a[170:171], v14 offset:9216
v_mfma_f32_32x32x16_bf16 a[112:127], a[156:159], a[140:143], a[112:127]
ds_read_b64_tr_b16 a[156:157], v15 offset:0
v_mfma_f32_32x32x16_bf16 v[176:191], a[136:139], a[172:175], v[176:191]
ds_read_b64_tr_b16 a[158:159], v15 offset:1024
v_mfma_f32_32x32x16_bf16 v[240:255], a[140:143], a[172:175], v[240:255]
ds_read_b64_tr_b16 a[172:173], v15 offset:8192
v_mfma_f32_32x32x16_bf16 a[0:15], a[144:147], a[128:131], a[0:15]
ds_read_b64_tr_b16 a[174:175], v15 offset:9216
ds_read_b128 a[136:139], v9 offset:0
v_mfma_f32_32x32x16_bf16 a[16:31], a[144:147], a[132:135], a[16:31]
ds_read_b128 a[140:143], v9 offset:4096
ds_read_b64_tr_b16 a[144:145], v12 offset:4096
s_add_u32 m0, s3, 8192
s_add_u32 s43, s53, 640
v_mfma_f32_32x32x16_bf16 v[128:143], a[128:131], a[160:163], v[128:143]
ds_read_b64_tr_b16 a[146:147], v12 offset:5120
v_mfma_f32_32x32x16_bf16 v[192:207], a[132:135], a[160:163], v[192:207]
ds_read_b64_tr_b16 a[160:161], v12 offset:12288
buffer_load_dwordx4 v2, s[4:7], s43 offen offset:0 lds
s_cmp_lg_u32 s38, 0
s_cbranch_scc1 L_w0_3
v_mov_b32 v63, 0
s_mov_b64 s[64:65], exec
s_mov_b64 exec, 1
buffer_load_dword v63, v63, s[32:35], 0 offen sc1
s_mov_b64 exec, s[64:65]
L_w0_3:
s_waitcnt lgkmcnt(15)
v_mfma_f32_32x32x16_bf16 a[32:47], a[148:151], a[128:131], a[32:47]
ds_read_b64_tr_b16 a[162:163], v12 offset:13312
v_mfma_f32_32x32x16_bf16 a[48:63], a[148:151], a[132:135], a[48:63]
ds_read_b64_tr_b16 a[148:149], v13 offset:4096
buffer_load_dwordx4 v3, s[4:7], s43 offen offset:1024 lds
s_waitcnt lgkmcnt(15)
v_mfma_f32_32x32x16_bf16 v[144:159], a[128:131], a[164:167], v[144:159]
ds_read_b64_tr_b16 a[150:151], v13 offset:5120
v_mfma_f32_32x32x16_bf16 v[208:223], a[132:135], a[164:167], v[208:223]
ds_read_b64_tr_b16 a[164:165], v13 offset:12288
buffer_load_dwordx4 v4, s[4:7], s43 offen offset:2048 lds
s_waitcnt lgkmcnt(15)
v_mfma_f32_32x32x16_bf16 a[64:79], a[152:155], a[128:131], a[64:79]
ds_read_b64_tr_b16 a[166:167], v13 offset:13312
v_mfma_f32_32x32x16_bf16 a[80:95], a[152:155], a[132:135], a[80:95]
ds_read_b64_tr_b16 a[152:153], v14 offset:4096
buffer_load_dwordx4 v5, s[4:7], s43 offen offset:3072 lds
s_waitcnt lgkmcnt(15)
v_mfma_f32_32x32x16_bf16 v[160:175], a[128:131], a[168:171], v[160:175]
ds_read_b64_tr_b16 a[154:155], v14 offset:5120
v_mfma_f32_32x32x16_bf16 v[224:239], a[132:135], a[168:171], v[224:239]
ds_read_b64_tr_b16 a[168:169], v14 offset:12288
s_add_u32 m0, s3, 12288
s_add_u32 s43, s53, 33408
s_waitcnt lgkmcnt(15)
v_mfma_f32_32x32x16_bf16 a[96:111], a[156:159], a[128:131], a[96:111]
ds_read_b64_tr_b16 a[170:171], v14 offset:13312
v_mfma_f32_32x32x16_bf16 a[112:127], a[156:159], a[132:135], a[112:127]
ds_read_b64_tr_b16 a[156:157], v15 offset:4096
buffer_load_dwordx4 v2, s[4:7], s43 offen offset:0 lds
s_waitcnt lgkmcnt(15)
v_mfma_f32_32x32x16_bf16 v[176:191], a[128:131], a[172:175], v[176:191]
ds_read_b64_tr_b16 a[158:159], v15 offset:5120
v_mfma_f32_32x32x16_bf16 v[240:255], a[132:135], a[172:175], v[240:255]
ds_read_b64_tr_b16 a[172:173], v15 offset:12288
buffer_load_dwordx4 v3, s[4:7], s43 offen offset:1024 lds
s_waitcnt lgkmcnt(13)
v_mfma_f32_32x32x16_bf16 a[0:15], a[144:147], a[136:139], a[0:15]
ds_read_b64_tr_b16 a[174:175], v15 offset:13312
s_waitcnt vmcnt(10)
s_barrier
ds_read_b128 a[128:131], v10 offset:0
v_mfma_f32_32x32x16_bf16 a[16:31], a[144:147], a[140:143], a[16:31]
ds_read_b128 a[132:135], v10 offset:4096
ds_read_b64_tr_b16 a[144:145], v12 offset:16384
buffer_load_dwordx4 v4, s[4:7], s43 offen offset:2048 lds
s_waitcnt lgkmcnt(15)
v_mfma_f32_32x32x16_bf16 v[128:143], a[136:139], a[160:163], v[128:143]
ds_read_b64_tr_b16 a[146:147], v12 offset:17408
v_mfma_f32_32x32x16_bf16 v[192:207], a[140:143], a[160:163], v[192:207]
ds_read_b64_tr_b16 a[160:161], v12 offset:24576
buffer_load_dwordx4 v5, s[4:7], s43 offen offset:3072 lds
s_waitcnt lgkmcnt(15)
v_mfma_f32_32x32x16_bf16 a[32:47], a[148:151], a[136:139], a[32:47]
ds_read_b64_tr_b16 a[162:163], v12 offset:25600
v_mfma_f32_32x32x16_bf16 a[48:63], a[148:151], a[140:143], a[48:63]
ds_read_b64_tr_b16 a[148:149], v13 offset:16384
s_add_u32 m0, s46, 114688
s_mov_b32 s44, 2883584
s_waitcnt lgkmcnt(15)
v_mfma_f32_32x32x16_bf16 v[144:159], a[136:139], a[164:167], v[144:159]
ds_read_b64_tr_b16 a[150:151], v13 offset:17408
v_mfma_f32_32x32x16_bf16 v[208:223], a[140:143], a[164:167], v[208:223]
ds_read_b64_tr_b16 a[164:165], v13 offset:24576
buffer_load_dwordx4 v6, s[8:11], s44 offen offset:0 lds
s_waitcnt lgkmcnt(15)
v_mfma_f32_32x32x16_bf16 a[64:79], a[152:155], a[136:139], a[64:79]
ds_read_b64_tr_b16 a[166:167], v13 offset:25600
v_mfma_f32_32x32x16_bf16 a[80:95], a[152:155], a[140:143], a[80:95]
ds_read_b64_tr_b16 a[152:153], v14 offset:16384
buffer_load_dwordx4 v7, s[8:11], s44 offen offset:1024 lds
s_waitcnt lgkmcnt(15)
v_mfma_f32_32x32x16_bf16 v[160:175], a[136:139], a[168:171], v[160:175]
ds_read_b64_tr_b16 a[154:155], v14 offset:17408
v_mfma_f32_32x32x16_bf16 v[224:239], a[140:143], a[168:171], v[224:239]
ds_read_b64_tr_b16 a[168:169], v14 offset:24576
s_add_u32 m0, s46, 122880
s_nop 0
s_waitcnt lgkmcnt(15)
v_mfma_f32_32x32x16_bf16 a[96:111], a[156:159], a[136:139], a[96:111]
ds_read_b64_tr_b16 a[170:171], v14 offset:25600
v_mfma_f32_32x32x16_bf16 a[112:127], a[156:159], a[140:143], a[112:127]
ds_read_b64_tr_b16 a[156:157], v15 offset:16384
buffer_load_dwordx4 v6, s[12:15], s44 offen offset:0 lds
s_waitcnt lgkmcnt(15)
v_mfma_f32_32x32x16_bf16 v[176:191], a[136:139], a[172:175], v[176:191]
ds_read_b64_tr_b16 a[158:159], v15 offset:17408
v_mfma_f32_32x32x16_bf16 v[240:255], a[140:143], a[172:175], v[240:255]
ds_read_b64_tr_b16 a[172:173], v15 offset:24576
buffer_load_dwordx4 v7, s[12:15], s44 offen offset:1024 lds
s_waitcnt lgkmcnt(13)
v_mfma_f32_32x32x16_bf16 a[0:15], a[144:147], a[128:131], a[0:15]
ds_read_b64_tr_b16 a[174:175], v15 offset:25600
ds_read_b128 a[136:139], v11 offset:0
v_mfma_f32_32x32x16_bf16 a[16:31], a[144:147], a[132:135], a[16:31]
ds_read_b128 a[140:143], v11 offset:4096
ds_read_b64_tr_b16 a[144:145], v12 offset:20480
s_waitcnt lgkmcnt(15)
v_mfma_f32_32x32x16_bf16 v[128:143], a[128:131], a[160:163], v[128:143]
ds_read_b64_tr_b16 a[146:147], v12 offset:21504
v_mfma_f32_32x32x16_bf16 v[192:207], a[132:135], a[160:163], v[192:207]
ds_read_b64_tr_b16 a[160:161], v12 offset:28672
s_waitcnt lgkmcnt(15)
v_mfma_f32_32x32x16_bf16 a[32:47], a[148:151], a[128:131], a[32:47]
ds_read_b64_tr_b16 a[162:163], v12 offset:29696
v_mfma_f32_32x32x16_bf16 a[48:63], a[148:151], a[132:135], a[48:63]
ds_read_b64_tr_b16 a[148:149], v13 offset:20480
s_waitcnt lgkmcnt(15)
v_mfma_f32_32x32x16_bf16 v[144:159], a[128:131], a[164:167], v[144:159]
ds_read_b64_tr_b16 a[150:151], v13 offset:21504
v_mfma_f32_32x32x16_bf16 v[208:223], a[132:135], a[164:167], v[208:223]
ds_read_b64_tr_b16 a[164:165], v13 offset:28672
s_waitcnt lgkmcnt(15)
v_mfma_f32_32x32x16_bf16 a[64:79], a[152:155], a[128:131], a[64:79]
ds_read_b64_tr_b16 a[166:167], v13 offset:29696
v_mfma_f32_32x32x16_bf16 a[80:95], a[152:155], a[132:135], a[80:95]
ds_read_b64_tr_b16 a[152:153], v14 offset:20480
s_waitcnt lgkmcnt(15)
v_mfma_f32_32x32x16_bf16 v[160:175], a[128:131], a[168:171], v[160:175]
ds_read_b64_tr_b16 a[154:155], v14 offset:21504
v_mfma_f32_32x32x16_bf16 v[224:239], a[132:135], a[168:171], v[224:239]
ds_read_b64_tr_b16 a[168:169], v14 offset:28672
s_waitcnt lgkmcnt(15)
v_mfma_f32_32x32x16_bf16 a[96:111], a[156:159], a[128:131], a[96:111]
ds_read_b64_tr_b16 a[170:171], v14 offset:29696
v_mfma_f32_32x32x16_bf16 a[112:127], a[156:159], a[132:135], a[112:127]
ds_read_b64_tr_b16 a[156:157], v15 offset:20480
s_waitcnt lgkmcnt(15)
v_mfma_f32_32x32x16_bf16 v[176:191], a[128:131], a[172:175], v[176:191]
ds_read_b64_tr_b16 a[158:159], v15 offset:21504
v_mfma_f32_32x32x16_bf16 v[240:255], a[132:135], a[172:175], v[240:255]
ds_read_b64_tr_b16 a[172:173], v15 offset:28672
s_waitcnt lgkmcnt(13)
v_mfma_f32_32x32x16_bf16 a[0:15], a[144:147], a[136:139], a[0:15]
ds_read_b64_tr_b16 a[174:175], v15 offset:29696
s_waitcnt vmcnt(12)
s_barrier
s_waitcnt vmcnt(4)
ds_read_b128 a[128:131], v8 offset:8192
v_mfma_f32_32x32x16_bf16 a[16:31], a[144:147], a[140:143], a[16:31]
ds_read_b128 a[132:135], v8 offset:12288
ds_read_b64_tr_b16 a[144:145], v12 offset:32768
s_add_u32 m0, s46, 65536
s_mov_b32 s44, 3145728
s_waitcnt lgkmcnt(15)
v_mfma_f32_32x32x16_bf16 v[128:143], a[136:139], a[160:163], v[128:143]
ds_read_b64_tr_b16 a[146:147], v12 offset:33792
v_mfma_f32_32x32x16_bf16 v[192:207], a[140:143], a[160:163], v[192:207]
ds_read_b64_tr_b16 a[160:161], v12 offset:40960
buffer_load_dwordx4 v6, s[8:11], s44 offen offset:0 lds
s_waitcnt lgkmcnt(15)
v_mfma_f32_32x32x16_bf16 a[32:47], a[148:151], a[136:139], a[32:47]
ds_read_b64_tr_b16 a[162:163], v12 offset:41984
v_mfma_f32_32x32x16_bf16 a[48:63], a[148:151], a[140:143], a[48:63]
ds_read_b64_tr_b16 a[148:149], v13 offset:32768
buffer_load_dwordx4 v7, s[8:11], s44 offen offset:1024 lds
s_waitcnt lgkmcnt(15)
v_mfma_f32_32x32x16_bf16 v[144:159], a[136:139], a[164:167], v[144:159]
ds_read_b64_tr_b16 a[150:151], v13 offset:33792
v_mfma_f32_32x32x16_bf16 v[208:223], a[140:143], a[164:167], v[208:223]
ds_read_b64_tr_b16 a[164:165], v13 offset:40960
s_add_u32 m0, s46, 73728
s_nop 0
s_waitcnt lgkmcnt(15)
v_mfma_f32_32x32x16_bf16 a[64:79], a[152:155], a[136:139], a[64:79]
ds_read_b64_tr_b16 a[166:167], v13 offset:41984
v_mfma_f32_32x32x16_bf16 a[80:95], a[152:155], a[140:143], a[80:95]
ds_read_b64_tr_b16 a[152:153], v14 offset:32768
buffer_load_dwordx4 v6, s[12:15], s44 offen offset:0 lds
s_waitcnt lgkmcnt(15)
v_mfma_f32_32x32x16_bf16 v[160:175], a[136:139], a[168:171], v[160:175]
ds_read_b64_tr_b16 a[154:155], v14 offset:33792
v_mfma_f32_32x32x16_bf16 v[224:239], a[140:143], a[168:171], v[224:239]
ds_read_b64_tr_b16 a[168:169], v14 offset:40960
buffer_load_dwordx4 v7, s[12:15], s44 offen offset:1024 lds
s_waitcnt lgkmcnt(15)
v_mfma_f32_32x32x16_bf16 a[96:111], a[156:159], a[136:139], a[96:111]
ds_read_b64_tr_b16 a[170:171], v14 offset:41984
v_mfma_f32_32x32x16_bf16 a[112:127], a[156:159], a[140:143], a[112:127]
ds_read_b64_tr_b16 a[156:157], v15 offset:32768
s_waitcnt lgkmcnt(15)
v_mfma_f32_32x32x16_bf16 v[176:191], a[136:139], a[172:175], v[176:191]
ds_read_b64_tr_b16 a[158:159], v15 offset:33792
v_mfma_f32_32x32x16_bf16 v[240:255], a[140:143], a[172:175], v[240:255]
ds_read_b64_tr_b16 a[172:173], v15 offset:40960
s_waitcnt lgkmcnt(13)
v_mfma_f32_32x32x16_bf16 a[0:15], a[144:147], a[128:131], a[0:15]
ds_read_b64_tr_b16 a[174:175], v15 offset:41984
ds_read_b128 a[136:139], v9 offset:8192
v_mfma_f32_32x32x16_bf16 a[16:31], a[144:147], a[132:135], a[16:31]
ds_read_b128 a[140:143], v9 offset:12288
ds_read_b64_tr_b16 a[144:145], v12 offset:36864
s_add_u32 m0, s3, 0
s_add_u32 s43, s53, 768
s_waitcnt lgkmcnt(15)
v_mfma_f32_32x32x16_bf16 v[128:143], a[128:131], a[160:163], v[128:143]
ds_read_b64_tr_b16 a[146:147], v12 offset:37888
v_mfma_f32_32x32x16_bf16 v[192:207], a[132:135], a[160:163], v[192:207]
ds_read_b64_tr_b16 a[160:161], v12 offset:45056
buffer_load_dwordx4 v2, s[4:7], s43 offen offset:0 lds
s_cmp_lg_u32 s38, 0
s_cbranch_scc1 L_w0_4
v_readfirstlane_b32 s71, v63
s_cmp_lg_u32 s71, 0
s_cbranch_scc1 L_ngok_6
v_mov_b32 v62, 0
L_ng_5:
buffer_load_dword v63, v62, s[32:35], 0 offen sc1
s_waitcnt vmcnt(0)
v_readfirstlane_b32 s71, v63
s_cmp_eq_u32 s71, 0
s_cbranch_scc1 L_ng_5
L_ngok_6:
s_getreg_b32 s61, hwreg(HW_REG_XCC_ID, 0, 4)
s_lshl_b32 s41, s36, 3
s_add_u32 s41, s41, s37
s_lshl_b32 s41, s41, 7
s_add_u32 s41, s41, 0x3908000
v_mov_b32 v60, s71
v_mov_b32 v61, s61
v_mov_b32 v62, s41
s_mov_b64 s[64:65], exec
s_mov_b64 exec, 1
buffer_store_dwordx2 v[60:61], v62, s[16:19], 0 offen sc1
s_mov_b64 exec, s[64:65]
L_w0_4:
s_waitcnt lgkmcnt(15)
v_mfma_f32_32x32x16_bf16 a[32:47], a[148:151], a[128:131], a[32:47]
ds_read_b64_tr_b16 a[162:163], v12 offset:46080
v_mfma_f32_32x32x16_bf16 a[48:63], a[148:151], a[132:135], a[48:63]
ds_read_b64_tr_b16 a[148:149], v13 offset:36864
buffer_load_dwordx4 v3, s[4:7], s43 offen offset:1024 lds
s_waitcnt lgkmcnt(15)
v_mfma_f32_32x32x16_bf16 v[144:159], a[128:131], a[164:167], v[144:159]
ds_read_b64_tr_b16 a[150:151], v13 offset:37888
v_mfma_f32_32x32x16_bf16 v[208:223], a[132:135], a[164:167], v[208:223]
ds_read_b64_tr_b16 a[164:165], v13 offset:45056
buffer_load_dwordx4 v4, s[4:7], s43 offen offset:2048 lds
s_waitcnt lgkmcnt(15)
v_mfma_f32_32x32x16_bf16 a[64:79], a[152:155], a[128:131], a[64:79]
ds_read_b64_tr_b16 a[166:167], v13 offset:46080
v_mfma_f32_32x32x16_bf16 a[80:95], a[152:155], a[132:135], a[80:95]
ds_read_b64_tr_b16 a[152:153], v14 offset:36864
buffer_load_dwordx4 v5, s[4:7], s43 offen offset:3072 lds
s_waitcnt lgkmcnt(15)
v_mfma_f32_32x32x16_bf16 v[160:175], a[128:131], a[168:171], v[160:175]
ds_read_b64_tr_b16 a[154:155], v14 offset:37888
v_mfma_f32_32x32x16_bf16 v[224:239], a[132:135], a[168:171], v[224:239]
ds_read_b64_tr_b16 a[168:169], v14 offset:45056
s_add_u32 m0, s3, 4096
s_add_u32 s43, s53, 33536
s_waitcnt lgkmcnt(15)
v_mfma_f32_32x32x16_bf16 a[96:111], a[156:159], a[128:131], a[96:111]
ds_read_b64_tr_b16 a[170:171], v14 offset:46080
v_mfma_f32_32x32x16_bf16 a[112:127], a[156:159], a[132:135], a[112:127]
ds_read_b64_tr_b16 a[156:157], v15 offset:36864
buffer_load_dwordx4 v2, s[4:7], s43 offen offset:0 lds
s_waitcnt lgkmcnt(15)
v_mfma_f32_32x32x16_bf16 v[176:191], a[128:131], a[172:175], v[176:191]
ds_read_b64_tr_b16 a[158:159], v15 offset:37888
v_mfma_f32_32x32x16_bf16 v[240:255], a[132:135], a[172:175], v[240:255]
ds_read_b64_tr_b16 a[172:173], v15 offset:45056
buffer_load_dwordx4 v3, s[4:7], s43 offen offset:1024 lds
s_waitcnt lgkmcnt(13)
v_mfma_f32_32x32x16_bf16 a[0:15], a[144:147], a[136:139], a[0:15]
ds_read_b64_tr_b16 a[174:175], v15 offset:46080
s_waitcnt vmcnt(10)
s_barrier
ds_read_b128 a[128:131], v10 offset:8192
v_mfma_f32_32x32x16_bf16 a[16:31], a[144:147], a[140:143], a[16:31]
ds_read_b128 a[132:135], v10 offset:12288
ds_read_b64_tr_b16 a[144:145], v12 offset:49152
buffer_load_dwordx4 v4, s[4:7], s43 offen offset:2048 lds
s_waitcnt lgkmcnt(15)
v_mfma_f32_32x32x16_bf16 v[128:143], a[136:139], a[160:163], v[128:143]
ds_read_b64_tr_b16 a[146:147], v12 offset:50176
v_mfma_f32_32x32x16_bf16 v[192:207], a[140:143], a[160:163], v[192:207]
ds_read_b64_tr_b16 a[160:161], v12 offset:57344
buffer_load_dwordx4 v5, s[4:7], s43 offen offset:3072 lds
s_waitcnt lgkmcnt(15)
v_mfma_f32_32x32x16_bf16 a[32:47], a[148:151], a[136:139], a[32:47]
ds_read_b64_tr_b16 a[162:163], v12 offset:58368
v_mfma_f32_32x32x16_bf16 a[48:63], a[148:151], a[140:143], a[48:63]
ds_read_b64_tr_b16 a[148:149], v13 offset:49152
s_add_u32 m0, s46, 81920
s_mov_b32 s44, 3407872
s_waitcnt lgkmcnt(15)
v_mfma_f32_32x32x16_bf16 v[144:159], a[136:139], a[164:167], v[144:159]
ds_read_b64_tr_b16 a[150:151], v13 offset:50176
v_mfma_f32_32x32x16_bf16 v[208:223], a[140:143], a[164:167], v[208:223]
ds_read_b64_tr_b16 a[164:165], v13 offset:57344
buffer_load_dwordx4 v6, s[8:11], s44 offen offset:0 lds
s_waitcnt lgkmcnt(15)
v_mfma_f32_32x32x16_bf16 a[64:79], a[152:155], a[136:139], a[64:79]
ds_read_b64_tr_b16 a[166:167], v13 offset:58368
v_mfma_f32_32x32x16_bf16 a[80:95], a[152:155], a[140:143], a[80:95]
ds_read_b64_tr_b16 a[152:153], v14 offset:49152
buffer_load_dwordx4 v7, s[8:11], s44 offen offset:1024 lds
s_waitcnt lgkmcnt(15)
v_mfma_f32_32x32x16_bf16 v[160:175], a[136:139], a[168:171], v[160:175]
ds_read_b64_tr_b16 a[154:155], v14 offset:50176
v_mfma_f32_32x32x16_bf16 v[224:239], a[140:143], a[168:171], v[224:239]
ds_read_b64_tr_b16 a[168:169], v14 offset:57344
s_add_u32 m0, s46, 90112
s_nop 0
s_waitcnt lgkmcnt(15)
v_mfma_f32_32x32x16_bf16 a[96:111], a[156:159], a[136:139], a[96:111]
ds_read_b64_tr_b16 a[170:171], v14 offset:58368
v_mfma_f32_32x32x16_bf16 a[112:127], a[156:159], a[140:143], a[112:127]
ds_read_b64_tr_b16 a[156:157], v15 offset:49152
buffer_load_dwordx4 v6, s[12:15], s44 offen offset:0 lds
s_waitcnt lgkmcnt(15)
v_mfma_f32_32x32x16_bf16 v[176:191], a[136:139], a[172:175], v[176:191]
ds_read_b64_tr_b16 a[158:159], v15 offset:50176
v_mfma_f32_32x32x16_bf16 v[240:255], a[140:143], a[172:175], v[240:255]
ds_read_b64_tr_b16 a[172:173], v15 offset:57344
buffer_load_dwordx4 v7, s[12:15], s44 offen offset:1024 lds
s_waitcnt lgkmcnt(13)
v_mfma_f32_32x32x16_bf16 a[0:15], a[144:147], a[128:131], a[0:15]
ds_read_b64_tr_b16 a[174:175], v15 offset:58368
ds_read_b128 a[136:139], v11 offset:8192
v_mfma_f32_32x32x16_bf16 a[16:31], a[144:147], a[132:135], a[16:31]
ds_read_b128 a[140:143], v11 offset:12288
ds_read_b64_tr_b16 a[144:145], v12 offset:53248
s_waitcnt lgkmcnt(15)
v_mfma_f32_32x32x16_bf16 v[128:143], a[128:131], a[160:163], v[128:143]
ds_read_b64_tr_b16 a[146:147], v12 offset:54272
v_mfma_f32_32x32x16_bf16 v[192:207], a[132:135], a[160:163], v[192:207]
ds_read_b64_tr_b16 a[160:161], v12 offset:61440
s_waitcnt lgkmcnt(15)
v_mfma_f32_32x32x16_bf16 a[32:47], a[148:151], a[128:131], a[32:47]
ds_read_b64_tr_b16 a[162:163], v12 offset:62464
v_mfma_f32_32x32x16_bf16 a[48:63], a[148:151], a[132:135], a[48:63]
ds_read_b64_tr_b16 a[148:149], v13 offset:53248
s_waitcnt lgkmcnt(15)
v_mfma_f32_32x32x16_bf16 v[144:159], a[128:131], a[164:167], v[144:159]
ds_read_b64_tr_b16 a[150:151], v13 offset:54272
v_mfma_f32_32x32x16_bf16 v[208:223], a[132:135], a[164:167], v[208:223]
ds_read_b64_tr_b16 a[164:165], v13 offset:61440
s_waitcnt lgkmcnt(15)
v_mfma_f32_32x32x16_bf16 a[64:79], a[152:155], a[128:131], a[64:79]
ds_read_b64_tr_b16 a[166:167], v13 offset:62464
v_mfma_f32_32x32x16_bf16 a[80:95], a[152:155], a[132:135], a[80:95]
ds_read_b64_tr_b16 a[152:153], v14 offset:53248
s_waitcnt lgkmcnt(15)
v_mfma_f32_32x32x16_bf16 v[160:175], a[128:131], a[168:171], v[160:175]
ds_read_b64_tr_b16 a[154:155], v14 offset:54272
v_mfma_f32_32x32x16_bf16 v[224:239], a[132:135], a[168:171], v[224:239]
ds_read_b64_tr_b16 a[168:169], v14 offset:61440
s_waitcnt lgkmcnt(15)
v_mfma_f32_32x32x16_bf16 a[96:111], a[156:159], a[128:131], a[96:111]
ds_read_b64_tr_b16 a[170:171], v14 offset:62464
v_mfma_f32_32x32x16_bf16 a[112:127], a[156:159], a[132:135], a[112:127]
ds_read_b64_tr_b16 a[156:157], v15 offset:53248
s_waitcnt lgkmcnt(15)
v_mfma_f32_32x32x16_bf16 v[176:191], a[128:131], a[172:175], v[176:191]
ds_read_b64_tr_b16 a[158:159], v15 offset:54272
v_mfma_f32_32x32x16_bf16 v[240:255], a[132:135], a[172:175], v[240:255]
ds_read_b64_tr_b16 a[172:173], v15 offset:61440
s_waitcnt lgkmcnt(13)
v_mfma_f32_32x32x16_bf16 a[0:15], a[144:147], a[136:139], a[0:15]
ds_read_b64_tr_b16 a[174:175], v15 offset:62464
s_waitcnt vmcnt(12)
s_barrier
s_waitcnt vmcnt(4)
ds_read_b128 a[128:131], v8 offset:0
v_mfma_f32_32x32x16_bf16 a[16:31], a[144:147], a[140:143], a[16:31]
ds_read_b128 a[132:135], v8 offset:4096
ds_read_b64_tr_b16 a[144:145], v12 offset:0
s_add_u32 m0, s46, 98304
s_mov_b32 s44, 3670016
s_waitcnt lgkmcnt(15)
v_mfma_f32_32x32x16_bf16 v[128:143], a[136:139], a[160:163], v[128:143]
ds_read_b64_tr_b16 a[146:147], v12 offset:1024
v_mfma_f32_32x32x16_bf16 v[192:207], a[140:143], a[160:163], v[192:207]
ds_read_b64_tr_b16 a[160:161], v12 offset:8192
buffer_load_dwordx4 v6, s[8:11], s44 offen offset:0 lds
s_waitcnt lgkmcnt(15)
v_mfma_f32_32x32x16_bf16 a[32:47], a[148:151], a[136:139], a[32:47]
ds_read_b64_tr_b16 a[162:163], v12 offset:9216
v_mfma_f32_32x32x16_bf16 a[48:63], a[148:151], a[140:143], a[48:63]
ds_read_b64_tr_b16 a[148:149], v13 offset:0
buffer_load_dwordx4 v7, s[8:11], s44 offen offset:1024 lds
s_waitcnt lgkmcnt(15)
v_mfma_f32_32x32x16_bf16 v[144:159], a[136:139], a[164:167], v[144:159]
ds_read_b64_tr_b16 a[150:151], v13 offset:1024
v_mfma_f32_32x32x16_bf16 v[208:223], a[140:143], a[164:167], v[208:223]
ds_read_b64_tr_b16 a[164:165], v13 offset:8192
s_add_u32 m0, s46, 106496
s_nop 0
s_waitcnt lgkmcnt(15)
v_mfma_f32_32x32x16_bf16 a[64:79], a[152:155], a[136:139], a[64:79]
ds_read_b64_tr_b16 a[166:167], v13 offset:9216
v_mfma_f32_32x32x16_bf16 a[80:95], a[152:155], a[140:143], a[80:95]
ds_read_b64_tr_b16 a[152:153], v14 offset:0
buffer_load_dwordx4 v6, s[12:15], s44 offen offset:0 lds
s_waitcnt lgkmcnt(15)
v_mfma_f32_32x32x16_bf16 v[160:175], a[136:139], a[168:171], v[160:175]
ds_read_b64_tr_b16 a[154:155], v14 offset:1024
v_mfma_f32_32x32x16_bf16 v[224:239], a[140:143], a[168:171], v[224:239]
ds_read_b64_tr_b16 a[168:169], v14 offset:8192
buffer_load_dwordx4 v7, s[12:15], s44 offen offset:1024 lds
s_waitcnt lgkmcnt(15)
v_mfma_f32_32x32x16_bf16 a[96:111], a[156:159], a[136:139], a[96:111]
ds_read_b64_tr_b16 a[170:171], v14 offset:9216
v_mfma_f32_32x32x16_bf16 a[112:127], a[156:159], a[140:143], a[112:127]
ds_read_b64_tr_b16 a[156:157], v15 offset:0
s_waitcnt lgkmcnt(15)
v_mfma_f32_32x32x16_bf16 v[176:191], a[136:139], a[172:175], v[176:191]
ds_read_b64_tr_b16 a[158:159], v15 offset:1024
v_mfma_f32_32x32x16_bf16 v[240:255], a[140:143], a[172:175], v[240:255]
ds_read_b64_tr_b16 a[172:173], v15 offset:8192
s_waitcnt lgkmcnt(13)
v_mfma_f32_32x32x16_bf16 a[0:15], a[144:147], a[128:131], a[0:15]
ds_read_b64_tr_b16 a[174:175], v15 offset:9216
ds_read_b128 a[136:139], v9 offset:0
v_mfma_f32_32x32x16_bf16 a[16:31], a[144:147], a[132:135], a[16:31]
ds_read_b128 a[140:143], v9 offset:4096
ds_read_b64_tr_b16 a[144:145], v12 offset:4096
s_add_u32 m0, s3, 8192
s_add_u32 s43, s53, 896
s_waitcnt lgkmcnt(15)
v_mfma_f32_32x32x16_bf16 v[128:143], a[128:131], a[160:163], v[128:143]
ds_read_b64_tr_b16 a[146:147], v12 offset:5120
v_mfma_f32_32x32x16_bf16 v[192:207], a[132:135], a[160:163], v[192:207]
ds_read_b64_tr_b16 a[160:161], v12 offset:12288
buffer_load_dwordx4 v2, s[4:7], s43 offen offset:0 lds
s_waitcnt lgkmcnt(15)
v_mfma_f32_32x32x16_bf16 a[32:47], a[148:151], a[128:131], a[32:47]
ds_read_b64_tr_b16 a[162:163], v12 offset:13312
v_mfma_f32_32x32x16_bf16 a[48:63], a[148:151], a[132:135], a[48:63]
ds_read_b64_tr_b16 a[148:149], v13 offset:4096
buffer_load_dwordx4 v3, s[4:7], s43 offen offset:1024 lds
s_waitcnt lgkmcnt(15)
v_mfma_f32_32x32x16_bf16 v[144:159], a[128:131], a[164:167], v[144:159]
ds_read_b64_tr_b16 a[150:151], v13 offset:5120
v_mfma_f32_32x32x16_bf16 v[208:223], a[132:135], a[164:167], v[208:223]
ds_read_b64_tr_b16 a[164:165], v13 offset:12288
buffer_load_dwordx4 v4, s[4:7], s43 offen offset:2048 lds
s_waitcnt lgkmcnt(15)
v_mfma_f32_32x32x16_bf16 a[64:79], a[152:155], a[128:131], a[64:79]
ds_read_b64_tr_b16 a[166:167], v13 offset:13312
v_mfma_f32_32x32x16_bf16 a[80:95], a[152:155], a[132:135], a[80:95]
ds_read_b64_tr_b16 a[152:153], v14 offset:4096
buffer_load_dwordx4 v5, s[4:7], s43 offen offset:3072 lds
s_waitcnt lgkmcnt(15)
v_mfma_f32_32x32x16_bf16 v[160:175], a[128:131], a[168:171], v[160:175]
ds_read_b64_tr_b16 a[154:155], v14 offset:5120
v_mfma_f32_32x32x16_bf16 v[224:239], a[132:135], a[168:171], v[224:239]
ds_read_b64_tr_b16 a[168:169], v14 offset:12288
s_add_u32 m0, s3, 12288
s_add_u32 s43, s53, 33664
s_waitcnt lgkmcnt(15)
v_mfma_f32_32x32x16_bf16 a[96:111], a[156:159], a[128:131], a[96:111]
ds_read_b64_tr_b16 a[170:171], v14 offset:13312
v_mfma_f32_32x32x16_bf16 a[112:127], a[156:159], a[132:135], a[112:127]
ds_read_b64_tr_b16 a[156:157], v15 offset:4096
buffer_load_dwordx4 v2, s[4:7], s43 offen offset:0 lds
s_waitcnt lgkmcnt(15)
v_mfma_f32_32x32x16_bf16 v[176:191], a[128:131], a[172:175], v[176:191]
ds_read_b64_tr_b16 a[158:159], v15 offset:5120
v_mfma_f32_32x32x16_bf16 v[240:255], a[132:135], a[172:175], v[240:255]
ds_read_b64_tr_b16 a[172:173], v15 offset:12288
buffer_load_dwordx4 v3, s[4:7], s43 offen offset:1024 lds
s_waitcnt lgkmcnt(13)
v_mfma_f32_32x32x16_bf16 a[0:15], a[144:147], a[136:139], a[0:15]
ds_read_b64_tr_b16 a[174:175], v15 offset:13312
s_waitcnt vmcnt(10)
s_barrier
ds_read_b128 a[128:131], v10 offset:0
v_mfma_f32_32x32x16_bf16 a[16:31], a[144:147], a[140:143], a[16:31]
ds_read_b128 a[132:135], v10 offset:4096
ds_read_b64_tr_b16 a[144:145], v12 offset:16384
buffer_load_dwordx4 v4, s[4:7], s43 offen offset:2048 lds
s_mov_b32 s72, s86
s_waitcnt lgkmcnt(15)
v_mfma_f32_32x32x16_bf16 v[128:143], a[136:139], a[160:163], v[128:143]
ds_read_b64_tr_b16 a[146:147], v12 offset:17408
s_mov_b32 s73, s87
v_mfma_f32_32x32x16_bf16 v[192:207], a[140:143], a[160:163], v[192:207]
ds_read_b64_tr_b16 a[160:161], v12 offset:24576
buffer_load_dwordx4 v5, s[4:7], s43 offen offset:3072 lds
s_mov_b32 s74, 4194304
s_waitcnt lgkmcnt(15)
v_mfma_f32_32x32x16_bf16 a[32:47], a[148:151], a[136:139], a[32:47]
ds_read_b64_tr_b16 a[162:163], v12 offset:25600
s_mov_b32 s75, 0x20000
v_mfma_f32_32x32x16_bf16 a[48:63], a[148:151], a[140:143], a[48:63]
ds_read_b64_tr_b16 a[148:149], v13 offset:16384
s_add_u32 m0, s46, 114688
s_mov_b32 s44, 3932160
s_waitcnt lgkmcnt(15)
v_mfma_f32_32x32x16_bf16 v[144:159], a[136:139], a[164:167], v[144:159]
ds_read_b64_tr_b16 a[150:151], v13 offset:17408
s_mul_i32 s77, s76, 4096
v_mfma_f32_32x32x16_bf16 v[208:223], a[140:143], a[164:167], v[208:223]
ds_read_b64_tr_b16 a[164:165], v13 offset:24576
buffer_load_dwordx4 v6, s[8:11], s44 offen offset:0 lds
buffer_load_dwordx4 v[52:55], v49, s[72:75], s77 offen offset:0
s_waitcnt lgkmcnt(15)
v_mfma_f32_32x32x16_bf16 a[64:79], a[152:155], a[136:139], a[64:79]
ds_read_b64_tr_b16 a[166:167], v13 offset:25600
buffer_load_dwordx4 v[52:55], v49, s[72:75], s77 offen offset:1024
v_mfma_f32_32x32x16_bf16 a[80:95], a[152:155], a[140:143], a[80:95]
ds_read_b64_tr_b16 a[152:153], v14 offset:16384
buffer_load_dwordx4 v7, s[8:11], s44 offen offset:1024 lds
buffer_load_dwordx4 v[52:55], v49, s[72:75], s77 offen offset:2048
s_waitcnt lgkmcnt(15)
v_mfma_f32_32x32x16_bf16 v[160:175], a[136:139], a[168:171], v[160:175]
ds_read_b64_tr_b16 a[154:155], v14 offset:17408
buffer_load_dwordx4 v[52:55], v49, s[72:75], s77 offen offset:3072
v_mfma_f32_32x32x16_bf16 v[224:239], a[140:143], a[168:171], v[224:239]
ds_read_b64_tr_b16 a[168:169], v14 offset:24576
s_add_u32 m0, s46, 122880
s_nop 0
s_waitcnt lgkmcnt(15)
v_mfma_f32_32x32x16_bf16 a[96:111], a[156:159], a[136:139], a[96:111]
ds_read_b64_tr_b16 a[170:171], v14 offset:25600
s_mov_b32 s72, s88
v_mfma_f32_32x32x16_bf16 a[112:127], a[156:159], a[140:143], a[112:127]
ds_read_b64_tr_b16 a[156:157], v15 offset:16384
buffer_load_dwordx4 v6, s[12:15], s44 offen offset:0 lds
s_mov_b32 s73, s89
s_waitcnt lgkmcnt(15)
v_mfma_f32_32x32x16_bf16 v[176:191], a[136:139], a[172:175], v[176:191]
ds_read_b64_tr_b16 a[158:159], v15 offset:17408
s_mov_b32 s74, 1409024
v_mfma_f32_32x32x16_bf16 v[240:255], a[140:143], a[172:175], v[240:255]
ds_read_b64_tr_b16 a[172:173], v15 offset:24576
buffer_load_dwordx4 v7, s[12:15], s44 offen offset:1024 lds
s_mov_b32 s75, 0x20000
s_waitcnt lgkmcnt(13)
v_mfma_f32_32x32x16_bf16 a[0:15], a[144:147], a[128:131], a[0:15]
ds_read_b64_tr_b16 a[174:175], v15 offset:25600
ds_read_b128 a[136:139], v11 offset:0
v_mfma_f32_32x32x16_bf16 a[16:31], a[144:147], a[132:135], a[16:31]
ds_read_b128 a[140:143], v11 offset:4096
ds_read_b64_tr_b16 a[144:145], v12 offset:20480
s_mul_i32 s77, s76, 2048
s_waitcnt lgkmcnt(15)
v_mfma_f32_32x32x16_bf16 v[128:143], a[128:131], a[160:163], v[128:143]
ds_read_b64_tr_b16 a[146:147], v12 offset:21504
buffer_load_dwordx4 v[52:55], v49, s[72:75], s77 offen offset:0
v_mfma_f32_32x32x16_bf16 v[192:207], a[132:135], a[160:163], v[192:207]
ds_read_b64_tr_b16 a[160:161], v12 offset:28672
buffer_load_dwordx4 v[52:55], v49, s[72:75], s77 offen offset:1024
s_lshl_b32 s41, s36, 3
v_add_u32 v60, s41, v1
s_lshl_b32 s41, s37, 4
s_sub_u32 s42, s41, 8
v_add_u32 v61, s42, v1
s_sub_u32 s42, 216, s41
v_add_u32 v62, s42, v1
v_cmp_gt_u32 vcc, 8, v1
s_nop 1
v_cndmask_b32 v61, v61, v60, vcc
v_cmp_gt_u32 vcc, 24, v1
s_nop 1
v_cndmask_b32 v61, v62, v61, vcc
v_lshlrev_b32 v61, 7, v61
v_add_u32 v59, 0x3908000, v61
s_cmp_lg_u32 s38, 0
s_cbranch_scc1 L_w0_7
s_mov_b64 s[64:65], exec
s_mov_b32 exec_lo, -1
s_mov_b32 exec_hi, 0xff
buffer_load_dwordx2 v[60:61], v59, s[16:19], 0 offen sc1
s_mov_b64 exec, s[64:65]
L_w0_7:
s_waitcnt lgkmcnt(15)
v_mfma_f32_32x32x16_bf16 a[32:47], a[148:151], a[128:131], a[32:47]
ds_read_b64_tr_b16 a[162:163], v12 offset:29696
v_mfma_f32_32x32x16_bf16 a[48:63], a[148:151], a[132:135], a[48:63]
ds_read_b64_tr_b16 a[148:149], v13 offset:20480
s_waitcnt lgkmcnt(15)
v_mfma_f32_32x32x16_bf16 v[144:159], a[128:131], a[164:167], v[144:159]
ds_read_b64_tr_b16 a[150:151], v13 offset:21504
v_mfma_f32_32x32x16_bf16 v[208:223], a[132:135], a[164:167], v[208:223]
ds_read_b64_tr_b16 a[164:165], v13 offset:28672
s_waitcnt lgkmcnt(15)
v_mfma_f32_32x32x16_bf16 a[64:79], a[152:155], a[128:131], a[64:79]
ds_read_b64_tr_b16 a[166:167], v13 offset:29696
v_mfma_f32_32x32x16_bf16 a[80:95], a[152:155], a[132:135], a[80:95]
ds_read_b64_tr_b16 a[152:153], v14 offset:20480
s_waitcnt lgkmcnt(15)
v_mfma_f32_32x32x16_bf16 v[160:175], a[128:131], a[168:171], v[160:175]
ds_read_b64_tr_b16 a[154:155], v14 offset:21504
v_mfma_f32_32x32x16_bf16 v[224:239], a[132:135], a[168:171], v[224:239]
ds_read_b64_tr_b16 a[168:169], v14 offset:28672
s_waitcnt lgkmcnt(15)
v_mfma_f32_32x32x16_bf16 a[96:111], a[156:159], a[128:131], a[96:111]
ds_read_b64_tr_b16 a[170:171], v14 offset:29696
v_mfma_f32_32x32x16_bf16 a[112:127], a[156:159], a[132:135], a[112:127]
ds_read_b64_tr_b16 a[156:157], v15 offset:20480
s_waitcnt lgkmcnt(15)
v_mfma_f32_32x32x16_bf16 v[176:191], a[128:131], a[172:175], v[176:191]
ds_read_b64_tr_b16 a[158:159], v15 offset:21504
v_mfma_f32_32x32x16_bf16 v[240:255], a[132:135], a[172:175], v[240:255]
ds_read_b64_tr_b16 a[172:173], v15 offset:28672
s_waitcnt lgkmcnt(13)
v_mfma_f32_32x32x16_bf16 a[0:15], a[144:147], a[136:139], a[0:15]
ds_read_b64_tr_b16 a[174:175], v15 offset:29696
s_waitcnt vmcnt(12)
s_barrier
s_waitcnt vmcnt(4)
ds_read_b128 a[128:131], v8 offset:8192
v_mfma_f32_32x32x16_bf16 a[16:31], a[144:147], a[140:143], a[16:31]
ds_read_b128 a[132:135], v8 offset:12288
ds_read_b64_tr_b16 a[144:145], v12 offset:32768
s_add_u32 m0, s46, 65536
s_mov_b32 s44, 0
s_waitcnt lgkmcnt(15)
v_mfma_f32_32x32x16_bf16 v[128:143], a[136:139], a[160:163], v[128:143]
ds_read_b64_tr_b16 a[146:147], v12 offset:33792
v_mfma_f32_32x32x16_bf16 v[192:207], a[140:143], a[160:163], v[192:207]
ds_read_b64_tr_b16 a[160:161], v12 offset:40960
buffer_load_dwordx4 v24, s[24:27], s44 offen offset:0 lds
s_waitcnt lgkmcnt(15)
v_mfma_f32_32x32x16_bf16 a[32:47], a[148:151], a[136:139], a[32:47]
ds_read_b64_tr_b16 a[162:163], v12 offset:41984
v_mfma_f32_32x32x16_bf16 a[48:63], a[148:151], a[140:143], a[48:63]
ds_read_b64_tr_b16 a[148:149], v13 offset:32768
buffer_load_dwordx4 v25, s[24:27], s44 offen offset:1024 lds
s_waitcnt lgkmcnt(15)
v_mfma_f32_32x32x16_bf16 v[144:159], a[136:139], a[164:167], v[144:159]
ds_read_b64_tr_b16 a[150:151], v13 offset:33792
v_mfma_f32_32x32x16_bf16 v[208:223], a[140:143], a[164:167], v[208:223]
ds_read_b64_tr_b16 a[164:165], v13 offset:40960
s_lshl_b32 s42, s38, 10
s_add_u32 m0, s42, 73728
s_mov_b32 s52, 0
s_waitcnt lgkmcnt(15)
v_mfma_f32_32x32x16_bf16 a[64:79], a[152:155], a[136:139], a[64:79]
ds_read_b64_tr_b16 a[166:167], v13 offset:41984
v_mfma_f32_32x32x16_bf16 a[80:95], a[152:155], a[140:143], a[80:95]
ds_read_b64_tr_b16 a[152:153], v14 offset:32768
buffer_load_dwordx4 v26, s[28:31], s52 offen lds
s_waitcnt lgkmcnt(15)
v_mfma_f32_32x32x16_bf16 v[160:175], a[136:139], a[168:171], v[160:175]
ds_read_b64_tr_b16 a[154:155], v14 offset:33792
v_mfma_f32_32x32x16_bf16 v[224:239], a[140:143], a[168:171], v[224:239]
ds_read_b64_tr_b16 a[168:169], v14 offset:40960
s_waitcnt lgkmcnt(15)
v_mfma_f32_32x32x16_bf16 a[96:111], a[156:159], a[136:139], a[96:111]
ds_read_b64_tr_b16 a[170:171], v14 offset:41984
v_mfma_f32_32x32x16_bf16 a[112:127], a[156:159], a[140:143], a[112:127]
ds_read_b64_tr_b16 a[156:157], v15 offset:32768
s_waitcnt lgkmcnt(15)
v_mfma_f32_32x32x16_bf16 v[176:191], a[136:139], a[172:175], v[176:191]
ds_read_b64_tr_b16 a[158:159], v15 offset:33792
v_mfma_f32_32x32x16_bf16 v[240:255], a[140:143], a[172:175], v[240:255]
ds_read_b64_tr_b16 a[172:173], v15 offset:40960
s_waitcnt lgkmcnt(13)
v_mfma_f32_32x32x16_bf16 a[0:15], a[144:147], a[128:131], a[0:15]
ds_read_b64_tr_b16 a[174:175], v15 offset:41984
ds_read_b128 a[136:139], v9 offset:8192
v_mfma_f32_32x32x16_bf16 a[16:31], a[144:147], a[132:135], a[16:31]
ds_read_b128 a[140:143], v9 offset:12288
ds_read_b64_tr_b16 a[144:145], v12 offset:36864
s_add_u32 m0, s3, 0
s_add_u32 s43, s54, 0
s_waitcnt lgkmcnt(15)
v_mfma_f32_32x32x16_bf16 v[128:143], a[128:131], a[160:163], v[128:143]
ds_read_b64_tr_b16 a[146:147], v12 offset:37888
v_mfma_f32_32x32x16_bf16 v[192:207], a[132:135], a[160:163], v[192:207]
ds_read_b64_tr_b16 a[160:161], v12 offset:45056
buffer_load_dwordx4 v20, s[20:23], s43 offen offset:0 lds
s_waitcnt lgkmcnt(15)
v_mfma_f32_32x32x16_bf16 a[32:47], a[148:151], a[128:131], a[32:47]
ds_read_b64_tr_b16 a[162:163], v12 offset:46080
v_mfma_f32_32x32x16_bf16 a[48:63], a[148:151], a[132:135], a[48:63]
ds_read_b64_tr_b16 a[148:149], v13 offset:36864
buffer_load_dwordx4 v21, s[20:23], s43 offen offset:1024 lds
s_waitcnt lgkmcnt(15)
v_mfma_f32_32x32x16_bf16 v[144:159], a[128:131], a[164:167], v[144:159]
ds_read_b64_tr_b16 a[150:151], v13 offset:37888
v_mfma_f32_32x32x16_bf16 v[208:223], a[132:135], a[164:167], v[208:223]
ds_read_b64_tr_b16 a[164:165], v13 offset:45056
buffer_load_dwordx4 v22, s[20:23], s43 offen offset:2048 lds
s_waitcnt lgkmcnt(15)
v_mfma_f32_32x32x16_bf16 a[64:79], a[152:155], a[128:131], a[64:79]
ds_read_b64_tr_b16 a[166:167], v13 offset:46080
v_mfma_f32_32x32x16_bf16 a[80:95], a[152:155], a[132:135], a[80:95]
ds_read_b64_tr_b16 a[152:153], v14 offset:36864
buffer_load_dwordx4 v23, s[20:23], s43 offen offset:3072 lds
s_waitcnt lgkmcnt(15)
v_mfma_f32_32x32x16_bf16 v[160:175], a[128:131], a[168:171], v[160:175]
ds_read_b64_tr_b16 a[154:155], v14 offset:37888
v_mfma_f32_32x32x16_bf16 v[224:239], a[132:135], a[168:171], v[224:239]
ds_read_b64_tr_b16 a[168:169], v14 offset:45056
s_add_u32 m0, s3, 4096
s_add_u32 s43, s55, 0
s_waitcnt lgkmcnt(15)
v_mfma_f32_32x32x16_bf16 a[96:111], a[156:159], a[128:131], a[96:111]
ds_read_b64_tr_b16 a[170:171], v14 offset:46080
v_mfma_f32_32x32x16_bf16 a[112:127], a[156:159], a[132:135], a[112:127]
ds_read_b64_tr_b16 a[156:157], v15 offset:36864
buffer_load_dwordx4 v20, s[20:23], s43 offen offset:0 lds
s_waitcnt lgkmcnt(15)
v_mfma_f32_32x32x16_bf16 v[176:191], a[128:131], a[172:175], v[176:191]
ds_read_b64_tr_b16 a[158:159], v15 offset:37888
v_mfma_f32_32x32x16_bf16 v[240:255], a[132:135], a[172:175], v[240:255]
ds_read_b64_tr_b16 a[172:173], v15 offset:45056
buffer_load_dwordx4 v21, s[20:23], s43 offen offset:1024 lds
s_waitcnt lgkmcnt(13)
v_mfma_f32_32x32x16_bf16 a[0:15], a[144:147], a[136:139], a[0:15]
ds_read_b64_tr_b16 a[174:175], v15 offset:46080
s_waitcnt vmcnt(9)
s_barrier
ds_read_b128 a[128:131], v10 offset:8192
v_mfma_f32_32x32x16_bf16 a[16:31], a[144:147], a[140:143], a[16:31]
ds_read_b128 a[132:135], v10 offset:12288
ds_read_b64_tr_b16 a[144:145], v12 offset:49152
buffer_load_dwordx4 v22, s[20:23], s43 offen offset:2048 lds
s_waitcnt lgkmcnt(15)
v_mfma_f32_32x32x16_bf16 v[128:143], a[136:139], a[160:163], v[128:143]
ds_read_b64_tr_b16 a[146:147], v12 offset:50176
v_mfma_f32_32x32x16_bf16 v[192:207], a[140:143], a[160:163], v[192:207]
ds_read_b64_tr_b16 a[160:161], v12 offset:57344
buffer_load_dwordx4 v23, s[20:23], s43 offen offset:3072 lds
s_waitcnt lgkmcnt(15)
v_mfma_f32_32x32x16_bf16 a[32:47], a[148:151], a[136:139], a[32:47]
ds_read_b64_tr_b16 a[162:163], v12 offset:58368
v_mfma_f32_32x32x16_bf16 a[48:63], a[148:151], a[140:143], a[48:63]
ds_read_b64_tr_b16 a[148:149], v13 offset:49152
s_add_u32 m0, s46, 81920
s_mov_b32 s44, 262144
s_waitcnt lgkmcnt(15)
v_mfma_f32_32x32x16_bf16 v[144:159], a[136:139], a[164:167], v[144:159]
ds_read_b64_tr_b16 a[150:151], v13 offset:50176
v_mfma_f32_32x32x16_bf16 v[208:223], a[140:143], a[164:167], v[208:223]
ds_read_b64_tr_b16 a[164:165], v13 offset:57344
buffer_load_dwordx4 v24, s[24:27], s44 offen offset:0 lds
s_waitcnt lgkmcnt(15)
v_mfma_f32_32x32x16_bf16 a[64:79], a[152:155], a[136:139], a[64:79]
ds_read_b64_tr_b16 a[166:167], v13 offset:58368
v_mfma_f32_32x32x16_bf16 a[80:95], a[152:155], a[140:143], a[80:95]
ds_read_b64_tr_b16 a[152:153], v14 offset:49152
buffer_load_dwordx4 v25, s[24:27], s44 offen offset:1024 lds
s_waitcnt lgkmcnt(15)
v_mfma_f32_32x32x16_bf16 v[160:175], a[136:139], a[168:171], v[160:175]
ds_read_b64_tr_b16 a[154:155], v14 offset:50176
v_mfma_f32_32x32x16_bf16 v[224:239], a[140:143], a[168:171], v[224:239]
ds_read_b64_tr_b16 a[168:169], v14 offset:57344
s_lshl_b32 s42, s38, 10
s_add_u32 m0, s42, 90112
s_mov_b32 s52, 88064
s_waitcnt lgkmcnt(15)
v_mfma_f32_32x32x16_bf16 a[96:111], a[156:159], a[136:139], a[96:111]
ds_read_b64_tr_b16 a[170:171], v14 offset:58368
v_mfma_f32_32x32x16_bf16 a[112:127], a[156:159], a[140:143], a[112:127]
ds_read_b64_tr_b16 a[156:157], v15 offset:49152
buffer_load_dwordx4 v26, s[28:31], s52 offen lds
s_waitcnt lgkmcnt(15)
v_mfma_f32_32x32x16_bf16 v[176:191], a[136:139], a[172:175], v[176:191]
ds_read_b64_tr_b16 a[158:159], v15 offset:50176
v_mfma_f32_32x32x16_bf16 v[240:255], a[140:143], a[172:175], v[240:255]
ds_read_b64_tr_b16 a[172:173], v15 offset:57344
s_waitcnt lgkmcnt(13)
v_mfma_f32_32x32x16_bf16 a[0:15], a[144:147], a[128:131], a[0:15]
ds_read_b64_tr_b16 a[174:175], v15 offset:58368
ds_read_b128 a[136:139], v11 offset:8192
v_mfma_f32_32x32x16_bf16 a[16:31], a[144:147], a[132:135], a[16:31]
ds_read_b128 a[140:143], v11 offset:12288
ds_read_b64_tr_b16 a[144:145], v12 offset:53248
s_waitcnt lgkmcnt(15)
v_mfma_f32_32x32x16_bf16 v[128:143], a[128:131], a[160:163], v[128:143]
ds_read_b64_tr_b16 a[146:147], v12 offset:54272
v_mfma_f32_32x32x16_bf16 v[192:207], a[132:135], a[160:163], v[192:207]
ds_read_b64_tr_b16 a[160:161], v12 offset:61440
s_cmp_lg_u32 s38, 0
s_cbranch_scc1 L_w0_8
v_cmp_eq_u32 s[64:65], s71, v60
v_cmp_eq_u32 vcc, s61, v61
s_nop 1
s_and_b32 s41, s64, vcc_lo
s_and_b32 s41, s41, 0xff
s_cmp_eq_u32 s41, 0xff
s_cselect_b32 s60, 1, 0
s_and_b32 s65, s65, 0xff
s_and_b32 s41, s64, s65
s_cmp_eq_u32 s64, -1
s_cselect_b32 s41, s65, 0
s_cmp_eq_u32 s41, 0xff
s_cbranch_scc1 L_stat_ok_9
s_mov_b64 s[64:65], exec
s_mov_b32 exec_lo, 0xffffffff
s_mov_b32 exec_hi, 0xff
L_poll_10:
buffer_load_dword v62, v59, s[16:19], 0 offen sc1
s_waitcnt vmcnt(0)
v_cmp_eq_u32 vcc, s71, v62
s_nop 1
s_cmp_eq_u64 vcc, exec
s_cbranch_scc0 L_poll_10
s_mov_b64 exec, s[64:65]
L_stat_ok_9:
L_w0_8:
s_waitcnt lgkmcnt(15)
v_mfma_f32_32x32x16_bf16 a[32:47], a[148:151], a[128:131], a[32:47]
ds_read_b64_tr_b16 a[162:163], v12 offset:62464
v_mfma_f32_32x32x16_bf16 a[48:63], a[148:151], a[132:135], a[48:63]
ds_read_b64_tr_b16 a[148:149], v13 offset:53248
s_waitcnt lgkmcnt(15)
v_mfma_f32_32x32x16_bf16 v[144:159], a[128:131], a[164:167], v[144:159]
ds_read_b64_tr_b16 a[150:151], v13 offset:54272
v_mfma_f32_32x32x16_bf16 v[208:223], a[132:135], a[164:167], v[208:223]
ds_read_b64_tr_b16 a[164:165], v13 offset:61440
s_waitcnt lgkmcnt(15)
v_mfma_f32_32x32x16_bf16 a[64:79], a[152:155], a[128:131], a[64:79]
ds_read_b64_tr_b16 a[166:167], v13 offset:62464
v_mfma_f32_32x32x16_bf16 a[80:95], a[152:155], a[132:135], a[80:95]
ds_read_b64_tr_b16 a[152:153], v14 offset:53248
s_waitcnt lgkmcnt(15)
v_mfma_f32_32x32x16_bf16 v[160:175], a[128:131], a[168:171], v[160:175]
ds_read_b64_tr_b16 a[154:155], v14 offset:54272
v_mfma_f32_32x32x16_bf16 v[224:239], a[132:135], a[168:171], v[224:239]
ds_read_b64_tr_b16 a[168:169], v14 offset:61440
s_waitcnt lgkmcnt(15)
v_mfma_f32_32x32x16_bf16 a[96:111], a[156:159], a[128:131], a[96:111]
ds_read_b64_tr_b16 a[170:171], v14 offset:62464
v_mfma_f32_32x32x16_bf16 a[112:127], a[156:159], a[132:135], a[112:127]
ds_read_b64_tr_b16 a[156:157], v15 offset:53248
s_waitcnt lgkmcnt(15)
v_mfma_f32_32x32x16_bf16 v[176:191], a[128:131], a[172:175], v[176:191]
ds_read_b64_tr_b16 a[158:159], v15 offset:54272
v_mfma_f32_32x32x16_bf16 v[240:255], a[132:135], a[172:175], v[240:255]
ds_read_b64_tr_b16 a[172:173], v15 offset:61440
s_waitcnt lgkmcnt(13)
v_mfma_f32_32x32x16_bf16 a[0:15], a[144:147], a[136:139], a[0:15]
ds_read_b64_tr_b16 a[174:175], v15 offset:62464
s_waitcnt vmcnt(11)
s_barrier
v_mfma_f32_32x32x16_bf16 a[16:31], a[144:147], a[140:143], a[16:31]
s_add_u32 m0, s46, 98304
s_mov_b32 s44, 524288
s_waitcnt lgkmcnt(12)
v_mfma_f32_32x32x16_bf16 v[128:143], a[136:139], a[160:163], v[128:143]
v_mfma_f32_32x32x16_bf16 v[192:207], a[140:143], a[160:163], v[192:207]
buffer_load_dwordx4 v24, s[24:27], s44 offen offset:0 lds
s_waitcnt lgkmcnt(10)
v_mfma_f32_32x32x16_bf16 a[32:47], a[148:151], a[136:139], a[32:47]
v_mfma_f32_32x32x16_bf16 a[48:63], a[148:151], a[140:143], a[48:63]
buffer_load_dwordx4 v25, s[24:27], s44 offen offset:1024 lds
s_waitcnt lgkmcnt(8)
v_mfma_f32_32x32x16_bf16 v[144:159], a[136:139], a[164:167], v[144:159]
v_mfma_f32_32x32x16_bf16 v[208:223], a[140:143], a[164:167], v[208:223]
s_lshl_b32 s42, s38, 10
s_add_u32 m0, s42, 106496
s_mov_b32 s52, 176128
s_waitcnt lgkmcnt(6)
v_mfma_f32_32x32x16_bf16 a[64:79], a[152:155], a[136:139], a[64:79]
v_mfma_f32_32x32x16_bf16 a[80:95], a[152:155], a[140:143], a[80:95]
buffer_load_dwordx4 v26, s[28:31], s52 offen lds
s_waitcnt lgkmcnt(4)
v_mfma_f32_32x32x16_bf16 v[160:175], a[136:139], a[168:171], v[160:175]
v_mfma_f32_32x32x16_bf16 v[224:239], a[140:143], a[168:171], v[224:239]
s_waitcnt lgkmcnt(2)
v_mfma_f32_32x32x16_bf16 a[96:111], a[156:159], a[136:139], a[96:111]
v_mfma_f32_32x32x16_bf16 a[112:127], a[156:159], a[140:143], a[112:127]
s_waitcnt lgkmcnt(0)
v_mfma_f32_32x32x16_bf16 v[176:191], a[136:139], a[172:175], v[176:191]
v_mfma_f32_32x32x16_bf16 v[240:255], a[140:143], a[172:175], v[240:255]
s_load_dwordx2 s[12:13], s[0:1], 72
s_load_dwordx2 s[78:79], s[0:1], 40
s_lshl_b32 s39, s36, 19
s_lshl_b32 s40, s37, 16
s_add_u32 s39, s39, s40
s_lshl_b32 s40, s38, 14
s_add_u32 s39, s39, s40
v_lshlrev_b32 v50, 4, v1
v_add_u32 v16, s39, v50
v_add_u32 v17, 0x1000000, v16
v_add_u32 v18, 0x2000, v16
v_add_u32 v19, 0x2000, v17
s_waitcnt vmcnt(6)
ds_read_b128 a[128:131], v27 offset:0
ds_read_b128 a[132:135], v27 offset:4096
ds_read_b128 a[136:139], v31 offset:0
ds_read_b64_tr_b16 a[152:153], v35 offset:0
ds_read_b64_tr_b16 a[156:157], v36 offset:0
ds_read_b64_tr_b16 a[160:161], v37 offset:0
ds_read_b64_tr_b16 a[164:165], v38 offset:0
ds_read_b64_tr_b16 a[168:169], v39 offset:0
ds_read_b64_tr_b16 a[172:173], v39 offset:2048
ds_read_b64_tr_b16 a[154:155], v35 offset:1024
ds_read_b64_tr_b16 a[158:159], v36 offset:1024
ds_read_b64_tr_b16 a[162:163], v37 offset:1024
ds_read_b64_tr_b16 a[166:167], v38 offset:1024
ds_read_b64_tr_b16 a[170:171], v39 offset:256
ds_read_b64_tr_b16 a[174:175], v39 offset:2304
v_cvt_pk_bf16_f32 v64, v128, v129
v_cvt_pk_bf16_f32 v65, v130, v131
v_cvt_pk_bf16_f32 v66, v132, v133
v_cvt_pk_bf16_f32 v67, v134, v135
v_cvt_pk_bf16_f32 v68, v136, v137
v_cvt_pk_bf16_f32 v69, v138, v139
v_cvt_pk_bf16_f32 v70, v140, v141
v_cvt_pk_bf16_f32 v71, v142, v143
v_cvt_pk_bf16_f32 v72, v144, v145
v_cvt_pk_bf16_f32 v73, v146, v147
v_cvt_pk_bf16_f32 v74, v148, v149
v_cvt_pk_bf16_f32 v75, v150, v151
v_cvt_pk_bf16_f32 v76, v152, v153
v_cvt_pk_bf16_f32 v77, v154, v155
v_cvt_pk_bf16_f32 v78, v156, v157
v_cvt_pk_bf16_f32 v79, v158, v159
v_cvt_pk_bf16_f32 v80, v160, v161
v_cvt_pk_bf16_f32 v81, v162, v163
v_cvt_pk_bf16_f32 v82, v164, v165
v_cvt_pk_bf16_f32 v83, v166, v167
v_cvt_pk_bf16_f32 v84, v168, v169
v_cvt_pk_bf16_f32 v85, v170, v171
v_cvt_pk_bf16_f32 v86, v172, v173
v_cvt_pk_bf16_f32 v87, v174, v175
v_cvt_pk_bf16_f32 v88, v176, v177
v_cvt_pk_bf16_f32 v89, v178, v179
v_cvt_pk_bf16_f32 v90, v180, v181
v_cvt_pk_bf16_f32 v91, v182, v183
v_cvt_pk_bf16_f32 v92, v184, v185
v_cvt_pk_bf16_f32 v93, v186, v187
v_cvt_pk_bf16_f32 v94, v188, v189
v_cvt_pk_bf16_f32 v95, v190, v191
v_cvt_pk_bf16_f32 v96, v192, v193
v_cvt_pk_bf16_f32 v97, v194, v195
v_cvt_pk_bf16_f32 v98, v196, v197
v_cvt_pk_bf16_f32 v99, v198, v199
v_cvt_pk_bf16_f32 v100, v200, v201
v_cvt_pk_bf16_f32 v101, v202, v203
v_cvt_pk_bf16_f32 v102, v204, v205
v_cvt_pk_bf16_f32 v103, v206, v207
v_cvt_pk_bf16_f32 v104, v208, v209
v_cvt_pk_bf16_f32 v105, v210, v211
v_cvt_pk_bf16_f32 v106, v212, v213
v_cvt_pk_bf16_f32 v107, v214, v215
v_cvt_pk_bf16_f32 v108, v216, v217
v_cvt_pk_bf16_f32 v109, v218, v219
v_cvt_pk_bf16_f32 v110, v220, v221
v_cvt_pk_bf16_f32 v111, v222, v223
v_cvt_pk_bf16_f32 v112, v224, v225
v_cvt_pk_bf16_f32 v113, v226, v227
v_cvt_pk_bf16_f32 v114, v228, v229
v_cvt_pk_bf16_f32 v115, v230, v231
v_cvt_pk_bf16_f32 v116, v232, v233
v_cvt_pk_bf16_f32 v117, v234, v235
v_cvt_pk_bf16_f32 v118, v236, v237
v_cvt_pk_bf16_f32 v119, v238, v239
v_cvt_pk_bf16_f32 v120, v240, v241
v_cvt_pk_bf16_f32 v121, v242, v243
v_cvt_pk_bf16_f32 v122, v244, v245
v_cvt_pk_bf16_f32 v123, v246, v247
v_cvt_pk_bf16_f32 v124, v248, v249
v_cvt_pk_bf16_f32 v125, v250, v251
v_cvt_pk_bf16_f32 v126, v252, v253
v_cvt_pk_bf16_f32 v127, v254, v255
s_nop 1
s_waitcnt lgkmcnt(5)
v_mfma_f32_32x32x16_bf16 v[128:143], a[152:155], a[128:131], 0
ds_read_b128 a[140:143], v28 offset:0
v_mfma_f32_32x32x16_bf16 v[192:207], a[152:155], a[132:135], 0
ds_read_b128 a[144:147], v28 offset:4096
ds_read_b64_tr_b16 a[152:153], v35 offset:4096
s_add_u32 m0, s3, 8192
s_add_u32 s43, s54, 128
s_waitcnt lgkmcnt(7)
v_mfma_f32_32x32x16_bf16 v[144:159], a[156:159], a[128:131], 0
ds_read_b128 a[148:151], v32 offset:0
ds_read_b64_tr_b16 a[154:155], v35 offset:5120
buffer_load_dwordx4 v20, s[20:23], s43 offen offset:0 lds
v_accvgpr_read_b32 v45, a0
v_mfma_f32_32x32x16_bf16 v[208:223], a[156:159], a[132:135], 0
ds_read_b64_tr_b16 a[156:157], v36 offset:4096
buffer_load_dwordx4 v21, s[20:23], s43 offen offset:1024 lds
v_accvgpr_read_b32 v46, a1
v_cvt_pk_bf16_f32 v47, v45, v46
v_accvgpr_write_b32 a0, v47
s_waitcnt lgkmcnt(7)
v_mfma_f32_32x32x16_bf16 a[176:191], a[168:171], a[128:131], 0
ds_read_b64_tr_b16 a[158:159], v36 offset:5120
buffer_load_dwordx4 v22, s[20:23], s43 offen offset:2048 lds
v_accvgpr_read_b32 v48, a2
v_accvgpr_read_b32 v49, a3
v_mfma_f32_32x32x16_bf16 a[192:207], a[168:171], a[132:135], 0
ds_read_b64_tr_b16 a[168:169], v39 offset:1024
buffer_load_dwordx4 v23, s[20:23], s43 offen offset:3072 lds
v_cvt_pk_bf16_f32 v50, v48, v49
v_accvgpr_write_b32 a1, v50
v_mfma_f32_32x32x16_bf16 v[160:175], a[160:163], a[128:131], 0
ds_read_b64_tr_b16 a[170:171], v39 offset:1280
v_accvgpr_read_b32 v45, a4
v_accvgpr_read_b32 v46, a5
v_cvt_pk_bf16_f32 v47, v45, v46
v_mfma_f32_32x32x16_bf16 v[224:239], a[160:163], a[132:135], 0
ds_read_b64_tr_b16 a[160:161], v37 offset:4096
s_add_u32 m0, s3, 12288
s_add_u32 s43, s55, 128
v_accvgpr_write_b32 a2, v47
v_mfma_f32_32x32x16_bf16 v[176:191], a[164:167], a[128:131], 0
ds_read_b64_tr_b16 a[162:163], v37 offset:5120
buffer_load_dwordx4 v20, s[20:23], s43 offen offset:0 lds
v_accvgpr_read_b32 v48, a6
v_accvgpr_read_b32 v49, a7
v_cvt_pk_bf16_f32 v50, v48, v49
v_mfma_f32_32x32x16_bf16 v[240:255], a[164:167], a[132:135], 0
ds_read_b64_tr_b16 a[164:165], v38 offset:4096
buffer_load_dwordx4 v21, s[20:23], s43 offen offset:1024 lds
v_accvgpr_write_b32 a3, v50
v_accvgpr_read_b32 v45, a8
s_waitcnt lgkmcnt(12)
v_mfma_f32_32x32x16_bf16 a[208:223], a[172:175], a[136:139], 0
ds_read_b64_tr_b16 a[166:167], v38 offset:5120
ds_read_b64_tr_b16 a[172:173], v39 offset:3072
buffer_load_dwordx4 v22, s[20:23], s43 offen offset:2048 lds
v_accvgpr_read_b32 v46, a9
s_waitcnt lgkmcnt(9)
v_mfma_f32_32x32x16_bf16 v[128:143], a[152:155], a[140:143], v[128:143]
ds_read_b64_tr_b16 a[174:175], v39 offset:3328
s_waitcnt vmcnt(10)
s_barrier
ds_read_b128 a[128:131], v29 offset:0
buffer_load_dwordx4 v23, s[20:23], s43 offen offset:3072 lds
v_cvt_pk_bf16_f32 v47, v45, v46
v_mfma_f32_32x32x16_bf16 v[192:207], a[152:155], a[144:147], v[192:207]
ds_read_b128 a[132:135], v29 offset:4096
ds_read_b64_tr_b16 a[152:153], v35 offset:16384
v_accvgpr_write_b32 a4, v47
v_accvgpr_read_b32 v48, a10
s_waitcnt lgkmcnt(11)
v_mfma_f32_32x32x16_bf16 v[144:159], a[156:159], a[140:143], v[144:159]
ds_read_b128 a[136:139], v33 offset:0
ds_read_b64_tr_b16 a[154:155], v35 offset:17408
s_add_u32 m0, s46, 114688
s_mov_b32 s44, 786432
v_accvgpr_read_b32 v49, a11
v_mfma_f32_32x32x16_bf16 v[208:223], a[156:159], a[144:147], v[208:223]
ds_read_b64_tr_b16 a[156:157], v36 offset:16384
buffer_load_dwordx4 v24, s[24:27], s44 offen offset:0 lds
v_cvt_pk_bf16_f32 v50, v48, v49
v_accvgpr_write_b32 a5, v50
s_waitcnt lgkmcnt(12)
v_mfma_f32_32x32x16_bf16 a[176:191], a[168:171], a[140:143], a[176:191]
ds_read_b64_tr_b16 a[158:159], v36 offset:17408
buffer_load_dwordx4 v25, s[24:27], s44 offen offset:1024 lds
s_mov_b32 s47, 0
buffer_store_dwordx4 v[64:67], v17, s[16:19], s47 offen offset:0
v_accvgpr_read_b32 v45, a12
v_accvgpr_read_b32 v46, a13
v_mfma_f32_32x32x16_bf16 a[192:207], a[168:171], a[144:147], a[192:207]
ds_read_b64_tr_b16 a[168:169], v39 offset:16384
s_lshl_b32 s42, s38, 10
s_add_u32 m0, s42, 122880
s_mov_b32 s52, 264192
v_cvt_pk_bf16_f32 v47, v45, v46
s_waitcnt lgkmcnt(12)
v_mfma_f32_32x32x16_bf16 v[160:175], a[160:163], a[140:143], v[160:175]
ds_read_b64_tr_b16 a[170:171], v39 offset:16640
buffer_load_dwordx4 v26, s[28:31], s52 offen lds
v_accvgpr_write_b32 a6, v47
v_accvgpr_read_b32 v48, a14
v_mfma_f32_32x32x16_bf16 v[224:239], a[160:163], a[144:147], v[224:239]
ds_read_b64_tr_b16 a[160:161], v37 offset:16384
v_accvgpr_read_b32 v49, a15
v_cvt_pk_bf16_f32 v50, v48, v49
v_accvgpr_write_b32 a7, v50
s_waitcnt lgkmcnt(12)
v_mfma_f32_32x32x16_bf16 v[176:191], a[164:167], a[140:143], v[176:191]
ds_read_b64_tr_b16 a[162:163], v37 offset:17408
v_accvgpr_read_b32 v45, a16
v_accvgpr_read_b32 v46, a17
v_cvt_pk_bf16_f32 v47, v45, v46
v_mfma_f32_32x32x16_bf16 v[240:255], a[164:167], a[144:147], v[240:255]
ds_read_b64_tr_b16 a[164:165], v38 offset:16384
v_accvgpr_write_b32 a8, v47
v_accvgpr_read_b32 v48, a18
v_accvgpr_read_b32 v49, a19
s_waitcnt lgkmcnt(12)
v_mfma_f32_32x32x16_bf16 a[208:223], a[172:175], a[148:151], a[208:223]
ds_read_b64_tr_b16 a[166:167], v38 offset:17408
ds_read_b64_tr_b16 a[172:173], v39 offset:18432
v_cvt_pk_bf16_f32 v50, v48, v49
v_accvgpr_write_b32 a9, v50
s_waitcnt lgkmcnt(9)
v_mfma_f32_32x32x16_bf16 v[128:143], a[152:155], a[128:131], v[128:143]
ds_read_b64_tr_b16 a[174:175], v39 offset:18688
ds_read_b128 a[140:143], v30 offset:0
v_accvgpr_read_b32 v45, a20
v_accvgpr_read_b32 v46, a21
v_mfma_f32_32x32x16_bf16 v[192:207], a[152:155], a[132:135], v[192:207]
ds_read_b128 a[144:147], v30 offset:4096
ds_read_b64_tr_b16 a[152:153], v35 offset:20480
v_cvt_pk_bf16_f32 v47, v45, v46
v_accvgpr_write_b32 a10, v47
s_waitcnt lgkmcnt(11)
v_mfma_f32_32x32x16_bf16 v[144:159], a[156:159], a[128:131], v[144:159]
ds_read_b128 a[148:151], v34 offset:0
ds_read_b64_tr_b16 a[154:155], v35 offset:21504
v_accvgpr_read_b32 v48, a22
v_accvgpr_read_b32 v49, a23
v_mfma_f32_32x32x16_bf16 v[208:223], a[156:159], a[132:135], v[208:223]
ds_read_b64_tr_b16 a[156:157], v36 offset:20480
s_mov_b32 s47, 4096
buffer_store_dwordx4 v[68:71], v17, s[16:19], s47 offen offset:0
v_cvt_pk_bf16_f32 v50, v48, v49
v_accvgpr_write_b32 a11, v50
v_accvgpr_read_b32 v45, a24
s_waitcnt lgkmcnt(12)
v_mfma_f32_32x32x16_bf16 a[176:191], a[168:171], a[128:131], a[176:191]
ds_read_b64_tr_b16 a[158:159], v36 offset:21504
v_accvgpr_read_b32 v46, a25
v_cvt_pk_bf16_f32 v47, v45, v46
v_accvgpr_write_b32 a12, v47
v_mfma_f32_32x32x16_bf16 a[192:207], a[168:171], a[132:135], a[192:207]
ds_read_b64_tr_b16 a[168:169], v39 offset:17408
v_accvgpr_read_b32 v48, a26
v_accvgpr_read_b32 v49, a27
v_cvt_pk_bf16_f32 v50, v48, v49
s_waitcnt lgkmcnt(12)
v_mfma_f32_32x32x16_bf16 v[160:175], a[160:163], a[128:131], v[160:175]
ds_read_b64_tr_b16 a[170:171], v39 offset:17664
v_accvgpr_write_b32 a13, v50
v_accvgpr_read_b32 v45, a28
v_accvgpr_read_b32 v46, a29
v_mfma_f32_32x32x16_bf16 v[224:239], a[160:163], a[132:135], v[224:239]
ds_read_b64_tr_b16 a[160:161], v37 offset:20480
v_cvt_pk_bf16_f32 v47, v45, v46
v_accvgpr_write_b32 a14, v47
v_accvgpr_read_b32 v48, a30
s_waitcnt lgkmcnt(12)
v_mfma_f32_32x32x16_bf16 v[176:191], a[164:167], a[128:131], v[176:191]
ds_read_b64_tr_b16 a[162:163], v37 offset:21504
v_accvgpr_read_b32 v49, a31
v_cvt_pk_bf16_f32 v50, v48, v49
v_accvgpr_write_b32 a15, v50
v_mfma_f32_32x32x16_bf16 v[240:255], a[164:167], a[132:135], v[240:255]
ds_read_b64_tr_b16 a[164:165], v38 offset:20480
v_accvgpr_read_b32 v45, a32
v_accvgpr_read_b32 v46, a33
v_cvt_pk_bf16_f32 v47, v45, v46
s_waitcnt lgkmcnt(12)
v_mfma_f32_32x32x16_bf16 a[208:223], a[172:175], a[136:139], a[208:223]
ds_read_b64_tr_b16 a[166:167], v38 offset:21504
ds_read_b64_tr_b16 a[172:173], v39 offset:19456
v_accvgpr_write_b32 a16, v47
v_accvgpr_read_b32 v48, a34
s_waitcnt lgkmcnt(9)
v_mfma_f32_32x32x16_bf16 v[128:143], a[152:155], a[140:143], v[128:143]
ds_read_b64_tr_b16 a[174:175], v39 offset:19712
s_waitcnt vmcnt(13)
s_barrier
s_waitcnt vmcnt(5)
ds_read_b128 a[128:131], v27 offset:8192
v_accvgpr_read_b32 v49, a35
v_mfma_f32_32x32x16_bf16 v[192:207], a[152:155], a[144:147], v[192:207]
ds_read_b128 a[132:135], v27 offset:12288
ds_read_b64_tr_b16 a[152:153], v35 offset:32768
s_add_u32 m0, s46, 65536
s_mov_b32 s44, 1048576
s_waitcnt lgkmcnt(11)
v_mfma_f32_32x32x16_bf16 v[144:159], a[156:159], a[140:143], v[144:159]
ds_read_b128 a[136:139], v31 offset:8192
ds_read_b64_tr_b16 a[154:155], v35 offset:33792
buffer_load_dwordx4 v24, s[24:27], s44 offen offset:0 lds
s_mov_b32 s47, 0
buffer_store_dwordx4 v[72:75], v17, s[16:19], s47 offen offset:1024
v_cvt_pk_bf16_f32 v50, v48, v49
v_accvgpr_write_b32 a17, v50
v_mfma_f32_32x32x16_bf16 v[208:223], a[156:159], a[144:147], v[208:223]
ds_read_b64_tr_b16 a[156:157], v36 offset:32768
buffer_load_dwordx4 v25, s[24:27], s44 offen offset:1024 lds
v_accvgpr_read_b32 v45, a36
v_accvgpr_read_b32 v46, a37
s_waitcnt lgkmcnt(12)
v_mfma_f32_32x32x16_bf16 a[176:191], a[168:171], a[140:143], a[176:191]
ds_read_b64_tr_b16 a[158:159], v36 offset:33792
s_lshl_b32 s42, s38, 10
s_add_u32 m0, s42, 73728
s_mov_b32 s52, 352256
v_cvt_pk_bf16_f32 v47, v45, v46
v_mfma_f32_32x32x16_bf16 a[192:207], a[168:171], a[144:147], a[192:207]
ds_read_b64_tr_b16 a[168:169], v39 offset:32768
buffer_load_dwordx4 v26, s[28:31], s52 offen lds
v_accvgpr_write_b32 a18, v47
v_accvgpr_read_b32 v48, a38
s_waitcnt lgkmcnt(12)
v_mfma_f32_32x32x16_bf16 v[160:175], a[160:163], a[140:143], v[160:175]
ds_read_b64_tr_b16 a[170:171], v39 offset:33024
v_accvgpr_read_b32 v49, a39
v_cvt_pk_bf16_f32 v50, v48, v49
v_accvgpr_write_b32 a19, v50
v_mfma_f32_32x32x16_bf16 v[224:239], a[160:163], a[144:147], v[224:239]
ds_read_b64_tr_b16 a[160:161], v37 offset:32768
v_accvgpr_read_b32 v45, a40
v_accvgpr_read_b32 v46, a41
v_cvt_pk_bf16_f32 v47, v45, v46
s_waitcnt lgkmcnt(12)
v_mfma_f32_32x32x16_bf16 v[176:191], a[164:167], a[140:143], v[176:191]
ds_read_b64_tr_b16 a[162:163], v37 offset:33792
v_accvgpr_write_b32 a20, v47
v_accvgpr_read_b32 v48, a42
v_accvgpr_read_b32 v49, a43
v_mfma_f32_32x32x16_bf16 v[240:255], a[164:167], a[144:147], v[240:255]
ds_read_b64_tr_b16 a[164:165], v38 offset:32768
v_cvt_pk_bf16_f32 v50, v48, v49
v_accvgpr_write_b32 a21, v50
s_waitcnt lgkmcnt(12)
v_mfma_f32_32x32x16_bf16 a[208:223], a[172:175], a[148:151], a[208:223]
ds_read_b64_tr_b16 a[166:167], v38 offset:33792
ds_read_b64_tr_b16 a[172:173], v39 offset:34816
v_accvgpr_read_b32 v45, a44
v_accvgpr_read_b32 v46, a45
v_cvt_pk_bf16_f32 v47, v45, v46
s_waitcnt lgkmcnt(9)
v_mfma_f32_32x32x16_bf16 v[128:143], a[152:155], a[128:131], v[128:143]
ds_read_b64_tr_b16 a[174:175], v39 offset:35072
ds_read_b128 a[140:143], v28 offset:8192
v_accvgpr_write_b32 a22, v47
v_accvgpr_read_b32 v48, a46
v_mfma_f32_32x32x16_bf16 v[192:207], a[152:155], a[132:135], v[192:207]
ds_read_b128 a[144:147], v28 offset:12288
ds_read_b64_tr_b16 a[152:153], v35 offset:36864
s_add_u32 m0, s3, 0
s_add_u32 s43, s54, 256
s_mov_b32 s47, 4096
buffer_store_dwordx4 v[76:79], v17, s[16:19], s47 offen offset:1024
v_accvgpr_read_b32 v49, a47
s_waitcnt lgkmcnt(11)
v_mfma_f32_32x32x16_bf16 v[144:159], a[156:159], a[128:131], v[144:159]
ds_read_b128 a[148:151], v32 offset:8192
ds_read_b64_tr_b16 a[154:155], v35 offset:37888
buffer_load_dwordx4 v20, s[20:23], s43 offen offset:0 lds
v_cvt_pk_bf16_f32 v50, v48, v49
v_mfma_f32_32x32x16_bf16 v[208:223], a[156:159], a[132:135], v[208:223]
ds_read_b64_tr_b16 a[156:157], v36 offset:36864
buffer_load_dwordx4 v21, s[20:23], s43 offen offset:1024 lds
v_accvgpr_write_b32 a23, v50
v_accvgpr_read_b32 v45, a48
s_waitcnt lgkmcnt(12)
v_mfma_f32_32x32x16_bf16 a[176:191], a[168:171], a[128:131], a[176:191]
ds_read_b64_tr_b16 a[158:159], v36 offset:37888
buffer_load_dwordx4 v22, s[20:23], s43 offen offset:2048 lds
v_accvgpr_read_b32 v46, a49
v_cvt_pk_bf16_f32 v47, v45, v46
v_mfma_f32_32x32x16_bf16 a[192:207], a[168:171], a[132:135], a[192:207]
ds_read_b64_tr_b16 a[168:169], v39 offset:33792
buffer_load_dwordx4 v23, s[20:23], s43 offen offset:3072 lds
v_accvgpr_write_b32 a24, v47
v_accvgpr_read_b32 v48, a50
v_accvgpr_read_b32 v49, a51
s_waitcnt lgkmcnt(12)
v_mfma_f32_32x32x16_bf16 v[160:175], a[160:163], a[128:131], v[160:175]
ds_read_b64_tr_b16 a[170:171], v39 offset:34048
v_cvt_pk_bf16_f32 v50, v48, v49
v_accvgpr_write_b32 a25, v50
v_mfma_f32_32x32x16_bf16 v[224:239], a[160:163], a[132:135], v[224:239]
ds_read_b64_tr_b16 a[160:161], v37 offset:36864
s_add_u32 m0, s3, 4096
s_add_u32 s43, s55, 256
v_accvgpr_read_b32 v45, a52
v_accvgpr_read_b32 v46, a53
s_waitcnt lgkmcnt(12)
v_mfma_f32_32x32x16_bf16 v[176:191], a[164:167], a[128:131], v[176:191]
ds_read_b64_tr_b16 a[162:163], v37 offset:37888
buffer_load_dwordx4 v20, s[20:23], s43 offen offset:0 lds
v_cvt_pk_bf16_f32 v47, v45, v46
v_accvgpr_write_b32 a26, v47
v_mfma_f32_32x32x16_bf16 v[240:255], a[164:167], a[132:135], v[240:255]
ds_read_b64_tr_b16 a[164:165], v38 offset:36864
buffer_load_dwordx4 v21, s[20:23], s43 offen offset:1024 lds
v_accvgpr_read_b32 v48, a54
v_accvgpr_read_b32 v49, a55
s_waitcnt lgkmcnt(12)
v_mfma_f32_32x32x16_bf16 a[208:223], a[172:175], a[136:139], a[208:223]
ds_read_b64_tr_b16 a[166:167], v38 offset:37888
ds_read_b64_tr_b16 a[172:173], v39 offset:35840
buffer_load_dwordx4 v22, s[20:23], s43 offen offset:2048 lds
v_cvt_pk_bf16_f32 v50, v48, v49
v_accvgpr_write_b32 a27, v50
s_waitcnt lgkmcnt(9)
v_mfma_f32_32x32x16_bf16 v[128:143], a[152:155], a[140:143], v[128:143]
ds_read_b64_tr_b16 a[174:175], v39 offset:36096
s_waitcnt vmcnt(13)
s_barrier
ds_read_b128 a[128:131], v29 offset:8192
buffer_load_dwordx4 v23, s[20:23], s43 offen offset:3072 lds
s_mov_b32 s47, 0
buffer_store_dwordx4 v[80:83], v17, s[16:19], s47 offen offset:2048
v_mfma_f32_32x32x16_bf16 v[192:207], a[152:155], a[144:147], v[192:207]
ds_read_b128 a[132:135], v29 offset:12288
ds_read_b64_tr_b16 a[152:153], v35 offset:49152
v_accvgpr_read_b32 v45, a56
v_accvgpr_read_b32 v46, a57
v_cvt_pk_bf16_f32 v47, v45, v46
s_waitcnt lgkmcnt(11)
v_mfma_f32_32x32x16_bf16 v[144:159], a[156:159], a[140:143], v[144:159]
ds_read_b128 a[136:139], v33 offset:8192
ds_read_b64_tr_b16 a[154:155], v35 offset:50176
s_add_u32 m0, s46, 81920
s_mov_b32 s44, 1310720
v_mfma_f32_32x32x16_bf16 v[208:223], a[156:159], a[144:147], v[208:223]
ds_read_b64_tr_b16 a[156:157], v36 offset:49152
buffer_load_dwordx4 v24, s[24:27], s44 offen offset:0 lds
v_accvgpr_write_b32 a28, v47
v_accvgpr_read_b32 v48, a58
s_waitcnt lgkmcnt(12)
v_mfma_f32_32x32x16_bf16 a[176:191], a[168:171], a[140:143], a[176:191]
ds_read_b64_tr_b16 a[158:159], v36 offset:50176
buffer_load_dwordx4 v25, s[24:27], s44 offen offset:1024 lds
v_accvgpr_read_b32 v49, a59
v_cvt_pk_bf16_f32 v50, v48, v49
v_accvgpr_write_b32 a29, v50
v_mfma_f32_32x32x16_bf16 a[192:207], a[168:171], a[144:147], a[192:207]
ds_read_b64_tr_b16 a[168:169], v39 offset:49152
s_lshl_b32 s42, s38, 10
s_add_u32 m0, s42, 90112
s_mov_b32 s52, 440320
s_waitcnt lgkmcnt(12)
v_mfma_f32_32x32x16_bf16 v[160:175], a[160:163], a[140:143], v[160:175]
ds_read_b64_tr_b16 a[170:171], v39 offset:49408
buffer_load_dwordx4 v26, s[28:31], s52 offen lds
v_accvgpr_read_b32 v45, a60
v_accvgpr_read_b32 v46, a61
v_cvt_pk_bf16_f32 v47, v45, v46
v_mfma_f32_32x32x16_bf16 v[224:239], a[160:163], a[144:147], v[224:239]
ds_read_b64_tr_b16 a[160:161], v37 offset:49152
v_accvgpr_write_b32 a30, v47
v_accvgpr_read_b32 v48, a62
s_waitcnt lgkmcnt(12)
v_mfma_f32_32x32x16_bf16 v[176:191], a[164:167], a[140:143], v[176:191]
ds_read_b64_tr_b16 a[162:163], v37 offset:50176
v_accvgpr_read_b32 v49, a63
v_cvt_pk_bf16_f32 v50, v48, v49
v_accvgpr_write_b32 a31, v50
v_mfma_f32_32x32x16_bf16 v[240:255], a[164:167], a[144:147], v[240:255]
ds_read_b64_tr_b16 a[164:165], v38 offset:49152
v_accvgpr_read_b32 v45, a64
v_accvgpr_read_b32 v46, a65
v_cvt_pk_bf16_f32 v47, v45, v46
s_waitcnt lgkmcnt(12)
v_mfma_f32_32x32x16_bf16 a[208:223], a[172:175], a[148:151], a[208:223]
ds_read_b64_tr_b16 a[166:167], v38 offset:50176
ds_read_b64_tr_b16 a[172:173], v39 offset:51200
s_mov_b32 s47, 4096
buffer_store_dwordx4 v[84:87], v17, s[16:19], s47 offen offset:2048
v_accvgpr_write_b32 a32, v47
v_accvgpr_read_b32 v48, a66
s_waitcnt lgkmcnt(9)
v_mfma_f32_32x32x16_bf16 v[128:143], a[152:155], a[128:131], v[128:143]
ds_read_b64_tr_b16 a[174:175], v39 offset:51456
ds_read_b128 a[140:143], v30 offset:8192
v_accvgpr_read_b32 v49, a67
v_cvt_pk_bf16_f32 v50, v48, v49
v_accvgpr_write_b32 a33, v50
v_mfma_f32_32x32x16_bf16 v[192:207], a[152:155], a[132:135], v[192:207]
ds_read_b128 a[144:147], v30 offset:12288
ds_read_b64_tr_b16 a[152:153], v35 offset:53248
v_accvgpr_read_b32 v45, a68
v_accvgpr_read_b32 v46, a69
s_waitcnt lgkmcnt(11)
v_mfma_f32_32x32x16_bf16 v[144:159], a[156:159], a[128:131], v[144:159]
ds_read_b128 a[148:151], v34 offset:8192
ds_read_b64_tr_b16 a[154:155], v35 offset:54272
v_cvt_pk_bf16_f32 v47, v45, v46
v_accvgpr_write_b32 a34, v47
v_mfma_f32_32x32x16_bf16 v[208:223], a[156:159], a[132:135], v[208:223]
ds_read_b64_tr_b16 a[156:157], v36 offset:53248
v_accvgpr_read_b32 v48, a70
v_accvgpr_read_b32 v49, a71
v_cvt_pk_bf16_f32 v50, v48, v49
s_waitcnt lgkmcnt(12)
v_mfma_f32_32x32x16_bf16 a[176:191], a[168:171], a[128:131], a[176:191]
ds_read_b64_tr_b16 a[158:159], v36 offset:54272
v_accvgpr_write_b32 a35, v50
v_accvgpr_read_b32 v45, a72
v_accvgpr_read_b32 v46, a73
v_mfma_f32_32x32x16_bf16 a[192:207], a[168:171], a[132:135], a[192:207]
ds_read_b64_tr_b16 a[168:169], v39 offset:50176
v_cvt_pk_bf16_f32 v47, v45, v46
v_accvgpr_write_b32 a36, v47
v_accvgpr_read_b32 v48, a74
s_waitcnt lgkmcnt(12)
v_mfma_f32_32x32x16_bf16 v[160:175], a[160:163], a[128:131], v[160:175]
ds_read_b64_tr_b16 a[170:171], v39 offset:50432
v_accvgpr_read_b32 v49, a75
v_cvt_pk_bf16_f32 v50, v48, v49
v_accvgpr_write_b32 a37, v50
v_mfma_f32_32x32x16_bf16 v[224:239], a[160:163], a[132:135], v[224:239]
ds_read_b64_tr_b16 a[160:161], v37 offset:53248
v_accvgpr_read_b32 v45, a76
v_accvgpr_read_b32 v46, a77
s_waitcnt lgkmcnt(12)
v_mfma_f32_32x32x16_bf16 v[176:191], a[164:167], a[128:131], v[176:191]
ds_read_b64_tr_b16 a[162:163], v37 offset:54272
v_cvt_pk_bf16_f32 v47, v45, v46
v_accvgpr_write_b32 a38, v47
v_accvgpr_read_b32 v48, a78
v_mfma_f32_32x32x16_bf16 v[240:255], a[164:167], a[132:135], v[240:255]
ds_read_b64_tr_b16 a[164:165], v38 offset:53248
s_mov_b32 s47, 0
buffer_store_dwordx4 v[88:91], v17, s[16:19], s47 offen offset:3072
v_accvgpr_read_b32 v49, a79
v_cvt_pk_bf16_f32 v50, v48, v49
v_accvgpr_write_b32 a39, v50
s_waitcnt lgkmcnt(12)
v_mfma_f32_32x32x16_bf16 a[208:223], a[172:175], a[136:139], a[208:223]
ds_read_b64_tr_b16 a[166:167], v38 offset:54272
ds_read_b64_tr_b16 a[172:173], v39 offset:52224
v_accvgpr_read_b32 v45, a80
v_accvgpr_read_b32 v46, a81
s_waitcnt lgkmcnt(9)
v_mfma_f32_32x32x16_bf16 v[128:143], a[152:155], a[140:143], v[128:143]
ds_read_b64_tr_b16 a[174:175], v39 offset:52480
s_waitcnt vmcnt(15)
s_barrier
s_waitcnt vmcnt(6)
ds_read_b128 a[128:131], v27 offset:0
v_cvt_pk_bf16_f32 v47, v45, v46
v_mfma_f32_32x32x16_bf16 v[192:207], a[152:155], a[144:147], v[192:207]
ds_read_b128 a[132:135], v27 offset:4096
ds_read_b64_tr_b16 a[152:153], v35 offset:0
s_add_u32 m0, s46, 98304
s_mov_b32 s44, 1572864
v_accvgpr_write_b32 a40, v47
s_waitcnt lgkmcnt(11)
v_mfma_f32_32x32x16_bf16 v[144:159], a[156:159], a[140:143], v[144:159]
ds_read_b128 a[136:139], v31 offset:0
ds_read_b64_tr_b16 a[154:155], v35 offset:1024
buffer_load_dwordx4 v24, s[24:27], s44 offen offset:0 lds
v_accvgpr_read_b32 v48, a82
v_mfma_f32_32x32x16_bf16 v[208:223], a[156:159], a[144:147], v[208:223]
ds_read_b64_tr_b16 a[156:157], v36 offset:0
buffer_load_dwordx4 v25, s[24:27], s44 offen offset:1024 lds
v_accvgpr_read_b32 v49, a83
v_cvt_pk_bf16_f32 v50, v48, v49
v_accvgpr_write_b32 a41, v50
s_waitcnt lgkmcnt(12)
v_mfma_f32_32x32x16_bf16 a[176:191], a[168:171], a[140:143], a[176:191]
ds_read_b64_tr_b16 a[158:159], v36 offset:1024
s_lshl_b32 s42, s38, 10
s_add_u32 m0, s42, 106496
s_mov_b32 s52, 528384
v_mfma_f32_32x32x16_bf16 a[192:207], a[168:171], a[144:147], a[192:207]
ds_read_b64_tr_b16 a[168:169], v39 offset:0
buffer_load_dwordx4 v26, s[28:31], s52 offen lds
v_accvgpr_read_b32 v45, a84
v_accvgpr_read_b32 v46, a85
s_waitcnt lgkmcnt(12)
v_mfma_f32_32x32x16_bf16 v[160:175], a[160:163], a[140:143], v[160:175]
ds_read_b64_tr_b16 a[170:171], v39 offset:256
v_cvt_pk_bf16_f32 v47, v45, v46
v_accvgpr_write_b32 a42, v47
v_accvgpr_read_b32 v48, a86
v_mfma_f32_32x32x16_bf16 v[224:239], a[160:163], a[144:147], v[224:239]
ds_read_b64_tr_b16 a[160:161], v37 offset:0
v_accvgpr_read_b32 v49, a87
v_cvt_pk_bf16_f32 v50, v48, v49
v_accvgpr_write_b32 a43, v50
s_waitcnt lgkmcnt(12)
v_mfma_f32_32x32x16_bf16 v[176:191], a[164:167], a[140:143], v[176:191]
ds_read_b64_tr_b16 a[162:163], v37 offset:1024
s_mov_b32 s47, 4096
buffer_store_dwordx4 v[92:95], v17, s[16:19], s47 offen offset:3072
v_accvgpr_read_b32 v45, a88
v_accvgpr_read_b32 v46, a89
v_cvt_pk_bf16_f32 v47, v45, v46
v_mfma_f32_32x32x16_bf16 v[240:255], a[164:167], a[144:147], v[240:255]
ds_read_b64_tr_b16 a[164:165], v38 offset:0
v_accvgpr_write_b32 a44, v47
v_accvgpr_read_b32 v48, a90
v_accvgpr_read_b32 v49, a91
s_waitcnt lgkmcnt(12)
v_mfma_f32_32x32x16_bf16 a[208:223], a[172:175], a[148:151], a[208:223]
ds_read_b64_tr_b16 a[166:167], v38 offset:1024
ds_read_b64_tr_b16 a[172:173], v39 offset:2048
v_cvt_pk_bf16_f32 v50, v48, v49
v_accvgpr_write_b32 a45, v50
s_waitcnt lgkmcnt(9)
v_mfma_f32_32x32x16_bf16 v[128:143], a[152:155], a[128:131], v[128:143]
ds_read_b64_tr_b16 a[174:175], v39 offset:2304
ds_read_b128 a[140:143], v28 offset:0
v_accvgpr_read_b32 v45, a92
v_accvgpr_read_b32 v46, a93
v_mfma_f32_32x32x16_bf16 v[192:207], a[152:155], a[132:135], v[192:207]
ds_read_b128 a[144:147], v28 offset:4096
ds_read_b64_tr_b16 a[152:153], v35 offset:4096
s_add_u32 m0, s3, 8192
s_add_u32 s43, s54, 384
v_cvt_pk_bf16_f32 v47, v45, v46
s_waitcnt lgkmcnt(11)
v_mfma_f32_32x32x16_bf16 v[144:159], a[156:159], a[128:131], v[144:159]
ds_read_b128 a[148:151], v32 offset:0
ds_read_b64_tr_b16 a[154:155], v35 offset:5120
buffer_load_dwordx4 v20, s[20:23], s43 offen offset:0 lds
v_accvgpr_write_b32 a46, v47
v_accvgpr_read_b32 v48, a94
v_mfma_f32_32x32x16_bf16 v[208:223], a[156:159], a[132:135], v[208:223]
ds_read_b64_tr_b16 a[156:157], v36 offset:4096
buffer_load_dwordx4 v21, s[20:23], s43 offen offset:1024 lds
v_accvgpr_read_b32 v49, a95
v_cvt_pk_bf16_f32 v50, v48, v49
s_waitcnt lgkmcnt(12)
v_mfma_f32_32x32x16_bf16 a[176:191], a[168:171], a[128:131], a[176:191]
ds_read_b64_tr_b16 a[158:159], v36 offset:5120
buffer_load_dwordx4 v22, s[20:23], s43 offen offset:2048 lds
v_accvgpr_write_b32 a47, v50
v_accvgpr_read_b32 v45, a96
v_mfma_f32_32x32x16_bf16 a[192:207], a[168:171], a[132:135], a[192:207]
ds_read_b64_tr_b16 a[168:169], v39 offset:1024
buffer_load_dwordx4 v23, s[20:23], s43 offen offset:3072 lds
v_accvgpr_read_b32 v46, a97
v_cvt_pk_bf16_f32 v47, v45, v46
s_waitcnt lgkmcnt(12)
v_mfma_f32_32x32x16_bf16 v[160:175], a[160:163], a[128:131], v[160:175]
ds_read_b64_tr_b16 a[170:171], v39 offset:1280
v_accvgpr_write_b32 a48, v47
v_accvgpr_read_b32 v48, a98
v_accvgpr_read_b32 v49, a99
v_mfma_f32_32x32x16_bf16 v[224:239], a[160:163], a[132:135], v[224:239]
ds_read_b64_tr_b16 a[160:161], v37 offset:4096
s_add_u32 m0, s3, 12288
s_add_u32 s43, s55, 384
v_cvt_pk_bf16_f32 v50, v48, v49
s_waitcnt lgkmcnt(12)
v_mfma_f32_32x32x16_bf16 v[176:191], a[164:167], a[128:131], v[176:191]
ds_read_b64_tr_b16 a[162:163], v37 offset:5120
buffer_load_dwordx4 v20, s[20:23], s43 offen offset:0 lds
s_mov_b32 s47, 0
buffer_store_dwordx4 v[96:99], v19, s[16:19], s47 offen offset:0
v_accvgpr_write_b32 a49, v50
v_accvgpr_read_b32 v45, a100
v_accvgpr_read_b32 v46, a101
v_mfma_f32_32x32x16_bf16 v[240:255], a[164:167], a[132:135], v[240:255]
ds_read_b64_tr_b16 a[164:165], v38 offset:4096
buffer_load_dwordx4 v21, s[20:23], s43 offen offset:1024 lds
v_cvt_pk_bf16_f32 v47, v45, v46
v_accvgpr_write_b32 a50, v47
s_waitcnt lgkmcnt(12)
v_mfma_f32_32x32x16_bf16 a[208:223], a[172:175], a[136:139], a[208:223]
ds_read_b64_tr_b16 a[166:167], v38 offset:5120
ds_read_b64_tr_b16 a[172:173], v39 offset:3072
buffer_load_dwordx4 v22, s[20:23], s43 offen offset:2048 lds
v_accvgpr_read_b32 v48, a102
s_waitcnt lgkmcnt(9)
v_mfma_f32_32x32x16_bf16 v[128:143], a[152:155], a[140:143], v[128:143]
ds_read_b64_tr_b16 a[174:175], v39 offset:3328
s_waitcnt vmcnt(14)
s_barrier
ds_read_b128 a[128:131], v29 offset:0
buffer_load_dwordx4 v23, s[20:23], s43 offen offset:3072 lds
v_accvgpr_read_b32 v49, a103
v_mfma_f32_32x32x16_bf16 v[192:207], a[152:155], a[144:147], v[192:207]
ds_read_b128 a[132:135], v29 offset:4096
ds_read_b64_tr_b16 a[152:153], v35 offset:16384
v_cvt_pk_bf16_f32 v50, v48, v49
v_accvgpr_write_b32 a51, v50
s_waitcnt lgkmcnt(11)
v_mfma_f32_32x32x16_bf16 v[144:159], a[156:159], a[140:143], v[144:159]
ds_read_b128 a[136:139], v33 offset:0
ds_read_b64_tr_b16 a[154:155], v35 offset:17408
s_add_u32 m0, s46, 114688
s_mov_b32 s44, 1835008
v_accvgpr_read_b32 v45, a104
v_mfma_f32_32x32x16_bf16 v[208:223], a[156:159], a[144:147], v[208:223]
ds_read_b64_tr_b16 a[156:157], v36 offset:16384
buffer_load_dwordx4 v24, s[24:27], s44 offen offset:0 lds
v_accvgpr_read_b32 v46, a105
v_cvt_pk_bf16_f32 v47, v45, v46
s_waitcnt lgkmcnt(12)
v_mfma_f32_32x32x16_bf16 a[176:191], a[168:171], a[140:143], a[176:191]
ds_read_b64_tr_b16 a[158:159], v36 offset:17408
buffer_load_dwordx4 v25, s[24:27], s44 offen offset:1024 lds
v_accvgpr_write_b32 a52, v47
v_accvgpr_read_b32 v48, a106
v_mfma_f32_32x32x16_bf16 a[192:207], a[168:171], a[144:147], a[192:207]
ds_read_b64_tr_b16 a[168:169], v39 offset:16384
s_lshl_b32 s42, s38, 10
s_add_u32 m0, s42, 122880
s_mov_b32 s52, 616448
v_accvgpr_read_b32 v49, a107
s_waitcnt lgkmcnt(12)
v_mfma_f32_32x32x16_bf16 v[160:175], a[160:163], a[140:143], v[160:175]
ds_read_b64_tr_b16 a[170:171], v39 offset:16640
buffer_load_dwordx4 v26, s[28:31], s52 offen lds
v_cvt_pk_bf16_f32 v50, v48, v49
v_accvgpr_write_b32 a53, v50
v_mfma_f32_32x32x16_bf16 v[224:239], a[160:163], a[144:147], v[224:239]
ds_read_b64_tr_b16 a[160:161], v37 offset:16384
s_mov_b32 s47, 4096
buffer_store_dwordx4 v[100:103], v19, s[16:19], s47 offen offset:0
v_accvgpr_read_b32 v45, a108
v_accvgpr_read_b32 v46, a109
v_cvt_pk_bf16_f32 v47, v45, v46
s_waitcnt lgkmcnt(12)
v_mfma_f32_32x32x16_bf16 v[176:191], a[164:167], a[140:143], v[176:191]
ds_read_b64_tr_b16 a[162:163], v37 offset:17408
v_accvgpr_write_b32 a54, v47
v_accvgpr_read_b32 v48, a110
v_accvgpr_read_b32 v49, a111
v_mfma_f32_32x32x16_bf16 v[240:255], a[164:167], a[144:147], v[240:255]
ds_read_b64_tr_b16 a[164:165], v38 offset:16384
v_cvt_pk_bf16_f32 v50, v48, v49
v_accvgpr_write_b32 a55, v50
v_accvgpr_read_b32 v45, a112
s_waitcnt lgkmcnt(12)
v_mfma_f32_32x32x16_bf16 a[208:223], a[172:175], a[148:151], a[208:223]
ds_read_b64_tr_b16 a[166:167], v38 offset:17408
ds_read_b64_tr_b16 a[172:173], v39 offset:18432
v_accvgpr_read_b32 v46, a113
v_cvt_pk_bf16_f32 v47, v45, v46
s_waitcnt lgkmcnt(9)
v_mfma_f32_32x32x16_bf16 v[128:143], a[152:155], a[128:131], v[128:143]
ds_read_b64_tr_b16 a[174:175], v39 offset:18688
ds_read_b128 a[140:143], v30 offset:0
v_accvgpr_write_b32 a56, v47
v_accvgpr_read_b32 v48, a114
v_mfma_f32_32x32x16_bf16 v[192:207], a[152:155], a[132:135], v[192:207]
ds_read_b128 a[144:147], v30 offset:4096
ds_read_b64_tr_b16 a[152:153], v35 offset:20480
v_accvgpr_read_b32 v49, a115
v_cvt_pk_bf16_f32 v50, v48, v49
s_waitcnt lgkmcnt(11)
v_mfma_f32_32x32x16_bf16 v[144:159], a[156:159], a[128:131], v[144:159]
ds_read_b128 a[148:151], v34 offset:0
ds_read_b64_tr_b16 a[154:155], v35 offset:21504
v_accvgpr_write_b32 a57, v50
v_accvgpr_read_b32 v45, a116
v_accvgpr_read_b32 v46, a117
v_mfma_f32_32x32x16_bf16 v[208:223], a[156:159], a[132:135], v[208:223]
ds_read_b64_tr_b16 a[156:157], v36 offset:20480
v_cvt_pk_bf16_f32 v47, v45, v46
v_accvgpr_write_b32 a58, v47
s_waitcnt lgkmcnt(12)
v_mfma_f32_32x32x16_bf16 a[176:191], a[168:171], a[128:131], a[176:191]
ds_read_b64_tr_b16 a[158:159], v36 offset:21504
v_accvgpr_read_b32 v48, a118
v_accvgpr_read_b32 v49, a119
v_cvt_pk_bf16_f32 v50, v48, v49
v_mfma_f32_32x32x16_bf16 a[192:207], a[168:171], a[132:135], a[192:207]
ds_read_b64_tr_b16 a[168:169], v39 offset:17408
v_accvgpr_write_b32 a59, v50
v_accvgpr_read_b32 v45, a120
v_accvgpr_read_b32 v46, a121
s_waitcnt lgkmcnt(12)
v_mfma_f32_32x32x16_bf16 v[160:175], a[160:163], a[128:131], v[160:175]
ds_read_b64_tr_b16 a[170:171], v39 offset:17664
s_mov_b32 s47, 0
buffer_store_dwordx4 v[104:107], v19, s[16:19], s47 offen offset:1024
v_cvt_pk_bf16_f32 v47, v45, v46
v_accvgpr_write_b32 a60, v47
v_accvgpr_read_b32 v48, a122
v_mfma_f32_32x32x16_bf16 v[224:239], a[160:163], a[132:135], v[224:239]
ds_read_b64_tr_b16 a[160:161], v37 offset:20480
v_accvgpr_read_b32 v49, a123
v_cvt_pk_bf16_f32 v50, v48, v49
v_accvgpr_write_b32 a61, v50
s_waitcnt lgkmcnt(12)
v_mfma_f32_32x32x16_bf16 v[176:191], a[164:167], a[128:131], v[176:191]
ds_read_b64_tr_b16 a[162:163], v37 offset:21504
v_accvgpr_read_b32 v45, a124
v_accvgpr_read_b32 v46, a125
v_cvt_pk_bf16_f32 v47, v45, v46
v_mfma_f32_32x32x16_bf16 v[240:255], a[164:167], a[132:135], v[240:255]
ds_read_b64_tr_b16 a[164:165], v38 offset:20480
v_accvgpr_write_b32 a62, v47
v_accvgpr_read_b32 v48, a126
v_accvgpr_read_b32 v49, a127
s_waitcnt lgkmcnt(12)
v_mfma_f32_32x32x16_bf16 a[208:223], a[172:175], a[136:139], a[208:223]
ds_read_b64_tr_b16 a[166:167], v38 offset:21504
ds_read_b64_tr_b16 a[172:173], v39 offset:19456
v_cvt_pk_bf16_f32 v50, v48, v49
v_accvgpr_write_b32 a63, v50
s_waitcnt lgkmcnt(9)
v_mfma_f32_32x32x16_bf16 v[128:143], a[152:155], a[140:143], v[128:143]
ds_read_b64_tr_b16 a[174:175], v39 offset:19712
s_waitcnt vmcnt(15)
s_barrier
s_waitcnt vmcnt(5)
ds_read_b128 a[128:131], v27 offset:8192
v_mfma_f32_32x32x16_bf16 v[192:207], a[152:155], a[144:147], v[192:207]
ds_read_b128 a[132:135], v27 offset:12288
ds_read_b64_tr_b16 a[152:153], v35 offset:32768
s_add_u32 m0, s46, 65536
s_mov_b32 s44, 2097152
s_waitcnt lgkmcnt(11)
v_mfma_f32_32x32x16_bf16 v[144:159], a[156:159], a[140:143], v[144:159]
ds_read_b128 a[136:139], v31 offset:8192
ds_read_b64_tr_b16 a[154:155], v35 offset:33792
buffer_load_dwordx4 v24, s[24:27], s44 offen offset:0 lds
v_mfma_f32_32x32x16_bf16 v[208:223], a[156:159], a[144:147], v[208:223]
ds_read_b64_tr_b16 a[156:157], v36 offset:32768
buffer_load_dwordx4 v25, s[24:27], s44 offen offset:1024 lds
s_waitcnt lgkmcnt(12)
v_mfma_f32_32x32x16_bf16 a[176:191], a[168:171], a[140:143], a[176:191]
ds_read_b64_tr_b16 a[158:159], v36 offset:33792
s_lshl_b32 s42, s38, 10
s_add_u32 m0, s42, 73728
s_mov_b32 s52, 704512
v_mfma_f32_32x32x16_bf16 a[192:207], a[168:171], a[144:147], a[192:207]
ds_read_b64_tr_b16 a[168:169], v39 offset:32768
buffer_load_dwordx4 v26, s[28:31], s52 offen lds
s_mov_b32 s47, 4096
buffer_store_dwordx4 v[108:111], v19, s[16:19], s47 offen offset:1024
s_waitcnt lgkmcnt(12)
v_mfma_f32_32x32x16_bf16 v[160:175], a[160:163], a[140:143], v[160:175]
ds_read_b64_tr_b16 a[170:171], v39 offset:33024
v_mfma_f32_32x32x16_bf16 v[224:239], a[160:163], a[144:147], v[224:239]
ds_read_b64_tr_b16 a[160:161], v37 offset:32768
s_waitcnt lgkmcnt(12)
v_mfma_f32_32x32x16_bf16 v[176:191], a[164:167], a[140:143], v[176:191]
ds_read_b64_tr_b16 a[162:163], v37 offset:33792
v_mfma_f32_32x32x16_bf16 v[240:255], a[164:167], a[144:147], v[240:255]
ds_read_b64_tr_b16 a[164:165], v38 offset:32768
s_waitcnt lgkmcnt(12)
v_mfma_f32_32x32x16_bf16 a[208:223], a[172:175], a[148:151], a[208:223]
ds_read_b64_tr_b16 a[166:167], v38 offset:33792
ds_read_b64_tr_b16 a[172:173], v39 offset:34816
s_waitcnt lgkmcnt(9)
v_mfma_f32_32x32x16_bf16 v[128:143], a[152:155], a[128:131], v[128:143]
ds_read_b64_tr_b16 a[174:175], v39 offset:35072
ds_read_b128 a[140:143], v28 offset:8192
v_mfma_f32_32x32x16_bf16 v[192:207], a[152:155], a[132:135], v[192:207]
ds_read_b128 a[144:147], v28 offset:12288
ds_read_b64_tr_b16 a[152:153], v35 offset:36864
s_add_u32 m0, s3, 0
s_add_u32 s43, s54, 512
s_waitcnt lgkmcnt(11)
v_mfma_f32_32x32x16_bf16 v[144:159], a[156:159], a[128:131], v[144:159]
ds_read_b128 a[148:151], v32 offset:8192
ds_read_b64_tr_b16 a[154:155], v35 offset:37888
buffer_load_dwordx4 v20, s[20:23], s43 offen offset:0 lds
v_mfma_f32_32x32x16_bf16 v[208:223], a[156:159], a[132:135], v[208:223]
ds_read_b64_tr_b16 a[156:157], v36 offset:36864
buffer_load_dwordx4 v21, s[20:23], s43 offen offset:1024 lds
s_waitcnt lgkmcnt(12)
v_mfma_f32_32x32x16_bf16 a[176:191], a[168:171], a[128:131], a[176:191]
ds_read_b64_tr_b16 a[158:159], v36 offset:37888
buffer_load_dwordx4 v22, s[20:23], s43 offen offset:2048 lds
s_mov_b32 s47, 0
buffer_store_dwordx4 v[112:115], v19, s[16:19], s47 offen offset:2048
v_mfma_f32_32x32x16_bf16 a[192:207], a[168:171], a[132:135], a[192:207]
ds_read_b64_tr_b16 a[168:169], v39 offset:33792
buffer_load_dwordx4 v23, s[20:23], s43 offen offset:3072 lds
s_waitcnt lgkmcnt(12)
v_mfma_f32_32x32x16_bf16 v[160:175], a[160:163], a[128:131], v[160:175]
ds_read_b64_tr_b16 a[170:171], v39 offset:34048
v_mfma_f32_32x32x16_bf16 v[224:239], a[160:163], a[132:135], v[224:239]
ds_read_b64_tr_b16 a[160:161], v37 offset:36864
s_add_u32 m0, s3, 4096
s_add_u32 s43, s55, 512
s_waitcnt lgkmcnt(12)
v_mfma_f32_32x32x16_bf16 v[176:191], a[164:167], a[128:131], v[176:191]
ds_read_b64_tr_b16 a[162:163], v37 offset:37888
buffer_load_dwordx4 v20, s[20:23], s43 offen offset:0 lds
v_mfma_f32_32x32x16_bf16 v[240:255], a[164:167], a[132:135], v[240:255]
ds_read_b64_tr_b16 a[164:165], v38 offset:36864
buffer_load_dwordx4 v21, s[20:23], s43 offen offset:1024 lds
s_waitcnt lgkmcnt(12)
v_mfma_f32_32x32x16_bf16 a[208:223], a[172:175], a[136:139], a[208:223]
ds_read_b64_tr_b16 a[166:167], v38 offset:37888
ds_read_b64_tr_b16 a[172:173], v39 offset:35840
buffer_load_dwordx4 v22, s[20:23], s43 offen offset:2048 lds
s_waitcnt lgkmcnt(9)
v_mfma_f32_32x32x16_bf16 v[128:143], a[152:155], a[140:143], v[128:143]
ds_read_b64_tr_b16 a[174:175], v39 offset:36096
s_waitcnt vmcnt(14)
s_barrier
ds_read_b128 a[128:131], v29 offset:8192
buffer_load_dwordx4 v23, s[20:23], s43 offen offset:3072 lds
v_mfma_f32_32x32x16_bf16 v[192:207], a[152:155], a[144:147], v[192:207]
ds_read_b128 a[132:135], v29 offset:12288
ds_read_b64_tr_b16 a[152:153], v35 offset:49152
s_waitcnt lgkmcnt(11)
v_mfma_f32_32x32x16_bf16 v[144:159], a[156:159], a[140:143], v[144:159]
ds_read_b128 a[136:139], v33 offset:8192
ds_read_b64_tr_b16 a[154:155], v35 offset:50176
s_add_u32 m0, s46, 81920
s_mov_b32 s44, 2359296
v_mfma_f32_32x32x16_bf16 v[208:223], a[156:159], a[144:147], v[208:223]
ds_read_b64_tr_b16 a[156:157], v36 offset:49152
buffer_load_dwordx4 v24, s[24:27], s44 offen offset:0 lds
s_mov_b32 s47, 4096
buffer_store_dwordx4 v[116:119], v19, s[16:19], s47 offen offset:2048
s_waitcnt lgkmcnt(12)
v_mfma_f32_32x32x16_bf16 a[176:191], a[168:171], a[140:143], a[176:191]
ds_read_b64_tr_b16 a[158:159], v36 offset:50176
buffer_load_dwordx4 v25, s[24:27], s44 offen offset:1024 lds
v_mfma_f32_32x32x16_bf16 a[192:207], a[168:171], a[144:147], a[192:207]
ds_read_b64_tr_b16 a[168:169], v39 offset:49152
s_lshl_b32 s42, s38, 10
s_add_u32 m0, s42, 90112
s_mov_b32 s52, 792576
s_waitcnt lgkmcnt(12)
v_mfma_f32_32x32x16_bf16 v[160:175], a[160:163], a[140:143], v[160:175]
ds_read_b64_tr_b16 a[170:171], v39 offset:49408
buffer_load_dwordx4 v26, s[28:31], s52 offen lds
v_mfma_f32_32x32x16_bf16 v[224:239], a[160:163], a[144:147], v[224:239]
ds_read_b64_tr_b16 a[160:161], v37 offset:49152
s_waitcnt lgkmcnt(12)
v_mfma_f32_32x32x16_bf16 v[176:191], a[164:167], a[140:143], v[176:191]
ds_read_b64_tr_b16 a[162:163], v37 offset:50176
v_mfma_f32_32x32x16_bf16 v[240:255], a[164:167], a[144:147], v[240:255]
ds_read_b64_tr_b16 a[164:165], v38 offset:49152
s_waitcnt lgkmcnt(12)
v_mfma_f32_32x32x16_bf16 a[208:223], a[172:175], a[148:151], a[208:223]
ds_read_b64_tr_b16 a[166:167], v38 offset:50176
ds_read_b64_tr_b16 a[172:173], v39 offset:51200
s_waitcnt lgkmcnt(9)
v_mfma_f32_32x32x16_bf16 v[128:143], a[152:155], a[128:131], v[128:143]
ds_read_b64_tr_b16 a[174:175], v39 offset:51456
ds_read_b128 a[140:143], v30 offset:8192
v_mfma_f32_32x32x16_bf16 v[192:207], a[152:155], a[132:135], v[192:207]
ds_read_b128 a[144:147], v30 offset:12288
ds_read_b64_tr_b16 a[152:153], v35 offset:53248
s_waitcnt lgkmcnt(11)
v_mfma_f32_32x32x16_bf16 v[144:159], a[156:159], a[128:131], v[144:159]
ds_read_b128 a[148:151], v34 offset:8192
ds_read_b64_tr_b16 a[154:155], v35 offset:54272
s_mov_b32 s47, 0
buffer_store_dwordx4 v[120:123], v19, s[16:19], s47 offen offset:3072
v_mfma_f32_32x32x16_bf16 v[208:223], a[156:159], a[132:135], v[208:223]
ds_read_b64_tr_b16 a[156:157], v36 offset:53248
s_waitcnt lgkmcnt(12)
v_mfma_f32_32x32x16_bf16 a[176:191], a[168:171], a[128:131], a[176:191]
ds_read_b64_tr_b16 a[158:159], v36 offset:54272
v_mfma_f32_32x32x16_bf16 a[192:207], a[168:171], a[132:135], a[192:207]
ds_read_b64_tr_b16 a[168:169], v39 offset:50176
s_waitcnt lgkmcnt(12)
v_mfma_f32_32x32x16_bf16 v[160:175], a[160:163], a[128:131], v[160:175]
ds_read_b64_tr_b16 a[170:171], v39 offset:50432
v_mfma_f32_32x32x16_bf16 v[224:239], a[160:163], a[132:135], v[224:239]
ds_read_b64_tr_b16 a[160:161], v37 offset:53248
s_waitcnt lgkmcnt(12)
v_mfma_f32_32x32x16_bf16 v[176:191], a[164:167], a[128:131], v[176:191]
ds_read_b64_tr_b16 a[162:163], v37 offset:54272
v_mfma_f32_32x32x16_bf16 v[240:255], a[164:167], a[132:135], v[240:255]
ds_read_b64_tr_b16 a[164:165], v38 offset:53248
s_waitcnt lgkmcnt(12)
v_mfma_f32_32x32x16_bf16 a[208:223], a[172:175], a[136:139], a[208:223]
ds_read_b64_tr_b16 a[166:167], v38 offset:54272
ds_read_b64_tr_b16 a[172:173], v39 offset:52224
s_waitcnt lgkmcnt(9)
v_mfma_f32_32x32x16_bf16 v[128:143], a[152:155], a[140:143], v[128:143]
ds_read_b64_tr_b16 a[174:175], v39 offset:52480
s_waitcnt vmcnt(15)
s_barrier
s_waitcnt vmcnt(5)
ds_read_b128 a[128:131], v27 offset:0
v_mfma_f32_32x32x16_bf16 v[192:207], a[152:155], a[144:147], v[192:207]
ds_read_b128 a[132:135], v27 offset:4096
ds_read_b64_tr_b16 a[152:153], v35 offset:0
s_add_u32 m0, s46, 98304
s_mov_b32 s44, 2621440
s_waitcnt lgkmcnt(11)
v_mfma_f32_32x32x16_bf16 v[144:159], a[156:159], a[140:143], v[144:159]
ds_read_b128 a[136:139], v31 offset:0
ds_read_b64_tr_b16 a[154:155], v35 offset:1024
buffer_load_dwordx4 v24, s[24:27], s44 offen offset:0 lds
s_mov_b32 s47, 4096
buffer_store_dwordx4 v[124:127], v19, s[16:19], s47 offen offset:3072
v_mfma_f32_32x32x16_bf16 v[208:223], a[156:159], a[144:147], v[208:223]
ds_read_b64_tr_b16 a[156:157], v36 offset:0
buffer_load_dwordx4 v25, s[24:27], s44 offen offset:1024 lds
s_waitcnt lgkmcnt(12)
v_mfma_f32_32x32x16_bf16 a[176:191], a[168:171], a[140:143], a[176:191]
ds_read_b64_tr_b16 a[158:159], v36 offset:1024
s_lshl_b32 s42, s38, 10
s_add_u32 m0, s42, 106496
s_mov_b32 s52, 880640
v_mfma_f32_32x32x16_bf16 a[192:207], a[168:171], a[144:147], a[192:207]
ds_read_b64_tr_b16 a[168:169], v39 offset:0
buffer_load_dwordx4 v26, s[28:31], s52 offen lds
s_waitcnt lgkmcnt(12)
v_mfma_f32_32x32x16_bf16 v[160:175], a[160:163], a[140:143], v[160:175]
ds_read_b64_tr_b16 a[170:171], v39 offset:256
v_mfma_f32_32x32x16_bf16 v[224:239], a[160:163], a[144:147], v[224:239]
ds_read_b64_tr_b16 a[160:161], v37 offset:0
s_waitcnt lgkmcnt(12)
v_mfma_f32_32x32x16_bf16 v[176:191], a[164:167], a[140:143], v[176:191]
ds_read_b64_tr_b16 a[162:163], v37 offset:1024
v_mfma_f32_32x32x16_bf16 v[240:255], a[164:167], a[144:147], v[240:255]
ds_read_b64_tr_b16 a[164:165], v38 offset:0
s_waitcnt lgkmcnt(12)
v_mfma_f32_32x32x16_bf16 a[208:223], a[172:175], a[148:151], a[208:223]
ds_read_b64_tr_b16 a[166:167], v38 offset:1024
ds_read_b64_tr_b16 a[172:173], v39 offset:2048
s_waitcnt lgkmcnt(9)
v_mfma_f32_32x32x16_bf16 v[128:143], a[152:155], a[128:131], v[128:143]
ds_read_b64_tr_b16 a[174:175], v39 offset:2304
ds_read_b128 a[140:143], v28 offset:0
v_mfma_f32_32x32x16_bf16 v[192:207], a[152:155], a[132:135], v[192:207]
ds_read_b128 a[144:147], v28 offset:4096
ds_read_b64_tr_b16 a[152:153], v35 offset:4096
s_add_u32 m0, s3, 8192
s_add_u32 s43, s54, 640
s_mov_b32 s47, 0
buffer_store_dwordx4 a[0:3], v16, s[16:19], s47 offen offset:0
s_waitcnt lgkmcnt(11)
v_mfma_f32_32x32x16_bf16 v[144:159], a[156:159], a[128:131], v[144:159]
ds_read_b128 a[148:151], v32 offset:0
ds_read_b64_tr_b16 a[154:155], v35 offset:5120
buffer_load_dwordx4 v20, s[20:23], s43 offen offset:0 lds
v_mfma_f32_32x32x16_bf16 v[208:223], a[156:159], a[132:135], v[208:223]
ds_read_b64_tr_b16 a[156:157], v36 offset:4096
buffer_load_dwordx4 v21, s[20:23], s43 offen offset:1024 lds
s_waitcnt lgkmcnt(12)
v_mfma_f32_32x32x16_bf16 a[176:191], a[168:171], a[128:131], a[176:191]
ds_read_b64_tr_b16 a[158:159], v36 offset:5120
buffer_load_dwordx4 v22, s[20:23], s43 offen offset:2048 lds
v_mfma_f32_32x32x16_bf16 a[192:207], a[168:171], a[132:135], a[192:207]
ds_read_b64_tr_b16 a[168:169], v39 offset:1024
buffer_load_dwordx4 v23, s[20:23], s43 offen offset:3072 lds
s_waitcnt lgkmcnt(12)
v_mfma_f32_32x32x16_bf16 v[160:175], a[160:163], a[128:131], v[160:175]
ds_read_b64_tr_b16 a[170:171], v39 offset:1280
v_mfma_f32_32x32x16_bf16 v[224:239], a[160:163], a[132:135], v[224:239]
ds_read_b64_tr_b16 a[160:161], v37 offset:4096
s_add_u32 m0, s3, 12288
s_add_u32 s43, s55, 640
s_waitcnt lgkmcnt(12)
v_mfma_f32_32x32x16_bf16 v[176:191], a[164:167], a[128:131], v[176:191]
ds_read_b64_tr_b16 a[162:163], v37 offset:5120
buffer_load_dwordx4 v20, s[20:23], s43 offen offset:0 lds
v_mfma_f32_32x32x16_bf16 v[240:255], a[164:167], a[132:135], v[240:255]
ds_read_b64_tr_b16 a[164:165], v38 offset:4096
buffer_load_dwordx4 v21, s[20:23], s43 offen offset:1024 lds
s_waitcnt lgkmcnt(12)
v_mfma_f32_32x32x16_bf16 a[208:223], a[172:175], a[136:139], a[208:223]
ds_read_b64_tr_b16 a[166:167], v38 offset:5120
ds_read_b64_tr_b16 a[172:173], v39 offset:3072
buffer_load_dwordx4 v22, s[20:23], s43 offen offset:2048 lds
s_waitcnt lgkmcnt(9)
v_mfma_f32_32x32x16_bf16 v[128:143], a[152:155], a[140:143], v[128:143]
ds_read_b64_tr_b16 a[174:175], v39 offset:3328
s_waitcnt vmcnt(13)
s_barrier
ds_read_b128 a[128:131], v29 offset:0
buffer_load_dwordx4 v23, s[20:23], s43 offen offset:3072 lds
s_mov_b32 s47, 0
buffer_store_dwordx4 a[4:7], v16, s[16:19], s47 offen offset:1024
v_mfma_f32_32x32x16_bf16 v[192:207], a[152:155], a[144:147], v[192:207]
ds_read_b128 a[132:135], v29 offset:4096
ds_read_b64_tr_b16 a[152:153], v35 offset:16384
s_waitcnt lgkmcnt(11)
v_mfma_f32_32x32x16_bf16 v[144:159], a[156:159], a[140:143], v[144:159]
ds_read_b128 a[136:139], v33 offset:0
ds_read_b64_tr_b16 a[154:155], v35 offset:17408
s_add_u32 m0, s46, 114688
s_mov_b32 s44, 2883584
v_mfma_f32_32x32x16_bf16 v[208:223], a[156:159], a[144:147], v[208:223]
ds_read_b64_tr_b16 a[156:157], v36 offset:16384
buffer_load_dwordx4 v24, s[24:27], s44 offen offset:0 lds
s_waitcnt lgkmcnt(12)
v_mfma_f32_32x32x16_bf16 a[176:191], a[168:171], a[140:143], a[176:191]
ds_read_b64_tr_b16 a[158:159], v36 offset:17408
buffer_load_dwordx4 v25, s[24:27], s44 offen offset:1024 lds
v_mfma_f32_32x32x16_bf16 a[192:207], a[168:171], a[144:147], a[192:207]
ds_read_b64_tr_b16 a[168:169], v39 offset:16384
s_lshl_b32 s42, s38, 10
s_add_u32 m0, s42, 122880
s_mov_b32 s52, 968704
s_waitcnt lgkmcnt(12)
v_mfma_f32_32x32x16_bf16 v[160:175], a[160:163], a[140:143], v[160:175]
ds_read_b64_tr_b16 a[170:171], v39 offset:16640
buffer_load_dwordx4 v26, s[28:31], s52 offen lds
v_mfma_f32_32x32x16_bf16 v[224:239], a[160:163], a[144:147], v[224:239]
ds_read_b64_tr_b16 a[160:161], v37 offset:16384
s_waitcnt lgkmcnt(12)
v_mfma_f32_32x32x16_bf16 v[176:191], a[164:167], a[140:143], v[176:191]
ds_read_b64_tr_b16 a[162:163], v37 offset:17408
v_mfma_f32_32x32x16_bf16 v[240:255], a[164:167], a[144:147], v[240:255]
ds_read_b64_tr_b16 a[164:165], v38 offset:16384
s_waitcnt lgkmcnt(12)
v_mfma_f32_32x32x16_bf16 a[208:223], a[172:175], a[148:151], a[208:223]
ds_read_b64_tr_b16 a[166:167], v38 offset:17408
ds_read_b64_tr_b16 a[172:173], v39 offset:18432
s_mov_b32 s47, 0
buffer_store_dwordx4 a[16:19], v16, s[16:19], s47 offen offset:2048
s_waitcnt lgkmcnt(9)
v_mfma_f32_32x32x16_bf16 v[128:143], a[152:155], a[128:131], v[128:143]
ds_read_b64_tr_b16 a[174:175], v39 offset:18688
ds_read_b128 a[140:143], v30 offset:0
v_mfma_f32_32x32x16_bf16 v[192:207], a[152:155], a[132:135], v[192:207]
ds_read_b128 a[144:147], v30 offset:4096
ds_read_b64_tr_b16 a[152:153], v35 offset:20480
s_waitcnt lgkmcnt(11)
v_mfma_f32_32x32x16_bf16 v[144:159], a[156:159], a[128:131], v[144:159]
ds_read_b128 a[148:151], v34 offset:0
ds_read_b64_tr_b16 a[154:155], v35 offset:21504
v_mfma_f32_32x32x16_bf16 v[208:223], a[156:159], a[132:135], v[208:223]
ds_read_b64_tr_b16 a[156:157], v36 offset:20480
s_waitcnt lgkmcnt(12)
v_mfma_f32_32x32x16_bf16 a[176:191], a[168:171], a[128:131], a[176:191]
ds_read_b64_tr_b16 a[158:159], v36 offset:21504
v_mfma_f32_32x32x16_bf16 a[192:207], a[168:171], a[132:135], a[192:207]
ds_read_b64_tr_b16 a[168:169], v39 offset:17408
s_waitcnt lgkmcnt(12)
v_mfma_f32_32x32x16_bf16 v[160:175], a[160:163], a[128:131], v[160:175]
ds_read_b64_tr_b16 a[170:171], v39 offset:17664
v_mfma_f32_32x32x16_bf16 v[224:239], a[160:163], a[132:135], v[224:239]
ds_read_b64_tr_b16 a[160:161], v37 offset:20480
s_waitcnt lgkmcnt(12)
v_mfma_f32_32x32x16_bf16 v[176:191], a[164:167], a[128:131], v[176:191]
ds_read_b64_tr_b16 a[162:163], v37 offset:21504
v_mfma_f32_32x32x16_bf16 v[240:255], a[164:167], a[132:135], v[240:255]
ds_read_b64_tr_b16 a[164:165], v38 offset:20480
s_mov_b32 s47, 0
buffer_store_dwordx4 a[20:23], v16, s[16:19], s47 offen offset:3072
s_waitcnt lgkmcnt(12)
v_mfma_f32_32x32x16_bf16 a[208:223], a[172:175], a[136:139], a[208:223]
ds_read_b64_tr_b16 a[166:167], v38 offset:21504
ds_read_b64_tr_b16 a[172:173], v39 offset:19456
s_waitcnt lgkmcnt(9)
v_mfma_f32_32x32x16_bf16 v[128:143], a[152:155], a[140:143], v[128:143]
ds_read_b64_tr_b16 a[174:175], v39 offset:19712
s_waitcnt vmcnt(15)
s_barrier
s_waitcnt vmcnt(6)
ds_read_b128 a[128:131], v27 offset:8192
v_mfma_f32_32x32x16_bf16 v[192:207], a[152:155], a[144:147], v[192:207]
ds_read_b128 a[132:135], v27 offset:12288
ds_read_b64_tr_b16 a[152:153], v35 offset:32768
s_add_u32 m0, s46, 65536
s_mov_b32 s44, 3145728
s_waitcnt lgkmcnt(11)
v_mfma_f32_32x32x16_bf16 v[144:159], a[156:159], a[140:143], v[144:159]
ds_read_b128 a[136:139], v31 offset:8192
ds_read_b64_tr_b16 a[154:155], v35 offset:33792
buffer_load_dwordx4 v24, s[24:27], s44 offen offset:0 lds
v_mfma_f32_32x32x16_bf16 v[208:223], a[156:159], a[144:147], v[208:223]
ds_read_b64_tr_b16 a[156:157], v36 offset:32768
buffer_load_dwordx4 v25, s[24:27], s44 offen offset:1024 lds
s_waitcnt lgkmcnt(12)
v_mfma_f32_32x32x16_bf16 a[176:191], a[168:171], a[140:143], a[176:191]
ds_read_b64_tr_b16 a[158:159], v36 offset:33792
s_lshl_b32 s42, s38, 10
s_add_u32 m0, s42, 73728
s_mov_b32 s52, 1056768
v_mfma_f32_32x32x16_bf16 a[192:207], a[168:171], a[144:147], a[192:207]
ds_read_b64_tr_b16 a[168:169], v39 offset:32768
buffer_load_dwordx4 v26, s[28:31], s52 offen lds
s_waitcnt lgkmcnt(12)
v_mfma_f32_32x32x16_bf16 v[160:175], a[160:163], a[140:143], v[160:175]
ds_read_b64_tr_b16 a[170:171], v39 offset:33024
v_mfma_f32_32x32x16_bf16 v[224:239], a[160:163], a[144:147], v[224:239]
ds_read_b64_tr_b16 a[160:161], v37 offset:32768
s_waitcnt lgkmcnt(12)
v_mfma_f32_32x32x16_bf16 v[176:191], a[164:167], a[140:143], v[176:191]
ds_read_b64_tr_b16 a[162:163], v37 offset:33792
s_mov_b32 s47, 4096
buffer_store_dwordx4 a[32:35], v16, s[16:19], s47 offen offset:0
v_mfma_f32_32x32x16_bf16 v[240:255], a[164:167], a[144:147], v[240:255]
ds_read_b64_tr_b16 a[164:165], v38 offset:32768
s_waitcnt lgkmcnt(12)
v_mfma_f32_32x32x16_bf16 a[208:223], a[172:175], a[148:151], a[208:223]
ds_read_b64_tr_b16 a[166:167], v38 offset:33792
ds_read_b64_tr_b16 a[172:173], v39 offset:34816
s_waitcnt lgkmcnt(9)
v_mfma_f32_32x32x16_bf16 v[128:143], a[152:155], a[128:131], v[128:143]
ds_read_b64_tr_b16 a[174:175], v39 offset:35072
ds_read_b128 a[140:143], v28 offset:8192
v_mfma_f32_32x32x16_bf16 v[192:207], a[152:155], a[132:135], v[192:207]
ds_read_b128 a[144:147], v28 offset:12288
ds_read_b64_tr_b16 a[152:153], v35 offset:36864
s_add_u32 m0, s3, 0
s_add_u32 s43, s54, 768
s_waitcnt lgkmcnt(11)
v_mfma_f32_32x32x16_bf16 v[144:159], a[156:159], a[128:131], v[144:159]
ds_read_b128 a[148:151], v32 offset:8192
ds_read_b64_tr_b16 a[154:155], v35 offset:37888
buffer_load_dwordx4 v20, s[20:23], s43 offen offset:0 lds
v_mfma_f32_32x32x16_bf16 v[208:223], a[156:159], a[132:135], v[208:223]
ds_read_b64_tr_b16 a[156:157], v36 offset:36864
buffer_load_dwordx4 v21, s[20:23], s43 offen offset:1024 lds
s_waitcnt lgkmcnt(12)
v_mfma_f32_32x32x16_bf16 a[176:191], a[168:171], a[128:131], a[176:191]
ds_read_b64_tr_b16 a[158:159], v36 offset:37888
buffer_load_dwordx4 v22, s[20:23], s43 offen offset:2048 lds
v_mfma_f32_32x32x16_bf16 a[192:207], a[168:171], a[132:135], a[192:207]
ds_read_b64_tr_b16 a[168:169], v39 offset:33792
buffer_load_dwordx4 v23, s[20:23], s43 offen offset:3072 lds
s_waitcnt lgkmcnt(12)
v_mfma_f32_32x32x16_bf16 v[160:175], a[160:163], a[128:131], v[160:175]
ds_read_b64_tr_b16 a[170:171], v39 offset:34048
v_mfma_f32_32x32x16_bf16 v[224:239], a[160:163], a[132:135], v[224:239]
ds_read_b64_tr_b16 a[160:161], v37 offset:36864
s_add_u32 m0, s3, 4096
s_add_u32 s43, s55, 768
s_mov_b32 s47, 4096
buffer_store_dwordx4 a[36:39], v16, s[16:19], s47 offen offset:1024
s_waitcnt lgkmcnt(12)
v_mfma_f32_32x32x16_bf16 v[176:191], a[164:167], a[128:131], v[176:191]
ds_read_b64_tr_b16 a[162:163], v37 offset:37888
buffer_load_dwordx4 v20, s[20:23], s43 offen offset:0 lds
v_mfma_f32_32x32x16_bf16 v[240:255], a[164:167], a[132:135], v[240:255]
ds_read_b64_tr_b16 a[164:165], v38 offset:36864
buffer_load_dwordx4 v21, s[20:23], s43 offen offset:1024 lds
s_waitcnt lgkmcnt(12)
v_mfma_f32_32x32x16_bf16 a[208:223], a[172:175], a[136:139], a[208:223]
ds_read_b64_tr_b16 a[166:167], v38 offset:37888
ds_read_b64_tr_b16 a[172:173], v39 offset:35840
buffer_load_dwordx4 v22, s[20:23], s43 offen offset:2048 lds
s_waitcnt lgkmcnt(9)
v_mfma_f32_32x32x16_bf16 v[128:143], a[152:155], a[140:143], v[128:143]
ds_read_b64_tr_b16 a[174:175], v39 offset:36096
s_waitcnt vmcnt(14)
s_barrier
ds_read_b128 a[128:131], v29 offset:8192
buffer_load_dwordx4 v23, s[20:23], s43 offen offset:3072 lds
v_mfma_f32_32x32x16_bf16 v[192:207], a[152:155], a[144:147], v[192:207]
ds_read_b128 a[132:135], v29 offset:12288
ds_read_b64_tr_b16 a[152:153], v35 offset:49152
s_waitcnt lgkmcnt(11)
v_mfma_f32_32x32x16_bf16 v[144:159], a[156:159], a[140:143], v[144:159]
ds_read_b128 a[136:139], v33 offset:8192
ds_read_b64_tr_b16 a[154:155], v35 offset:50176
s_add_u32 m0, s46, 81920
s_mov_b32 s44, 3407872
v_mfma_f32_32x32x16_bf16 v[208:223], a[156:159], a[144:147], v[208:223]
ds_read_b64_tr_b16 a[156:157], v36 offset:49152
buffer_load_dwordx4 v24, s[24:27], s44 offen offset:0 lds
s_waitcnt lgkmcnt(12)
v_mfma_f32_32x32x16_bf16 a[176:191], a[168:171], a[140:143], a[176:191]
ds_read_b64_tr_b16 a[158:159], v36 offset:50176
buffer_load_dwordx4 v25, s[24:27], s44 offen offset:1024 lds
v_mfma_f32_32x32x16_bf16 a[192:207], a[168:171], a[144:147], a[192:207]
ds_read_b64_tr_b16 a[168:169], v39 offset:49152
s_lshl_b32 s42, s38, 10
s_add_u32 m0, s42, 90112
s_mov_b32 s52, 1144832
s_waitcnt lgkmcnt(12)
v_mfma_f32_32x32x16_bf16 v[160:175], a[160:163], a[140:143], v[160:175]
ds_read_b64_tr_b16 a[170:171], v39 offset:49408
buffer_load_dwordx4 v26, s[28:31], s52 offen lds
v_mfma_f32_32x32x16_bf16 v[224:239], a[160:163], a[144:147], v[224:239]
ds_read_b64_tr_b16 a[160:161], v37 offset:49152
s_mov_b32 s47, 4096
buffer_store_dwordx4 a[48:51], v16, s[16:19], s47 offen offset:2048
s_waitcnt lgkmcnt(12)
v_mfma_f32_32x32x16_bf16 v[176:191], a[164:167], a[140:143], v[176:191]
ds_read_b64_tr_b16 a[162:163], v37 offset:50176
v_mfma_f32_32x32x16_bf16 v[240:255], a[164:167], a[144:147], v[240:255]
ds_read_b64_tr_b16 a[164:165], v38 offset:49152
s_waitcnt lgkmcnt(12)
v_mfma_f32_32x32x16_bf16 a[208:223], a[172:175], a[148:151], a[208:223]
ds_read_b64_tr_b16 a[166:167], v38 offset:50176
ds_read_b64_tr_b16 a[172:173], v39 offset:51200
s_waitcnt lgkmcnt(9)
v_mfma_f32_32x32x16_bf16 v[128:143], a[152:155], a[128:131], v[128:143]
ds_read_b64_tr_b16 a[174:175], v39 offset:51456
ds_read_b128 a[140:143], v30 offset:8192
v_mfma_f32_32x32x16_bf16 v[192:207], a[152:155], a[132:135], v[192:207]
ds_read_b128 a[144:147], v30 offset:12288
ds_read_b64_tr_b16 a[152:153], v35 offset:53248
s_waitcnt lgkmcnt(11)
v_mfma_f32_32x32x16_bf16 v[144:159], a[156:159], a[128:131], v[144:159]
ds_read_b128 a[148:151], v34 offset:8192
ds_read_b64_tr_b16 a[154:155], v35 offset:54272
v_mfma_f32_32x32x16_bf16 v[208:223], a[156:159], a[132:135], v[208:223]
ds_read_b64_tr_b16 a[156:157], v36 offset:53248
s_waitcnt lgkmcnt(12)
v_mfma_f32_32x32x16_bf16 a[176:191], a[168:171], a[128:131], a[176:191]
ds_read_b64_tr_b16 a[158:159], v36 offset:54272
v_mfma_f32_32x32x16_bf16 a[192:207], a[168:171], a[132:135], a[192:207]
ds_read_b64_tr_b16 a[168:169], v39 offset:50176
s_waitcnt lgkmcnt(12)
v_mfma_f32_32x32x16_bf16 v[160:175], a[160:163], a[128:131], v[160:175]
ds_read_b64_tr_b16 a[170:171], v39 offset:50432
s_mov_b32 s47, 4096
buffer_store_dwordx4 a[52:55], v16, s[16:19], s47 offen offset:3072
v_mfma_f32_32x32x16_bf16 v[224:239], a[160:163], a[132:135], v[224:239]
ds_read_b64_tr_b16 a[160:161], v37 offset:53248
s_waitcnt lgkmcnt(12)
v_mfma_f32_32x32x16_bf16 v[176:191], a[164:167], a[128:131], v[176:191]
ds_read_b64_tr_b16 a[162:163], v37 offset:54272
v_mfma_f32_32x32x16_bf16 v[240:255], a[164:167], a[132:135], v[240:255]
ds_read_b64_tr_b16 a[164:165], v38 offset:53248
s_waitcnt lgkmcnt(12)
v_mfma_f32_32x32x16_bf16 a[208:223], a[172:175], a[136:139], a[208:223]
ds_read_b64_tr_b16 a[166:167], v38 offset:54272
ds_read_b64_tr_b16 a[172:173], v39 offset:52224
s_waitcnt lgkmcnt(9)
v_mfma_f32_32x32x16_bf16 v[128:143], a[152:155], a[140:143], v[128:143]
ds_read_b64_tr_b16 a[174:175], v39 offset:52480
s_waitcnt vmcnt(15)
s_barrier
s_waitcnt vmcnt(5)
ds_read_b128 a[128:131], v27 offset:0
v_mfma_f32_32x32x16_bf16 v[192:207], a[152:155], a[144:147], v[192:207]
ds_read_b128 a[132:135], v27 offset:4096
ds_read_b64_tr_b16 a[152:153], v35 offset:0
s_add_u32 m0, s46, 98304
s_mov_b32 s44, 3670016
s_waitcnt lgkmcnt(11)
v_mfma_f32_32x32x16_bf16 v[144:159], a[156:159], a[140:143], v[144:159]
ds_read_b128 a[136:139], v31 offset:0
ds_read_b64_tr_b16 a[154:155], v35 offset:1024
buffer_load_dwordx4 v24, s[24:27], s44 offen offset:0 lds
v_mfma_f32_32x32x16_bf16 v[208:223], a[156:159], a[144:147], v[208:223]
ds_read_b64_tr_b16 a[156:157], v36 offset:0
buffer_load_dwordx4 v25, s[24:27], s44 offen offset:1024 lds
s_waitcnt lgkmcnt(12)
v_mfma_f32_32x32x16_bf16 a[176:191], a[168:171], a[140:143], a[176:191]
ds_read_b64_tr_b16 a[158:159], v36 offset:1024
s_lshl_b32 s42, s38, 10
s_add_u32 m0, s42, 106496
s_mov_b32 s52, 1232896
v_mfma_f32_32x32x16_bf16 a[192:207], a[168:171], a[144:147], a[192:207]
ds_read_b64_tr_b16 a[168:169], v39 offset:0
buffer_load_dwordx4 v26, s[28:31], s52 offen lds
s_mov_b32 s47, 0
buffer_store_dwordx4 a[8:11], v18, s[16:19], s47 offen offset:0
s_waitcnt lgkmcnt(12)
v_mfma_f32_32x32x16_bf16 v[160:175], a[160:163], a[140:143], v[160:175]
ds_read_b64_tr_b16 a[170:171], v39 offset:256
v_mfma_f32_32x32x16_bf16 v[224:239], a[160:163], a[144:147], v[224:239]
ds_read_b64_tr_b16 a[160:161], v37 offset:0
s_waitcnt lgkmcnt(12)
v_mfma_f32_32x32x16_bf16 v[176:191], a[164:167], a[140:143], v[176:191]
ds_read_b64_tr_b16 a[162:163], v37 offset:1024
v_mfma_f32_32x32x16_bf16 v[240:255], a[164:167], a[144:147], v[240:255]
ds_read_b64_tr_b16 a[164:165], v38 offset:0
s_waitcnt lgkmcnt(12)
v_mfma_f32_32x32x16_bf16 a[208:223], a[172:175], a[148:151], a[208:223]
ds_read_b64_tr_b16 a[166:167], v38 offset:1024
ds_read_b64_tr_b16 a[172:173], v39 offset:2048
s_waitcnt lgkmcnt(9)
v_mfma_f32_32x32x16_bf16 v[128:143], a[152:155], a[128:131], v[128:143]
ds_read_b64_tr_b16 a[174:175], v39 offset:2304
ds_read_b128 a[140:143], v28 offset:0
v_mfma_f32_32x32x16_bf16 v[192:207], a[152:155], a[132:135], v[192:207]
ds_read_b128 a[144:147], v28 offset:4096
ds_read_b64_tr_b16 a[152:153], v35 offset:4096
s_add_u32 m0, s3, 8192
s_add_u32 s43, s54, 896
s_waitcnt lgkmcnt(11)
v_mfma_f32_32x32x16_bf16 v[144:159], a[156:159], a[128:131], v[144:159]
ds_read_b128 a[148:151], v32 offset:0
ds_read_b64_tr_b16 a[154:155], v35 offset:5120
buffer_load_dwordx4 v20, s[20:23], s43 offen offset:0 lds
v_mfma_f32_32x32x16_bf16 v[208:223], a[156:159], a[132:135], v[208:223]
ds_read_b64_tr_b16 a[156:157], v36 offset:4096
buffer_load_dwordx4 v21, s[20:23], s43 offen offset:1024 lds
s_waitcnt lgkmcnt(12)
v_mfma_f32_32x32x16_bf16 a[176:191], a[168:171], a[128:131], a[176:191]
ds_read_b64_tr_b16 a[158:159], v36 offset:5120
buffer_load_dwordx4 v22, s[20:23], s43 offen offset:2048 lds
s_mov_b32 s47, 0
buffer_store_dwordx4 a[12:15], v18, s[16:19], s47 offen offset:1024
v_mfma_f32_32x32x16_bf16 a[192:207], a[168:171], a[132:135], a[192:207]
ds_read_b64_tr_b16 a[168:169], v39 offset:1024
buffer_load_dwordx4 v23, s[20:23], s43 offen offset:3072 lds
s_waitcnt lgkmcnt(12)
v_mfma_f32_32x32x16_bf16 v[160:175], a[160:163], a[128:131], v[160:175]
ds_read_b64_tr_b16 a[170:171], v39 offset:1280
v_mfma_f32_32x32x16_bf16 v[224:239], a[160:163], a[132:135], v[224:239]
ds_read_b64_tr_b16 a[160:161], v37 offset:4096
s_add_u32 m0, s3, 12288
s_add_u32 s43, s55, 896
s_waitcnt lgkmcnt(12)
v_mfma_f32_32x32x16_bf16 v[176:191], a[164:167], a[128:131], v[176:191]
ds_read_b64_tr_b16 a[162:163], v37 offset:5120
buffer_load_dwordx4 v20, s[20:23], s43 offen offset:0 lds
v_mfma_f32_32x32x16_bf16 v[240:255], a[164:167], a[132:135], v[240:255]
ds_read_b64_tr_b16 a[164:165], v38 offset:4096
buffer_load_dwordx4 v21, s[20:23], s43 offen offset:1024 lds
s_waitcnt lgkmcnt(12)
v_mfma_f32_32x32x16_bf16 a[208:223], a[172:175], a[136:139], a[208:223]
ds_read_b64_tr_b16 a[166:167], v38 offset:5120
ds_read_b64_tr_b16 a[172:173], v39 offset:3072
buffer_load_dwordx4 v22, s[20:23], s43 offen offset:2048 lds
s_waitcnt lgkmcnt(9)
v_mfma_f32_32x32x16_bf16 v[128:143], a[152:155], a[140:143], v[128:143]
ds_read_b64_tr_b16 a[174:175], v39 offset:3328
s_waitcnt vmcnt(14)
s_barrier
ds_read_b128 a[128:131], v29 offset:0
buffer_load_dwordx4 v23, s[20:23], s43 offen offset:3072 lds
v_mfma_f32_32x32x16_bf16 v[192:207], a[152:155], a[144:147], v[192:207]
ds_read_b128 a[132:135], v29 offset:4096
ds_read_b64_tr_b16 a[152:153], v35 offset:16384
s_waitcnt lgkmcnt(11)
v_mfma_f32_32x32x16_bf16 v[144:159], a[156:159], a[140:143], v[144:159]
ds_read_b128 a[136:139], v33 offset:0
ds_read_b64_tr_b16 a[154:155], v35 offset:17408
s_add_u32 m0, s46, 114688
s_mov_b32 s44, 3932160
v_mfma_f32_32x32x16_bf16 v[208:223], a[156:159], a[144:147], v[208:223]
ds_read_b64_tr_b16 a[156:157], v36 offset:16384
buffer_load_dwordx4 v24, s[24:27], s44 offen offset:0 lds
s_mov_b32 s47, 0
buffer_store_dwordx4 a[24:27], v18, s[16:19], s47 offen offset:2048
s_waitcnt lgkmcnt(12)
v_mfma_f32_32x32x16_bf16 a[176:191], a[168:171], a[140:143], a[176:191]
ds_read_b64_tr_b16 a[158:159], v36 offset:17408
buffer_load_dwordx4 v25, s[24:27], s44 offen offset:1024 lds
v_mfma_f32_32x32x16_bf16 a[192:207], a[168:171], a[144:147], a[192:207]
ds_read_b64_tr_b16 a[168:169], v39 offset:16384
s_lshl_b32 s42, s38, 10
s_add_u32 m0, s42, 122880
s_mov_b32 s52, 1320960
s_waitcnt lgkmcnt(12)
v_mfma_f32_32x32x16_bf16 v[160:175], a[160:163], a[140:143], v[160:175]
ds_read_b64_tr_b16 a[170:171], v39 offset:16640
buffer_load_dwordx4 v26, s[28:31], s52 offen lds
v_mfma_f32_32x32x16_bf16 v[224:239], a[160:163], a[144:147], v[224:239]
ds_read_b64_tr_b16 a[160:161], v37 offset:16384
s_waitcnt lgkmcnt(12)
v_mfma_f32_32x32x16_bf16 v[176:191], a[164:167], a[140:143], v[176:191]
ds_read_b64_tr_b16 a[162:163], v37 offset:17408
v_mfma_f32_32x32x16_bf16 v[240:255], a[164:167], a[144:147], v[240:255]
ds_read_b64_tr_b16 a[164:165], v38 offset:16384
s_waitcnt lgkmcnt(12)
v_mfma_f32_32x32x16_bf16 a[208:223], a[172:175], a[148:151], a[208:223]
ds_read_b64_tr_b16 a[166:167], v38 offset:17408
ds_read_b64_tr_b16 a[172:173], v39 offset:18432
s_waitcnt lgkmcnt(9)
v_mfma_f32_32x32x16_bf16 v[128:143], a[152:155], a[128:131], v[128:143]
ds_read_b64_tr_b16 a[174:175], v39 offset:18688
ds_read_b128 a[140:143], v30 offset:0
v_and_b32 v56, 31, v1
v_mfma_f32_32x32x16_bf16 v[192:207], a[152:155], a[132:135], v[192:207]
ds_read_b128 a[144:147], v30 offset:4096
ds_read_b64_tr_b16 a[152:153], v35 offset:20480
v_add_u32 v57, s48, v56
s_waitcnt lgkmcnt(11)
v_mfma_f32_32x32x16_bf16 v[144:159], a[156:159], a[128:131], v[144:159]
ds_read_b128 a[148:151], v34 offset:0
ds_read_b64_tr_b16 a[154:155], v35 offset:21504
s_mov_b32 s47, 0
buffer_store_dwordx4 a[28:31], v18, s[16:19], s47 offen offset:3072
v_lshlrev_b32 v57, 4, v57
v_mfma_f32_32x32x16_bf16 v[208:223], a[156:159], a[132:135], v[208:223]
ds_read_b64_tr_b16 a[156:157], v36 offset:20480
v_add_u32 v57, 0x3800000, v57
s_waitcnt lgkmcnt(12)
v_mfma_f32_32x32x16_bf16 a[176:191], a[168:171], a[128:131], a[176:191]
ds_read_b64_tr_b16 a[158:159], v36 offset:21504
buffer_load_dwordx4 v[8:11], v57, s[16:19], 0 offen sc1
v_mfma_f32_32x32x16_bf16 a[192:207], a[168:171], a[132:135], a[192:207]
ds_read_b64_tr_b16 a[168:169], v39 offset:17408
v_add_u32 v57, s49, v56
v_lshlrev_b32 v57, 4, v57
s_waitcnt lgkmcnt(12)
v_mfma_f32_32x32x16_bf16 v[160:175], a[160:163], a[128:131], v[160:175]
ds_read_b64_tr_b16 a[170:171], v39 offset:17664
v_add_u32 v57, 0x3800000, v57
v_mfma_f32_32x32x16_bf16 v[224:239], a[160:163], a[132:135], v[224:239]
ds_read_b64_tr_b16 a[160:161], v37 offset:20480
buffer_load_dwordx4 v[12:15], v57, s[16:19], 0 offen sc1
s_waitcnt lgkmcnt(12)
v_mfma_f32_32x32x16_bf16 v[176:191], a[164:167], a[128:131], v[176:191]
ds_read_b64_tr_b16 a[162:163], v37 offset:21504
v_lshrrev_b32 v56, 5, v1
v_lshlrev_b32 v56, 3, v56
v_mfma_f32_32x32x16_bf16 v[240:255], a[164:167], a[132:135], v[240:255]
ds_read_b64_tr_b16 a[164:165], v38 offset:20480
s_lshl_b32 s76, s36, 6
s_waitcnt lgkmcnt(12)
v_mfma_f32_32x32x16_bf16 a[208:223], a[172:175], a[136:139], a[208:223]
ds_read_b64_tr_b16 a[166:167], v38 offset:21504
ds_read_b64_tr_b16 a[172:173], v39 offset:19456
buffer_load_dwordx2 v[40:41], v56, s[56:59], s76 offen offset:0
s_waitcnt lgkmcnt(9)
v_mfma_f32_32x32x16_bf16 v[128:143], a[152:155], a[140:143], v[128:143]
ds_read_b64_tr_b16 a[174:175], v39 offset:19712
s_waitcnt vmcnt(18)
s_barrier
s_waitcnt vmcnt(8)
ds_read_b128 a[128:131], v27 offset:8192
v_mfma_f32_32x32x16_bf16 v[192:207], a[152:155], a[144:147], v[192:207]
ds_read_b128 a[132:135], v27 offset:12288
ds_read_b64_tr_b16 a[152:153], v35 offset:32768
s_mov_b32 s47, 4096
buffer_store_dwordx4 a[40:43], v18, s[16:19], s47 offen offset:0
buffer_load_dwordx2 v[42:43], v56, s[56:59], s76 offen offset:16
s_waitcnt lgkmcnt(11)
v_mfma_f32_32x32x16_bf16 v[144:159], a[156:159], a[140:143], v[144:159]
ds_read_b128 a[136:139], v31 offset:8192
ds_read_b64_tr_b16 a[154:155], v35 offset:33792
buffer_load_dwordx2 v[44:45], v56, s[56:59], s76 offen offset:32
v_mfma_f32_32x32x16_bf16 v[208:223], a[156:159], a[144:147], v[208:223]
ds_read_b64_tr_b16 a[156:157], v36 offset:32768
buffer_load_dwordx2 v[46:47], v56, s[56:59], s76 offen offset:48
s_waitcnt lgkmcnt(12)
v_mfma_f32_32x32x16_bf16 a[176:191], a[168:171], a[140:143], a[176:191]
ds_read_b64_tr_b16 a[158:159], v36 offset:33792
s_lshl_b32 s76, s50, 6
buffer_load_dwordx2 v[48:49], v56, s[56:59], s76 offen offset:0
v_mfma_f32_32x32x16_bf16 a[192:207], a[168:171], a[144:147], a[192:207]
ds_read_b64_tr_b16 a[168:169], v39 offset:32768
buffer_load_dwordx2 v[50:51], v56, s[56:59], s76 offen offset:16
s_waitcnt lgkmcnt(12)
v_mfma_f32_32x32x16_bf16 v[160:175], a[160:163], a[140:143], v[160:175]
ds_read_b64_tr_b16 a[170:171], v39 offset:33024
buffer_load_dwordx2 v[52:53], v56, s[56:59], s76 offen offset:32
v_mfma_f32_32x32x16_bf16 v[224:239], a[160:163], a[144:147], v[224:239]
ds_read_b64_tr_b16 a[160:161], v37 offset:32768
buffer_load_dwordx2 v[54:55], v56, s[56:59], s76 offen offset:48
v_lshlrev_b32 v58, 2, v1
s_waitcnt lgkmcnt(12)
v_mfma_f32_32x32x16_bf16 v[176:191], a[164:167], a[140:143], v[176:191]
ds_read_b64_tr_b16 a[162:163], v37 offset:33792
s_lshl_b32 s77, s36, 11
v_mfma_f32_32x32x16_bf16 v[240:255], a[164:167], a[144:147], v[240:255]
ds_read_b64_tr_b16 a[164:165], v38 offset:32768
s_add_u32 s77, s77, 0x3a00000
s_waitcnt lgkmcnt(12)
v_mfma_f32_32x32x16_bf16 a[208:223], a[172:175], a[148:151], a[208:223]
ds_read_b64_tr_b16 a[166:167], v38 offset:33792
ds_read_b64_tr_b16 a[172:173], v39 offset:34816
buffer_load_dword v2, v58, s[16:19], s77 offen offset:0 sc1
s_waitcnt lgkmcnt(9)
v_mfma_f32_32x32x16_bf16 v[128:143], a[152:155], a[128:131], v[128:143]
ds_read_b64_tr_b16 a[174:175], v39 offset:35072
ds_read_b128 a[140:143], v28 offset:8192
buffer_load_dword v3, v58, s[16:19], s77 offen offset:256 sc1
v_mfma_f32_32x32x16_bf16 v[192:207], a[152:155], a[132:135], v[192:207]
ds_read_b128 a[144:147], v28 offset:12288
ds_read_b64_tr_b16 a[152:153], v35 offset:36864
s_mov_b32 s47, 4096
buffer_store_dwordx4 a[44:47], v18, s[16:19], s47 offen offset:1024
buffer_load_dword v4, v58, s[16:19], s77 offen offset:512 sc1
s_waitcnt lgkmcnt(11)
v_mfma_f32_32x32x16_bf16 v[144:159], a[156:159], a[128:131], v[144:159]
ds_read_b128 a[148:151], v32 offset:8192
ds_read_b64_tr_b16 a[154:155], v35 offset:37888
buffer_load_dword v5, v58, s[16:19], s77 offen offset:768 sc1
v_mfma_f32_32x32x16_bf16 v[208:223], a[156:159], a[132:135], v[208:223]
ds_read_b64_tr_b16 a[156:157], v36 offset:36864
buffer_load_dword v6, v58, s[16:19], s77 offen offset:1024 sc1
s_waitcnt lgkmcnt(12)
v_mfma_f32_32x32x16_bf16 a[176:191], a[168:171], a[128:131], a[176:191]
ds_read_b64_tr_b16 a[158:159], v36 offset:37888
buffer_load_dword v7, v58, s[16:19], s77 offen offset:1280 sc1
buffer_load_dword v59, v58, s[16:19], s77 offen offset:1536 sc1
v_mfma_f32_32x32x16_bf16 a[192:207], a[168:171], a[132:135], a[192:207]
ds_read_b64_tr_b16 a[168:169], v39 offset:33792
buffer_load_dword v60, v58, s[16:19], s77 offen offset:1792 sc1
s_waitcnt lgkmcnt(12)
v_mfma_f32_32x32x16_bf16 v[160:175], a[160:163], a[128:131], v[160:175]
ds_read_b64_tr_b16 a[170:171], v39 offset:34048
v_mfma_f32_32x32x16_bf16 v[224:239], a[160:163], a[132:135], v[224:239]
ds_read_b64_tr_b16 a[160:161], v37 offset:36864
s_waitcnt lgkmcnt(12)
v_mfma_f32_32x32x16_bf16 v[176:191], a[164:167], a[128:131], v[176:191]
ds_read_b64_tr_b16 a[162:163], v37 offset:37888
v_mfma_f32_32x32x16_bf16 v[240:255], a[164:167], a[132:135], v[240:255]
ds_read_b64_tr_b16 a[164:165], v38 offset:36864
s_waitcnt lgkmcnt(12)
v_mfma_f32_32x32x16_bf16 a[208:223], a[172:175], a[136:139], a[208:223]
ds_read_b64_tr_b16 a[166:167], v38 offset:37888
ds_read_b64_tr_b16 a[172:173], v39 offset:35840
s_waitcnt lgkmcnt(9)
v_mfma_f32_32x32x16_bf16 v[128:143], a[152:155], a[140:143], v[128:143]
ds_read_b64_tr_b16 a[174:175], v39 offset:36096
s_waitcnt vmcnt(21)
s_barrier
ds_read_b128 a[128:131], v29 offset:8192
s_mov_b32 s47, 4096
buffer_store_dwordx4 a[56:59], v18, s[16:19], s47 offen offset:2048
v_mfma_f32_32x32x16_bf16 v[192:207], a[152:155], a[144:147], v[192:207]
ds_read_b128 a[132:135], v29 offset:12288
ds_read_b64_tr_b16 a[152:153], v35 offset:49152
s_waitcnt lgkmcnt(11)
v_mfma_f32_32x32x16_bf16 v[144:159], a[156:159], a[140:143], v[144:159]
ds_read_b128 a[136:139], v33 offset:8192
ds_read_b64_tr_b16 a[154:155], v35 offset:50176
v_mfma_f32_32x32x16_bf16 v[208:223], a[156:159], a[144:147], v[208:223]
ds_read_b64_tr_b16 a[156:157], v36 offset:49152
s_waitcnt lgkmcnt(12)
v_mfma_f32_32x32x16_bf16 a[176:191], a[168:171], a[140:143], a[176:191]
ds_read_b64_tr_b16 a[158:159], v36 offset:50176
v_mfma_f32_32x32x16_bf16 a[192:207], a[168:171], a[144:147], a[192:207]
ds_read_b64_tr_b16 a[168:169], v39 offset:49152
s_waitcnt lgkmcnt(12)
v_mfma_f32_32x32x16_bf16 v[160:175], a[160:163], a[140:143], v[160:175]
ds_read_b64_tr_b16 a[170:171], v39 offset:49408
v_mfma_f32_32x32x16_bf16 v[224:239], a[160:163], a[144:147], v[224:239]
ds_read_b64_tr_b16 a[160:161], v37 offset:49152
s_waitcnt lgkmcnt(12)
v_mfma_f32_32x32x16_bf16 v[176:191], a[164:167], a[140:143], v[176:191]
ds_read_b64_tr_b16 a[162:163], v37 offset:50176
v_mfma_f32_32x32x16_bf16 v[240:255], a[164:167], a[144:147], v[240:255]
ds_read_b64_tr_b16 a[164:165], v38 offset:49152
s_waitcnt lgkmcnt(12)
v_mfma_f32_32x32x16_bf16 a[208:223], a[172:175], a[148:151], a[208:223]
ds_read_b64_tr_b16 a[166:167], v38 offset:50176
ds_read_b64_tr_b16 a[172:173], v39 offset:51200
s_mov_b32 s47, 4096
buffer_store_dwordx4 a[60:63], v18, s[16:19], s47 offen offset:3072
s_waitcnt lgkmcnt(9)
v_mfma_f32_32x32x16_bf16 v[128:143], a[152:155], a[128:131], v[128:143]
ds_read_b64_tr_b16 a[174:175], v39 offset:51456
ds_read_b128 a[140:143], v30 offset:8192
v_mfma_f32_32x32x16_bf16 v[192:207], a[152:155], a[132:135], v[192:207]
ds_read_b128 a[144:147], v30 offset:12288
ds_read_b64_tr_b16 a[152:153], v35 offset:53248
s_waitcnt lgkmcnt(11)
v_mfma_f32_32x32x16_bf16 v[144:159], a[156:159], a[128:131], v[144:159]
ds_read_b128 a[148:151], v34 offset:8192
ds_read_b64_tr_b16 a[154:155], v35 offset:54272
v_mfma_f32_32x32x16_bf16 v[208:223], a[156:159], a[132:135], v[208:223]
ds_read_b64_tr_b16 a[156:157], v36 offset:53248
s_waitcnt lgkmcnt(12)
v_mfma_f32_32x32x16_bf16 a[176:191], a[168:171], a[128:131], a[176:191]
ds_read_b64_tr_b16 a[158:159], v36 offset:54272
v_mfma_f32_32x32x16_bf16 a[192:207], a[168:171], a[132:135], a[192:207]
ds_read_b64_tr_b16 a[168:169], v39 offset:50176
s_waitcnt lgkmcnt(12)
v_mfma_f32_32x32x16_bf16 v[160:175], a[160:163], a[128:131], v[160:175]
ds_read_b64_tr_b16 a[170:171], v39 offset:50432
v_mfma_f32_32x32x16_bf16 v[224:239], a[160:163], a[132:135], v[224:239]
ds_read_b64_tr_b16 a[160:161], v37 offset:53248
s_waitcnt lgkmcnt(12)
v_mfma_f32_32x32x16_bf16 v[176:191], a[164:167], a[128:131], v[176:191]
ds_read_b64_tr_b16 a[162:163], v37 offset:54272
v_mfma_f32_32x32x16_bf16 v[240:255], a[164:167], a[132:135], v[240:255]
ds_read_b64_tr_b16 a[164:165], v38 offset:53248
s_waitcnt lgkmcnt(12)
v_mfma_f32_32x32x16_bf16 a[208:223], a[172:175], a[136:139], a[208:223]
ds_read_b64_tr_b16 a[166:167], v38 offset:54272
ds_read_b64_tr_b16 a[172:173], v39 offset:52224
s_waitcnt lgkmcnt(9)
v_mfma_f32_32x32x16_bf16 v[128:143], a[152:155], a[140:143], v[128:143]
ds_read_b64_tr_b16 a[174:175], v39 offset:52480
v_mfma_f32_32x32x16_bf16 v[192:207], a[152:155], a[144:147], v[192:207]
s_waitcnt lgkmcnt(8)
v_mfma_f32_32x32x16_bf16 v[144:159], a[156:159], a[140:143], v[144:159]
v_mfma_f32_32x32x16_bf16 v[208:223], a[156:159], a[144:147], v[208:223]
s_waitcnt lgkmcnt(6)
v_mfma_f32_32x32x16_bf16 a[176:191], a[168:171], a[140:143], a[176:191]
v_mfma_f32_32x32x16_bf16 a[192:207], a[168:171], a[144:147], a[192:207]
s_waitcnt lgkmcnt(4)
v_mfma_f32_32x32x16_bf16 v[160:175], a[160:163], a[140:143], v[160:175]
v_mfma_f32_32x32x16_bf16 v[224:239], a[160:163], a[144:147], v[224:239]
s_waitcnt lgkmcnt(2)
v_mfma_f32_32x32x16_bf16 v[176:191], a[164:167], a[140:143], v[176:191]
v_mfma_f32_32x32x16_bf16 v[240:255], a[164:167], a[144:147], v[240:255]
s_waitcnt lgkmcnt(0)
v_mfma_f32_32x32x16_bf16 a[208:223], a[172:175], a[148:151], a[208:223]
s_lshl_b32 s39, s37, 1
s_add_u32 s53, s39, 2
s_sub_u32 s54, 32, s39
s_lshl_b32 s39, s36, 19
s_add_u32 s4, s16, s39
s_addc_u32 s5, s17, 0
s_lshl_b32 s6, s54, 14
s_mov_b32 s7, 0x20000
s_add_u32 s8, s4, 0x1000000
s_addc_u32 s9, s5, 0
s_mov_b32 s10, s6
s_mov_b32 s11, 0x20000
s_waitcnt vmcnt(2)
v_add_f32 v2, v2, v3
v_add_f32 v4, v4, v5
v_add_f32 v6, v6, v7
v_add_f32 v59, v59, v60
v_add_f32 v2, v2, v4
v_add_f32 v6, v6, v59
v_lshlrev_b32 v7, 2, v1
v_add_f32 v2, v2, v6
v_add_u32 v7, 131072, v7
ds_write_b32 v7, v2
s_waitcnt lgkmcnt(0)
s_mov_b32 s62, 0x3e0293ee
v_mov_b32 v60, 0x3e0293ee
s_nop 4
v_pk_mul_f32 v[128:129], v[128:129], v[60:61] op_sel:[0,0] op_sel_hi:[1,0]
v_pk_mul_f32 v[130:131], v[130:131], v[60:61] op_sel:[0,0] op_sel_hi:[1,0]
v_pk_mul_f32 v[132:133], v[132:133], v[60:61] op_sel:[0,0] op_sel_hi:[1,0]
v_pk_mul_f32 v[134:135], v[134:135], v[60:61] op_sel:[0,0] op_sel_hi:[1,0]
v_pk_mul_f32 v[136:137], v[136:137], v[60:61] op_sel:[0,0] op_sel_hi:[1,0]
v_pk_mul_f32 v[138:139], v[138:139], v[60:61] op_sel:[0,0] op_sel_hi:[1,0]
v_pk_mul_f32 v[140:141], v[140:141], v[60:61] op_sel:[0,0] op_sel_hi:[1,0]
v_pk_mul_f32 v[142:143], v[142:143], v[60:61] op_sel:[0,0] op_sel_hi:[1,0]
v_cvt_pk_bf16_f32 v64, v128, v129
v_cvt_pk_bf16_f32 v65, v130, v131
v_cvt_pk_bf16_f32 v66, v132, v133
v_cvt_pk_bf16_f32 v67, v134, v135
v_cvt_pk_bf16_f32 v68, v136, v137
v_cvt_pk_bf16_f32 v69, v138, v139
v_cvt_pk_bf16_f32 v70, v140, v141
v_cvt_pk_bf16_f32 v71, v142, v143
v_pk_mul_f32 v[144:145], v[144:145], v[60:61] op_sel:[0,0] op_sel_hi:[1,0]
v_pk_mul_f32 v[146:147], v[146:147], v[60:61] op_sel:[0,0] op_sel_hi:[1,0]
v_pk_mul_f32 v[148:149], v[148:149], v[60:61] op_sel:[0,0] op_sel_hi:[1,0]
v_pk_mul_f32 v[150:151], v[150:151], v[60:61] op_sel:[0,0] op_sel_hi:[1,0]
v_pk_mul_f32 v[152:153], v[152:153], v[60:61] op_sel:[0,0] op_sel_hi:[1,0]
v_pk_mul_f32 v[154:155], v[154:155], v[60:61] op_sel:[0,0] op_sel_hi:[1,0]
v_pk_mul_f32 v[156:157], v[156:157], v[60:61] op_sel:[0,0] op_sel_hi:[1,0]
v_pk_mul_f32 v[158:159], v[158:159], v[60:61] op_sel:[0,0] op_sel_hi:[1,0]
v_cvt_pk_bf16_f32 v72, v144, v145
v_cvt_pk_bf16_f32 v73, v146, v147
v_cvt_pk_bf16_f32 v74, v148, v149
v_cvt_pk_bf16_f32 v75, v150, v151
v_cvt_pk_bf16_f32 v76, v152, v153
v_cvt_pk_bf16_f32 v77, v154, v155
v_cvt_pk_bf16_f32 v78, v156, v157
v_cvt_pk_bf16_f32 v79, v158, v159
v_pk_mul_f32 v[160:161], v[160:161], v[60:61] op_sel:[0,0] op_sel_hi:[1,0]
v_pk_mul_f32 v[162:163], v[162:163], v[60:61] op_sel:[0,0] op_sel_hi:[1,0]
v_pk_mul_f32 v[164:165], v[164:165], v[60:61] op_sel:[0,0] op_sel_hi:[1,0]
v_pk_mul_f32 v[166:167], v[166:167], v[60:61] op_sel:[0,0] op_sel_hi:[1,0]
v_pk_mul_f32 v[168:169], v[168:169], v[60:61] op_sel:[0,0] op_sel_hi:[1,0]
v_pk_mul_f32 v[170:171], v[170:171], v[60:61] op_sel:[0,0] op_sel_hi:[1,0]
v_pk_mul_f32 v[172:173], v[172:173], v[60:61] op_sel:[0,0] op_sel_hi:[1,0]
v_pk_mul_f32 v[174:175], v[174:175], v[60:61] op_sel:[0,0] op_sel_hi:[1,0]
v_cvt_pk_bf16_f32 v80, v160, v161
v_cvt_pk_bf16_f32 v81, v162, v163
v_cvt_pk_bf16_f32 v82, v164, v165
v_cvt_pk_bf16_f32 v83, v166, v167
v_cvt_pk_bf16_f32 v84, v168, v169
v_cvt_pk_bf16_f32 v85, v170, v171
v_cvt_pk_bf16_f32 v86, v172, v173
v_cvt_pk_bf16_f32 v87, v174, v175
v_pk_mul_f32 v[176:177], v[176:177], v[60:61] op_sel:[0,0] op_sel_hi:[1,0]
v_pk_mul_f32 v[178:179], v[178:179], v[60:61] op_sel:[0,0] op_sel_hi:[1,0]
v_pk_mul_f32 v[180:181], v[180:181], v[60:61] op_sel:[0,0] op_sel_hi:[1,0]
v_pk_mul_f32 v[182:183], v[182:183], v[60:61] op_sel:[0,0] op_sel_hi:[1,0]
v_pk_mul_f32 v[184:185], v[184:185], v[60:61] op_sel:[0,0] op_sel_hi:[1,0]
v_pk_mul_f32 v[186:187], v[186:187], v[60:61] op_sel:[0,0] op_sel_hi:[1,0]
v_pk_mul_f32 v[188:189], v[188:189], v[60:61] op_sel:[0,0] op_sel_hi:[1,0]
v_pk_mul_f32 v[190:191], v[190:191], v[60:61] op_sel:[0,0] op_sel_hi:[1,0]
v_cvt_pk_bf16_f32 v88, v176, v177
v_cvt_pk_bf16_f32 v89, v178, v179
v_cvt_pk_bf16_f32 v90, v180, v181
v_cvt_pk_bf16_f32 v91, v182, v183
v_cvt_pk_bf16_f32 v92, v184, v185
v_cvt_pk_bf16_f32 v93, v186, v187
v_cvt_pk_bf16_f32 v94, v188, v189
v_cvt_pk_bf16_f32 v95, v190, v191
v_pk_mul_f32 v[192:193], v[192:193], v[60:61] op_sel:[0,0] op_sel_hi:[1,0]
v_pk_mul_f32 v[194:195], v[194:195], v[60:61] op_sel:[0,0] op_sel_hi:[1,0]
v_pk_mul_f32 v[196:197], v[196:197], v[60:61] op_sel:[0,0] op_sel_hi:[1,0]
v_pk_mul_f32 v[198:199], v[198:199], v[60:61] op_sel:[0,0] op_sel_hi:[1,0]
v_pk_mul_f32 v[200:201], v[200:201], v[60:61] op_sel:[0,0] op_sel_hi:[1,0]
v_pk_mul_f32 v[202:203], v[202:203], v[60:61] op_sel:[0,0] op_sel_hi:[1,0]
v_pk_mul_f32 v[204:205], v[204:205], v[60:61] op_sel:[0,0] op_sel_hi:[1,0]
v_pk_mul_f32 v[206:207], v[206:207], v[60:61] op_sel:[0,0] op_sel_hi:[1,0]
v_cvt_pk_bf16_f32 v96, v192, v193
v_cvt_pk_bf16_f32 v97, v194, v195
v_cvt_pk_bf16_f32 v98, v196, v197
v_cvt_pk_bf16_f32 v99, v198, v199
v_cvt_pk_bf16_f32 v100, v200, v201
v_cvt_pk_bf16_f32 v101, v202, v203
v_cvt_pk_bf16_f32 v102, v204, v205
v_cvt_pk_bf16_f32 v103, v206, v207
v_pk_mul_f32 v[208:209], v[208:209], v[60:61] op_sel:[0,0] op_sel_hi:[1,0]
v_pk_mul_f32 v[210:211], v[210:211], v[60:61] op_sel:[0,0] op_sel_hi:[1,0]
v_pk_mul_f32 v[212:213], v[212:213], v[60:61] op_sel:[0,0] op_sel_hi:[1,0]
v_pk_mul_f32 v[214:215], v[214:215], v[60:61] op_sel:[0,0] op_sel_hi:[1,0]
v_pk_mul_f32 v[216:217], v[216:217], v[60:61] op_sel:[0,0] op_sel_hi:[1,0]
v_pk_mul_f32 v[218:219], v[218:219], v[60:61] op_sel:[0,0] op_sel_hi:[1,0]
v_pk_mul_f32 v[220:221], v[220:221], v[60:61] op_sel:[0,0] op_sel_hi:[1,0]
v_pk_mul_f32 v[222:223], v[222:223], v[60:61] op_sel:[0,0] op_sel_hi:[1,0]
v_cvt_pk_bf16_f32 v104, v208, v209
v_cvt_pk_bf16_f32 v105, v210, v211
v_cvt_pk_bf16_f32 v106, v212, v213
v_cvt_pk_bf16_f32 v107, v214, v215
v_cvt_pk_bf16_f32 v108, v216, v217
v_cvt_pk_bf16_f32 v109, v218, v219
v_cvt_pk_bf16_f32 v110, v220, v221
v_cvt_pk_bf16_f32 v111, v222, v223
v_pk_mul_f32 v[224:225], v[224:225], v[60:61] op_sel:[0,0] op_sel_hi:[1,0]
v_pk_mul_f32 v[226:227], v[226:227], v[60:61] op_sel:[0,0] op_sel_hi:[1,0]
v_pk_mul_f32 v[228:229], v[228:229], v[60:61] op_sel:[0,0] op_sel_hi:[1,0]
v_pk_mul_f32 v[230:231], v[230:231], v[60:61] op_sel:[0,0] op_sel_hi:[1,0]
v_pk_mul_f32 v[232:233], v[232:233], v[60:61] op_sel:[0,0] op_sel_hi:[1,0]
v_pk_mul_f32 v[234:235], v[234:235], v[60:61] op_sel:[0,0] op_sel_hi:[1,0]
v_pk_mul_f32 v[236:237], v[236:237], v[60:61] op_sel:[0,0] op_sel_hi:[1,0]
v_pk_mul_f32 v[238:239], v[238:239], v[60:61] op_sel:[0,0] op_sel_hi:[1,0]
v_cvt_pk_bf16_f32 v112, v224, v225
v_cvt_pk_bf16_f32 v113, v226, v227
v_cvt_pk_bf16_f32 v114, v228, v229
v_cvt_pk_bf16_f32 v115, v230, v231
v_cvt_pk_bf16_f32 v116, v232, v233
v_cvt_pk_bf16_f32 v117, v234, v235
v_cvt_pk_bf16_f32 v118, v236, v237
v_cvt_pk_bf16_f32 v119, v238, v239
v_pk_mul_f32 v[240:241], v[240:241], v[60:61] op_sel:[0,0] op_sel_hi:[1,0]
v_pk_mul_f32 v[242:243], v[242:243], v[60:61] op_sel:[0,0] op_sel_hi:[1,0]
v_pk_mul_f32 v[244:245], v[244:245], v[60:61] op_sel:[0,0] op_sel_hi:[1,0]
v_pk_mul_f32 v[246:247], v[246:247], v[60:61] op_sel:[0,0] op_sel_hi:[1,0]
v_pk_mul_f32 v[248:249], v[248:249], v[60:61] op_sel:[0,0] op_sel_hi:[1,0]
v_pk_mul_f32 v[250:251], v[250:251], v[60:61] op_sel:[0,0] op_sel_hi:[1,0]
v_pk_mul_f32 v[252:253], v[252:253], v[60:61] op_sel:[0,0] op_sel_hi:[1,0]
v_pk_mul_f32 v[254:255], v[254:255], v[60:61] op_sel:[0,0] op_sel_hi:[1,0]
v_cvt_pk_bf16_f32 v120, v240, v241
v_cvt_pk_bf16_f32 v121, v242, v243
v_cvt_pk_bf16_f32 v122, v244, v245
v_cvt_pk_bf16_f32 v123, v246, v247
v_cvt_pk_bf16_f32 v124, v248, v249
v_cvt_pk_bf16_f32 v125, v250, v251
v_cvt_pk_bf16_f32 v126, v252, v253
v_cvt_pk_bf16_f32 v127, v254, v255
v_mov_b32 v162, 0xbdd2d3e8
v_mov_b32 v163, 0xc0135761
v_mov_b32 v164, 1.0
v_lshlrev_b32 v56, 4, v1
s_waitcnt vmcnt(0)
s_barrier
s_cmp_lg_u32 s38, 0
s_cbranch_scc1 L_w0_11
s_cmp_eq_u32 s60, 1
s_cbranch_scc1 L_nowb_12
buffer_wbl2 sc1
s_waitcnt vmcnt(0)
L_nowb_12:
s_lshl_b32 s41, s36, 3
s_add_u32 s41, s41, s37
s_lshl_b32 s42, s41, 7
s_add_u32 s42, s42, 0x3900000
v_mov_b32 v61, s42
v_mov_b32 v62, s71
s_mov_b64 s[64:65], exec
s_mov_b64 exec, 1
buffer_store_dword v62, v61, s[16:19], 0 offen sc1
s_mov_b64 exec, s[64:65]
L_w0_11:
v_mov_b32 v32, v8
v_mov_b32 v33, v9
v_mov_b32 v34, v10
v_mov_b32 v35, v11
v_mov_b32 v36, v12
v_mov_b32 v37, v13
v_mov_b32 v38, v14
v_mov_b32 v39, v15
s_mov_b32 s63, s48
v_lshrrev_b32 v160, 5, v1
v_lshlrev_b32 v160, 4, v160
v_add_u32 v160, 131072, v160
ds_read_b128 v[128:131], v160 offset:0
ds_read_b128 v[132:135], v160 offset:32
ds_read_b128 v[136:139], v160 offset:64
ds_read_b128 v[140:143], v160 offset:96
v_accvgpr_read_b32 v144, a176
v_accvgpr_read_b32 v145, a177
v_accvgpr_read_b32 v146, a178
v_accvgpr_read_b32 v147, a179
v_accvgpr_read_b32 v148, a180
v_accvgpr_read_b32 v149, a181
v_accvgpr_read_b32 v150, a182
v_accvgpr_read_b32 v151, a183
v_accvgpr_read_b32 v152, a184
v_accvgpr_read_b32 v153, a185
v_accvgpr_read_b32 v154, a186
v_accvgpr_read_b32 v155, a187
v_accvgpr_read_b32 v156, a188
v_accvgpr_read_b32 v157, a189
v_accvgpr_read_b32 v158, a190
v_accvgpr_read_b32 v159, a191
v_sub_f32 v166, 1.0, v34
v_lshlrev_b32 v168, 16, v40
v_and_b32 v169, 0xffff0000, v40
v_lshlrev_b32 v170, 16, v41
v_and_b32 v171, 0xffff0000, v41
v_lshlrev_b32 v172, 16, v42
v_and_b32 v173, 0xffff0000, v42
v_lshlrev_b32 v174, 16, v43
v_and_b32 v175, 0xffff0000, v43
v_lshlrev_b32 v176, 16, v44
v_and_b32 v177, 0xffff0000, v44
v_lshlrev_b32 v178, 16, v45
v_and_b32 v179, 0xffff0000, v45
v_lshlrev_b32 v180, 16, v46
v_and_b32 v181, 0xffff0000, v46
v_lshlrev_b32 v182, 16, v47
v_and_b32 v183, 0xffff0000, v47
s_waitcnt lgkmcnt(0)
v_pk_fma_f32 v[128:129], v[128:129], v[32:33], v[168:169] op_sel:[0,1,0] op_sel_hi:[1,1,1]
v_pk_fma_f32 v[130:131], v[130:131], v[32:33], v[170:171] op_sel:[0,1,0] op_sel_hi:[1,1,1]
v_pk_fma_f32 v[132:133], v[132:133], v[32:33], v[172:173] op_sel:[0,1,0] op_sel_hi:[1,1,1]
v_pk_fma_f32 v[134:135], v[134:135], v[32:33], v[174:175] op_sel:[0,1,0] op_sel_hi:[1,1,1]
v_pk_fma_f32 v[136:137], v[136:137], v[32:33], v[176:177] op_sel:[0,1,0] op_sel_hi:[1,1,1]
v_pk_fma_f32 v[138:139], v[138:139], v[32:33], v[178:179] op_sel:[0,1,0] op_sel_hi:[1,1,1]
v_pk_fma_f32 v[140:141], v[140:141], v[32:33], v[180:181] op_sel:[0,1,0] op_sel_hi:[1,1,1]
v_pk_fma_f32 v[142:143], v[142:143], v[32:33], v[182:183] op_sel:[0,1,0] op_sel_hi:[1,1,1]
v_pk_fma_f32 v[144:145], v[144:145], v[32:33], v[128:129] op_sel:[0,0,0] op_sel_hi:[1,0,1]
v_pk_fma_f32 v[146:147], v[146:147], v[32:33], v[130:131] op_sel:[0,0,0] op_sel_hi:[1,0,1]
v_pk_fma_f32 v[148:149], v[148:149], v[32:33], v[132:133] op_sel:[0,0,0] op_sel_hi:[1,0,1]
v_pk_fma_f32 v[150:151], v[150:151], v[32:33], v[134:135] op_sel:[0,0,0] op_sel_hi:[1,0,1]
v_pk_fma_f32 v[152:153], v[152:153], v[32:33], v[136:137] op_sel:[0,0,0] op_sel_hi:[1,0,1]
v_pk_fma_f32 v[154:155], v[154:155], v[32:33], v[138:139] op_sel:[0,0,0] op_sel_hi:[1,0,1]
v_pk_fma_f32 v[156:157], v[156:157], v[32:33], v[140:141] op_sel:[0,0,0] op_sel_hi:[1,0,1]
v_pk_fma_f32 v[158:159], v[158:159], v[32:33], v[142:143] op_sel:[0,0,0] op_sel_hi:[1,0,1]
v_pk_mul_f32 v[128:129], v[144:145], v[144:145] op_sel:[0,0] op_sel_hi:[1,1]
v_pk_mul_f32 v[130:131], v[146:147], v[146:147] op_sel:[0,0] op_sel_hi:[1,1]
v_pk_mul_f32 v[132:133], v[148:149], v[148:149] op_sel:[0,0] op_sel_hi:[1,1]
v_pk_mul_f32 v[134:135], v[150:151], v[150:151] op_sel:[0,0] op_sel_hi:[1,1]
v_pk_mul_f32 v[136:137], v[152:153], v[152:153] op_sel:[0,0] op_sel_hi:[1,1]
v_pk_mul_f32 v[138:139], v[154:155], v[154:155] op_sel:[0,0] op_sel_hi:[1,1]
v_pk_mul_f32 v[140:141], v[156:157], v[156:157] op_sel:[0,0] op_sel_hi:[1,1]
v_pk_mul_f32 v[142:143], v[158:159], v[158:159] op_sel:[0,0] op_sel_hi:[1,1]
v_pk_fma_f32 v[128:129], v[128:129], v[162:163], v[162:163] op_sel:[0,0,1] op_sel_hi:[1,0,1]
v_pk_fma_f32 v[130:131], v[130:131], v[162:163], v[162:163] op_sel:[0,0,1] op_sel_hi:[1,0,1]
v_pk_fma_f32 v[132:133], v[132:133], v[162:163], v[162:163] op_sel:[0,0,1] op_sel_hi:[1,0,1]
v_pk_fma_f32 v[134:135], v[134:135], v[162:163], v[162:163] op_sel:[0,0,1] op_sel_hi:[1,0,1]
v_pk_fma_f32 v[136:137], v[136:137], v[162:163], v[162:163] op_sel:[0,0,1] op_sel_hi:[1,0,1]
v_pk_fma_f32 v[138:139], v[138:139], v[162:163], v[162:163] op_sel:[0,0,1] op_sel_hi:[1,0,1]
v_pk_fma_f32 v[140:141], v[140:141], v[162:163], v[162:163] op_sel:[0,0,1] op_sel_hi:[1,0,1]
v_pk_fma_f32 v[142:143], v[142:143], v[162:163], v[162:163] op_sel:[0,0,1] op_sel_hi:[1,0,1]
v_pk_mul_f32 v[128:129], v[128:129], v[144:145] op_sel:[0,0] op_sel_hi:[1,1]
v_pk_mul_f32 v[130:131], v[130:131], v[146:147] op_sel:[0,0] op_sel_hi:[1,1]
v_pk_mul_f32 v[132:133], v[132:133], v[148:149] op_sel:[0,0] op_sel_hi:[1,1]
v_pk_mul_f32 v[134:135], v[134:135], v[150:151] op_sel:[0,0] op_sel_hi:[1,1]
v_pk_mul_f32 v[136:137], v[136:137], v[152:153] op_sel:[0,0] op_sel_hi:[1,1]
v_pk_mul_f32 v[138:139], v[138:139], v[154:155] op_sel:[0,0] op_sel_hi:[1,1]
v_pk_mul_f32 v[140:141], v[140:141], v[156:157] op_sel:[0,0] op_sel_hi:[1,1]
v_pk_mul_f32 v[142:143], v[142:143], v[158:159] op_sel:[0,0] op_sel_hi:[1,1]
v_exp_f32 v128, v128
v_exp_f32 v129, v129
v_exp_f32 v130, v130
v_exp_f32 v131, v131
v_exp_f32 v132, v132
v_exp_f32 v133, v133
v_exp_f32 v134, v134
v_exp_f32 v135, v135
v_exp_f32 v136, v136
v_exp_f32 v137, v137
v_exp_f32 v138, v138
v_exp_f32 v139, v139
v_exp_f32 v140, v140
v_exp_f32 v141, v141
v_exp_f32 v142, v142
v_exp_f32 v143, v143
v_pk_mul_f32 v[144:145], v[144:145], v[166:167] op_sel:[0,0] op_sel_hi:[1,0]
v_pk_mul_f32 v[146:147], v[146:147], v[166:167] op_sel:[0,0] op_sel_hi:[1,0]
v_pk_mul_f32 v[148:149], v[148:149], v[166:167] op_sel:[0,0] op_sel_hi:[1,0]
v_pk_mul_f32 v[150:151], v[150:151], v[166:167] op_sel:[0,0] op_sel_hi:[1,0]
v_pk_mul_f32 v[152:153], v[152:153], v[166:167] op_sel:[0,0] op_sel_hi:[1,0]
v_pk_mul_f32 v[154:155], v[154:155], v[166:167] op_sel:[0,0] op_sel_hi:[1,0]
v_pk_mul_f32 v[156:157], v[156:157], v[166:167] op_sel:[0,0] op_sel_hi:[1,0]
v_pk_mul_f32 v[158:159], v[158:159], v[166:167] op_sel:[0,0] op_sel_hi:[1,0]
v_pk_add_f32 v[128:129], v[128:129], v[164:165] op_sel:[0,0] op_sel_hi:[1,0]
v_pk_add_f32 v[130:131], v[130:131], v[164:165] op_sel:[0,0] op_sel_hi:[1,0]
v_pk_add_f32 v[132:133], v[132:133], v[164:165] op_sel:[0,0] op_sel_hi:[1,0]
v_pk_add_f32 v[134:135], v[134:135], v[164:165] op_sel:[0,0] op_sel_hi:[1,0]
v_pk_add_f32 v[136:137], v[136:137], v[164:165] op_sel:[0,0] op_sel_hi:[1,0]
v_pk_add_f32 v[138:139], v[138:139], v[164:165] op_sel:[0,0] op_sel_hi:[1,0]
v_pk_add_f32 v[140:141], v[140:141], v[164:165] op_sel:[0,0] op_sel_hi:[1,0]
v_pk_add_f32 v[142:143], v[142:143], v[164:165] op_sel:[0,0] op_sel_hi:[1,0]
v_rcp_f32 v128, v128
v_rcp_f32 v129, v129
v_rcp_f32 v130, v130
v_rcp_f32 v131, v131
v_rcp_f32 v132, v132
v_rcp_f32 v133, v133
v_rcp_f32 v134, v134
v_rcp_f32 v135, v135
v_rcp_f32 v136, v136
v_rcp_f32 v137, v137
v_rcp_f32 v138, v138
v_rcp_f32 v139, v139
v_rcp_f32 v140, v140
v_rcp_f32 v141, v141
v_rcp_f32 v142, v142
v_rcp_f32 v143, v143
s_nop 0
v_pk_mul_f32 v[144:145], v[144:145], v[128:129] op_sel:[0,0] op_sel_hi:[1,1]
v_pk_mul_f32 v[146:147], v[146:147], v[130:131] op_sel:[0,0] op_sel_hi:[1,1]
v_pk_mul_f32 v[148:149], v[148:149], v[132:133] op_sel:[0,0] op_sel_hi:[1,1]
v_pk_mul_f32 v[150:151], v[150:151], v[134:135] op_sel:[0,0] op_sel_hi:[1,1]
v_pk_mul_f32 v[152:153], v[152:153], v[136:137] op_sel:[0,0] op_sel_hi:[1,1]
v_pk_mul_f32 v[154:155], v[154:155], v[138:139] op_sel:[0,0] op_sel_hi:[1,1]
v_pk_mul_f32 v[156:157], v[156:157], v[140:141] op_sel:[0,0] op_sel_hi:[1,1]
v_pk_mul_f32 v[158:159], v[158:159], v[142:143] op_sel:[0,0] op_sel_hi:[1,1]
v_cvt_pk_bf16_f32 v192, v144, v145
v_cvt_pk_bf16_f32 v193, v146, v147
v_cvt_pk_bf16_f32 v194, v148, v149
v_cvt_pk_bf16_f32 v195, v150, v151
v_cvt_pk_bf16_f32 v196, v152, v153
v_cvt_pk_bf16_f32 v197, v154, v155
v_cvt_pk_bf16_f32 v198, v156, v157
v_cvt_pk_bf16_f32 v199, v158, v159
s_lshr_b32 s63, s63, 5
s_mul_i32 s63, s63, 350208
s_lshl_b32 s42, s36, 11
s_add_u32 s63, s63, s42
s_add_u32 s63, s63, 0x2040000
s_cmp_lg_u32 s38, 0
s_cbranch_scc1 L_w0_13
s_lshl_b32 s41, s36, 3
v_and_b32 v57, 7, v1
v_add_u32 v57, s41, v57
v_lshlrev_b32 v57, 7, v57
v_add_u32 v57, 0x3900000, v57
s_mov_b64 s[64:65], exec
s_mov_b32 exec_lo, 0xff
s_mov_b32 exec_hi, 0x0
L_poll_14:
buffer_load_dword v62, v57, s[16:19], 0 offen sc1
s_waitcnt vmcnt(0)
v_cmp_eq_u32 vcc, s71, v62
s_nop 1
s_cmp_eq_u64 vcc, exec
s_cbranch_scc0 L_poll_14
s_mov_b64 exec, s[64:65]
L_w0_13:
s_waitcnt lgkmcnt(0)
s_barrier
v_lshlrev_b32 v57, 4, v1
v_add_u32 v58, s46, v57
v_add_u32 v57, s45, v57
s_add_u32 m0, s46, 106496
s_mov_b32 s66, 0
buffer_load_dwordx4 v58, s[4:7], s66 offen offset:0 lds
buffer_load_dwordx4 v58, s[4:7], s66 offen offset:1024 lds
s_mov_b32 s41, s49
v_lshrrev_b32 v160, 5, v1
v_lshlrev_b32 v160, 4, v160
v_add_u32 v160, 131072, v160
ds_read_b128 v[128:131], v160 offset:0
ds_read_b128 v[132:135], v160 offset:32
ds_read_b128 v[136:139], v160 offset:64
ds_read_b128 v[140:143], v160 offset:96
v_accvgpr_read_b32 v144, a192
v_accvgpr_read_b32 v145, a193
v_accvgpr_read_b32 v146, a194
v_accvgpr_read_b32 v147, a195
s_add_u32 m0, s45, 0
s_mov_b32 s66, 8192
v_accvgpr_read_b32 v148, a196
v_accvgpr_read_b32 v149, a197
v_accvgpr_read_b32 v150, a198
v_accvgpr_read_b32 v151, a199
v_accvgpr_read_b32 v152, a200
v_accvgpr_read_b32 v153, a201
v_accvgpr_read_b32 v154, a202
v_accvgpr_read_b32 v155, a203
v_accvgpr_read_b32 v156, a204
v_accvgpr_read_b32 v157, a205
v_accvgpr_read_b32 v158, a206
v_accvgpr_read_b32 v159, a207
buffer_load_dwordx4 v57, s[4:7], s66 offen offset:0 lds
v_sub_f32 v166, 1.0, v38
v_lshlrev_b32 v168, 16, v40
v_and_b32 v169, 0xffff0000, v40
v_lshlrev_b32 v170, 16, v41
v_and_b32 v171, 0xffff0000, v41
v_lshlrev_b32 v172, 16, v42
v_and_b32 v173, 0xffff0000, v42
v_lshlrev_b32 v174, 16, v43
v_and_b32 v175, 0xffff0000, v43
v_lshlrev_b32 v176, 16, v44
v_and_b32 v177, 0xffff0000, v44
v_lshlrev_b32 v178, 16, v45
buffer_load_dwordx4 v57, s[4:7], s66 offen offset:1024 lds
v_and_b32 v179, 0xffff0000, v45
v_lshlrev_b32 v180, 16, v46
v_and_b32 v181, 0xffff0000, v46
v_lshlrev_b32 v182, 16, v47
v_and_b32 v183, 0xffff0000, v47
s_waitcnt lgkmcnt(0)
v_pk_fma_f32 v[128:129], v[128:129], v[36:37], v[168:169] op_sel:[0,1,0] op_sel_hi:[1,1,1]
v_pk_fma_f32 v[130:131], v[130:131], v[36:37], v[170:171] op_sel:[0,1,0] op_sel_hi:[1,1,1]
v_pk_fma_f32 v[132:133], v[132:133], v[36:37], v[172:173] op_sel:[0,1,0] op_sel_hi:[1,1,1]
v_pk_fma_f32 v[134:135], v[134:135], v[36:37], v[174:175] op_sel:[0,1,0] op_sel_hi:[1,1,1]
v_pk_fma_f32 v[136:137], v[136:137], v[36:37], v[176:177] op_sel:[0,1,0] op_sel_hi:[1,1,1]
v_pk_fma_f32 v[138:139], v[138:139], v[36:37], v[178:179] op_sel:[0,1,0] op_sel_hi:[1,1,1]
buffer_load_dwordx4 v57, s[4:7], s66 offen offset:2048 lds
v_pk_fma_f32 v[140:141], v[140:141], v[36:37], v[180:181] op_sel:[0,1,0] op_sel_hi:[1,1,1]
v_pk_fma_f32 v[142:143], v[142:143], v[36:37], v[182:183] op_sel:[0,1,0] op_sel_hi:[1,1,1]
v_pk_fma_f32 v[144:145], v[144:145], v[36:37], v[128:129] op_sel:[0,0,0] op_sel_hi:[1,0,1]
v_pk_fma_f32 v[146:147], v[146:147], v[36:37], v[130:131] op_sel:[0,0,0] op_sel_hi:[1,0,1]
v_pk_fma_f32 v[148:149], v[148:149], v[36:37], v[132:133] op_sel:[0,0,0] op_sel_hi:[1,0,1]
v_pk_fma_f32 v[150:151], v[150:151], v[36:37], v[134:135] op_sel:[0,0,0] op_sel_hi:[1,0,1]
v_pk_fma_f32 v[152:153], v[152:153], v[36:37], v[136:137] op_sel:[0,0,0] op_sel_hi:[1,0,1]
v_pk_fma_f32 v[154:155], v[154:155], v[36:37], v[138:139] op_sel:[0,0,0] op_sel_hi:[1,0,1]
v_pk_fma_f32 v[156:157], v[156:157], v[36:37], v[140:141] op_sel:[0,0,0] op_sel_hi:[1,0,1]
v_pk_fma_f32 v[158:159], v[158:159], v[36:37], v[142:143] op_sel:[0,0,0] op_sel_hi:[1,0,1]
v_pk_mul_f32 v[128:129], v[144:145], v[144:145] op_sel:[0,0] op_sel_hi:[1,1]
v_pk_mul_f32 v[130:131], v[146:147], v[146:147] op_sel:[0,0] op_sel_hi:[1,1]
buffer_load_dwordx4 v57, s[4:7], s66 offen offset:3072 lds
v_pk_mul_f32 v[132:133], v[148:149], v[148:149] op_sel:[0,0] op_sel_hi:[1,1]
v_pk_mul_f32 v[134:135], v[150:151], v[150:151] op_sel:[0,0] op_sel_hi:[1,1]
v_pk_mul_f32 v[136:137], v[152:153], v[152:153] op_sel:[0,0] op_sel_hi:[1,1]
v_pk_mul_f32 v[138:139], v[154:155], v[154:155] op_sel:[0,0] op_sel_hi:[1,1]
v_pk_mul_f32 v[140:141], v[156:157], v[156:157] op_sel:[0,0] op_sel_hi:[1,1]
v_pk_mul_f32 v[142:143], v[158:159], v[158:159] op_sel:[0,0] op_sel_hi:[1,1]
v_pk_fma_f32 v[128:129], v[128:129], v[162:163], v[162:163] op_sel:[0,0,1] op_sel_hi:[1,0,1]
v_pk_fma_f32 v[130:131], v[130:131], v[162:163], v[162:163] op_sel:[0,0,1] op_sel_hi:[1,0,1]
v_pk_fma_f32 v[132:133], v[132:133], v[162:163], v[162:163] op_sel:[0,0,1] op_sel_hi:[1,0,1]
v_pk_fma_f32 v[134:135], v[134:135], v[162:163], v[162:163] op_sel:[0,0,1] op_sel_hi:[1,0,1]
v_pk_fma_f32 v[136:137], v[136:137], v[162:163], v[162:163] op_sel:[0,0,1] op_sel_hi:[1,0,1]
v_pk_fma_f32 v[138:139], v[138:139], v[162:163], v[162:163] op_sel:[0,0,1] op_sel_hi:[1,0,1]
s_add_u32 m0, s45, 16384
s_mov_b32 s67, 0
v_pk_fma_f32 v[140:141], v[140:141], v[162:163], v[162:163] op_sel:[0,0,1] op_sel_hi:[1,0,1]
v_pk_fma_f32 v[142:143], v[142:143], v[162:163], v[162:163] op_sel:[0,0,1] op_sel_hi:[1,0,1]
v_pk_mul_f32 v[128:129], v[128:129], v[144:145] op_sel:[0,0] op_sel_hi:[1,1]
v_pk_mul_f32 v[130:131], v[130:131], v[146:147] op_sel:[0,0] op_sel_hi:[1,1]
v_pk_mul_f32 v[132:133], v[132:133], v[148:149] op_sel:[0,0] op_sel_hi:[1,1]
v_pk_mul_f32 v[134:135], v[134:135], v[150:151] op_sel:[0,0] op_sel_hi:[1,1]
v_pk_mul_f32 v[136:137], v[136:137], v[152:153] op_sel:[0,0] op_sel_hi:[1,1]
v_pk_mul_f32 v[138:139], v[138:139], v[154:155] op_sel:[0,0] op_sel_hi:[1,1]
v_pk_mul_f32 v[140:141], v[140:141], v[156:157] op_sel:[0,0] op_sel_hi:[1,1]
v_pk_mul_f32 v[142:143], v[142:143], v[158:159] op_sel:[0,0] op_sel_hi:[1,1]
v_exp_f32 v128, v128
v_exp_f32 v129, v129
buffer_load_dwordx4 v57, s[8:11], s67 offen offset:0 lds
v_exp_f32 v130, v130
v_exp_f32 v131, v131
v_exp_f32 v132, v132
v_exp_f32 v133, v133
v_exp_f32 v134, v134
v_exp_f32 v135, v135
v_exp_f32 v136, v136
v_exp_f32 v137, v137
v_exp_f32 v138, v138
v_exp_f32 v139, v139
v_exp_f32 v140, v140
v_exp_f32 v141, v141
buffer_load_dwordx4 v57, s[8:11], s67 offen offset:1024 lds
v_exp_f32 v142, v142
v_exp_f32 v143, v143
v_pk_mul_f32 v[144:145], v[144:145], v[166:167] op_sel:[0,0] op_sel_hi:[1,0]
v_pk_mul_f32 v[146:147], v[146:147], v[166:167] op_sel:[0,0] op_sel_hi:[1,0]
v_pk_mul_f32 v[148:149], v[148:149], v[166:167] op_sel:[0,0] op_sel_hi:[1,0]
v_pk_mul_f32 v[150:151], v[150:151], v[166:167] op_sel:[0,0] op_sel_hi:[1,0]
v_pk_mul_f32 v[152:153], v[152:153], v[166:167] op_sel:[0,0] op_sel_hi:[1,0]
v_pk_mul_f32 v[154:155], v[154:155], v[166:167] op_sel:[0,0] op_sel_hi:[1,0]
v_pk_mul_f32 v[156:157], v[156:157], v[166:167] op_sel:[0,0] op_sel_hi:[1,0]
v_pk_mul_f32 v[158:159], v[158:159], v[166:167] op_sel:[0,0] op_sel_hi:[1,0]
v_pk_add_f32 v[128:129], v[128:129], v[164:165] op_sel:[0,0] op_sel_hi:[1,0]
v_pk_add_f32 v[130:131], v[130:131], v[164:165] op_sel:[0,0] op_sel_hi:[1,0]
buffer_load_dwordx4 v57, s[8:11], s67 offen offset:2048 lds
v_pk_add_f32 v[132:133], v[132:133], v[164:165] op_sel:[0,0] op_sel_hi:[1,0]
v_pk_add_f32 v[134:135], v[134:135], v[164:165] op_sel:[0,0] op_sel_hi:[1,0]
v_pk_add_f32 v[136:137], v[136:137], v[164:165] op_sel:[0,0] op_sel_hi:[1,0]
v_pk_add_f32 v[138:139], v[138:139], v[164:165] op_sel:[0,0] op_sel_hi:[1,0]
v_pk_add_f32 v[140:141], v[140:141], v[164:165] op_sel:[0,0] op_sel_hi:[1,0]
v_pk_add_f32 v[142:143], v[142:143], v[164:165] op_sel:[0,0] op_sel_hi:[1,0]
v_rcp_f32 v128, v128
v_rcp_f32 v129, v129
v_rcp_f32 v130, v130
v_rcp_f32 v131, v131
v_rcp_f32 v132, v132
v_rcp_f32 v133, v133
buffer_load_dwordx4 v57, s[8:11], s67 offen offset:3072 lds
v_rcp_f32 v134, v134
v_rcp_f32 v135, v135
v_rcp_f32 v136, v136
v_rcp_f32 v137, v137
v_rcp_f32 v138, v138
v_rcp_f32 v139, v139
v_rcp_f32 v140, v140
v_rcp_f32 v141, v141
v_rcp_f32 v142, v142
v_rcp_f32 v143, v143
s_nop 0
v_pk_mul_f32 v[144:145], v[144:145], v[128:129] op_sel:[0,0] op_sel_hi:[1,1]
v_pk_mul_f32 v[146:147], v[146:147], v[130:131] op_sel:[0,0] op_sel_hi:[1,1]
v_pk_mul_f32 v[148:149], v[148:149], v[132:133] op_sel:[0,0] op_sel_hi:[1,1]
v_pk_mul_f32 v[150:151], v[150:151], v[134:135] op_sel:[0,0] op_sel_hi:[1,1]
v_pk_mul_f32 v[152:153], v[152:153], v[136:137] op_sel:[0,0] op_sel_hi:[1,1]
v_pk_mul_f32 v[154:155], v[154:155], v[138:139] op_sel:[0,0] op_sel_hi:[1,1]
v_pk_mul_f32 v[156:157], v[156:157], v[140:141] op_sel:[0,0] op_sel_hi:[1,1]
v_pk_mul_f32 v[158:159], v[158:159], v[142:143] op_sel:[0,0] op_sel_hi:[1,1]
v_cvt_pk_bf16_f32 v200, v144, v145
v_cvt_pk_bf16_f32 v201, v146, v147
v_cvt_pk_bf16_f32 v202, v148, v149
v_cvt_pk_bf16_f32 v203, v150, v151
v_cvt_pk_bf16_f32 v204, v152, v153
v_cvt_pk_bf16_f32 v205, v154, v155
v_cvt_pk_bf16_f32 v206, v156, v157
v_cvt_pk_bf16_f32 v207, v158, v159
s_lshr_b32 s41, s41, 5
s_mul_i32 s41, s41, 350208
s_lshl_b32 s42, s36, 11
s_add_u32 s41, s41, s42
s_add_u32 s41, s41, 0x2040000
buffer_store_dwordx4 v[200:203], v56, s[16:19], s41 offen offset:0 sc1
buffer_store_dwordx4 v[204:207], v56, s[16:19], s41 offen offset:1024 sc1
buffer_store_dwordx4 v[192:195], v56, s[16:19], s63 offen offset:0 sc1
buffer_store_dwordx4 v[196:199], v56, s[16:19], s63 offen offset:1024 sc1
s_cmp_eq_u32 s51, 0
s_cselect_b32 s41, s48, s49
s_cselect_b64 s[64:65], -1, 0
v_cndmask_b32 v60, v36, v32, s[64:65]
v_cndmask_b32 v61, v37, v33, s[64:65]
v_cndmask_b32 v62, v38, v34, s[64:65]
s_cmp_ge_u32 s36, 22
s_cbranch_scc1 L_skip_mlp_15
v_lshrrev_b32 v160, 5, v1
v_lshlrev_b32 v160, 4, v160
v_add_u32 v160, 131200, v160
ds_read_b128 v[128:131], v160 offset:0
ds_read_b128 v[132:135], v160 offset:32
ds_read_b128 v[136:139], v160 offset:64
ds_read_b128 v[140:143], v160 offset:96
v_accvgpr_read_b32 v144, a208
v_accvgpr_read_b32 v145, a209
v_accvgpr_read_b32 v146, a210
v_accvgpr_read_b32 v147, a211
v_accvgpr_read_b32 v148, a212
v_accvgpr_read_b32 v149, a213
v_accvgpr_read_b32 v150, a214
v_accvgpr_read_b32 v151, a215
v_accvgpr_read_b32 v152, a216
v_accvgpr_read_b32 v153, a217
v_accvgpr_read_b32 v154, a218
v_accvgpr_read_b32 v155, a219
v_accvgpr_read_b32 v156, a220
v_accvgpr_read_b32 v157, a221
v_accvgpr_read_b32 v158, a222
v_accvgpr_read_b32 v159, a223
v_sub_f32 v166, 1.0, v62
v_lshlrev_b32 v168, 16, v48
v_and_b32 v169, 0xffff0000, v48
v_lshlrev_b32 v170, 16, v49
v_and_b32 v171, 0xffff0000, v49
v_lshlrev_b32 v172, 16, v50
v_and_b32 v173, 0xffff0000, v50
v_lshlrev_b32 v174, 16, v51
v_and_b32 v175, 0xffff0000, v51
v_lshlrev_b32 v176, 16, v52
v_and_b32 v177, 0xffff0000, v52
v_lshlrev_b32 v178, 16, v53
v_and_b32 v179, 0xffff0000, v53
v_lshlrev_b32 v180, 16, v54
v_and_b32 v181, 0xffff0000, v54
v_lshlrev_b32 v182, 16, v55
v_and_b32 v183, 0xffff0000, v55
s_waitcnt lgkmcnt(0)
v_pk_fma_f32 v[128:129], v[128:129], v[60:61], v[168:169] op_sel:[0,1,0] op_sel_hi:[1,1,1]
v_pk_fma_f32 v[130:131], v[130:131], v[60:61], v[170:171] op_sel:[0,1,0] op_sel_hi:[1,1,1]
v_pk_fma_f32 v[132:133], v[132:133], v[60:61], v[172:173] op_sel:[0,1,0] op_sel_hi:[1,1,1]
v_pk_fma_f32 v[134:135], v[134:135], v[60:61], v[174:175] op_sel:[0,1,0] op_sel_hi:[1,1,1]
v_pk_fma_f32 v[136:137], v[136:137], v[60:61], v[176:177] op_sel:[0,1,0] op_sel_hi:[1,1,1]
v_pk_fma_f32 v[138:139], v[138:139], v[60:61], v[178:179] op_sel:[0,1,0] op_sel_hi:[1,1,1]
v_pk_fma_f32 v[140:141], v[140:141], v[60:61], v[180:181] op_sel:[0,1,0] op_sel_hi:[1,1,1]
v_pk_fma_f32 v[142:143], v[142:143], v[60:61], v[182:183] op_sel:[0,1,0] op_sel_hi:[1,1,1]
v_pk_fma_f32 v[144:145], v[144:145], v[60:61], v[128:129] op_sel:[0,0,0] op_sel_hi:[1,0,1]
v_pk_fma_f32 v[146:147], v[146:147], v[60:61], v[130:131] op_sel:[0,0,0] op_sel_hi:[1,0,1]
v_pk_fma_f32 v[148:149], v[148:149], v[60:61], v[132:133] op_sel:[0,0,0] op_sel_hi:[1,0,1]
v_pk_fma_f32 v[150:151], v[150:151], v[60:61], v[134:135] op_sel:[0,0,0] op_sel_hi:[1,0,1]
v_pk_fma_f32 v[152:153], v[152:153], v[60:61], v[136:137] op_sel:[0,0,0] op_sel_hi:[1,0,1]
v_pk_fma_f32 v[154:155], v[154:155], v[60:61], v[138:139] op_sel:[0,0,0] op_sel_hi:[1,0,1]
v_pk_fma_f32 v[156:157], v[156:157], v[60:61], v[140:141] op_sel:[0,0,0] op_sel_hi:[1,0,1]
v_pk_fma_f32 v[158:159], v[158:159], v[60:61], v[142:143] op_sel:[0,0,0] op_sel_hi:[1,0,1]
v_pk_mul_f32 v[128:129], v[144:145], v[144:145] op_sel:[0,0] op_sel_hi:[1,1]
v_pk_mul_f32 v[130:131], v[146:147], v[146:147] op_sel:[0,0] op_sel_hi:[1,1]
v_pk_mul_f32 v[132:133], v[148:149], v[148:149] op_sel:[0,0] op_sel_hi:[1,1]
v_pk_mul_f32 v[134:135], v[150:151], v[150:151] op_sel:[0,0] op_sel_hi:[1,1]
v_pk_mul_f32 v[136:137], v[152:153], v[152:153] op_sel:[0,0] op_sel_hi:[1,1]
v_pk_mul_f32 v[138:139], v[154:155], v[154:155] op_sel:[0,0] op_sel_hi:[1,1]
v_pk_mul_f32 v[140:141], v[156:157], v[156:157] op_sel:[0,0] op_sel_hi:[1,1]
v_pk_mul_f32 v[142:143], v[158:159], v[158:159] op_sel:[0,0] op_sel_hi:[1,1]
v_pk_fma_f32 v[128:129], v[128:129], v[162:163], v[162:163] op_sel:[0,0,1] op_sel_hi:[1,0,1]
v_pk_fma_f32 v[130:131], v[130:131], v[162:163], v[162:163] op_sel:[0,0,1] op_sel_hi:[1,0,1]
v_pk_fma_f32 v[132:133], v[132:133], v[162:163], v[162:163] op_sel:[0,0,1] op_sel_hi:[1,0,1]
v_pk_fma_f32 v[134:135], v[134:135], v[162:163], v[162:163] op_sel:[0,0,1] op_sel_hi:[1,0,1]
v_pk_fma_f32 v[136:137], v[136:137], v[162:163], v[162:163] op_sel:[0,0,1] op_sel_hi:[1,0,1]
v_pk_fma_f32 v[138:139], v[138:139], v[162:163], v[162:163] op_sel:[0,0,1] op_sel_hi:[1,0,1]
v_pk_fma_f32 v[140:141], v[140:141], v[162:163], v[162:163] op_sel:[0,0,1] op_sel_hi:[1,0,1]
v_pk_fma_f32 v[142:143], v[142:143], v[162:163], v[162:163] op_sel:[0,0,1] op_sel_hi:[1,0,1]
v_pk_mul_f32 v[128:129], v[128:129], v[144:145] op_sel:[0,0] op_sel_hi:[1,1]
v_pk_mul_f32 v[130:131], v[130:131], v[146:147] op_sel:[0,0] op_sel_hi:[1,1]
v_pk_mul_f32 v[132:133], v[132:133], v[148:149] op_sel:[0,0] op_sel_hi:[1,1]
v_pk_mul_f32 v[134:135], v[134:135], v[150:151] op_sel:[0,0] op_sel_hi:[1,1]
v_pk_mul_f32 v[136:137], v[136:137], v[152:153] op_sel:[0,0] op_sel_hi:[1,1]
v_pk_mul_f32 v[138:139], v[138:139], v[154:155] op_sel:[0,0] op_sel_hi:[1,1]
v_pk_mul_f32 v[140:141], v[140:141], v[156:157] op_sel:[0,0] op_sel_hi:[1,1]
v_pk_mul_f32 v[142:143], v[142:143], v[158:159] op_sel:[0,0] op_sel_hi:[1,1]
v_exp_f32 v128, v128
v_exp_f32 v129, v129
v_exp_f32 v130, v130
v_exp_f32 v131, v131
v_exp_f32 v132, v132
v_exp_f32 v133, v133
v_exp_f32 v134, v134
v_exp_f32 v135, v135
v_exp_f32 v136, v136
v_exp_f32 v137, v137
v_exp_f32 v138, v138
v_exp_f32 v139, v139
v_exp_f32 v140, v140
v_exp_f32 v141, v141
v_exp_f32 v142, v142
v_exp_f32 v143, v143
v_pk_mul_f32 v[144:145], v[144:145], v[166:167] op_sel:[0,0] op_sel_hi:[1,0]
v_pk_mul_f32 v[146:147], v[146:147], v[166:167] op_sel:[0,0] op_sel_hi:[1,0]
v_pk_mul_f32 v[148:149], v[148:149], v[166:167] op_sel:[0,0] op_sel_hi:[1,0]
v_pk_mul_f32 v[150:151], v[150:151], v[166:167] op_sel:[0,0] op_sel_hi:[1,0]
v_pk_mul_f32 v[152:153], v[152:153], v[166:167] op_sel:[0,0] op_sel_hi:[1,0]
v_pk_mul_f32 v[154:155], v[154:155], v[166:167] op_sel:[0,0] op_sel_hi:[1,0]
v_pk_mul_f32 v[156:157], v[156:157], v[166:167] op_sel:[0,0] op_sel_hi:[1,0]
v_pk_mul_f32 v[158:159], v[158:159], v[166:167] op_sel:[0,0] op_sel_hi:[1,0]
v_pk_add_f32 v[128:129], v[128:129], v[164:165] op_sel:[0,0] op_sel_hi:[1,0]
v_pk_add_f32 v[130:131], v[130:131], v[164:165] op_sel:[0,0] op_sel_hi:[1,0]
v_pk_add_f32 v[132:133], v[132:133], v[164:165] op_sel:[0,0] op_sel_hi:[1,0]
v_pk_add_f32 v[134:135], v[134:135], v[164:165] op_sel:[0,0] op_sel_hi:[1,0]
v_pk_add_f32 v[136:137], v[136:137], v[164:165] op_sel:[0,0] op_sel_hi:[1,0]
v_pk_add_f32 v[138:139], v[138:139], v[164:165] op_sel:[0,0] op_sel_hi:[1,0]
v_pk_add_f32 v[140:141], v[140:141], v[164:165] op_sel:[0,0] op_sel_hi:[1,0]
v_pk_add_f32 v[142:143], v[142:143], v[164:165] op_sel:[0,0] op_sel_hi:[1,0]
v_rcp_f32 v128, v128
v_rcp_f32 v129, v129
v_rcp_f32 v130, v130
v_rcp_f32 v131, v131
v_rcp_f32 v132, v132
v_rcp_f32 v133, v133
v_rcp_f32 v134, v134
v_rcp_f32 v135, v135
v_rcp_f32 v136, v136
v_rcp_f32 v137, v137
v_rcp_f32 v138, v138
v_rcp_f32 v139, v139
v_rcp_f32 v140, v140
v_rcp_f32 v141, v141
v_rcp_f32 v142, v142
v_rcp_f32 v143, v143
s_nop 0
v_pk_mul_f32 v[144:145], v[144:145], v[128:129] op_sel:[0,0] op_sel_hi:[1,1]
v_pk_mul_f32 v[146:147], v[146:147], v[130:131] op_sel:[0,0] op_sel_hi:[1,1]
v_pk_mul_f32 v[148:149], v[148:149], v[132:133] op_sel:[0,0] op_sel_hi:[1,1]
v_pk_mul_f32 v[150:151], v[150:151], v[134:135] op_sel:[0,0] op_sel_hi:[1,1]
v_pk_mul_f32 v[152:153], v[152:153], v[136:137] op_sel:[0,0] op_sel_hi:[1,1]
v_pk_mul_f32 v[154:155], v[154:155], v[138:139] op_sel:[0,0] op_sel_hi:[1,1]
v_pk_mul_f32 v[156:157], v[156:157], v[140:141] op_sel:[0,0] op_sel_hi:[1,1]
v_pk_mul_f32 v[158:159], v[158:159], v[142:143] op_sel:[0,0] op_sel_hi:[1,1]
v_cvt_pk_bf16_f32 v192, v144, v145
v_cvt_pk_bf16_f32 v193, v146, v147
v_cvt_pk_bf16_f32 v194, v148, v149
v_cvt_pk_bf16_f32 v195, v150, v151
v_cvt_pk_bf16_f32 v196, v152, v153
v_cvt_pk_bf16_f32 v197, v154, v155
v_cvt_pk_bf16_f32 v198, v156, v157
v_cvt_pk_bf16_f32 v199, v158, v159
s_lshr_b32 s41, s41, 5
s_mul_i32 s41, s41, 350208
s_lshl_b32 s42, s50, 11
s_add_u32 s41, s41, s42
s_add_u32 s41, s41, 0x2040000
buffer_store_dwordx4 v[192:195], v56, s[16:19], s41 offen offset:0 sc1
buffer_store_dwordx4 v[196:199], v56, s[16:19], s41 offen offset:1024 sc1
L_skip_mlp_15:
v_lshlrev_b32 v31, 4, v1
v_add_u32 v2, s45, v31
v_and_b32 v18, 31, v1
v_lshrrev_b32 v19, 5, v1
v_lshlrev_b32 v19, 2, v19
v_sub_u32 v18, v18, v19
v_mov_b32 v4, 0
v_mov_b32 v5, 0
v_and_b32 v18, 31, v1
v_lshrrev_b32 v19, 5, v1
v_lshlrev_b32 v19, 2, v19
v_sub_u32 v18, v18, v19
v_mov_b32 v19, 0xf149f2ca
v_cmp_le_i32_e64 s[20:21], 0, v18
v_cmp_le_i32_e64 s[22:23], 1, v18
v_cmp_le_i32_e64 s[24:25], 2, v18
v_cmp_le_i32_e64 s[26:27], 3, v18
v_cndmask_b32_e64 v40, v19, 0, s[20:21]
v_cmp_le_i32_e64 s[20:21], 8, v18
v_cndmask_b32_e64 v41, v19, 0, s[22:23]
v_cmp_le_i32_e64 s[22:23], 9, v18
v_cndmask_b32_e64 v42, v19, 0, s[24:25]
v_cmp_le_i32_e64 s[24:25], 10, v18
v_cndmask_b32_e64 v43, v19, 0, s[26:27]
v_cmp_le_i32_e64 s[26:27], 11, v18
v_cndmask_b32_e64 v44, v19, 0, s[20:21]
v_cmp_le_i32_e64 s[20:21], 16, v18
v_cndmask_b32_e64 v45, v19, 0, s[22:23]
v_cmp_le_i32_e64 s[22:23], 17, v18
v_cndmask_b32_e64 v46, v19, 0, s[24:25]
v_cmp_le_i32_e64 s[24:25], 18, v18
v_cndmask_b32_e64 v47, v19, 0, s[26:27]
v_cmp_le_i32_e64 s[26:27], 19, v18
v_cndmask_b32_e64 v48, v19, 0, s[20:21]
v_cmp_le_i32_e64 s[20:21], 24, v18
v_cndmask_b32_e64 v49, v19, 0, s[22:23]
v_cmp_le_i32_e64 s[22:23], 25, v18
v_cndmask_b32_e64 v50, v19, 0, s[24:25]
v_cmp_le_i32_e64 s[24:25], 26, v18
v_cndmask_b32_e64 v51, v19, 0, s[26:27]
v_cmp_le_i32_e64 s[26:27], 27, v18
v_cndmask_b32_e64 v52, v19, 0, s[20:21]
v_cndmask_b32_e64 v53, v19, 0, s[22:23]
v_cndmask_b32_e64 v54, v19, 0, s[24:25]
v_cndmask_b32_e64 v55, v19, 0, s[26:27]
v_mov_b32 v11, 0xff800000
v_mov_b32 v30, 0
s_mov_b32 s70, 0x45800000
s_getpc_b64 s[64:65]
L_pc_16:
s_add_u32 s28, s64, L_sub_0_2-L_pc_16
s_addc_u32 s29, s65, 0
s_add_u32 s30, s64, L_sub_1_2-L_pc_16
s_addc_u32 s31, s65, 0
s_add_u32 s74, s64, L_sub_0_1-L_pc_16
s_addc_u32 s75, s65, 0
s_add_u32 s76, s64, L_sub_1_1-L_pc_16
s_addc_u32 s77, s65, 0
s_waitcnt vmcnt(12)
s_barrier
v_add_u32 v3, 98304, v31
ds_read_b128 a[128:131], v3 offset:8192
ds_read_b128 a[132:135], v3 offset:9216
ds_read_b128 a[136:139], v3 offset:10240
ds_read_b128 a[140:143], v3 offset:11264
ds_read_b128 a[144:147], v3 offset:12288
ds_read_b128 a[148:151], v3 offset:13312
ds_read_b128 a[152:155], v3 offset:14336
ds_read_b128 a[156:159], v3 offset:15360
s_mov_b32 s68, -32
s_sub_u32 s22, s48, s68
s_sub_u32 s22, s22, 32
s_cmp_eq_u32 s22, 0
s_cselect_b32 s20, 1.0, 0
s_cmp_lt_i32 s22, 0
s_cselect_b32 s21, 0xf149f2ca, 0
v_mov_b32 v10, s21
v_fma_f32 v128, v40, s20, v10
v_fma_f32 v129, v41, s20, v10
v_fma_f32 v130, v42, s20, v10
v_fma_f32 v131, v43, s20, v10
v_fma_f32 v132, v44, s20, v10
v_fma_f32 v133, v45, s20, v10
v_fma_f32 v134, v46, s20, v10
v_fma_f32 v135, v47, s20, v10
v_fma_f32 v136, v48, s20, v10
v_fma_f32 v137, v49, s20, v10
v_fma_f32 v138, v50, s20, v10
v_fma_f32 v139, v51, s20, v10
v_fma_f32 v140, v52, s20, v10
v_fma_f32 v141, v53, s20, v10
v_fma_f32 v142, v54, s20, v10
v_fma_f32 v143, v55, s20, v10
s_mov_b32 s68, 0
s_nop 1
s_waitcnt lgkmcnt(7)
v_mfma_f32_32x32x16_bf16 v[128:143], a[128:131], v[64:67], v[128:143]
s_add_u32 m0, s45, 32768
s_mov_b32 s66, 24576
v_mfma_f32_32x32x16_bf16 v[144:159], a[128:131], v[96:99], 0
buffer_load_dwordx4 v57, s[4:7], s66 offen offset:0 lds
s_waitcnt lgkmcnt(6)
v_mfma_f32_32x32x16_bf16 v[128:143], a[132:135], v[68:71], v[128:143]
buffer_load_dwordx4 v57, s[4:7], s66 offen offset:1024 lds
v_mfma_f32_32x32x16_bf16 v[144:159], a[132:135], v[100:103], v[144:159]
buffer_load_dwordx4 v57, s[4:7], s66 offen offset:2048 lds
s_waitcnt lgkmcnt(5)
v_mfma_f32_32x32x16_bf16 v[128:143], a[136:139], v[72:75], v[128:143]
buffer_load_dwordx4 v57, s[4:7], s66 offen offset:3072 lds
v_mfma_f32_32x32x16_bf16 v[144:159], a[136:139], v[104:107], v[144:159]
s_add_u32 m0, s45, 49152
s_mov_b32 s67, 16384
s_waitcnt lgkmcnt(4)
v_mfma_f32_32x32x16_bf16 v[128:143], a[140:143], v[76:79], v[128:143]
buffer_load_dwordx4 v57, s[8:11], s67 offen offset:0 lds
v_mfma_f32_32x32x16_bf16 v[144:159], a[140:143], v[108:111], v[144:159]
buffer_load_dwordx4 v57, s[8:11], s67 offen offset:1024 lds
s_waitcnt lgkmcnt(3)
v_mfma_f32_32x32x16_bf16 v[128:143], a[144:147], v[80:83], v[128:143]
buffer_load_dwordx4 v57, s[8:11], s67 offen offset:2048 lds
v_mfma_f32_32x32x16_bf16 v[144:159], a[144:147], v[112:115], v[144:159]
buffer_load_dwordx4 v57, s[8:11], s67 offen offset:3072 lds
s_waitcnt lgkmcnt(2)
v_mfma_f32_32x32x16_bf16 v[128:143], a[148:151], v[84:87], v[128:143]
v_mfma_f32_32x32x16_bf16 v[144:159], a[148:151], v[116:119], v[144:159]
s_waitcnt lgkmcnt(1)
v_mfma_f32_32x32x16_bf16 v[128:143], a[152:155], v[88:91], v[128:143]
v_mfma_f32_32x32x16_bf16 v[144:159], a[152:155], v[120:123], v[144:159]
s_waitcnt lgkmcnt(0)
v_mfma_f32_32x32x16_bf16 v[128:143], a[156:159], v[92:95], v[128:143]
v_mfma_f32_32x32x16_bf16 v[144:159], a[156:159], v[124:127], v[144:159]
s_nop 15
v_max3_f32 v18, v128, v129, v130
v_max3_f32 v18, v18, v131, v132
v_max3_f32 v18, v18, v133, v134
v_max3_f32 v18, v18, v135, v136
v_max3_f32 v18, v18, v137, v138
v_max3_f32 v18, v18, v139, v140
v_max3_f32 v18, v18, v141, v142
v_max_f32 v18, v18, v143
v_mov_b32 v19, v18
v_max3_f32 v20, v144, v145, v146
v_max3_f32 v20, v20, v147, v148
v_max3_f32 v20, v20, v149, v150
v_max3_f32 v20, v20, v151, v152
v_max3_f32 v20, v20, v153, v154
v_max3_f32 v20, v20, v155, v156
v_max3_f32 v20, v20, v157, v158
v_max_f32 v20, v20, v159
v_mov_b32 v21, v20
s_nop 1
v_permlane32_swap_b32 v19, v18
v_permlane32_swap_b32 v21, v20
s_nop 1
v_max_f32 v18, v18, v19
v_max_f32 v20, v20, v21
v_sub_f32 v128, v128, v18
v_sub_f32 v224, 0, v18
v_sub_f32 v129, v129, v18
v_sub_f32 v225, 0, v18
v_sub_f32 v130, v130, v18
v_sub_f32 v226, 0, v18
v_sub_f32 v131, v131, v18
v_sub_f32 v227, 0, v18
v_sub_f32 v132, v132, v18
v_sub_f32 v228, 0, v18
v_sub_f32 v133, v133, v18
v_sub_f32 v229, 0, v18
v_sub_f32 v134, v134, v18
v_sub_f32 v230, 0, v18
v_sub_f32 v135, v135, v18
v_sub_f32 v231, 0, v18
v_sub_f32 v136, v136, v18
v_sub_f32 v232, 0, v18
v_sub_f32 v137, v137, v18
v_sub_f32 v233, 0, v18
v_sub_f32 v138, v138, v18
v_sub_f32 v234, 0, v18
v_sub_f32 v139, v139, v18
v_sub_f32 v235, 0, v18
v_sub_f32 v140, v140, v18
v_sub_f32 v236, 0, v18
v_sub_f32 v141, v141, v18
v_sub_f32 v237, 0, v18
v_sub_f32 v142, v142, v18
v_sub_f32 v238, 0, v18
v_sub_f32 v143, v143, v18
v_sub_f32 v239, 0, v18
v_sub_f32 v144, v144, v20
v_sub_f32 v240, 0, v20
v_sub_f32 v145, v145, v20
v_sub_f32 v241, 0, v20
v_sub_f32 v146, v146, v20
v_sub_f32 v242, 0, v20
v_sub_f32 v147, v147, v20
v_sub_f32 v243, 0, v20
v_sub_f32 v148, v148, v20
v_sub_f32 v244, 0, v20
v_sub_f32 v149, v149, v20
v_sub_f32 v245, 0, v20
v_sub_f32 v150, v150, v20
v_sub_f32 v246, 0, v20
v_sub_f32 v151, v151, v20
v_sub_f32 v247, 0, v20
v_sub_f32 v152, v152, v20
v_sub_f32 v248, 0, v20
v_sub_f32 v153, v153, v20
v_sub_f32 v249, 0, v20
v_sub_f32 v154, v154, v20
v_sub_f32 v250, 0, v20
v_sub_f32 v155, v155, v20
v_sub_f32 v251, 0, v20
v_sub_f32 v156, v156, v20
v_sub_f32 v252, 0, v20
v_sub_f32 v157, v157, v20
v_sub_f32 v253, 0, v20
v_sub_f32 v158, v158, v20
v_sub_f32 v254, 0, v20
v_sub_f32 v159, v159, v20
v_sub_f32 v255, 0, v20
s_mov_b32 s63, 98304
s_mov_b32 s69, 65536
s_mov_b32 s66, 40960
s_mov_b32 s67, 32768
s_waitcnt vmcnt(12)
s_waitcnt lgkmcnt(0)
s_barrier
s_add_u32 s63, s63, 0x8000
s_and_b32 s63, s63, 0x1ffff
v_add_u32 v3, s63, v31
ds_read_b128 a[128:131], v3 offset:0
ds_read_b128 a[132:135], v3 offset:1024
ds_read_b128 a[136:139], v3 offset:2048
ds_read_b128 a[140:143], v3 offset:3072
ds_read_b128 a[144:147], v3 offset:4096
ds_read_b128 a[148:151], v3 offset:5120
ds_read_b128 a[152:155], v3 offset:6144
ds_read_b128 a[156:159], v3 offset:7168
s_sub_u32 s22, s48, s68
s_sub_u32 s22, s22, 32
s_cmp_eq_u32 s22, 0
s_cselect_b32 s20, 1.0, 0
s_cmp_lt_i32 s22, 0
s_cselect_b32 s21, 0xf149f2ca, 0
v_add_f32 v10, s21, v224
v_fma_f32 v160, v40, s20, v10
v_fma_f32 v161, v41, s20, v10
v_fma_f32 v162, v42, s20, v10
v_fma_f32 v163, v43, s20, v10
v_fma_f32 v164, v44, s20, v10
v_fma_f32 v165, v45, s20, v10
v_fma_f32 v166, v46, s20, v10
v_fma_f32 v167, v47, s20, v10
v_fma_f32 v168, v48, s20, v10
v_fma_f32 v169, v49, s20, v10
v_fma_f32 v170, v50, s20, v10
v_fma_f32 v171, v51, s20, v10
v_fma_f32 v172, v52, s20, v10
v_fma_f32 v173, v53, s20, v10
v_fma_f32 v174, v54, s20, v10
v_fma_f32 v175, v55, s20, v10
s_nop 1
s_waitcnt lgkmcnt(4)
v_mfma_f32_32x32x16_bf16 v[160:175], a[128:131], v[64:67], v[160:175]
ds_read_b128 a[160:163], v3 offset:16384
v_mfma_f32_32x32x16_bf16 v[176:191], a[128:131], v[96:99], v[240:255]
ds_read_b128 a[164:167], v3 offset:17408
s_add_u32 m0, s45, s69
s_add_u32 s69, s69, 0x8000
buffer_load_dwordx4 v2, s[4:7], s66 offen offset:0 lds
v_mfma_f32_32x32x16_bf16 v[160:175], a[132:135], v[68:71], v[160:175]
ds_read_b128 a[168:171], v3 offset:18432
buffer_load_dwordx4 v2, s[4:7], s66 offen offset:1024 lds
v_mfma_f32_32x32x16_bf16 v[176:191], a[132:135], v[100:103], v[176:191]
buffer_load_dwordx4 v2, s[4:7], s66 offen offset:2048 lds
buffer_load_dwordx4 v2, s[4:7], s66 offen offset:3072 lds
v_mfma_f32_32x32x16_bf16 v[160:175], a[136:139], v[72:75], v[160:175]
ds_read_b128 a[172:175], v3 offset:19456
s_add_u32 m0, m0, 16384
s_add_u32 s66, s66, 16384
v_exp_f32 v12, v128
v_exp_f32 v13, v129
v_exp_f32 v14, v130
v_add_f32 v6, v12, v13
v_cvt_pk_bf16_f32 v192, v12, v13
v_mfma_f32_32x32x16_bf16 v[176:191], a[136:139], v[104:107], v[176:191]
ds_read_b128 a[176:179], v3 offset:20480
buffer_load_dwordx4 v2, s[8:11], s67 offen offset:0 lds
buffer_load_dwordx4 v2, s[8:11], s67 offen offset:1024 lds
v_exp_f32 v15, v131
v_add_f32 v6, v6, v14
v_exp_f32 v16, v132
v_add_f32 v6, v6, v15
v_cvt_pk_bf16_f32 v193, v14, v15
v_exp_f32 v17, v133
v_mfma_f32_32x32x16_bf16 v[160:175], a[140:143], v[76:79], v[160:175]
ds_read_b128 a[180:183], v3 offset:21504
buffer_load_dwordx4 v2, s[8:11], s67 offen offset:2048 lds
v_add_f32 v6, v6, v16
v_exp_f32 v12, v134
v_add_f32 v6, v6, v17
v_cvt_pk_bf16_f32 v194, v16, v17
v_exp_f32 v13, v135
v_add_f32 v6, v6, v12
v_exp_f32 v14, v136
v_mfma_f32_32x32x16_bf16 v[176:191], a[140:143], v[108:111], v[176:191]
buffer_load_dwordx4 v2, s[8:11], s67 offen offset:3072 lds
s_add_u32 s67, s67, 16384
s_and_b32 s69, s69, 0x1ffff
v_add_f32 v6, v6, v13
v_cvt_pk_bf16_f32 v195, v12, v13
v_exp_f32 v15, v137
v_add_f32 v6, v6, v14
v_exp_f32 v16, v138
v_add_f32 v6, v6, v15
s_waitcnt lgkmcnt(6)
v_mfma_f32_32x32x16_bf16 v[160:175], a[144:147], v[80:83], v[160:175]
ds_read_b128 a[184:187], v3 offset:22528
s_add_u32 m0, s45, s69
s_add_u32 s69, s69, 0x8000
v_cvt_pk_bf16_f32 v196, v14, v15
v_exp_f32 v17, v139
v_add_f32 v6, v6, v16
v_exp_f32 v12, v140
v_add_f32 v6, v6, v17
v_cvt_pk_bf16_f32 v197, v16, v17
v_mfma_f32_32x32x16_bf16 v[176:191], a[144:147], v[112:115], v[176:191]
ds_read_b128 a[188:191], v3 offset:23552
buffer_load_dwordx4 v2, s[4:7], s66 offen offset:0 lds
buffer_load_dwordx4 v2, s[4:7], s66 offen offset:1024 lds
v_exp_f32 v13, v141
v_add_f32 v6, v6, v12
v_exp_f32 v14, v142
v_add_f32 v6, v6, v13
v_cvt_pk_bf16_f32 v198, v12, v13
v_mfma_f32_32x32x16_bf16 v[160:175], a[148:151], v[84:87], v[160:175]
buffer_load_dwordx4 v2, s[4:7], s66 offen offset:2048 lds
v_exp_f32 v15, v143
v_add_f32 v6, v6, v14
v_add_f32 v6, v6, v15
v_cvt_pk_bf16_f32 v199, v14, v15
v_exp_f32 v12, v144
v_exp_f32 v13, v145
v_exp_f32 v14, v146
v_add_f32 v7, v12, v13
v_cvt_pk_bf16_f32 v200, v12, v13
v_exp_f32 v15, v147
v_mfma_f32_32x32x16_bf16 v[176:191], a[148:151], v[116:119], v[176:191]
buffer_load_dwordx4 v2, s[4:7], s66 offen offset:3072 lds
v_add_f32 v7, v7, v14
v_exp_f32 v16, v148
v_add_f32 v7, v7, v15
v_cvt_pk_bf16_f32 v201, v14, v15
v_exp_f32 v17, v149
v_add_f32 v7, v7, v16
v_exp_f32 v12, v150
v_add_f32 v7, v7, v17
v_cvt_pk_bf16_f32 v202, v16, v17
v_mfma_f32_32x32x16_bf16 v[160:175], a[152:155], v[88:91], v[160:175]
v_exp_f32 v13, v151
v_add_f32 v7, v7, v12
v_exp_f32 v14, v152
v_add_f32 v7, v7, v13
v_cvt_pk_bf16_f32 v203, v12, v13
v_exp_f32 v15, v153
v_add_f32 v7, v7, v14
v_exp_f32 v16, v154
v_add_f32 v7, v7, v15
v_cvt_pk_bf16_f32 v204, v14, v15
v_exp_f32 v17, v155
v_add_f32 v7, v7, v16
v_mfma_f32_32x32x16_bf16 v[160:175], a[156:159], v[92:95], v[160:175]
v_exp_f32 v12, v156
v_add_f32 v7, v7, v17
v_cvt_pk_bf16_f32 v205, v16, v17
v_exp_f32 v13, v157
v_add_f32 v7, v7, v12
v_exp_f32 v14, v158
v_add_f32 v7, v7, v13
v_cvt_pk_bf16_f32 v206, v12, v13
v_exp_f32 v15, v159
v_add_f32 v7, v7, v14
v_add_f32 v7, v7, v15
v_cvt_pk_bf16_f32 v207, v14, v15
v_mfma_f32_32x32x16_bf16 v[176:191], a[152:155], v[120:123], v[176:191]
v_max_f32 v18, v6, v7
v_cmp_lt_f32 vcc, s70, v18
v_mfma_f32_32x32x16_bf16 v[176:191], a[156:159], v[124:127], v[176:191]
s_cbranch_vccnz L_rare_17
L_back_18:
v_add_f32 v4, v4, v6
v_add_f32 v5, v5, v7
s_waitcnt lgkmcnt(0)
v_mfma_f32_32x32x16_bf16 a[0:15], a[160:163], v[192:195], 0
ds_read_b128 a[128:131], v3 offset:8192
s_sub_u32 s22, s48, s68
s_sub_u32 s22, s22, 64
v_mfma_f32_32x32x16_bf16 a[64:79], a[160:163], v[200:203], 0
ds_read_b128 a[132:135], v3 offset:9216
s_add_u32 m0, m0, 16384
s_add_u32 s66, s66, 16384
v_exp_f32 v12, v160
v_mfma_f32_32x32x16_bf16 a[16:31], a[164:167], v[192:195], 0
s_cmp_eq_u32 s22, 0
s_cselect_b32 s20, 1.0, 0
v_exp_f32 v13, v161
v_exp_f32 v14, v162
v_mfma_f32_32x32x16_bf16 a[80:95], a[164:167], v[200:203], 0
ds_read_b128 a[136:139], v3 offset:10240
s_cmp_lt_i32 s22, 0
s_cselect_b32 s21, 0xf149f2ca, 0
v_add_f32 v6, v12, v13
v_cvt_pk_bf16_f32 v208, v12, v13
v_mfma_f32_32x32x16_bf16 a[32:47], a[168:171], v[192:195], 0
ds_read_b128 a[140:143], v3 offset:11264
v_add_f32 v10, s21, v224
v_exp_f32 v15, v163
v_add_f32 v6, v6, v14
v_exp_f32 v16, v164
v_mfma_f32_32x32x16_bf16 a[96:111], a[168:171], v[200:203], 0
buffer_load_dwordx4 v2, s[8:11], s67 offen offset:0 lds
v_fma_f32 v128, v40, s20, v10
v_fma_f32 v129, v41, s20, v10
v_add_f32 v6, v6, v15
v_cvt_pk_bf16_f32 v209, v14, v15
v_mfma_f32_32x32x16_bf16 a[48:63], a[172:175], v[192:195], 0
ds_read_b128 a[144:147], v3 offset:12288
v_fma_f32 v130, v42, s20, v10
v_exp_f32 v17, v165
v_add_f32 v6, v6, v16
v_mfma_f32_32x32x16_bf16 a[112:127], a[172:175], v[200:203], 0
ds_read_b128 a[148:151], v3 offset:13312
v_fma_f32 v131, v43, s20, v10
v_fma_f32 v132, v44, s20, v10
v_exp_f32 v12, v166
v_add_f32 v6, v6, v17
v_mfma_f32_32x32x16_bf16 a[0:15], a[176:179], v[196:199], a[0:15]
v_fma_f32 v133, v45, s20, v10
v_cvt_pk_bf16_f32 v210, v16, v17
v_exp_f32 v13, v167
v_add_f32 v6, v6, v12
v_mfma_f32_32x32x16_bf16 a[64:79], a[176:179], v[204:207], a[64:79]
ds_read_b128 a[152:155], v3 offset:14336
v_fma_f32 v134, v46, s20, v10
v_fma_f32 v135, v47, s20, v10
v_exp_f32 v14, v168
v_add_f32 v6, v6, v13
v_mfma_f32_32x32x16_bf16 a[16:31], a[180:183], v[196:199], a[16:31]
ds_read_b128 a[156:159], v3 offset:15360
buffer_load_dwordx4 v2, s[8:11], s67 offen offset:1024 lds
v_fma_f32 v136, v48, s20, v10
v_cvt_pk_bf16_f32 v211, v12, v13
v_exp_f32 v15, v169
v_mfma_f32_32x32x16_bf16 a[80:95], a[180:183], v[204:207], a[80:95]
v_fma_f32 v137, v49, s20, v10
v_fma_f32 v138, v50, s20, v10
v_add_f32 v6, v6, v14
v_exp_f32 v16, v170
v_mfma_f32_32x32x16_bf16 a[32:47], a[184:187], v[196:199], a[32:47]
v_fma_f32 v139, v51, s20, v10
v_fma_f32 v140, v52, s20, v10
v_add_f32 v6, v6, v15
v_cvt_pk_bf16_f32 v212, v14, v15
v_exp_f32 v17, v171
v_mfma_f32_32x32x16_bf16 a[96:111], a[184:187], v[204:207], a[96:111]
v_fma_f32 v141, v53, s20, v10
v_fma_f32 v142, v54, s20, v10
v_add_f32 v6, v6, v16
v_exp_f32 v12, v172
v_mfma_f32_32x32x16_bf16 a[48:63], a[188:191], v[196:199], a[48:63]
buffer_load_dwordx4 v2, s[8:11], s67 offen offset:2048 lds
v_fma_f32 v143, v55, s20, v10
v_add_f32 v6, v6, v17
v_cvt_pk_bf16_f32 v213, v16, v17
v_exp_f32 v13, v173
v_mfma_f32_32x32x16_bf16 a[112:127], a[188:191], v[204:207], a[112:127]
v_add_f32 v6, v6, v12
v_exp_f32 v14, v174
v_add_f32 v6, v6, v13
v_cvt_pk_bf16_f32 v214, v12, v13
s_waitcnt lgkmcnt(4)
v_mfma_f32_32x32x16_bf16 v[128:143], a[128:131], v[64:67], v[128:143]
ds_read_b128 a[192:195], v3 offset:24576
v_exp_f32 v15, v175
v_add_f32 v6, v6, v14
v_add_f32 v6, v6, v15
v_cvt_pk_bf16_f32 v215, v14, v15
v_mfma_f32_32x32x16_bf16 v[144:159], a[128:131], v[96:99], v[240:255]
ds_read_b128 a[196:199], v3 offset:25600
v_exp_f32 v12, v176
v_exp_f32 v13, v177
v_mfma_f32_32x32x16_bf16 v[128:143], a[132:135], v[68:71], v[128:143]
ds_read_b128 a[200:203], v3 offset:26624
v_exp_f32 v14, v178
v_add_f32 v7, v12, v13
v_cvt_pk_bf16_f32 v216, v12, v13
v_mfma_f32_32x32x16_bf16 v[144:159], a[132:135], v[100:103], v[144:159]
buffer_load_dwordx4 v2, s[8:11], s67 offen offset:3072 lds
v_exp_f32 v15, v179
v_add_f32 v7, v7, v14
v_exp_f32 v16, v180
v_mfma_f32_32x32x16_bf16 v[128:143], a[136:139], v[72:75], v[128:143]
ds_read_b128 a[204:207], v3 offset:27648
v_add_f32 v7, v7, v15
v_cvt_pk_bf16_f32 v217, v14, v15
v_exp_f32 v17, v181
v_mfma_f32_32x32x16_bf16 v[144:159], a[136:139], v[104:107], v[144:159]
ds_read_b128 a[208:211], v3 offset:28672
v_add_f32 v7, v7, v16
v_exp_f32 v12, v182
v_add_f32 v7, v7, v17
v_cvt_pk_bf16_f32 v218, v16, v17
v_mfma_f32_32x32x16_bf16 v[128:143], a[140:143], v[76:79], v[128:143]
ds_read_b128 a[212:215], v3 offset:29696
v_exp_f32 v13, v183
v_add_f32 v7, v7, v12
v_mfma_f32_32x32x16_bf16 v[144:159], a[140:143], v[108:111], v[144:159]
s_add_u32 s67, s67, 16384
s_and_b32 s69, s69, 0x1ffff
v_exp_f32 v14, v184
v_add_f32 v7, v7, v13
v_cvt_pk_bf16_f32 v219, v12, v13
s_waitcnt lgkmcnt(6)
v_mfma_f32_32x32x16_bf16 v[128:143], a[144:147], v[80:83], v[128:143]
ds_read_b128 a[216:219], v3 offset:30720
v_exp_f32 v15, v185
v_add_f32 v7, v7, v14
v_exp_f32 v16, v186
v_mfma_f32_32x32x16_bf16 v[144:159], a[144:147], v[112:115], v[144:159]
ds_read_b128 a[220:223], v3 offset:31744
v_add_f32 v7, v7, v15
v_cvt_pk_bf16_f32 v220, v14, v15
v_exp_f32 v17, v187
v_mfma_f32_32x32x16_bf16 v[128:143], a[148:151], v[84:87], v[128:143]
v_add_f32 v7, v7, v16
v_exp_f32 v12, v188
v_add_f32 v7, v7, v17
v_cvt_pk_bf16_f32 v221, v16, v17
v_mfma_f32_32x32x16_bf16 v[144:159], a[148:151], v[116:119], v[144:159]
v_exp_f32 v13, v189
v_add_f32 v7, v7, v12
v_exp_f32 v14, v190
v_add_f32 v7, v7, v13
v_mfma_f32_32x32x16_bf16 v[128:143], a[152:155], v[88:91], v[128:143]
v_cvt_pk_bf16_f32 v222, v12, v13
v_exp_f32 v15, v191
v_add_f32 v7, v7, v14
v_add_f32 v7, v7, v15
v_mfma_f32_32x32x16_bf16 v[128:143], a[156:159], v[92:95], v[128:143]
s_waitcnt vmcnt(16) lgkmcnt(0)
s_barrier
s_add_u32 s63, s63, 0x8000
s_and_b32 s63, s63, 0x1ffff
v_add_u32 v3, s63, v31
v_cvt_pk_bf16_f32 v223, v14, v15
v_mfma_f32_32x32x16_bf16 v[144:159], a[152:155], v[120:123], v[144:159]
v_max_f32 v18, v6, v7
v_cmp_lt_f32 vcc, s70, v18
v_mfma_f32_32x32x16_bf16 v[144:159], a[156:159], v[124:127], v[144:159]
s_cbranch_vccnz L_rare_19
L_back_20:
v_add_f32 v4, v4, v6
v_add_f32 v5, v5, v7
s_add_u32 s68, s68, 64
s_cmp_lg_u32 s38, 0
s_cbranch_scc1 L_w0_21
s_lshl_b32 s41, s36, 3
s_add_u32 s41, s41, s37
s_lshl_b32 s42, s41, 7
s_add_u32 s42, s42, 0x3920000
v_mov_b32 v61, s42
v_mov_b32 v62, s71
s_mov_b64 s[64:65], exec
s_mov_b64 exec, 1
buffer_store_dword v62, v61, s[16:19], 0 offen sc1
s_mov_b64 exec, s[64:65]
L_w0_21:
s_sub_u32 s55, s53, 4
s_cmp_lt_i32 s55, 1
s_cbranch_scc1 L_loopend_23
.p2align 6
L_loop_22:
v_mfma_f32_32x32x16_bf16 a[0:15], a[192:195], v[208:211], a[0:15]
ds_read_b128 a[128:131], v3 offset:0
v_mfma_f32_32x32x16_bf16 a[64:79], a[192:195], v[216:219], a[64:79]
ds_read_b128 a[132:135], v3 offset:1024
s_add_u32 m0, s45, s69
s_add_u32 s69, s69, 0x8000
v_exp_f32 v12, v128
v_mfma_f32_32x32x16_bf16 a[16:31], a[196:199], v[208:211], a[16:31]
v_exp_f32 v13, v129
v_exp_f32 v14, v130
v_mfma_f32_32x32x16_bf16 a[80:95], a[196:199], v[216:219], a[80:95]
ds_read_b128 a[136:139], v3 offset:2048
v_add_f32 v6, v12, v13
v_cvt_pk_bf16_f32 v192, v12, v13
v_exp_f32 v15, v131
v_mfma_f32_32x32x16_bf16 a[32:47], a[200:203], v[208:211], a[32:47]
ds_read_b128 a[140:143], v3 offset:3072
v_add_f32 v6, v6, v14
v_exp_f32 v16, v132
v_add_f32 v6, v6, v15
v_mfma_f32_32x32x16_bf16 a[96:111], a[200:203], v[216:219], a[96:111]
v_cvt_pk_bf16_f32 v193, v14, v15
v_exp_f32 v17, v133
v_add_f32 v6, v6, v16
v_mfma_f32_32x32x16_bf16 a[48:63], a[204:207], v[208:211], a[48:63]
ds_read_b128 a[144:147], v3 offset:4096
buffer_load_dwordx4 v2, s[4:7], s66 offen offset:0 lds
v_exp_f32 v12, v134
v_add_f32 v6, v6, v17
v_mfma_f32_32x32x16_bf16 a[112:127], a[204:207], v[216:219], a[112:127]
ds_read_b128 a[148:151], v3 offset:5120
v_cvt_pk_bf16_f32 v194, v16, v17
v_exp_f32 v13, v135
v_mfma_f32_32x32x16_bf16 a[0:15], a[208:211], v[212:215], a[0:15]
v_add_f32 v6, v6, v12
v_exp_f32 v14, v136
v_add_f32 v6, v6, v13
v_cvt_pk_bf16_f32 v195, v12, v13
v_mfma_f32_32x32x16_bf16 a[64:79], a[208:211], v[220:223], a[64:79]
ds_read_b128 a[152:155], v3 offset:6144
v_exp_f32 v15, v137
v_add_f32 v6, v6, v14
v_mfma_f32_32x32x16_bf16 a[16:31], a[212:215], v[212:215], a[16:31]
ds_read_b128 a[156:159], v3 offset:7168
v_exp_f32 v16, v138
v_add_f32 v6, v6, v15
v_cvt_pk_bf16_f32 v196, v14, v15
v_mfma_f32_32x32x16_bf16 a[80:95], a[212:215], v[220:223], a[80:95]
buffer_load_dwordx4 v2, s[4:7], s66 offen offset:1024 lds
v_exp_f32 v17, v139
v_add_f32 v6, v6, v16
v_mfma_f32_32x32x16_bf16 a[32:47], a[216:219], v[212:215], a[32:47]
v_exp_f32 v12, v140
v_add_f32 v6, v6, v17
v_cvt_pk_bf16_f32 v197, v16, v17
v_mfma_f32_32x32x16_bf16 a[96:111], a[216:219], v[220:223], a[96:111]
v_exp_f32 v13, v141
v_add_f32 v6, v6, v12
v_exp_f32 v14, v142
v_mfma_f32_32x32x16_bf16 a[48:63], a[220:223], v[212:215], a[48:63]
v_add_f32 v6, v6, v13
v_cvt_pk_bf16_f32 v198, v12, v13
v_exp_f32 v15, v143
v_mfma_f32_32x32x16_bf16 a[112:127], a[220:223], v[220:223], a[112:127]
v_add_f32 v6, v6, v14
v_add_f32 v6, v6, v15
v_cvt_pk_bf16_f32 v199, v14, v15
v_exp_f32 v12, v144
s_waitcnt lgkmcnt(4)
v_mfma_f32_32x32x16_bf16 v[160:175], a[128:131], v[64:67], v[224:239]
ds_read_b128 a[160:163], v3 offset:16384
v_exp_f32 v13, v145
v_exp_f32 v14, v146
v_mfma_f32_32x32x16_bf16 v[176:191], a[128:131], v[96:99], v[240:255]
ds_read_b128 a[164:167], v3 offset:17408
buffer_load_dwordx4 v2, s[4:7], s66 offen offset:2048 lds
v_add_f32 v7, v12, v13
v_cvt_pk_bf16_f32 v200, v12, v13
v_mfma_f32_32x32x16_bf16 v[160:175], a[132:135], v[68:71], v[160:175]
ds_read_b128 a[168:171], v3 offset:18432
v_exp_f32 v15, v147
v_add_f32 v7, v7, v14
v_mfma_f32_32x32x16_bf16 v[176:191], a[132:135], v[100:103], v[176:191]
v_exp_f32 v16, v148
v_add_f32 v7, v7, v15
v_cvt_pk_bf16_f32 v201, v14, v15
v_exp_f32 v17, v149
v_mfma_f32_32x32x16_bf16 v[160:175], a[136:139], v[72:75], v[160:175]
ds_read_b128 a[172:175], v3 offset:19456
v_add_f32 v7, v7, v16
v_exp_f32 v12, v150
v_mfma_f32_32x32x16_bf16 v[176:191], a[136:139], v[104:107], v[176:191]
ds_read_b128 a[176:179], v3 offset:20480
v_add_f32 v7, v7, v17
v_cvt_pk_bf16_f32 v202, v16, v17
v_exp_f32 v13, v151
v_mfma_f32_32x32x16_bf16 v[160:175], a[140:143], v[76:79], v[160:175]
ds_read_b128 a[180:183], v3 offset:21504
buffer_load_dwordx4 v2, s[4:7], s66 offen offset:3072 lds
v_add_f32 v7, v7, v12
v_exp_f32 v14, v152
v_mfma_f32_32x32x16_bf16 v[176:191], a[140:143], v[108:111], v[176:191]
v_add_f32 v7, v7, v13
v_cvt_pk_bf16_f32 v203, v12, v13
v_exp_f32 v15, v153
s_waitcnt lgkmcnt(6)
v_mfma_f32_32x32x16_bf16 v[160:175], a[144:147], v[80:83], v[160:175]
ds_read_b128 a[184:187], v3 offset:22528
v_add_f32 v7, v7, v14
v_exp_f32 v16, v154
v_mfma_f32_32x32x16_bf16 v[176:191], a[144:147], v[112:115], v[176:191]
ds_read_b128 a[188:191], v3 offset:23552
v_add_f32 v7, v7, v15
v_cvt_pk_bf16_f32 v204, v14, v15
v_exp_f32 v17, v155
v_mfma_f32_32x32x16_bf16 v[160:175], a[148:151], v[84:87], v[160:175]
v_add_f32 v7, v7, v16
v_exp_f32 v12, v156
v_add_f32 v7, v7, v17
v_mfma_f32_32x32x16_bf16 v[176:191], a[148:151], v[116:119], v[176:191]
v_cvt_pk_bf16_f32 v205, v16, v17
v_exp_f32 v13, v157
v_add_f32 v7, v7, v12
v_mfma_f32_32x32x16_bf16 v[160:175], a[152:155], v[88:91], v[160:175]
v_exp_f32 v14, v158
v_add_f32 v7, v7, v13
v_cvt_pk_bf16_f32 v206, v12, v13
v_mfma_f32_32x32x16_bf16 v[160:175], a[156:159], v[92:95], v[160:175]
v_exp_f32 v15, v159
v_add_f32 v7, v7, v14
v_add_f32 v7, v7, v15
v_cvt_pk_bf16_f32 v207, v14, v15
v_mfma_f32_32x32x16_bf16 v[176:191], a[152:155], v[120:123], v[176:191]
v_max_f32 v18, v6, v7
v_cmp_lt_f32 vcc, s70, v18
v_mfma_f32_32x32x16_bf16 v[176:191], a[156:159], v[124:127], v[176:191]
s_cbranch_vccnz L_rare_24
L_back_25:
v_add_f32 v4, v4, v6
v_add_f32 v5, v5, v7
s_waitcnt lgkmcnt(0)
v_mfma_f32_32x32x16_bf16 a[0:15], a[160:163], v[192:195], a[0:15]
ds_read_b128 a[128:131], v3 offset:8192
v_mfma_f32_32x32x16_bf16 a[64:79], a[160:163], v[200:203], a[64:79]
ds_read_b128 a[132:135], v3 offset:9216
s_add_u32 m0, m0, 16384
s_add_u32 s66, s66, 16384
v_exp_f32 v12, v160
v_mfma_f32_32x32x16_bf16 a[16:31], a[164:167], v[192:195], a[16:31]
v_exp_f32 v13, v161
v_exp_f32 v14, v162
v_add_f32 v6, v12, v13
v_mfma_f32_32x32x16_bf16 a[80:95], a[164:167], v[200:203], a[80:95]
ds_read_b128 a[136:139], v3 offset:10240
v_cvt_pk_bf16_f32 v208, v12, v13
v_exp_f32 v15, v163
v_add_f32 v6, v6, v14
v_mfma_f32_32x32x16_bf16 a[32:47], a[168:171], v[192:195], a[32:47]
ds_read_b128 a[140:143], v3 offset:11264
v_exp_f32 v16, v164
v_add_f32 v6, v6, v15
v_mfma_f32_32x32x16_bf16 a[96:111], a[168:171], v[200:203], a[96:111]
buffer_load_dwordx4 v2, s[8:11], s67 offen offset:0 lds
v_cvt_pk_bf16_f32 v209, v14, v15
v_exp_f32 v17, v165
v_add_f32 v6, v6, v16
v_mfma_f32_32x32x16_bf16 a[48:63], a[172:175], v[192:195], a[48:63]
ds_read_b128 a[144:147], v3 offset:12288
v_exp_f32 v12, v166
v_add_f32 v6, v6, v17
v_cvt_pk_bf16_f32 v210, v16, v17
v_mfma_f32_32x32x16_bf16 a[112:127], a[172:175], v[200:203], a[112:127]
ds_read_b128 a[148:151], v3 offset:13312
v_exp_f32 v13, v167
v_add_f32 v6, v6, v12
v_mfma_f32_32x32x16_bf16 a[0:15], a[176:179], v[196:199], a[0:15]
v_exp_f32 v14, v168
v_add_f32 v6, v6, v13
v_cvt_pk_bf16_f32 v211, v12, v13
v_exp_f32 v15, v169
v_mfma_f32_32x32x16_bf16 a[64:79], a[176:179], v[204:207], a[64:79]
ds_read_b128 a[152:155], v3 offset:14336
v_add_f32 v6, v6, v14
v_exp_f32 v16, v170
v_mfma_f32_32x32x16_bf16 a[16:31], a[180:183], v[196:199], a[16:31]
ds_read_b128 a[156:159], v3 offset:15360
buffer_load_dwordx4 v2, s[8:11], s67 offen offset:1024 lds
v_add_f32 v6, v6, v15
v_cvt_pk_bf16_f32 v212, v14, v15
v_mfma_f32_32x32x16_bf16 a[80:95], a[180:183], v[204:207], a[80:95]
v_exp_f32 v17, v171
v_add_f32 v6, v6, v16
v_exp_f32 v12, v172
v_mfma_f32_32x32x16_bf16 a[32:47], a[184:187], v[196:199], a[32:47]
v_add_f32 v6, v6, v17
v_cvt_pk_bf16_f32 v213, v16, v17
v_exp_f32 v13, v173
v_add_f32 v6, v6, v12
v_mfma_f32_32x32x16_bf16 a[96:111], a[184:187], v[204:207], a[96:111]
v_exp_f32 v14, v174
v_add_f32 v6, v6, v13
v_cvt_pk_bf16_f32 v214, v12, v13
v_mfma_f32_32x32x16_bf16 a[48:63], a[188:191], v[196:199], a[48:63]
buffer_load_dwordx4 v2, s[8:11], s67 offen offset:2048 lds
v_exp_f32 v15, v175
v_add_f32 v6, v6, v14
v_add_f32 v6, v6, v15
v_mfma_f32_32x32x16_bf16 a[112:127], a[188:191], v[204:207], a[112:127]
v_cvt_pk_bf16_f32 v215, v14, v15
v_exp_f32 v12, v176
v_exp_f32 v13, v177
s_waitcnt lgkmcnt(4)
v_mfma_f32_32x32x16_bf16 v[128:143], a[128:131], v[64:67], v[224:239]
ds_read_b128 a[192:195], v3 offset:24576
v_exp_f32 v14, v178
v_add_f32 v7, v12, v13
v_cvt_pk_bf16_f32 v216, v12, v13
v_mfma_f32_32x32x16_bf16 v[144:159], a[128:131], v[96:99], v[240:255]
ds_read_b128 a[196:199], v3 offset:25600
v_exp_f32 v15, v179
v_add_f32 v7, v7, v14
v_mfma_f32_32x32x16_bf16 v[128:143], a[132:135], v[68:71], v[128:143]
ds_read_b128 a[200:203], v3 offset:26624
v_exp_f32 v16, v180
v_add_f32 v7, v7, v15
v_cvt_pk_bf16_f32 v217, v14, v15
v_mfma_f32_32x32x16_bf16 v[144:159], a[132:135], v[100:103], v[144:159]
buffer_load_dwordx4 v2, s[8:11], s67 offen offset:3072 lds
v_exp_f32 v17, v181
v_add_f32 v7, v7, v16
v_mfma_f32_32x32x16_bf16 v[128:143], a[136:139], v[72:75], v[128:143]
ds_read_b128 a[204:207], v3 offset:27648
v_exp_f32 v12, v182
v_add_f32 v7, v7, v17
v_cvt_pk_bf16_f32 v218, v16, v17
v_mfma_f32_32x32x16_bf16 v[144:159], a[136:139], v[104:107], v[144:159]
ds_read_b128 a[208:211], v3 offset:28672
v_exp_f32 v13, v183
v_add_f32 v7, v7, v12
v_exp_f32 v14, v184
v_mfma_f32_32x32x16_bf16 v[128:143], a[140:143], v[76:79], v[128:143]
ds_read_b128 a[212:215], v3 offset:29696
v_add_f32 v7, v7, v13
v_cvt_pk_bf16_f32 v219, v12, v13
v_exp_f32 v15, v185
v_mfma_f32_32x32x16_bf16 v[144:159], a[140:143], v[108:111], v[144:159]
s_add_u32 s67, s67, 16384
s_and_b32 s69, s69, 0x1ffff
v_add_f32 v7, v7, v14
v_exp_f32 v16, v186
s_waitcnt lgkmcnt(6)
v_mfma_f32_32x32x16_bf16 v[128:143], a[144:147], v[80:83], v[128:143]
ds_read_b128 a[216:219], v3 offset:30720
v_add_f32 v7, v7, v15
v_cvt_pk_bf16_f32 v220, v14, v15
v_mfma_f32_32x32x16_bf16 v[144:159], a[144:147], v[112:115], v[144:159]
ds_read_b128 a[220:223], v3 offset:31744
v_exp_f32 v17, v187
v_add_f32 v7, v7, v16
v_exp_f32 v12, v188
v_mfma_f32_32x32x16_bf16 v[128:143], a[148:151], v[84:87], v[128:143]
v_add_f32 v7, v7, v17
v_cvt_pk_bf16_f32 v221, v16, v17
v_exp_f32 v13, v189
v_mfma_f32_32x32x16_bf16 v[144:159], a[148:151], v[116:119], v[144:159]
v_add_f32 v7, v7, v12
v_exp_f32 v14, v190
v_add_f32 v7, v7, v13
v_cvt_pk_bf16_f32 v222, v12, v13
v_mfma_f32_32x32x16_bf16 v[128:143], a[152:155], v[88:91], v[128:143]
v_exp_f32 v15, v191
v_add_f32 v7, v7, v14
v_add_f32 v7, v7, v15
v_mfma_f32_32x32x16_bf16 v[128:143], a[156:159], v[92:95], v[128:143]
s_waitcnt vmcnt(16) lgkmcnt(0)
s_barrier
s_add_u32 s63, s63, 0x8000
s_and_b32 s63, s63, 0x1ffff
v_add_u32 v3, s63, v31
v_cvt_pk_bf16_f32 v223, v14, v15
v_mfma_f32_32x32x16_bf16 v[144:159], a[152:155], v[120:123], v[144:159]
v_max_f32 v18, v6, v7
v_cmp_lt_f32 vcc, s70, v18
v_mfma_f32_32x32x16_bf16 v[144:159], a[156:159], v[124:127], v[144:159]
s_cbranch_vccnz L_rare_26
L_back_27:
v_add_f32 v4, v4, v6
v_add_f32 v5, v5, v7
s_add_u32 s68, s68, 64
v_mfma_f32_32x32x16_bf16 a[0:15], a[192:195], v[208:211], a[0:15]
ds_read_b128 a[128:131], v3 offset:0
v_mfma_f32_32x32x16_bf16 a[64:79], a[192:195], v[216:219], a[64:79]
ds_read_b128 a[132:135], v3 offset:1024
s_add_u32 m0, s45, s69
s_add_u32 s69, s69, 0x8000
v_exp_f32 v12, v128
v_mfma_f32_32x32x16_bf16 a[16:31], a[196:199], v[208:211], a[16:31]
v_exp_f32 v13, v129
v_exp_f32 v14, v130
v_mfma_f32_32x32x16_bf16 a[80:95], a[196:199], v[216:219], a[80:95]
ds_read_b128 a[136:139], v3 offset:2048
v_add_f32 v6, v12, v13
v_cvt_pk_bf16_f32 v192, v12, v13
v_exp_f32 v15, v131
v_mfma_f32_32x32x16_bf16 a[32:47], a[200:203], v[208:211], a[32:47]
ds_read_b128 a[140:143], v3 offset:3072
v_add_f32 v6, v6, v14
v_exp_f32 v16, v132
v_add_f32 v6, v6, v15
v_mfma_f32_32x32x16_bf16 a[96:111], a[200:203], v[216:219], a[96:111]
v_cvt_pk_bf16_f32 v193, v14, v15
v_exp_f32 v17, v133
v_add_f32 v6, v6, v16
v_mfma_f32_32x32x16_bf16 a[48:63], a[204:207], v[208:211], a[48:63]
ds_read_b128 a[144:147], v3 offset:4096
buffer_load_dwordx4 v2, s[4:7], s66 offen offset:0 lds
v_exp_f32 v12, v134
v_add_f32 v6, v6, v17
v_mfma_f32_32x32x16_bf16 a[112:127], a[204:207], v[216:219], a[112:127]
ds_read_b128 a[148:151], v3 offset:5120
v_cvt_pk_bf16_f32 v194, v16, v17
v_exp_f32 v13, v135
v_mfma_f32_32x32x16_bf16 a[0:15], a[208:211], v[212:215], a[0:15]
v_add_f32 v6, v6, v12
v_exp_f32 v14, v136
v_add_f32 v6, v6, v13
v_cvt_pk_bf16_f32 v195, v12, v13
v_mfma_f32_32x32x16_bf16 a[64:79], a[208:211], v[220:223], a[64:79]
ds_read_b128 a[152:155], v3 offset:6144
v_exp_f32 v15, v137
v_add_f32 v6, v6, v14
v_mfma_f32_32x32x16_bf16 a[16:31], a[212:215], v[212:215], a[16:31]
ds_read_b128 a[156:159], v3 offset:7168
v_exp_f32 v16, v138
v_add_f32 v6, v6, v15
v_cvt_pk_bf16_f32 v196, v14, v15
v_mfma_f32_32x32x16_bf16 a[80:95], a[212:215], v[220:223], a[80:95]
buffer_load_dwordx4 v2, s[4:7], s66 offen offset:1024 lds
v_exp_f32 v17, v139
v_add_f32 v6, v6, v16
v_mfma_f32_32x32x16_bf16 a[32:47], a[216:219], v[212:215], a[32:47]
v_exp_f32 v12, v140
v_add_f32 v6, v6, v17
v_cvt_pk_bf16_f32 v197, v16, v17
v_mfma_f32_32x32x16_bf16 a[96:111], a[216:219], v[220:223], a[96:111]
v_exp_f32 v13, v141
v_add_f32 v6, v6, v12
v_exp_f32 v14, v142
v_mfma_f32_32x32x16_bf16 a[48:63], a[220:223], v[212:215], a[48:63]
v_add_f32 v6, v6, v13
v_cvt_pk_bf16_f32 v198, v12, v13
v_exp_f32 v15, v143
v_mfma_f32_32x32x16_bf16 a[112:127], a[220:223], v[220:223], a[112:127]
v_add_f32 v6, v6, v14
v_add_f32 v6, v6, v15
v_cvt_pk_bf16_f32 v199, v14, v15
v_exp_f32 v12, v144
s_waitcnt lgkmcnt(4)
v_mfma_f32_32x32x16_bf16 v[160:175], a[128:131], v[64:67], v[224:239]
ds_read_b128 a[160:163], v3 offset:16384
v_exp_f32 v13, v145
v_exp_f32 v14, v146
v_mfma_f32_32x32x16_bf16 v[176:191], a[128:131], v[96:99], v[240:255]
ds_read_b128 a[164:167], v3 offset:17408
buffer_load_dwordx4 v2, s[4:7], s66 offen offset:2048 lds
v_add_f32 v7, v12, v13
v_cvt_pk_bf16_f32 v200, v12, v13
v_mfma_f32_32x32x16_bf16 v[160:175], a[132:135], v[68:71], v[160:175]
ds_read_b128 a[168:171], v3 offset:18432
v_exp_f32 v15, v147
v_add_f32 v7, v7, v14
v_mfma_f32_32x32x16_bf16 v[176:191], a[132:135], v[100:103], v[176:191]
v_exp_f32 v16, v148
v_add_f32 v7, v7, v15
v_cvt_pk_bf16_f32 v201, v14, v15
v_exp_f32 v17, v149
v_mfma_f32_32x32x16_bf16 v[160:175], a[136:139], v[72:75], v[160:175]
ds_read_b128 a[172:175], v3 offset:19456
v_add_f32 v7, v7, v16
v_exp_f32 v12, v150
v_mfma_f32_32x32x16_bf16 v[176:191], a[136:139], v[104:107], v[176:191]
ds_read_b128 a[176:179], v3 offset:20480
v_add_f32 v7, v7, v17
v_cvt_pk_bf16_f32 v202, v16, v17
v_exp_f32 v13, v151
v_mfma_f32_32x32x16_bf16 v[160:175], a[140:143], v[76:79], v[160:175]
ds_read_b128 a[180:183], v3 offset:21504
buffer_load_dwordx4 v2, s[4:7], s66 offen offset:3072 lds
v_add_f32 v7, v7, v12
v_exp_f32 v14, v152
v_mfma_f32_32x32x16_bf16 v[176:191], a[140:143], v[108:111], v[176:191]
v_add_f32 v7, v7, v13
v_cvt_pk_bf16_f32 v203, v12, v13
v_exp_f32 v15, v153
s_waitcnt lgkmcnt(6)
v_mfma_f32_32x32x16_bf16 v[160:175], a[144:147], v[80:83], v[160:175]
ds_read_b128 a[184:187], v3 offset:22528
v_add_f32 v7, v7, v14
v_exp_f32 v16, v154
v_mfma_f32_32x32x16_bf16 v[176:191], a[144:147], v[112:115], v[176:191]
ds_read_b128 a[188:191], v3 offset:23552
v_add_f32 v7, v7, v15
v_cvt_pk_bf16_f32 v204, v14, v15
v_exp_f32 v17, v155
v_mfma_f32_32x32x16_bf16 v[160:175], a[148:151], v[84:87], v[160:175]
v_add_f32 v7, v7, v16
v_exp_f32 v12, v156
v_add_f32 v7, v7, v17
v_mfma_f32_32x32x16_bf16 v[176:191], a[148:151], v[116:119], v[176:191]
v_cvt_pk_bf16_f32 v205, v16, v17
v_exp_f32 v13, v157
v_add_f32 v7, v7, v12
v_mfma_f32_32x32x16_bf16 v[160:175], a[152:155], v[88:91], v[160:175]
v_exp_f32 v14, v158
v_add_f32 v7, v7, v13
v_cvt_pk_bf16_f32 v206, v12, v13
v_mfma_f32_32x32x16_bf16 v[160:175], a[156:159], v[92:95], v[160:175]
v_exp_f32 v15, v159
v_add_f32 v7, v7, v14
v_add_f32 v7, v7, v15
v_cvt_pk_bf16_f32 v207, v14, v15
v_mfma_f32_32x32x16_bf16 v[176:191], a[152:155], v[120:123], v[176:191]
v_max_f32 v18, v6, v7
v_cmp_lt_f32 vcc, s70, v18
v_mfma_f32_32x32x16_bf16 v[176:191], a[156:159], v[124:127], v[176:191]
s_cbranch_vccnz L_rare_28
L_back_29:
v_add_f32 v4, v4, v6
v_add_f32 v5, v5, v7
s_waitcnt lgkmcnt(0)
v_mfma_f32_32x32x16_bf16 a[0:15], a[160:163], v[192:195], a[0:15]
ds_read_b128 a[128:131], v3 offset:8192
v_mfma_f32_32x32x16_bf16 a[64:79], a[160:163], v[200:203], a[64:79]
ds_read_b128 a[132:135], v3 offset:9216
s_add_u32 m0, m0, 16384
s_add_u32 s66, s66, 16384
v_exp_f32 v12, v160
v_mfma_f32_32x32x16_bf16 a[16:31], a[164:167], v[192:195], a[16:31]
v_exp_f32 v13, v161
v_exp_f32 v14, v162
v_add_f32 v6, v12, v13
v_mfma_f32_32x32x16_bf16 a[80:95], a[164:167], v[200:203], a[80:95]
ds_read_b128 a[136:139], v3 offset:10240
v_cvt_pk_bf16_f32 v208, v12, v13
v_exp_f32 v15, v163
v_add_f32 v6, v6, v14
v_mfma_f32_32x32x16_bf16 a[32:47], a[168:171], v[192:195], a[32:47]
ds_read_b128 a[140:143], v3 offset:11264
v_exp_f32 v16, v164
v_add_f32 v6, v6, v15
v_mfma_f32_32x32x16_bf16 a[96:111], a[168:171], v[200:203], a[96:111]
buffer_load_dwordx4 v2, s[8:11], s67 offen offset:0 lds
v_cvt_pk_bf16_f32 v209, v14, v15
v_exp_f32 v17, v165
v_add_f32 v6, v6, v16
v_mfma_f32_32x32x16_bf16 a[48:63], a[172:175], v[192:195], a[48:63]
ds_read_b128 a[144:147], v3 offset:12288
v_exp_f32 v12, v166
v_add_f32 v6, v6, v17
v_cvt_pk_bf16_f32 v210, v16, v17
v_mfma_f32_32x32x16_bf16 a[112:127], a[172:175], v[200:203], a[112:127]
ds_read_b128 a[148:151], v3 offset:13312
v_exp_f32 v13, v167
v_add_f32 v6, v6, v12
v_mfma_f32_32x32x16_bf16 a[0:15], a[176:179], v[196:199], a[0:15]
v_exp_f32 v14, v168
v_add_f32 v6, v6, v13
v_cvt_pk_bf16_f32 v211, v12, v13
v_exp_f32 v15, v169
v_mfma_f32_32x32x16_bf16 a[64:79], a[176:179], v[204:207], a[64:79]
ds_read_b128 a[152:155], v3 offset:14336
v_add_f32 v6, v6, v14
v_exp_f32 v16, v170
v_mfma_f32_32x32x16_bf16 a[16:31], a[180:183], v[196:199], a[16:31]
ds_read_b128 a[156:159], v3 offset:15360
buffer_load_dwordx4 v2, s[8:11], s67 offen offset:1024 lds
v_add_f32 v6, v6, v15
v_cvt_pk_bf16_f32 v212, v14, v15
v_mfma_f32_32x32x16_bf16 a[80:95], a[180:183], v[204:207], a[80:95]
v_exp_f32 v17, v171
v_add_f32 v6, v6, v16
v_exp_f32 v12, v172
v_mfma_f32_32x32x16_bf16 a[32:47], a[184:187], v[196:199], a[32:47]
v_add_f32 v6, v6, v17
v_cvt_pk_bf16_f32 v213, v16, v17
v_exp_f32 v13, v173
v_add_f32 v6, v6, v12
v_mfma_f32_32x32x16_bf16 a[96:111], a[184:187], v[204:207], a[96:111]
v_exp_f32 v14, v174
v_add_f32 v6, v6, v13
v_cvt_pk_bf16_f32 v214, v12, v13
v_mfma_f32_32x32x16_bf16 a[48:63], a[188:191], v[196:199], a[48:63]
buffer_load_dwordx4 v2, s[8:11], s67 offen offset:2048 lds
v_exp_f32 v15, v175
v_add_f32 v6, v6, v14
v_add_f32 v6, v6, v15
v_mfma_f32_32x32x16_bf16 a[112:127], a[188:191], v[204:207], a[112:127]
v_cvt_pk_bf16_f32 v215, v14, v15
v_exp_f32 v12, v176
v_exp_f32 v13, v177
s_waitcnt lgkmcnt(4)
v_mfma_f32_32x32x16_bf16 v[128:143], a[128:131], v[64:67], v[224:239]
ds_read_b128 a[192:195], v3 offset:24576
v_exp_f32 v14, v178
v_add_f32 v7, v12, v13
v_cvt_pk_bf16_f32 v216, v12, v13
v_mfma_f32_32x32x16_bf16 v[144:159], a[128:131], v[96:99], v[240:255]
ds_read_b128 a[196:199], v3 offset:25600
v_exp_f32 v15, v179
v_add_f32 v7, v7, v14
v_mfma_f32_32x32x16_bf16 v[128:143], a[132:135], v[68:71], v[128:143]
ds_read_b128 a[200:203], v3 offset:26624
v_exp_f32 v16, v180
v_add_f32 v7, v7, v15
v_cvt_pk_bf16_f32 v217, v14, v15
v_mfma_f32_32x32x16_bf16 v[144:159], a[132:135], v[100:103], v[144:159]
buffer_load_dwordx4 v2, s[8:11], s67 offen offset:3072 lds
v_exp_f32 v17, v181
v_add_f32 v7, v7, v16
v_mfma_f32_32x32x16_bf16 v[128:143], a[136:139], v[72:75], v[128:143]
ds_read_b128 a[204:207], v3 offset:27648
v_exp_f32 v12, v182
v_add_f32 v7, v7, v17
v_cvt_pk_bf16_f32 v218, v16, v17
v_mfma_f32_32x32x16_bf16 v[144:159], a[136:139], v[104:107], v[144:159]
ds_read_b128 a[208:211], v3 offset:28672
v_exp_f32 v13, v183
v_add_f32 v7, v7, v12
v_exp_f32 v14, v184
v_mfma_f32_32x32x16_bf16 v[128:143], a[140:143], v[76:79], v[128:143]
ds_read_b128 a[212:215], v3 offset:29696
v_add_f32 v7, v7, v13
v_cvt_pk_bf16_f32 v219, v12, v13
v_exp_f32 v15, v185
v_mfma_f32_32x32x16_bf16 v[144:159], a[140:143], v[108:111], v[144:159]
s_add_u32 s67, s67, 16384
s_and_b32 s69, s69, 0x1ffff
v_add_f32 v7, v7, v14
v_exp_f32 v16, v186
s_waitcnt lgkmcnt(6)
v_mfma_f32_32x32x16_bf16 v[128:143], a[144:147], v[80:83], v[128:143]
ds_read_b128 a[216:219], v3 offset:30720
v_add_f32 v7, v7, v15
v_cvt_pk_bf16_f32 v220, v14, v15
v_mfma_f32_32x32x16_bf16 v[144:159], a[144:147], v[112:115], v[144:159]
ds_read_b128 a[220:223], v3 offset:31744
v_exp_f32 v17, v187
v_add_f32 v7, v7, v16
v_exp_f32 v12, v188
v_mfma_f32_32x32x16_bf16 v[128:143], a[148:151], v[84:87], v[128:143]
v_add_f32 v7, v7, v17
v_cvt_pk_bf16_f32 v221, v16, v17
v_exp_f32 v13, v189
v_mfma_f32_32x32x16_bf16 v[144:159], a[148:151], v[116:119], v[144:159]
v_add_f32 v7, v7, v12
v_exp_f32 v14, v190
v_add_f32 v7, v7, v13
v_cvt_pk_bf16_f32 v222, v12, v13
v_mfma_f32_32x32x16_bf16 v[128:143], a[152:155], v[88:91], v[128:143]
v_exp_f32 v15, v191
v_add_f32 v7, v7, v14
v_add_f32 v7, v7, v15
v_mfma_f32_32x32x16_bf16 v[128:143], a[156:159], v[92:95], v[128:143]
s_waitcnt vmcnt(16) lgkmcnt(0)
s_barrier
s_add_u32 s63, s63, 0x8000
s_and_b32 s63, s63, 0x1ffff
v_add_u32 v3, s63, v31
v_cvt_pk_bf16_f32 v223, v14, v15
v_mfma_f32_32x32x16_bf16 v[144:159], a[152:155], v[120:123], v[144:159]
v_max_f32 v18, v6, v7
v_cmp_lt_f32 vcc, s70, v18
v_mfma_f32_32x32x16_bf16 v[144:159], a[156:159], v[124:127], v[144:159]
s_cbranch_vccnz L_rare_30
L_back_31:
v_add_f32 v4, v4, v6
v_add_f32 v5, v5, v7
s_add_u32 s68, s68, 64
s_sub_u32 s55, s55, 2
s_cmp_gt_i32 s55, 0
s_cbranch_scc1 L_loop_22
L_loopend_23:
s_sub_u32 s55, s53, 2
s_min_i32 s55, s55, 2
s_cmp_lt_i32 s55, 1
s_cbranch_scc1 L_loopend_33
.p2align 6
L_loop_32:
v_mfma_f32_32x32x16_bf16 a[0:15], a[192:195], v[208:211], a[0:15]
ds_read_b128 a[128:131], v3 offset:0
s_sub_u32 s22, s48, s68
s_sub_u32 s22, s22, 32
v_mfma_f32_32x32x16_bf16 a[64:79], a[192:195], v[216:219], a[64:79]
ds_read_b128 a[132:135], v3 offset:1024
s_add_u32 m0, s45, s69
s_add_u32 s69, s69, 0x8000
v_exp_f32 v12, v128
v_mfma_f32_32x32x16_bf16 a[16:31], a[196:199], v[208:211], a[16:31]
s_cmp_eq_u32 s22, 0
s_cselect_b32 s20, 1.0, 0
v_exp_f32 v13, v129
v_exp_f32 v14, v130
v_mfma_f32_32x32x16_bf16 a[80:95], a[196:199], v[216:219], a[80:95]
ds_read_b128 a[136:139], v3 offset:2048
s_cmp_lt_i32 s22, 0
s_cselect_b32 s21, 0xf149f2ca, 0
v_add_f32 v6, v12, v13
v_cvt_pk_bf16_f32 v192, v12, v13
v_mfma_f32_32x32x16_bf16 a[32:47], a[200:203], v[208:211], a[32:47]
ds_read_b128 a[140:143], v3 offset:3072
v_add_f32 v10, s21, v224
v_exp_f32 v15, v131
v_add_f32 v6, v6, v14
v_mfma_f32_32x32x16_bf16 a[96:111], a[200:203], v[216:219], a[96:111]
v_fma_f32 v160, v40, s20, v10
v_fma_f32 v161, v41, s20, v10
v_exp_f32 v16, v132
v_add_f32 v6, v6, v15
v_cvt_pk_bf16_f32 v193, v14, v15
v_mfma_f32_32x32x16_bf16 a[48:63], a[204:207], v[208:211], a[48:63]
ds_read_b128 a[144:147], v3 offset:4096
buffer_load_dwordx4 v2, s[4:7], s66 offen offset:0 lds
v_fma_f32 v162, v42, s20, v10
v_exp_f32 v17, v133
v_add_f32 v6, v6, v16
v_mfma_f32_32x32x16_bf16 a[112:127], a[204:207], v[216:219], a[112:127]
ds_read_b128 a[148:151], v3 offset:5120
v_fma_f32 v163, v43, s20, v10
v_fma_f32 v164, v44, s20, v10
v_exp_f32 v12, v134
v_mfma_f32_32x32x16_bf16 a[0:15], a[208:211], v[212:215], a[0:15]
v_fma_f32 v165, v45, s20, v10
v_add_f32 v6, v6, v17
v_cvt_pk_bf16_f32 v194, v16, v17
v_exp_f32 v13, v135
v_mfma_f32_32x32x16_bf16 a[64:79], a[208:211], v[220:223], a[64:79]
ds_read_b128 a[152:155], v3 offset:6144
v_fma_f32 v166, v46, s20, v10
v_fma_f32 v167, v47, s20, v10
v_add_f32 v6, v6, v12
v_exp_f32 v14, v136
v_mfma_f32_32x32x16_bf16 a[16:31], a[212:215], v[212:215], a[16:31]
ds_read_b128 a[156:159], v3 offset:7168
v_fma_f32 v168, v48, s20, v10
v_add_f32 v6, v6, v13
v_cvt_pk_bf16_f32 v195, v12, v13
v_exp_f32 v15, v137
v_mfma_f32_32x32x16_bf16 a[80:95], a[212:215], v[220:223], a[80:95]
buffer_load_dwordx4 v2, s[4:7], s66 offen offset:1024 lds
v_fma_f32 v169, v49, s20, v10
v_fma_f32 v170, v50, s20, v10
v_add_f32 v6, v6, v14
v_mfma_f32_32x32x16_bf16 a[32:47], a[216:219], v[212:215], a[32:47]
v_fma_f32 v171, v51, s20, v10
v_exp_f32 v16, v138
v_add_f32 v6, v6, v15
v_cvt_pk_bf16_f32 v196, v14, v15
v_mfma_f32_32x32x16_bf16 a[96:111], a[216:219], v[220:223], a[96:111]
v_fma_f32 v172, v52, s20, v10
v_fma_f32 v173, v53, s20, v10
v_exp_f32 v17, v139
v_add_f32 v6, v6, v16
v_exp_f32 v12, v140
v_mfma_f32_32x32x16_bf16 a[48:63], a[220:223], v[212:215], a[48:63]
v_fma_f32 v174, v54, s20, v10
v_fma_f32 v175, v55, s20, v10
v_add_f32 v6, v6, v17
v_cvt_pk_bf16_f32 v197, v16, v17
v_mfma_f32_32x32x16_bf16 a[112:127], a[220:223], v[220:223], a[112:127]
v_exp_f32 v13, v141
v_add_f32 v6, v6, v12
v_exp_f32 v14, v142
s_waitcnt lgkmcnt(4)
v_mfma_f32_32x32x16_bf16 v[160:175], a[128:131], v[64:67], v[160:175]
ds_read_b128 a[160:163], v3 offset:16384
v_add_f32 v6, v6, v13
v_cvt_pk_bf16_f32 v198, v12, v13
v_exp_f32 v15, v143
v_add_f32 v6, v6, v14
v_mfma_f32_32x32x16_bf16 v[176:191], a[128:131], v[96:99], v[240:255]
ds_read_b128 a[164:167], v3 offset:17408
buffer_load_dwordx4 v2, s[4:7], s66 offen offset:2048 lds
v_add_f32 v6, v6, v15
v_cvt_pk_bf16_f32 v199, v14, v15
v_mfma_f32_32x32x16_bf16 v[160:175], a[132:135], v[68:71], v[160:175]
ds_read_b128 a[168:171], v3 offset:18432
v_exp_f32 v12, v144
v_exp_f32 v13, v145
v_exp_f32 v14, v146
v_mfma_f32_32x32x16_bf16 v[176:191], a[132:135], v[100:103], v[176:191]
v_add_f32 v7, v12, v13
v_cvt_pk_bf16_f32 v200, v12, v13
v_exp_f32 v15, v147
v_mfma_f32_32x32x16_bf16 v[160:175], a[136:139], v[72:75], v[160:175]
ds_read_b128 a[172:175], v3 offset:19456
v_add_f32 v7, v7, v14
v_exp_f32 v16, v148
v_add_f32 v7, v7, v15
v_mfma_f32_32x32x16_bf16 v[176:191], a[136:139], v[104:107], v[176:191]
ds_read_b128 a[176:179], v3 offset:20480
v_cvt_pk_bf16_f32 v201, v14, v15
v_exp_f32 v17, v149
v_add_f32 v7, v7, v16
v_mfma_f32_32x32x16_bf16 v[160:175], a[140:143], v[76:79], v[160:175]
ds_read_b128 a[180:183], v3 offset:21504
buffer_load_dwordx4 v2, s[4:7], s66 offen offset:3072 lds
v_exp_f32 v12, v150
v_add_f32 v7, v7, v17
v_cvt_pk_bf16_f32 v202, v16, v17
v_mfma_f32_32x32x16_bf16 v[176:191], a[140:143], v[108:111], v[176:191]
v_exp_f32 v13, v151
v_add_f32 v7, v7, v12
v_exp_f32 v14, v152
s_waitcnt lgkmcnt(6)
v_mfma_f32_32x32x16_bf16 v[160:175], a[144:147], v[80:83], v[160:175]
ds_read_b128 a[184:187], v3 offset:22528
v_add_f32 v7, v7, v13
v_cvt_pk_bf16_f32 v203, v12, v13
v_exp_f32 v15, v153
v_mfma_f32_32x32x16_bf16 v[176:191], a[144:147], v[112:115], v[176:191]
ds_read_b128 a[188:191], v3 offset:23552
v_add_f32 v7, v7, v14
v_exp_f32 v16, v154
v_add_f32 v7, v7, v15
v_mfma_f32_32x32x16_bf16 v[160:175], a[148:151], v[84:87], v[160:175]
v_cvt_pk_bf16_f32 v204, v14, v15
v_exp_f32 v17, v155
v_add_f32 v7, v7, v16
v_exp_f32 v12, v156
v_mfma_f32_32x32x16_bf16 v[176:191], a[148:151], v[116:119], v[176:191]
v_add_f32 v7, v7, v17
v_cvt_pk_bf16_f32 v205, v16, v17
v_exp_f32 v13, v157
v_mfma_f32_32x32x16_bf16 v[160:175], a[152:155], v[88:91], v[160:175]
v_add_f32 v7, v7, v12
v_exp_f32 v14, v158
v_add_f32 v7, v7, v13
v_cvt_pk_bf16_f32 v206, v12, v13
v_mfma_f32_32x32x16_bf16 v[160:175], a[156:159], v[92:95], v[160:175]
v_exp_f32 v15, v159
v_add_f32 v7, v7, v14
v_add_f32 v7, v7, v15
v_cvt_pk_bf16_f32 v207, v14, v15
v_mfma_f32_32x32x16_bf16 v[176:191], a[152:155], v[120:123], v[176:191]
v_max_f32 v18, v6, v7
v_cmp_lt_f32 vcc, s70, v18
v_mfma_f32_32x32x16_bf16 v[176:191], a[156:159], v[124:127], v[176:191]
s_cbranch_vccnz L_rare_34
L_back_35:
v_add_f32 v4, v4, v6
v_add_f32 v5, v5, v7
s_waitcnt lgkmcnt(0)
v_mfma_f32_32x32x16_bf16 a[0:15], a[160:163], v[192:195], a[0:15]
ds_read_b128 a[128:131], v3 offset:8192
s_sub_u32 s22, s48, s68
s_sub_u32 s22, s22, 64
v_mfma_f32_32x32x16_bf16 a[64:79], a[160:163], v[200:203], a[64:79]
ds_read_b128 a[132:135], v3 offset:9216
s_add_u32 m0, m0, 16384
s_add_u32 s66, s66, 16384
v_exp_f32 v12, v160
v_mfma_f32_32x32x16_bf16 a[16:31], a[164:167], v[192:195], a[16:31]
s_cmp_eq_u32 s22, 0
s_cselect_b32 s20, 1.0, 0
v_exp_f32 v13, v161
v_exp_f32 v14, v162
v_mfma_f32_32x32x16_bf16 a[80:95], a[164:167], v[200:203], a[80:95]
ds_read_b128 a[136:139], v3 offset:10240
s_cmp_lt_i32 s22, 0
s_cselect_b32 s21, 0xf149f2ca, 0
v_add_f32 v6, v12, v13
v_cvt_pk_bf16_f32 v208, v12, v13
v_mfma_f32_32x32x16_bf16 a[32:47], a[168:171], v[192:195], a[32:47]
ds_read_b128 a[140:143], v3 offset:11264
v_add_f32 v10, s21, v224
v_exp_f32 v15, v163
v_add_f32 v6, v6, v14
v_exp_f32 v16, v164
v_mfma_f32_32x32x16_bf16 a[96:111], a[168:171], v[200:203], a[96:111]
buffer_load_dwordx4 v2, s[8:11], s67 offen offset:0 lds
v_fma_f32 v128, v40, s20, v10
v_fma_f32 v129, v41, s20, v10
v_add_f32 v6, v6, v15
v_cvt_pk_bf16_f32 v209, v14, v15
v_mfma_f32_32x32x16_bf16 a[48:63], a[172:175], v[192:195], a[48:63]
ds_read_b128 a[144:147], v3 offset:12288
v_fma_f32 v130, v42, s20, v10
v_exp_f32 v17, v165
v_add_f32 v6, v6, v16
v_mfma_f32_32x32x16_bf16 a[112:127], a[172:175], v[200:203], a[112:127]
ds_read_b128 a[148:151], v3 offset:13312
v_fma_f32 v131, v43, s20, v10
v_fma_f32 v132, v44, s20, v10
v_exp_f32 v12, v166
v_add_f32 v6, v6, v17
v_mfma_f32_32x32x16_bf16 a[0:15], a[176:179], v[196:199], a[0:15]
v_fma_f32 v133, v45, s20, v10
v_cvt_pk_bf16_f32 v210, v16, v17
v_exp_f32 v13, v167
v_add_f32 v6, v6, v12
v_mfma_f32_32x32x16_bf16 a[64:79], a[176:179], v[204:207], a[64:79]
ds_read_b128 a[152:155], v3 offset:14336
v_fma_f32 v134, v46, s20, v10
v_fma_f32 v135, v47, s20, v10
v_exp_f32 v14, v168
v_add_f32 v6, v6, v13
v_mfma_f32_32x32x16_bf16 a[16:31], a[180:183], v[196:199], a[16:31]
ds_read_b128 a[156:159], v3 offset:15360
buffer_load_dwordx4 v2, s[8:11], s67 offen offset:1024 lds
v_fma_f32 v136, v48, s20, v10
v_cvt_pk_bf16_f32 v211, v12, v13
v_exp_f32 v15, v169
v_mfma_f32_32x32x16_bf16 a[80:95], a[180:183], v[204:207], a[80:95]
v_fma_f32 v137, v49, s20, v10
v_fma_f32 v138, v50, s20, v10
v_add_f32 v6, v6, v14
v_exp_f32 v16, v170
v_mfma_f32_32x32x16_bf16 a[32:47], a[184:187], v[196:199], a[32:47]
v_fma_f32 v139, v51, s20, v10
v_fma_f32 v140, v52, s20, v10
v_add_f32 v6, v6, v15
v_cvt_pk_bf16_f32 v212, v14, v15
v_exp_f32 v17, v171
v_mfma_f32_32x32x16_bf16 a[96:111], a[184:187], v[204:207], a[96:111]
v_fma_f32 v141, v53, s20, v10
v_fma_f32 v142, v54, s20, v10
v_add_f32 v6, v6, v16
v_exp_f32 v12, v172
v_mfma_f32_32x32x16_bf16 a[48:63], a[188:191], v[196:199], a[48:63]
buffer_load_dwordx4 v2, s[8:11], s67 offen offset:2048 lds
v_fma_f32 v143, v55, s20, v10
v_add_f32 v6, v6, v17
v_cvt_pk_bf16_f32 v213, v16, v17
v_exp_f32 v13, v173
v_mfma_f32_32x32x16_bf16 a[112:127], a[188:191], v[204:207], a[112:127]
v_add_f32 v6, v6, v12
v_exp_f32 v14, v174
v_add_f32 v6, v6, v13
v_cvt_pk_bf16_f32 v214, v12, v13
s_waitcnt lgkmcnt(4)
v_mfma_f32_32x32x16_bf16 v[128:143], a[128:131], v[64:67], v[128:143]
ds_read_b128 a[192:195], v3 offset:24576
v_exp_f32 v15, v175
v_add_f32 v6, v6, v14
v_add_f32 v6, v6, v15
v_cvt_pk_bf16_f32 v215, v14, v15
v_mfma_f32_32x32x16_bf16 v[144:159], a[128:131], v[96:99], v[240:255]
ds_read_b128 a[196:199], v3 offset:25600
v_exp_f32 v12, v176
v_exp_f32 v13, v177
v_mfma_f32_32x32x16_bf16 v[128:143], a[132:135], v[68:71], v[128:143]
ds_read_b128 a[200:203], v3 offset:26624
v_exp_f32 v14, v178
v_add_f32 v7, v12, v13
v_cvt_pk_bf16_f32 v216, v12, v13
v_mfma_f32_32x32x16_bf16 v[144:159], a[132:135], v[100:103], v[144:159]
buffer_load_dwordx4 v2, s[8:11], s67 offen offset:3072 lds
v_exp_f32 v15, v179
v_add_f32 v7, v7, v14
v_exp_f32 v16, v180
v_mfma_f32_32x32x16_bf16 v[128:143], a[136:139], v[72:75], v[128:143]
ds_read_b128 a[204:207], v3 offset:27648
v_add_f32 v7, v7, v15
v_cvt_pk_bf16_f32 v217, v14, v15
v_exp_f32 v17, v181
v_mfma_f32_32x32x16_bf16 v[144:159], a[136:139], v[104:107], v[144:159]
ds_read_b128 a[208:211], v3 offset:28672
v_add_f32 v7, v7, v16
v_exp_f32 v12, v182
v_add_f32 v7, v7, v17
v_cvt_pk_bf16_f32 v218, v16, v17
v_mfma_f32_32x32x16_bf16 v[128:143], a[140:143], v[76:79], v[128:143]
ds_read_b128 a[212:215], v3 offset:29696
v_exp_f32 v13, v183
v_add_f32 v7, v7, v12
v_mfma_f32_32x32x16_bf16 v[144:159], a[140:143], v[108:111], v[144:159]
s_add_u32 s67, s67, 16384
s_and_b32 s69, s69, 0x1ffff
v_exp_f32 v14, v184
v_add_f32 v7, v7, v13
v_cvt_pk_bf16_f32 v219, v12, v13
s_waitcnt lgkmcnt(6)
v_mfma_f32_32x32x16_bf16 v[128:143], a[144:147], v[80:83], v[128:143]
ds_read_b128 a[216:219], v3 offset:30720
v_exp_f32 v15, v185
v_add_f32 v7, v7, v14
v_exp_f32 v16, v186
v_mfma_f32_32x32x16_bf16 v[144:159], a[144:147], v[112:115], v[144:159]
ds_read_b128 a[220:223], v3 offset:31744
v_add_f32 v7, v7, v15
v_cvt_pk_bf16_f32 v220, v14, v15
v_exp_f32 v17, v187
v_mfma_f32_32x32x16_bf16 v[128:143], a[148:151], v[84:87], v[128:143]
v_add_f32 v7, v7, v16
v_exp_f32 v12, v188
v_add_f32 v7, v7, v17
v_cvt_pk_bf16_f32 v221, v16, v17
v_mfma_f32_32x32x16_bf16 v[144:159], a[148:151], v[116:119], v[144:159]
v_exp_f32 v13, v189
v_add_f32 v7, v7, v12
v_exp_f32 v14, v190
v_add_f32 v7, v7, v13
v_mfma_f32_32x32x16_bf16 v[128:143], a[152:155], v[88:91], v[128:143]
v_cvt_pk_bf16_f32 v222, v12, v13
v_exp_f32 v15, v191
v_add_f32 v7, v7, v14
v_add_f32 v7, v7, v15
v_mfma_f32_32x32x16_bf16 v[128:143], a[156:159], v[92:95], v[128:143]
s_waitcnt vmcnt(16) lgkmcnt(0)
s_barrier
s_add_u32 s63, s63, 0x8000
s_and_b32 s63, s63, 0x1ffff
v_add_u32 v3, s63, v31
v_cvt_pk_bf16_f32 v223, v14, v15
v_mfma_f32_32x32x16_bf16 v[144:159], a[152:155], v[120:123], v[144:159]
v_max_f32 v18, v6, v7
v_cmp_lt_f32 vcc, s70, v18
v_mfma_f32_32x32x16_bf16 v[144:159], a[156:159], v[124:127], v[144:159]
s_cbranch_vccnz L_rare_36
L_back_37:
v_add_f32 v4, v4, v6
v_add_f32 v5, v5, v7
s_add_u32 s68, s68, 64
s_sub_u32 s55, s55, 1
s_cmp_gt_i32 s55, 0
s_cbranch_scc1 L_loop_32
L_loopend_33:
v_mfma_f32_32x32x16_bf16 a[0:15], a[192:195], v[208:211], a[0:15]
ds_read_b128 a[128:131], v3 offset:0
s_sub_u32 s22, s48, s68
s_sub_u32 s22, s22, 32
v_mfma_f32_32x32x16_bf16 a[64:79], a[192:195], v[216:219], a[64:79]
ds_read_b128 a[132:135], v3 offset:1024
s_add_u32 m0, s45, s69
s_add_u32 s69, s69, 0x8000
v_exp_f32 v12, v128
v_mfma_f32_32x32x16_bf16 a[16:31], a[196:199], v[208:211], a[16:31]
buffer_load_dwordx4 v2, s[4:7], s66 offen offset:0 lds
s_cmp_eq_u32 s22, 0
s_cselect_b32 s20, 1.0, 0
v_exp_f32 v13, v129
v_exp_f32 v14, v130
v_mfma_f32_32x32x16_bf16 a[80:95], a[196:199], v[216:219], a[80:95]
ds_read_b128 a[136:139], v3 offset:2048
s_cmp_lt_i32 s22, 0
s_cselect_b32 s21, 0xf149f2ca, 0
v_add_f32 v6, v12, v13
v_cvt_pk_bf16_f32 v192, v12, v13
v_mfma_f32_32x32x16_bf16 a[32:47], a[200:203], v[208:211], a[32:47]
ds_read_b128 a[140:143], v3 offset:3072
buffer_load_dwordx4 v2, s[4:7], s66 offen offset:1024 lds
v_add_f32 v10, s21, v224
v_exp_f32 v15, v131
v_add_f32 v6, v6, v14
v_mfma_f32_32x32x16_bf16 a[96:111], a[200:203], v[216:219], a[96:111]
v_fma_f32 v160, v40, s20, v10
v_fma_f32 v161, v41, s20, v10
v_exp_f32 v16, v132
v_add_f32 v6, v6, v15
v_cvt_pk_bf16_f32 v193, v14, v15
v_mfma_f32_32x32x16_bf16 a[48:63], a[204:207], v[208:211], a[48:63]
ds_read_b128 a[144:147], v3 offset:4096
buffer_load_dwordx4 v2, s[4:7], s66 offen offset:2048 lds
v_fma_f32 v162, v42, s20, v10
v_fma_f32 v163, v43, s20, v10
v_exp_f32 v17, v133
v_mfma_f32_32x32x16_bf16 a[112:127], a[204:207], v[216:219], a[112:127]
ds_read_b128 a[148:151], v3 offset:5120
v_fma_f32 v164, v44, s20, v10
v_add_f32 v6, v6, v16
v_exp_f32 v12, v134
v_mfma_f32_32x32x16_bf16 a[0:15], a[208:211], v[212:215], a[0:15]
buffer_load_dwordx4 v2, s[4:7], s66 offen offset:3072 lds
v_fma_f32 v165, v45, s20, v10
v_fma_f32 v166, v46, s20, v10
v_add_f32 v6, v6, v17
v_cvt_pk_bf16_f32 v194, v16, v17
v_exp_f32 v13, v135
v_mfma_f32_32x32x16_bf16 a[64:79], a[208:211], v[220:223], a[64:79]
ds_read_b128 a[152:155], v3 offset:6144
v_fma_f32 v167, v47, s20, v10
v_fma_f32 v168, v48, s20, v10
v_add_f32 v6, v6, v12
v_mfma_f32_32x32x16_bf16 a[16:31], a[212:215], v[212:215], a[16:31]
ds_read_b128 a[156:159], v3 offset:7168
s_mov_b32 s56, s78
s_mov_b32 s57, s79
s_mov_b32 s58, 0x400000
s_mov_b32 s59, 0x20000
s_lshr_b32 s60, s2, 3
s_lshl_b32 s60, s60, 2
s_add_u32 s60, s60, s38
s_lshl_b32 s60, s60, 13
s_and_b32 s61, s2, 6
s_lshl_b32 s61, s61, 19
s_add_u32 s60, s60, s61
s_add_u32 s61, s60, 4096
v_exp_f32 v14, v136
v_mfma_f32_32x32x16_bf16 a[80:95], a[212:215], v[220:223], a[80:95]
v_fma_f32 v169, v49, s20, v10
v_fma_f32 v170, v50, s20, v10
v_add_f32 v6, v6, v13
v_cvt_pk_bf16_f32 v195, v12, v13
v_mfma_f32_32x32x16_bf16 a[32:47], a[216:219], v[212:215], a[32:47]
buffer_load_dwordx4 v[56:59], v31, s[56:59], s60 offen offset:0
v_fma_f32 v171, v51, s20, v10
v_exp_f32 v15, v137
v_add_f32 v6, v6, v14
v_exp_f32 v16, v138
v_mfma_f32_32x32x16_bf16 a[96:111], a[216:219], v[220:223], a[96:111]
v_fma_f32 v172, v52, s20, v10
v_fma_f32 v173, v53, s20, v10
v_add_f32 v6, v6, v15
v_cvt_pk_bf16_f32 v196, v14, v15
v_exp_f32 v17, v139
v_mfma_f32_32x32x16_bf16 a[48:63], a[220:223], v[212:215], a[48:63]
buffer_load_dwordx4 v[56:59], v31, s[56:59], s60 offen offset:1024
v_fma_f32 v174, v54, s20, v10
v_fma_f32 v175, v55, s20, v10
v_add_f32 v6, v6, v16
v_mfma_f32_32x32x16_bf16 a[112:127], a[220:223], v[220:223], a[112:127]
v_exp_f32 v12, v140
v_add_f32 v6, v6, v17
v_cvt_pk_bf16_f32 v197, v16, v17
v_exp_f32 v13, v141
s_waitcnt lgkmcnt(4)
v_mfma_f32_32x32x16_bf16 v[160:175], a[128:131], v[64:67], v[160:175]
ds_read_b128 a[160:163], v3 offset:16384
buffer_load_dwordx4 v[56:59], v31, s[56:59], s60 offen offset:2048
v_add_f32 v6, v6, v12
v_exp_f32 v14, v142
v_add_f32 v6, v6, v13
v_mfma_f32_32x32x16_bf16 v[176:191], a[128:131], v[96:99], v[240:255]
ds_read_b128 a[164:167], v3 offset:17408
v_cvt_pk_bf16_f32 v198, v12, v13
v_exp_f32 v15, v143
v_add_f32 v6, v6, v14
v_add_f32 v6, v6, v15
v_mfma_f32_32x32x16_bf16 v[160:175], a[132:135], v[68:71], v[160:175]
ds_read_b128 a[168:171], v3 offset:18432
buffer_load_dwordx4 v[56:59], v31, s[56:59], s60 offen offset:3072
v_cvt_pk_bf16_f32 v199, v14, v15
v_exp_f32 v12, v144
v_mfma_f32_32x32x16_bf16 v[176:191], a[132:135], v[100:103], v[176:191]
v_exp_f32 v13, v145
v_exp_f32 v14, v146
v_add_f32 v7, v12, v13
v_cvt_pk_bf16_f32 v200, v12, v13
v_mfma_f32_32x32x16_bf16 v[160:175], a[136:139], v[72:75], v[160:175]
ds_read_b128 a[172:175], v3 offset:19456
buffer_load_dwordx4 v[56:59], v31, s[56:59], s61 offen offset:0
v_exp_f32 v15, v147
v_add_f32 v7, v7, v14
v_mfma_f32_32x32x16_bf16 v[176:191], a[136:139], v[104:107], v[176:191]
ds_read_b128 a[176:179], v3 offset:20480
v_exp_f32 v16, v148
v_add_f32 v7, v7, v15
v_cvt_pk_bf16_f32 v201, v14, v15
v_exp_f32 v17, v149
v_mfma_f32_32x32x16_bf16 v[160:175], a[140:143], v[76:79], v[160:175]
ds_read_b128 a[180:183], v3 offset:21504
buffer_load_dwordx4 v[56:59], v31, s[56:59], s61 offen offset:1024
v_add_f32 v7, v7, v16
v_exp_f32 v12, v150
v_mfma_f32_32x32x16_bf16 v[176:191], a[140:143], v[108:111], v[176:191]
v_add_f32 v7, v7, v17
v_cvt_pk_bf16_f32 v202, v16, v17
v_exp_f32 v13, v151
v_add_f32 v7, v7, v12
s_waitcnt lgkmcnt(6)
v_mfma_f32_32x32x16_bf16 v[160:175], a[144:147], v[80:83], v[160:175]
ds_read_b128 a[184:187], v3 offset:22528
buffer_load_dwordx4 v[56:59], v31, s[56:59], s61 offen offset:2048
v_exp_f32 v14, v152
v_add_f32 v7, v7, v13
v_cvt_pk_bf16_f32 v203, v12, v13
v_mfma_f32_32x32x16_bf16 v[176:191], a[144:147], v[112:115], v[176:191]
ds_read_b128 a[188:191], v3 offset:23552
v_exp_f32 v15, v153
v_add_f32 v7, v7, v14
v_exp_f32 v16, v154
v_mfma_f32_32x32x16_bf16 v[160:175], a[148:151], v[84:87], v[160:175]
buffer_load_dwordx4 v[56:59], v31, s[56:59], s61 offen offset:3072
v_add_f32 v7, v7, v15
v_cvt_pk_bf16_f32 v204, v14, v15
v_exp_f32 v17, v155
v_mfma_f32_32x32x16_bf16 v[176:191], a[148:151], v[116:119], v[176:191]
v_add_f32 v7, v7, v16
v_exp_f32 v12, v156
v_add_f32 v7, v7, v17
v_cvt_pk_bf16_f32 v205, v16, v17
v_mfma_f32_32x32x16_bf16 v[160:175], a[152:155], v[88:91], v[160:175]
v_exp_f32 v13, v157
v_add_f32 v7, v7, v12
v_exp_f32 v14, v158
v_add_f32 v7, v7, v13
v_mfma_f32_32x32x16_bf16 v[160:175], a[156:159], v[92:95], v[160:175]
v_cvt_pk_bf16_f32 v206, v12, v13
v_exp_f32 v15, v159
v_add_f32 v7, v7, v14
v_add_f32 v7, v7, v15
v_cvt_pk_bf16_f32 v207, v14, v15
v_mfma_f32_32x32x16_bf16 v[176:191], a[152:155], v[120:123], v[176:191]
v_max_f32 v18, v6, v7
v_cmp_lt_f32 vcc, s70, v18
v_mfma_f32_32x32x16_bf16 v[176:191], a[156:159], v[124:127], v[176:191]
s_cbranch_vccnz L_rare_38
L_back_39:
v_add_f32 v4, v4, v6
v_add_f32 v5, v5, v7
s_waitcnt lgkmcnt(0)
v_mfma_f32_32x32x16_bf16 a[0:15], a[160:163], v[192:195], a[0:15]
ds_read_b128 a[128:131], v3 offset:8192
s_sub_u32 s22, s49, s68
s_sub_u32 s22, s22, 64
v_mfma_f32_32x32x16_bf16 a[64:79], a[160:163], v[200:203], a[64:79]
ds_read_b128 a[132:135], v3 offset:9216
s_add_u32 m0, m0, 16384
s_add_u32 s66, s66, 16384
v_exp_f32 v12, v160
v_exp_f32 v13, v161
v_mfma_f32_32x32x16_bf16 a[16:31], a[164:167], v[192:195], a[16:31]
buffer_load_dwordx4 v2, s[8:11], s67 offen offset:0 lds
s_cmp_eq_u32 s22, 0
s_cselect_b32 s20, 1.0, 0
v_exp_f32 v14, v162
v_add_f32 v6, v12, v13
v_cvt_pk_bf16_f32 v208, v12, v13
v_exp_f32 v15, v163
v_mfma_f32_32x32x16_bf16 a[80:95], a[164:167], v[200:203], a[80:95]
ds_read_b128 a[136:139], v3 offset:10240
s_cmp_lt_i32 s22, 0
s_cselect_b32 s21, 0xf149f2ca, 0
v_add_f32 v6, v6, v14
v_exp_f32 v16, v164
v_add_f32 v6, v6, v15
v_cvt_pk_bf16_f32 v209, v14, v15
v_mfma_f32_32x32x16_bf16 a[32:47], a[168:171], v[192:195], a[32:47]
ds_read_b128 a[140:143], v3 offset:11264
buffer_load_dwordx4 v2, s[8:11], s67 offen offset:1024 lds
v_add_f32 v10, s21, v240
v_fma_f32 v144, v40, s20, v10
v_exp_f32 v17, v165
v_add_f32 v6, v6, v16
v_mfma_f32_32x32x16_bf16 a[96:111], a[168:171], v[200:203], a[96:111]
v_fma_f32 v145, v41, s20, v10
v_fma_f32 v146, v42, s20, v10
v_exp_f32 v12, v166
v_add_f32 v6, v6, v17
v_cvt_pk_bf16_f32 v210, v16, v17
v_exp_f32 v13, v167
v_mfma_f32_32x32x16_bf16 a[48:63], a[172:175], v[192:195], a[48:63]
ds_read_b128 a[144:147], v3 offset:12288
buffer_load_dwordx4 v2, s[8:11], s67 offen offset:2048 lds
v_fma_f32 v147, v43, s20, v10
v_add_f32 v6, v6, v12
v_exp_f32 v14, v168
v_add_f32 v6, v6, v13
v_cvt_pk_bf16_f32 v211, v12, v13
v_mfma_f32_32x32x16_bf16 a[112:127], a[172:175], v[200:203], a[112:127]
ds_read_b128 a[148:151], v3 offset:13312
v_fma_f32 v148, v44, s20, v10
v_fma_f32 v149, v45, s20, v10
v_exp_f32 v15, v169
v_add_f32 v6, v6, v14
v_exp_f32 v16, v170
v_mfma_f32_32x32x16_bf16 a[0:15], a[176:179], v[196:199], a[0:15]
buffer_load_dwordx4 v2, s[8:11], s67 offen offset:3072 lds
v_fma_f32 v150, v46, s20, v10
v_add_f32 v6, v6, v15
v_cvt_pk_bf16_f32 v212, v14, v15
v_exp_f32 v17, v171
v_add_f32 v6, v6, v16
v_exp_f32 v12, v172
v_mfma_f32_32x32x16_bf16 a[64:79], a[176:179], v[204:207], a[64:79]
ds_read_b128 a[152:155], v3 offset:14336
v_fma_f32 v151, v47, s20, v10
v_fma_f32 v152, v48, s20, v10
v_add_f32 v6, v6, v17
v_cvt_pk_bf16_f32 v213, v16, v17
v_exp_f32 v13, v173
v_mfma_f32_32x32x16_bf16 a[16:31], a[180:183], v[196:199], a[16:31]
ds_read_b128 a[156:159], v3 offset:15360
s_add_u32 s67, s67, 16384
s_and_b32 s69, s69, 0x1ffff
v_fma_f32 v153, v49, s20, v10
v_add_f32 v6, v6, v12
v_exp_f32 v14, v174
v_mfma_f32_32x32x16_bf16 a[80:95], a[180:183], v[204:207], a[80:95]
v_fma_f32 v154, v50, s20, v10
v_fma_f32 v155, v51, s20, v10
v_add_f32 v6, v6, v13
v_cvt_pk_bf16_f32 v214, v12, v13
v_exp_f32 v15, v175
v_add_f32 v6, v6, v14
v_add_f32 v6, v6, v15
v_cvt_pk_bf16_f32 v215, v14, v15
v_mfma_f32_32x32x16_bf16 a[32:47], a[184:187], v[196:199], a[32:47]
s_mov_b32 s56, s12
s_mov_b32 s57, s13
s_mov_b32 s58, 1409024
s_lshr_b32 s60, s2, 3
s_mul_i32 s60, s60, 11
s_mul_i32 s61, s38, 3
s_add_u32 s60, s60, s61
s_and_b32 s61, s2, 6
s_mul_i32 s61, s61, 176
s_add_u32 s60, s60, s61
s_lshl_b32 s60, s60, 10
v_mfma_f32_32x32x16_bf16 a[96:111], a[184:187], v[204:207], a[96:111]
v_fma_f32 v156, v52, s20, v10
v_fma_f32 v157, v53, s20, v10
v_exp_f32 v12, v176
v_exp_f32 v13, v177
v_exp_f32 v14, v178
v_add_f32 v7, v12, v13
v_mfma_f32_32x32x16_bf16 a[48:63], a[188:191], v[196:199], a[48:63]
buffer_load_dwordx4 v[56:59], v31, s[56:59], s60 offen offset:0
v_fma_f32 v158, v54, s20, v10
v_fma_f32 v159, v55, s20, v10
v_cvt_pk_bf16_f32 v216, v12, v13
v_exp_f32 v15, v179
v_add_f32 v7, v7, v14
v_mfma_f32_32x32x16_bf16 a[112:127], a[188:191], v[204:207], a[112:127]
v_exp_f32 v16, v180
v_add_f32 v7, v7, v15
v_cvt_pk_bf16_f32 v217, v14, v15
v_exp_f32 v17, v181
v_add_f32 v7, v7, v16
v_exp_f32 v12, v182
v_add_f32 v7, v7, v17
s_waitcnt lgkmcnt(4)
v_mfma_f32_32x32x16_bf16 v[144:159], a[128:131], v[96:99], v[144:159]
ds_read_b128 a[192:195], v3 offset:24576
ds_read_b128 a[196:199], v3 offset:25600
buffer_load_dwordx4 v[56:59], v31, s[56:59], s60 offen offset:1024
v_cvt_pk_bf16_f32 v218, v16, v17
v_exp_f32 v13, v183
v_add_f32 v7, v7, v12
v_mfma_f32_32x32x16_bf16 v[144:159], a[132:135], v[100:103], v[144:159]
ds_read_b128 a[200:203], v3 offset:26624
ds_read_b128 a[204:207], v3 offset:27648
v_exp_f32 v14, v184
v_add_f32 v7, v7, v13
v_cvt_pk_bf16_f32 v219, v12, v13
v_exp_f32 v15, v185
v_add_f32 v7, v7, v14
v_mfma_f32_32x32x16_bf16 v[144:159], a[136:139], v[104:107], v[144:159]
ds_read_b128 a[208:211], v3 offset:28672
ds_read_b128 a[212:215], v3 offset:29696
buffer_load_dwordx4 v[56:59], v31, s[56:59], s60 offen offset:2048
v_exp_f32 v16, v186
v_add_f32 v7, v7, v15
v_cvt_pk_bf16_f32 v220, v14, v15
v_exp_f32 v17, v187
v_mfma_f32_32x32x16_bf16 v[144:159], a[140:143], v[108:111], v[144:159]
ds_read_b128 a[216:219], v3 offset:30720
ds_read_b128 a[220:223], v3 offset:31744
v_add_f32 v7, v7, v16
v_exp_f32 v12, v188
v_add_f32 v7, v7, v17
v_cvt_pk_bf16_f32 v221, v16, v17
s_waitcnt lgkmcnt(8)
v_mfma_f32_32x32x16_bf16 v[144:159], a[144:147], v[112:115], v[144:159]
v_exp_f32 v13, v189
v_add_f32 v7, v7, v12
v_exp_f32 v14, v190
v_add_f32 v7, v7, v13
v_cvt_pk_bf16_f32 v222, v12, v13
v_exp_f32 v15, v191
v_add_f32 v7, v7, v14
v_mfma_f32_32x32x16_bf16 v[144:159], a[148:151], v[116:119], v[144:159]
s_waitcnt vmcnt(16) lgkmcnt(0)
s_barrier
s_add_u32 s63, s63, 0x8000
s_and_b32 s63, s63, 0x1ffff
v_add_u32 v3, s63, v31
v_add_f32 v7, v7, v15
v_cvt_pk_bf16_f32 v223, v14, v15
v_mfma_f32_32x32x16_bf16 v[144:159], a[152:155], v[120:123], v[144:159]
v_max_f32 v18, v6, v7
v_cmp_lt_f32 vcc, s70, v18
v_mfma_f32_32x32x16_bf16 v[144:159], a[156:159], v[124:127], v[144:159]
s_cbranch_vccnz L_rare_40
L_back_41:
v_add_f32 v4, v4, v6
v_add_f32 v5, v5, v7
s_add_u32 s68, s68, 64
v_mfma_f32_32x32x16_bf16 a[0:15], a[192:195], v[208:211], a[0:15]
ds_read_b128 a[128:131], v3 offset:0
s_sub_u32 s22, s49, s68
s_sub_u32 s22, s22, 32
v_mfma_f32_32x32x16_bf16 a[64:79], a[192:195], v[216:219], a[64:79]
ds_read_b128 a[132:135], v3 offset:1024
s_add_u32 m0, s45, s69
s_add_u32 s69, s69, 0x8000
v_mfma_f32_32x32x16_bf16 a[16:31], a[196:199], v[208:211], a[16:31]
s_cmp_eq_u32 s22, 0
s_cselect_b32 s20, 1.0, 0
v_mfma_f32_32x32x16_bf16 a[80:95], a[196:199], v[216:219], a[80:95]
ds_read_b128 a[136:139], v3 offset:2048
s_cmp_lt_i32 s22, 0
s_cselect_b32 s21, 0xf149f2ca, 0
v_mfma_f32_32x32x16_bf16 a[32:47], a[200:203], v[208:211], a[32:47]
ds_read_b128 a[140:143], v3 offset:3072
buffer_load_dwordx4 v2, s[4:7], s66 offen offset:0 lds
v_add_f32 v10, s21, v240
v_exp_f32 v12, v144
v_mfma_f32_32x32x16_bf16 a[96:111], a[200:203], v[216:219], a[96:111]
v_fma_f32 v176, v40, s20, v10
v_fma_f32 v177, v41, s20, v10
v_exp_f32 v13, v145
v_exp_f32 v14, v146
v_mfma_f32_32x32x16_bf16 a[48:63], a[204:207], v[208:211], a[48:63]
ds_read_b128 a[144:147], v3 offset:4096
v_fma_f32 v178, v42, s20, v10
v_add_f32 v7, v12, v13
v_cvt_pk_bf16_f32 v200, v12, v13
v_mfma_f32_32x32x16_bf16 a[112:127], a[204:207], v[216:219], a[112:127]
ds_read_b128 a[148:151], v3 offset:5120
v_fma_f32 v179, v43, s20, v10
v_fma_f32 v180, v44, s20, v10
v_exp_f32 v15, v147
v_mfma_f32_32x32x16_bf16 a[0:15], a[208:211], v[212:215], a[0:15]
buffer_load_dwordx4 v2, s[4:7], s66 offen offset:1024 lds
v_fma_f32 v181, v45, s20, v10
v_add_f32 v7, v7, v14
v_exp_f32 v16, v148
v_mfma_f32_32x32x16_bf16 a[64:79], a[208:211], v[220:223], a[64:79]
ds_read_b128 a[152:155], v3 offset:6144
v_fma_f32 v182, v46, s20, v10
v_fma_f32 v183, v47, s20, v10
v_add_f32 v7, v7, v15
v_cvt_pk_bf16_f32 v201, v14, v15
v_mfma_f32_32x32x16_bf16 a[16:31], a[212:215], v[212:215], a[16:31]
ds_read_b128 a[156:159], v3 offset:7168
v_fma_f32 v184, v48, s20, v10
v_exp_f32 v17, v149
v_add_f32 v7, v7, v16
v_mfma_f32_32x32x16_bf16 a[80:95], a[212:215], v[220:223], a[80:95]
v_fma_f32 v185, v49, s20, v10
v_fma_f32 v186, v50, s20, v10
v_exp_f32 v12, v150
v_add_f32 v7, v7, v17
v_cvt_pk_bf16_f32 v202, v16, v17
v_mfma_f32_32x32x16_bf16 a[32:47], a[216:219], v[212:215], a[32:47]
buffer_load_dwordx4 v2, s[4:7], s66 offen offset:2048 lds
v_fma_f32 v187, v51, s20, v10
v_exp_f32 v13, v151
v_add_f32 v7, v7, v12
v_mfma_f32_32x32x16_bf16 a[96:111], a[216:219], v[220:223], a[96:111]
v_fma_f32 v188, v52, s20, v10
v_fma_f32 v189, v53, s20, v10
v_exp_f32 v14, v152
v_add_f32 v7, v7, v13
v_mfma_f32_32x32x16_bf16 a[48:63], a[220:223], v[212:215], a[48:63]
v_fma_f32 v190, v54, s20, v10
v_fma_f32 v191, v55, s20, v10
v_cvt_pk_bf16_f32 v203, v12, v13
v_exp_f32 v15, v153
v_mfma_f32_32x32x16_bf16 a[112:127], a[220:223], v[220:223], a[112:127]
v_add_f32 v7, v7, v14
v_exp_f32 v16, v154
v_add_f32 v7, v7, v15
s_waitcnt lgkmcnt(4)
v_mfma_f32_32x32x16_bf16 v[176:191], a[128:131], v[96:99], v[176:191]
ds_read_b128 a[160:163], v3 offset:16384
ds_read_b128 a[164:167], v3 offset:17408
buffer_load_dwordx4 v2, s[4:7], s66 offen offset:3072 lds
v_cvt_pk_bf16_f32 v204, v14, v15
v_exp_f32 v17, v155
v_mfma_f32_32x32x16_bf16 v[176:191], a[132:135], v[100:103], v[176:191]
ds_read_b128 a[168:171], v3 offset:18432
ds_read_b128 a[172:175], v3 offset:19456
v_add_f32 v7, v7, v16
v_exp_f32 v12, v156
v_mfma_f32_32x32x16_bf16 v[176:191], a[136:139], v[104:107], v[176:191]
ds_read_b128 a[176:179], v3 offset:20480
ds_read_b128 a[180:183], v3 offset:21504
v_add_f32 v7, v7, v17
v_cvt_pk_bf16_f32 v205, v16, v17
v_mfma_f32_32x32x16_bf16 v[176:191], a[140:143], v[108:111], v[176:191]
ds_read_b128 a[184:187], v3 offset:22528
ds_read_b128 a[188:191], v3 offset:23552
v_exp_f32 v13, v157
v_add_f32 v7, v7, v12
s_waitcnt lgkmcnt(8)
v_mfma_f32_32x32x16_bf16 v[176:191], a[144:147], v[112:115], v[176:191]
v_exp_f32 v14, v158
v_add_f32 v7, v7, v13
v_cvt_pk_bf16_f32 v206, v12, v13
v_mfma_f32_32x32x16_bf16 v[176:191], a[148:151], v[116:119], v[176:191]
v_exp_f32 v15, v159
v_add_f32 v7, v7, v14
v_add_f32 v7, v7, v15
v_cvt_pk_bf16_f32 v207, v14, v15
v_mfma_f32_32x32x16_bf16 v[176:191], a[152:155], v[120:123], v[176:191]
v_cmp_lt_f32 vcc, s70, v7
v_mfma_f32_32x32x16_bf16 v[176:191], a[156:159], v[124:127], v[176:191]
s_cbranch_vccnz L_rare_42
L_back_43:
v_add_f32 v5, v5, v7
s_waitcnt lgkmcnt(0)
v_mfma_f32_32x32x16_bf16 a[64:79], a[160:163], v[200:203], a[64:79]
ds_read_b128 a[128:131], v3 offset:8192
ds_read_b128 a[132:135], v3 offset:9216
s_sub_u32 s22, s49, s68
s_sub_u32 s22, s22, 64
s_cmp_eq_u32 s22, 0
s_cselect_b32 s20, 1.0, 0
v_mfma_f32_32x32x16_bf16 a[80:95], a[164:167], v[200:203], a[80:95]
ds_read_b128 a[136:139], v3 offset:10240
ds_read_b128 a[140:143], v3 offset:11264
s_cmp_lt_i32 s22, 0
s_cselect_b32 s21, 0xf149f2ca, 0
v_add_f32 v10, s21, v240
v_mfma_f32_32x32x16_bf16 a[96:111], a[168:171], v[200:203], a[96:111]
ds_read_b128 a[144:147], v3 offset:12288
ds_read_b128 a[148:151], v3 offset:13312
v_fma_f32 v144, v40, s20, v10
v_fma_f32 v145, v41, s20, v10
v_fma_f32 v146, v42, s20, v10
v_mfma_f32_32x32x16_bf16 a[112:127], a[172:175], v[200:203], a[112:127]
ds_read_b128 a[152:155], v3 offset:14336
ds_read_b128 a[156:159], v3 offset:15360
v_fma_f32 v147, v43, s20, v10
v_fma_f32 v148, v44, s20, v10
v_fma_f32 v149, v45, s20, v10
v_fma_f32 v150, v46, s20, v10
v_mfma_f32_32x32x16_bf16 a[64:79], a[176:179], v[204:207], a[64:79]
ds_read_b128 a[192:195], v3 offset:24576
s_add_u32 m0, m0, 16384
s_add_u32 s66, s66, 16384
v_fma_f32 v151, v47, s20, v10
v_fma_f32 v152, v48, s20, v10
v_exp_f32 v12, v176
v_mfma_f32_32x32x16_bf16 a[80:95], a[180:183], v[204:207], a[80:95]
ds_read_b128 a[196:199], v3 offset:25600
buffer_load_dwordx4 v2, s[8:11], s67 offen offset:0 lds
v_fma_f32 v153, v49, s20, v10
v_fma_f32 v154, v50, s20, v10
v_fma_f32 v155, v51, s20, v10
v_fma_f32 v156, v52, s20, v10
v_mfma_f32_32x32x16_bf16 a[96:111], a[184:187], v[204:207], a[96:111]
ds_read_b128 a[200:203], v3 offset:26624
buffer_load_dwordx4 v2, s[8:11], s67 offen offset:1024 lds
v_fma_f32 v157, v53, s20, v10
v_fma_f32 v158, v54, s20, v10
v_fma_f32 v159, v55, s20, v10
v_exp_f32 v13, v177
v_mfma_f32_32x32x16_bf16 a[112:127], a[188:191], v[204:207], a[112:127]
ds_read_b128 a[204:207], v3 offset:27648
v_exp_f32 v14, v178
v_add_f32 v7, v12, v13
v_cvt_pk_bf16_f32 v216, v12, v13
v_exp_f32 v15, v179
v_add_f32 v7, v7, v14
v_exp_f32 v16, v180
s_waitcnt lgkmcnt(8)
v_mfma_f32_32x32x16_bf16 v[144:159], a[128:131], v[96:99], v[144:159]
ds_read_b128 a[208:211], v3 offset:28672
buffer_load_dwordx4 v2, s[8:11], s67 offen offset:2048 lds
v_add_f32 v7, v7, v15
v_cvt_pk_bf16_f32 v217, v14, v15
v_exp_f32 v17, v181
v_add_f32 v7, v7, v16
v_exp_f32 v12, v182
v_mfma_f32_32x32x16_bf16 v[144:159], a[132:135], v[100:103], v[144:159]
ds_read_b128 a[212:215], v3 offset:29696
buffer_load_dwordx4 v2, s[8:11], s67 offen offset:3072 lds
v_add_f32 v7, v7, v17
v_cvt_pk_bf16_f32 v218, v16, v17
v_exp_f32 v13, v183
v_add_f32 v7, v7, v12
v_exp_f32 v14, v184
v_add_f32 v7, v7, v13
v_mfma_f32_32x32x16_bf16 v[144:159], a[136:139], v[104:107], v[144:159]
ds_read_b128 a[216:219], v3 offset:30720
s_add_u32 s67, s67, 16384
s_and_b32 s69, s69, 0x1ffff
v_cvt_pk_bf16_f32 v219, v12, v13
v_exp_f32 v15, v185
v_add_f32 v7, v7, v14
v_exp_f32 v16, v186
v_mfma_f32_32x32x16_bf16 v[144:159], a[140:143], v[108:111], v[144:159]
ds_read_b128 a[220:223], v3 offset:31744
v_add_f32 v7, v7, v15
v_cvt_pk_bf16_f32 v220, v14, v15
v_exp_f32 v17, v187
v_add_f32 v7, v7, v16
v_exp_f32 v12, v188
v_add_f32 v7, v7, v17
s_waitcnt lgkmcnt(8)
v_mfma_f32_32x32x16_bf16 v[144:159], a[144:147], v[112:115], v[144:159]
v_cvt_pk_bf16_f32 v221, v16, v17
v_exp_f32 v13, v189
v_add_f32 v7, v7, v12
v_exp_f32 v14, v190
v_add_f32 v7, v7, v13
v_cvt_pk_bf16_f32 v222, v12, v13
v_exp_f32 v15, v191
v_add_f32 v7, v7, v14
v_mfma_f32_32x32x16_bf16 v[144:159], a[148:151], v[116:119], v[144:159]
s_waitcnt vmcnt(16) lgkmcnt(0)
s_barrier
s_add_u32 s63, s63, 0x8000
s_and_b32 s63, s63, 0x1ffff
v_add_u32 v3, s63, v31
v_add_f32 v7, v7, v15
v_cvt_pk_bf16_f32 v223, v14, v15
v_mfma_f32_32x32x16_bf16 v[144:159], a[152:155], v[120:123], v[144:159]
v_cmp_lt_f32 vcc, s70, v7
v_mfma_f32_32x32x16_bf16 v[144:159], a[156:159], v[124:127], v[144:159]
s_cbranch_vccnz L_rare_44
L_back_45:
v_add_f32 v5, v5, v7
s_add_u32 s68, s68, 64
s_and_b32 s40, s2, 1
s_lshl_b32 s40, s40, 3
s_lshr_b32 s41, s2, 5
s_add_u32 s40, s40, s41
s_sub_u32 s41, 15, s40
s_min_u32 s40, s40, s41
v_lshlrev_b32 v208, 3, v1
v_add_u32 v208, s40, v208
v_lshlrev_b32 v208, 7, v208
v_add_u32 v208, 0x3920000, v208
s_cmp_lg_u32 s38, 0
s_cbranch_scc1 L_w0_46
s_mov_b64 s[64:65], exec
s_mov_b32 exec_hi, 0
buffer_load_dword v209, v208, s[16:19], 0 offen sc1
s_mov_b64 exec, s[64:65]
L_w0_46:
s_nop 15
v_mov_b32 v18, v4
s_nop 1
v_permlane32_swap_b32 v18, v4
s_nop 1
v_add_f32 v18, v18, v4
v_rcp_f32 v18, v18
s_lshr_b32 s41, s48, 5
s_mul_i32 s41, s41, 350208
v_mul_f32 v18, v18, v34
s_lshl_b32 s42, s36, 13
s_add_u32 s41, s41, s42
s_add_u32 s41, s41, 0x2000000
s_add_u32 s42, s41, 4096
v_lshlrev_b32 v19, 4, v1
v_accvgpr_read_b32 v128, a0
v_accvgpr_read_b32 v129, a1
v_accvgpr_read_b32 v130, a2
v_accvgpr_read_b32 v131, a3
v_accvgpr_read_b32 v132, a4
v_accvgpr_read_b32 v133, a5
v_accvgpr_read_b32 v134, a6
v_accvgpr_read_b32 v135, a7
v_pk_mul_f32 v[128:129], v[128:129], v[18:19] op_sel:[0,0] op_sel_hi:[1,0]
v_pk_mul_f32 v[130:131], v[130:131], v[18:19] op_sel:[0,0] op_sel_hi:[1,0]
v_pk_mul_f32 v[132:133], v[132:133], v[18:19] op_sel:[0,0] op_sel_hi:[1,0]
v_pk_mul_f32 v[134:135], v[134:135], v[18:19] op_sel:[0,0] op_sel_hi:[1,0]
v_cvt_pk_bf16_f32 v160, v128, v129
v_cvt_pk_bf16_f32 v161, v130, v131
v_cvt_pk_bf16_f32 v162, v132, v133
v_cvt_pk_bf16_f32 v163, v134, v135
buffer_store_dwordx4 v[160:163], v19, s[16:19], s41 offen offset:0 sc1
v_accvgpr_read_b32 v136, a8
v_accvgpr_read_b32 v137, a9
v_accvgpr_read_b32 v138, a10
v_accvgpr_read_b32 v139, a11
v_accvgpr_read_b32 v140, a12
v_accvgpr_read_b32 v141, a13
v_accvgpr_read_b32 v142, a14
v_accvgpr_read_b32 v143, a15
v_pk_mul_f32 v[136:137], v[136:137], v[18:19] op_sel:[0,0] op_sel_hi:[1,0]
v_pk_mul_f32 v[138:139], v[138:139], v[18:19] op_sel:[0,0] op_sel_hi:[1,0]
v_pk_mul_f32 v[140:141], v[140:141], v[18:19] op_sel:[0,0] op_sel_hi:[1,0]
v_pk_mul_f32 v[142:143], v[142:143], v[18:19] op_sel:[0,0] op_sel_hi:[1,0]
v_cvt_pk_bf16_f32 v164, v136, v137
v_cvt_pk_bf16_f32 v165, v138, v139
v_cvt_pk_bf16_f32 v166, v140, v141
v_cvt_pk_bf16_f32 v167, v142, v143
buffer_store_dwordx4 v[164:167], v19, s[16:19], s41 offen offset:1024 sc1
v_accvgpr_read_b32 v128, a16
v_accvgpr_read_b32 v129, a17
v_accvgpr_read_b32 v130, a18
v_accvgpr_read_b32 v131, a19
v_accvgpr_read_b32 v132, a20
v_accvgpr_read_b32 v133, a21
v_accvgpr_read_b32 v134, a22
v_accvgpr_read_b32 v135, a23
v_pk_mul_f32 v[128:129], v[128:129], v[18:19] op_sel:[0,0] op_sel_hi:[1,0]
v_pk_mul_f32 v[130:131], v[130:131], v[18:19] op_sel:[0,0] op_sel_hi:[1,0]
v_pk_mul_f32 v[132:133], v[132:133], v[18:19] op_sel:[0,0] op_sel_hi:[1,0]
v_pk_mul_f32 v[134:135], v[134:135], v[18:19] op_sel:[0,0] op_sel_hi:[1,0]
v_cvt_pk_bf16_f32 v168, v128, v129
v_cvt_pk_bf16_f32 v169, v130, v131
v_cvt_pk_bf16_f32 v170, v132, v133
v_cvt_pk_bf16_f32 v171, v134, v135
buffer_store_dwordx4 v[168:171], v19, s[16:19], s41 offen offset:2048 sc1
v_accvgpr_read_b32 v136, a24
v_accvgpr_read_b32 v137, a25
v_accvgpr_read_b32 v138, a26
v_accvgpr_read_b32 v139, a27
v_accvgpr_read_b32 v140, a28
v_accvgpr_read_b32 v141, a29
v_accvgpr_read_b32 v142, a30
v_accvgpr_read_b32 v143, a31
v_pk_mul_f32 v[136:137], v[136:137], v[18:19] op_sel:[0,0] op_sel_hi:[1,0]
v_pk_mul_f32 v[138:139], v[138:139], v[18:19] op_sel:[0,0] op_sel_hi:[1,0]
v_pk_mul_f32 v[140:141], v[140:141], v[18:19] op_sel:[0,0] op_sel_hi:[1,0]
v_pk_mul_f32 v[142:143], v[142:143], v[18:19] op_sel:[0,0] op_sel_hi:[1,0]
v_cvt_pk_bf16_f32 v172, v136, v137
v_cvt_pk_bf16_f32 v173, v138, v139
v_cvt_pk_bf16_f32 v174, v140, v141
v_cvt_pk_bf16_f32 v175, v142, v143
buffer_store_dwordx4 v[172:175], v19, s[16:19], s41 offen offset:3072 sc1
v_accvgpr_read_b32 v128, a32
v_accvgpr_read_b32 v129, a33
v_accvgpr_read_b32 v130, a34
v_accvgpr_read_b32 v131, a35
v_accvgpr_read_b32 v132, a36
v_accvgpr_read_b32 v133, a37
v_accvgpr_read_b32 v134, a38
v_accvgpr_read_b32 v135, a39
v_pk_mul_f32 v[128:129], v[128:129], v[18:19] op_sel:[0,0] op_sel_hi:[1,0]
v_pk_mul_f32 v[130:131], v[130:131], v[18:19] op_sel:[0,0] op_sel_hi:[1,0]
v_pk_mul_f32 v[132:133], v[132:133], v[18:19] op_sel:[0,0] op_sel_hi:[1,0]
v_pk_mul_f32 v[134:135], v[134:135], v[18:19] op_sel:[0,0] op_sel_hi:[1,0]
v_cvt_pk_bf16_f32 v160, v128, v129
v_cvt_pk_bf16_f32 v161, v130, v131
v_cvt_pk_bf16_f32 v162, v132, v133
v_cvt_pk_bf16_f32 v163, v134, v135
buffer_store_dwordx4 v[160:163], v19, s[16:19], s42 offen offset:0 sc1
v_accvgpr_read_b32 v136, a40
v_accvgpr_read_b32 v137, a41
v_accvgpr_read_b32 v138, a42
v_accvgpr_read_b32 v139, a43
v_accvgpr_read_b32 v140, a44
v_accvgpr_read_b32 v141, a45
v_accvgpr_read_b32 v142, a46
v_accvgpr_read_b32 v143, a47
v_pk_mul_f32 v[136:137], v[136:137], v[18:19] op_sel:[0,0] op_sel_hi:[1,0]
v_pk_mul_f32 v[138:139], v[138:139], v[18:19] op_sel:[0,0] op_sel_hi:[1,0]
v_pk_mul_f32 v[140:141], v[140:141], v[18:19] op_sel:[0,0] op_sel_hi:[1,0]
v_pk_mul_f32 v[142:143], v[142:143], v[18:19] op_sel:[0,0] op_sel_hi:[1,0]
v_cvt_pk_bf16_f32 v164, v136, v137
v_cvt_pk_bf16_f32 v165, v138, v139
v_cvt_pk_bf16_f32 v166, v140, v141
v_cvt_pk_bf16_f32 v167, v142, v143
buffer_store_dwordx4 v[164:167], v19, s[16:19], s42 offen offset:1024 sc1
v_accvgpr_read_b32 v128, a48
v_accvgpr_read_b32 v129, a49
v_accvgpr_read_b32 v130, a50
v_accvgpr_read_b32 v131, a51
v_accvgpr_read_b32 v132, a52
v_accvgpr_read_b32 v133, a53
v_accvgpr_read_b32 v134, a54
v_accvgpr_read_b32 v135, a55
v_pk_mul_f32 v[128:129], v[128:129], v[18:19] op_sel:[0,0] op_sel_hi:[1,0]
v_pk_mul_f32 v[130:131], v[130:131], v[18:19] op_sel:[0,0] op_sel_hi:[1,0]
v_pk_mul_f32 v[132:133], v[132:133], v[18:19] op_sel:[0,0] op_sel_hi:[1,0]
v_pk_mul_f32 v[134:135], v[134:135], v[18:19] op_sel:[0,0] op_sel_hi:[1,0]
v_cvt_pk_bf16_f32 v168, v128, v129
v_cvt_pk_bf16_f32 v169, v130, v131
v_cvt_pk_bf16_f32 v170, v132, v133
v_cvt_pk_bf16_f32 v171, v134, v135
buffer_store_dwordx4 v[168:171], v19, s[16:19], s42 offen offset:2048 sc1
v_accvgpr_read_b32 v136, a56
v_accvgpr_read_b32 v137, a57
v_accvgpr_read_b32 v138, a58
v_accvgpr_read_b32 v139, a59
v_accvgpr_read_b32 v140, a60
v_accvgpr_read_b32 v141, a61
v_accvgpr_read_b32 v142, a62
v_accvgpr_read_b32 v143, a63
v_pk_mul_f32 v[136:137], v[136:137], v[18:19] op_sel:[0,0] op_sel_hi:[1,0]
v_pk_mul_f32 v[138:139], v[138:139], v[18:19] op_sel:[0,0] op_sel_hi:[1,0]
v_pk_mul_f32 v[140:141], v[140:141], v[18:19] op_sel:[0,0] op_sel_hi:[1,0]
v_pk_mul_f32 v[142:143], v[142:143], v[18:19] op_sel:[0,0] op_sel_hi:[1,0]
v_cvt_pk_bf16_f32 v172, v136, v137
v_cvt_pk_bf16_f32 v173, v138, v139
v_cvt_pk_bf16_f32 v174, v140, v141
v_cvt_pk_bf16_f32 v175, v142, v143
buffer_store_dwordx4 v[172:175], v19, s[16:19], s42 offen offset:3072 sc1
s_sub_u32 s55, s54, s53
s_sub_u32 s55, s55, 4
s_cmp_lt_i32 s55, 1
s_cbranch_scc1 L_loopend_48
.p2align 6
L_loop_47:
v_mfma_f32_32x32x16_bf16 a[64:79], a[192:195], v[216:219], a[64:79]
ds_read_b128 a[128:131], v3 offset:0
ds_read_b128 a[132:135], v3 offset:1024
v_exp_f32 v12, v144
v_exp_f32 v13, v145
v_mfma_f32_32x32x16_bf16 a[80:95], a[196:199], v[216:219], a[80:95]
ds_read_b128 a[136:139], v3 offset:2048
ds_read_b128 a[140:143], v3 offset:3072
v_exp_f32 v14, v146
v_add_f32 v7, v12, v13
v_mfma_f32_32x32x16_bf16 a[96:111], a[200:203], v[216:219], a[96:111]
ds_read_b128 a[144:147], v3 offset:4096
ds_read_b128 a[148:151], v3 offset:5120
v_cvt_pk_bf16_f32 v200, v12, v13
v_exp_f32 v15, v147
v_add_f32 v7, v7, v14
v_mfma_f32_32x32x16_bf16 a[112:127], a[204:207], v[216:219], a[112:127]
ds_read_b128 a[152:155], v3 offset:6144
ds_read_b128 a[156:159], v3 offset:7168
v_exp_f32 v16, v148
v_add_f32 v7, v7, v15
s_waitcnt lgkmcnt(4)
v_mfma_f32_32x32x16_bf16 v[176:191], a[128:131], v[96:99], v[240:255]
ds_read_b128 a[160:163], v3 offset:16384
s_add_u32 m0, s45, s69
s_add_u32 s69, s69, 0x8000
v_cvt_pk_bf16_f32 v201, v14, v15
v_exp_f32 v17, v149
v_mfma_f32_32x32x16_bf16 v[176:191], a[132:135], v[100:103], v[176:191]
ds_read_b128 a[164:167], v3 offset:17408
buffer_load_dwordx4 v2, s[4:7], s66 offen offset:0 lds
v_add_f32 v7, v7, v16
v_exp_f32 v12, v150
v_mfma_f32_32x32x16_bf16 v[176:191], a[136:139], v[104:107], v[176:191]
ds_read_b128 a[168:171], v3 offset:18432
v_add_f32 v7, v7, v17
v_cvt_pk_bf16_f32 v202, v16, v17
v_exp_f32 v13, v151
v_add_f32 v7, v7, v12
v_mfma_f32_32x32x16_bf16 v[176:191], a[140:143], v[108:111], v[176:191]
ds_read_b128 a[172:175], v3 offset:19456
buffer_load_dwordx4 v2, s[4:7], s66 offen offset:1024 lds
v_exp_f32 v14, v152
v_add_f32 v7, v7, v13
s_waitcnt lgkmcnt(4)
v_mfma_f32_32x32x16_bf16 v[176:191], a[144:147], v[112:115], v[176:191]
ds_read_b128 a[176:179], v3 offset:20480
buffer_load_dwordx4 v2, s[4:7], s66 offen offset:2048 lds
v_cvt_pk_bf16_f32 v203, v12, v13
v_exp_f32 v15, v153
v_add_f32 v7, v7, v14
v_mfma_f32_32x32x16_bf16 v[176:191], a[148:151], v[116:119], v[176:191]
ds_read_b128 a[180:183], v3 offset:21504
v_exp_f32 v16, v154
v_add_f32 v7, v7, v15
v_cvt_pk_bf16_f32 v204, v14, v15
v_mfma_f32_32x32x16_bf16 v[176:191], a[152:155], v[120:123], v[176:191]
ds_read_b128 a[184:187], v3 offset:22528
buffer_load_dwordx4 v2, s[4:7], s66 offen offset:3072 lds
v_exp_f32 v17, v155
v_add_f32 v7, v7, v16
v_mfma_f32_32x32x16_bf16 v[176:191], a[156:159], v[124:127], v[176:191]
ds_read_b128 a[188:191], v3 offset:23552
v_exp_f32 v12, v156
v_add_f32 v7, v7, v17
v_cvt_pk_bf16_f32 v205, v16, v17
v_exp_f32 v13, v157
v_mfma_f32_32x32x16_bf16 a[64:79], a[208:211], v[220:223], a[64:79]
v_add_f32 v7, v7, v12
v_exp_f32 v14, v158
v_add_f32 v7, v7, v13
v_cvt_pk_bf16_f32 v206, v12, v13
v_mfma_f32_32x32x16_bf16 a[80:95], a[212:215], v[220:223], a[80:95]
v_exp_f32 v15, v159
v_add_f32 v7, v7, v14
v_add_f32 v7, v7, v15
v_cvt_pk_bf16_f32 v207, v14, v15
v_mfma_f32_32x32x16_bf16 a[96:111], a[216:219], v[220:223], a[96:111]
v_cmp_lt_f32 vcc, s70, v7
v_mfma_f32_32x32x16_bf16 a[112:127], a[220:223], v[220:223], a[112:127]
s_cbranch_vccnz L_rare_49
L_back_50:
v_add_f32 v5, v5, v7
s_waitcnt lgkmcnt(0)
v_mfma_f32_32x32x16_bf16 a[64:79], a[160:163], v[200:203], a[64:79]
ds_read_b128 a[128:131], v3 offset:8192
ds_read_b128 a[132:135], v3 offset:9216
v_exp_f32 v12, v176
v_exp_f32 v13, v177
v_mfma_f32_32x32x16_bf16 a[80:95], a[164:167], v[200:203], a[80:95]
ds_read_b128 a[136:139], v3 offset:10240
ds_read_b128 a[140:143], v3 offset:11264
v_exp_f32 v14, v178
v_add_f32 v7, v12, v13
v_cvt_pk_bf16_f32 v216, v12, v13
v_mfma_f32_32x32x16_bf16 a[96:111], a[168:171], v[200:203], a[96:111]
ds_read_b128 a[144:147], v3 offset:12288
ds_read_b128 a[148:151], v3 offset:13312
v_exp_f32 v15, v179
v_add_f32 v7, v7, v14
v_exp_f32 v16, v180
v_mfma_f32_32x32x16_bf16 a[112:127], a[172:175], v[200:203], a[112:127]
ds_read_b128 a[152:155], v3 offset:14336
ds_read_b128 a[156:159], v3 offset:15360
v_add_f32 v7, v7, v15
v_cvt_pk_bf16_f32 v217, v14, v15
v_exp_f32 v17, v181
s_waitcnt lgkmcnt(4)
v_mfma_f32_32x32x16_bf16 v[144:159], a[128:131], v[96:99], v[240:255]
ds_read_b128 a[192:195], v3 offset:24576
s_add_u32 m0, m0, 16384
s_add_u32 s66, s66, 16384
v_add_f32 v7, v7, v16
v_exp_f32 v12, v182
v_mfma_f32_32x32x16_bf16 v[144:159], a[132:135], v[100:103], v[144:159]
ds_read_b128 a[196:199], v3 offset:25600
buffer_load_dwordx4 v2, s[8:11], s67 offen offset:0 lds
v_add_f32 v7, v7, v17
v_cvt_pk_bf16_f32 v218, v16, v17
v_exp_f32 v13, v183
v_mfma_f32_32x32x16_bf16 v[144:159], a[136:139], v[104:107], v[144:159]
ds_read_b128 a[200:203], v3 offset:26624
buffer_load_dwordx4 v2, s[8:11], s67 offen offset:1024 lds
v_add_f32 v7, v7, v12
v_exp_f32 v14, v184
v_mfma_f32_32x32x16_bf16 v[144:159], a[140:143], v[108:111], v[144:159]
ds_read_b128 a[204:207], v3 offset:27648
v_add_f32 v7, v7, v13
v_cvt_pk_bf16_f32 v219, v12, v13
v_exp_f32 v15, v185
v_add_f32 v7, v7, v14
s_waitcnt lgkmcnt(4)
v_mfma_f32_32x32x16_bf16 v[144:159], a[144:147], v[112:115], v[144:159]
ds_read_b128 a[208:211], v3 offset:28672
buffer_load_dwordx4 v2, s[8:11], s67 offen offset:2048 lds
v_exp_f32 v16, v186
v_add_f32 v7, v7, v15
v_cvt_pk_bf16_f32 v220, v14, v15
v_mfma_f32_32x32x16_bf16 v[144:159], a[148:151], v[116:119], v[144:159]
ds_read_b128 a[212:215], v3 offset:29696
buffer_load_dwordx4 v2, s[8:11], s67 offen offset:3072 lds
v_exp_f32 v17, v187
v_add_f32 v7, v7, v16
v_exp_f32 v12, v188
v_mfma_f32_32x32x16_bf16 v[144:159], a[152:155], v[120:123], v[144:159]
ds_read_b128 a[216:219], v3 offset:30720
s_add_u32 s67, s67, 16384
s_and_b32 s69, s69, 0x1ffff
v_add_f32 v7, v7, v17
v_cvt_pk_bf16_f32 v221, v16, v17
v_mfma_f32_32x32x16_bf16 v[144:159], a[156:159], v[124:127], v[144:159]
ds_read_b128 a[220:223], v3 offset:31744
v_exp_f32 v13, v189
v_add_f32 v7, v7, v12
v_exp_f32 v14, v190
v_mfma_f32_32x32x16_bf16 a[64:79], a[176:179], v[204:207], a[64:79]
v_add_f32 v7, v7, v13
v_cvt_pk_bf16_f32 v222, v12, v13
v_exp_f32 v15, v191
v_add_f32 v7, v7, v14
v_add_f32 v7, v7, v15
v_mfma_f32_32x32x16_bf16 a[80:95], a[180:183], v[204:207], a[80:95]
s_waitcnt vmcnt(16) lgkmcnt(0)
s_barrier
s_add_u32 s63, s63, 0x8000
s_and_b32 s63, s63, 0x1ffff
v_add_u32 v3, s63, v31
v_cvt_pk_bf16_f32 v223, v14, v15
v_mfma_f32_32x32x16_bf16 a[96:111], a[184:187], v[204:207], a[96:111]
v_cmp_lt_f32 vcc, s70, v7
v_mfma_f32_32x32x16_bf16 a[112:127], a[188:191], v[204:207], a[112:127]
s_cbranch_vccnz L_rare_51
L_back_52:
v_add_f32 v5, v5, v7
s_add_u32 s68, s68, 64
s_sub_u32 s55, s55, 1
s_cmp_gt_i32 s55, 0
s_cbranch_scc1 L_loop_47
L_loopend_48:
s_sub_u32 s55, s54, s53
s_sub_u32 s55, s55, 2
s_min_i32 s55, s55, 2
s_cmp_lt_i32 s55, 1
s_cbranch_scc1 L_loopend_54
.p2align 6
L_loop_53:
v_mfma_f32_32x32x16_bf16 a[64:79], a[192:195], v[216:219], a[64:79]
ds_read_b128 a[128:131], v3 offset:0
ds_read_b128 a[132:135], v3 offset:1024
s_sub_u32 s22, s49, s68
s_sub_u32 s22, s22, 32
s_cmp_eq_u32 s22, 0
s_cselect_b32 s20, 1.0, 0
v_mfma_f32_32x32x16_bf16 a[80:95], a[196:199], v[216:219], a[80:95]
ds_read_b128 a[136:139], v3 offset:2048
ds_read_b128 a[140:143], v3 offset:3072
s_cmp_lt_i32 s22, 0
s_cselect_b32 s21, 0xf149f2ca, 0
v_add_f32 v10, s21, v240
v_mfma_f32_32x32x16_bf16 a[96:111], a[200:203], v[216:219], a[96:111]
ds_read_b128 a[144:147], v3 offset:4096
ds_read_b128 a[148:151], v3 offset:5120
v_fma_f32 v176, v40, s20, v10
v_fma_f32 v177, v41, s20, v10
v_fma_f32 v178, v42, s20, v10
v_mfma_f32_32x32x16_bf16 a[112:127], a[204:207], v[216:219], a[112:127]
ds_read_b128 a[152:155], v3 offset:6144
ds_read_b128 a[156:159], v3 offset:7168
v_fma_f32 v179, v43, s20, v10
v_fma_f32 v180, v44, s20, v10
v_fma_f32 v181, v45, s20, v10
v_mfma_f32_32x32x16_bf16 a[64:79], a[208:211], v[220:223], a[64:79]
ds_read_b128 a[160:163], v3 offset:16384
s_add_u32 m0, s45, s69
s_add_u32 s69, s69, 0x8000
v_fma_f32 v182, v46, s20, v10
v_fma_f32 v183, v47, s20, v10
v_fma_f32 v184, v48, s20, v10
v_mfma_f32_32x32x16_bf16 a[80:95], a[212:215], v[220:223], a[80:95]
ds_read_b128 a[164:167], v3 offset:17408
buffer_load_dwordx4 v2, s[4:7], s66 offen offset:0 lds
v_fma_f32 v185, v49, s20, v10
v_fma_f32 v186, v50, s20, v10
v_fma_f32 v187, v51, s20, v10
v_exp_f32 v12, v144
v_mfma_f32_32x32x16_bf16 a[96:111], a[216:219], v[220:223], a[96:111]
ds_read_b128 a[168:171], v3 offset:18432
v_fma_f32 v188, v52, s20, v10
v_fma_f32 v189, v53, s20, v10
v_fma_f32 v190, v54, s20, v10
v_fma_f32 v191, v55, s20, v10
v_exp_f32 v13, v145
v_mfma_f32_32x32x16_bf16 a[112:127], a[220:223], v[220:223], a[112:127]
ds_read_b128 a[172:175], v3 offset:19456
buffer_load_dwordx4 v2, s[4:7], s66 offen offset:1024 lds
v_exp_f32 v14, v146
v_add_f32 v7, v12, v13
v_cvt_pk_bf16_f32 v200, v12, v13
v_exp_f32 v15, v147
s_waitcnt lgkmcnt(8)
v_mfma_f32_32x32x16_bf16 v[176:191], a[128:131], v[96:99], v[176:191]
ds_read_b128 a[176:179], v3 offset:20480
buffer_load_dwordx4 v2, s[4:7], s66 offen offset:2048 lds
v_add_f32 v7, v7, v14
v_exp_f32 v16, v148
v_add_f32 v7, v7, v15
v_cvt_pk_bf16_f32 v201, v14, v15
v_mfma_f32_32x32x16_bf16 v[176:191], a[132:135], v[100:103], v[176:191]
ds_read_b128 a[180:183], v3 offset:21504
v_exp_f32 v17, v149
v_add_f32 v7, v7, v16
v_exp_f32 v12, v150
v_add_f32 v7, v7, v17
v_cvt_pk_bf16_f32 v202, v16, v17
v_exp_f32 v13, v151
v_mfma_f32_32x32x16_bf16 v[176:191], a[136:139], v[104:107], v[176:191]
ds_read_b128 a[184:187], v3 offset:22528
buffer_load_dwordx4 v2, s[4:7], s66 offen offset:3072 lds
v_add_f32 v7, v7, v12
v_exp_f32 v14, v152
v_add_f32 v7, v7, v13
v_cvt_pk_bf16_f32 v203, v12, v13
v_mfma_f32_32x32x16_bf16 v[176:191], a[140:143], v[108:111], v[176:191]
ds_read_b128 a[188:191], v3 offset:23552
v_exp_f32 v15, v153
v_add_f32 v7, v7, v14
v_exp_f32 v16, v154
v_add_f32 v7, v7, v15
v_cvt_pk_bf16_f32 v204, v14, v15
s_waitcnt lgkmcnt(8)
v_mfma_f32_32x32x16_bf16 v[176:191], a[144:147], v[112:115], v[176:191]
v_exp_f32 v17, v155
v_add_f32 v7, v7, v16
v_exp_f32 v12, v156
v_add_f32 v7, v7, v17
v_cvt_pk_bf16_f32 v205, v16, v17
v_exp_f32 v13, v157
v_add_f32 v7, v7, v12
v_mfma_f32_32x32x16_bf16 v[176:191], a[148:151], v[116:119], v[176:191]
v_exp_f32 v14, v158
v_add_f32 v7, v7, v13
v_cvt_pk_bf16_f32 v206, v12, v13
v_exp_f32 v15, v159
v_add_f32 v7, v7, v14
v_add_f32 v7, v7, v15
v_cvt_pk_bf16_f32 v207, v14, v15
v_mfma_f32_32x32x16_bf16 v[176:191], a[152:155], v[120:123], v[176:191]
v_cmp_lt_f32 vcc, s70, v7
v_mfma_f32_32x32x16_bf16 v[176:191], a[156:159], v[124:127], v[176:191]
s_cbranch_vccnz L_rare_55
L_back_56:
v_add_f32 v5, v5, v7
s_waitcnt lgkmcnt(0)
v_mfma_f32_32x32x16_bf16 a[64:79], a[160:163], v[200:203], a[64:79]
ds_read_b128 a[128:131], v3 offset:8192
ds_read_b128 a[132:135], v3 offset:9216
s_sub_u32 s22, s49, s68
s_sub_u32 s22, s22, 64
s_cmp_eq_u32 s22, 0
s_cselect_b32 s20, 1.0, 0
v_mfma_f32_32x32x16_bf16 a[80:95], a[164:167], v[200:203], a[80:95]
ds_read_b128 a[136:139], v3 offset:10240
ds_read_b128 a[140:143], v3 offset:11264
s_cmp_lt_i32 s22, 0
s_cselect_b32 s21, 0xf149f2ca, 0
v_add_f32 v10, s21, v240
v_mfma_f32_32x32x16_bf16 a[96:111], a[168:171], v[200:203], a[96:111]
ds_read_b128 a[144:147], v3 offset:12288
ds_read_b128 a[148:151], v3 offset:13312
v_fma_f32 v144, v40, s20, v10
v_fma_f32 v145, v41, s20, v10
v_fma_f32 v146, v42, s20, v10
v_mfma_f32_32x32x16_bf16 a[112:127], a[172:175], v[200:203], a[112:127]
ds_read_b128 a[152:155], v3 offset:14336
ds_read_b128 a[156:159], v3 offset:15360
v_fma_f32 v147, v43, s20, v10
v_fma_f32 v148, v44, s20, v10
v_fma_f32 v149, v45, s20, v10
v_fma_f32 v150, v46, s20, v10
v_mfma_f32_32x32x16_bf16 a[64:79], a[176:179], v[204:207], a[64:79]
ds_read_b128 a[192:195], v3 offset:24576
s_add_u32 m0, m0, 16384
s_add_u32 s66, s66, 16384
v_fma_f32 v151, v47, s20, v10
v_fma_f32 v152, v48, s20, v10
v_exp_f32 v12, v176
v_mfma_f32_32x32x16_bf16 a[80:95], a[180:183], v[204:207], a[80:95]
ds_read_b128 a[196:199], v3 offset:25600
buffer_load_dwordx4 v2, s[8:11], s67 offen offset:0 lds
v_fma_f32 v153, v49, s20, v10
v_fma_f32 v154, v50, s20, v10
v_fma_f32 v155, v51, s20, v10
v_fma_f32 v156, v52, s20, v10
v_mfma_f32_32x32x16_bf16 a[96:111], a[184:187], v[204:207], a[96:111]
ds_read_b128 a[200:203], v3 offset:26624
buffer_load_dwordx4 v2, s[8:11], s67 offen offset:1024 lds
v_fma_f32 v157, v53, s20, v10
v_fma_f32 v158, v54, s20, v10
v_fma_f32 v159, v55, s20, v10
v_exp_f32 v13, v177
v_mfma_f32_32x32x16_bf16 a[112:127], a[188:191], v[204:207], a[112:127]
ds_read_b128 a[204:207], v3 offset:27648
v_exp_f32 v14, v178
v_add_f32 v7, v12, v13
v_cvt_pk_bf16_f32 v216, v12, v13
v_exp_f32 v15, v179
v_add_f32 v7, v7, v14
v_exp_f32 v16, v180
s_waitcnt lgkmcnt(8)
v_mfma_f32_32x32x16_bf16 v[144:159], a[128:131], v[96:99], v[144:159]
ds_read_b128 a[208:211], v3 offset:28672
buffer_load_dwordx4 v2, s[8:11], s67 offen offset:2048 lds
v_add_f32 v7, v7, v15
v_cvt_pk_bf16_f32 v217, v14, v15
v_exp_f32 v17, v181
v_add_f32 v7, v7, v16
v_exp_f32 v12, v182
v_mfma_f32_32x32x16_bf16 v[144:159], a[132:135], v[100:103], v[144:159]
ds_read_b128 a[212:215], v3 offset:29696
buffer_load_dwordx4 v2, s[8:11], s67 offen offset:3072 lds
v_add_f32 v7, v7, v17
v_cvt_pk_bf16_f32 v218, v16, v17
v_exp_f32 v13, v183
v_add_f32 v7, v7, v12
v_exp_f32 v14, v184
v_add_f32 v7, v7, v13
v_mfma_f32_32x32x16_bf16 v[144:159], a[136:139], v[104:107], v[144:159]
ds_read_b128 a[216:219], v3 offset:30720
s_add_u32 s67, s67, 16384
s_and_b32 s69, s69, 0x1ffff
v_cvt_pk_bf16_f32 v219, v12, v13
v_exp_f32 v15, v185
v_add_f32 v7, v7, v14
v_exp_f32 v16, v186
v_mfma_f32_32x32x16_bf16 v[144:159], a[140:143], v[108:111], v[144:159]
ds_read_b128 a[220:223], v3 offset:31744
v_add_f32 v7, v7, v15
v_cvt_pk_bf16_f32 v220, v14, v15
v_exp_f32 v17, v187
v_add_f32 v7, v7, v16
v_exp_f32 v12, v188
v_add_f32 v7, v7, v17
s_waitcnt lgkmcnt(8)
v_mfma_f32_32x32x16_bf16 v[144:159], a[144:147], v[112:115], v[144:159]
v_cvt_pk_bf16_f32 v221, v16, v17
v_exp_f32 v13, v189
v_add_f32 v7, v7, v12
v_exp_f32 v14, v190
v_add_f32 v7, v7, v13
v_cvt_pk_bf16_f32 v222, v12, v13
v_exp_f32 v15, v191
v_add_f32 v7, v7, v14
v_mfma_f32_32x32x16_bf16 v[144:159], a[148:151], v[116:119], v[144:159]
s_waitcnt vmcnt(16) lgkmcnt(0)
s_barrier
s_add_u32 s63, s63, 0x8000
s_and_b32 s63, s63, 0x1ffff
v_add_u32 v3, s63, v31
v_add_f32 v7, v7, v15
v_cvt_pk_bf16_f32 v223, v14, v15
v_mfma_f32_32x32x16_bf16 v[144:159], a[152:155], v[120:123], v[144:159]
v_cmp_lt_f32 vcc, s70, v7
v_mfma_f32_32x32x16_bf16 v[144:159], a[156:159], v[124:127], v[144:159]
s_cbranch_vccnz L_rare_57
L_back_58:
v_add_f32 v5, v5, v7
s_add_u32 s68, s68, 64
s_sub_u32 s55, s55, 1
s_cmp_gt_i32 s55, 0
s_cbranch_scc1 L_loop_53
L_loopend_54:
s_cmp_eq_u32 s37, 7
s_cbranch_scc1 L_p7_59
s_waitcnt vmcnt(0)
s_branch L_p7j_60
L_p7_59:
s_waitcnt vmcnt(8)
L_p7j_60:
s_mov_b32 s8, s78
s_mov_b32 s9, s79
s_and_b32 s69, s54, 2
s_lshl_b32 s69, s69, 15
s_lshl_b32 s67, s36, 3
s_add_u32 s67, s67, s37
s_and_b32 s40, s2, 7
s_lshr_b32 s52, s40, 1
s_and_b32 s40, s40, 1
s_lshr_b32 s41, s2, 3
s_lshr_b32 s53, s41, 2
s_lshl_b32 s40, s40, 3
s_add_u32 s53, s53, s40
s_and_b32 s54, s41, 3
s_sub_u32 s40, 15, s53
s_min_u32 s66, s40, s53
s_lshl_b32 s40, s53, 2
s_add_u32 s40, s40, s38
s_mul_i32 s55, s40, 350208
s_mul_i32 s56, s52, 22
s_mov_b32 s57, 0x7f000000
v_lshlrev_b32 v224, 4, v1
v_lshrrev_b32 v234, 4, v1
v_bfe_u32 v235, v1, 2, 2
v_xor_b32 v235, v235, v234
v_lshlrev_b32 v235, 6, v235
v_and_b32 v236, 3, v1
v_lshl_add_u32 v235, v236, 4, v235
s_lshl_b32 s40, s54, 8
v_add_u32 v235, s40, v235
s_lshl_b32 s41, s38, 4
v_add_u32 v236, s41, v234
v_lshl_add_u32 v226, v236, 10, v235
v_add_u32 v227, 3072, v226
v_add_u32 v228, 6144, v226
v_add_u32 v229, 9216, v226
s_lshl_b32 s41, s38, 3
v_add_u32 v236, s41, v234
v_lshl_add_u32 v230, v236, 10, v235
v_add_u32 v231, 3072, v230
s_lshr_b32 s40, s38, 1
s_lshl_b32 s40, s40, 13
s_add_u32 s40, s40, s69
v_add_u32 v232, s40, v224
v_xor_b32 v233, 0x10000, v232
s_lshr_b32 s40, s38, 1
s_lshl_b32 s40, s40, 13
s_add_u32 s40, s40, 0x20000
v_add_u32 v239, s40, v224
v_bfe_u32 v234, v1, 2, 2
v_lshrrev_b32 v235, 5, v1
v_lshl_add_u32 v235, v235, 2, v234
v_lshlrev_b32 v235, 8, v235
v_bfe_u32 v236, v1, 4, 1
v_lshl_add_u32 v235, v236, 5, v235
v_and_b32 v236, 3, v1
v_lshl_add_u32 v235, v236, 3, v235
s_add_u32 s41, s69, 16384
v_add_u32 v235, s41, v235
s_and_b32 s40, s38, 1
s_lshl_b32 s40, s40, 1
s_add_u32 s41, s40, 0
v_xor_b32 v236, s41, v234
v_lshl_add_u32 v192, v236, 6, v235
v_xor_b32 v194, 0x10000, v192
v_subrev_u32 v196, s69, v192
v_add_u32 v196, 0x20000, v196
s_add_u32 s41, s40, 1
v_xor_b32 v236, s41, v234
v_lshl_add_u32 v193, v236, 6, v235
v_xor_b32 v195, 0x10000, v193
v_subrev_u32 v197, s69, v193
v_add_u32 v197, 0x20000, v197
s_add_u32 s4, s16, 0x2000000
s_addc_u32 s5, s17, 0
s_mov_b32 s6, 0x1560000
s_mov_b32 s7, 0x20000
s_mov_b32 s10, 0x400000
s_mov_b32 s11, 0x20000
s_mov_b32 s14, 0x158000
s_mov_b32 s15, 0x20000
s_cmp_lg_u32 s38, 0
s_cbranch_scc1 L_w0_61
v_cmp_eq_u32 vcc, s71, v209
s_nop 1
s_and_b32 s42, vcc_lo, 0xffffffff
s_cmp_eq_u32 s42, 0xffffffff
s_cbranch_scc1 L_fok_62
s_mov_b64 s[64:65], exec
s_mov_b32 exec_lo, 0xffffffff
s_mov_b32 exec_hi, 0x0
L_poll_63:
buffer_load_dword v62, v208, s[16:19], 0 offen sc1
s_waitcnt vmcnt(0)
v_cmp_eq_u32 vcc, s71, v62
s_nop 1
s_cmp_eq_u64 vcc, exec
s_cbranch_scc0 L_poll_63
s_mov_b64 exec, s[64:65]
L_fok_62:
L_w0_61:
s_cmp_lg_u32 s38, 0
s_cbranch_scc1 L_w0_64
v_mov_b32 v234, 132096
v_mov_b32 v235, s71
ds_write_b32 v234, v235
s_waitcnt lgkmcnt(0)
L_w0_64:
s_barrier
v_mfma_f32_32x32x16_bf16 a[64:79], a[192:195], v[216:219], a[64:79]
ds_read_b128 a[128:131], v3 offset:0
ds_read_b128 a[132:135], v3 offset:1024
s_sub_u32 s22, s49, s68
s_sub_u32 s22, s22, 32
s_cmp_eq_u32 s22, 0
s_cselect_b32 s20, 1.0, 0
v_mfma_f32_32x32x16_bf16 a[80:95], a[196:199], v[216:219], a[80:95]
ds_read_b128 a[136:139], v3 offset:2048
ds_read_b128 a[140:143], v3 offset:3072
s_cmp_lt_i32 s22, 0
s_cselect_b32 s21, 0xf149f2ca, 0
v_add_f32 v10, s21, v240
v_fma_f32 v176, v40, s20, v10
v_fma_f32 v177, v41, s20, v10
v_mfma_f32_32x32x16_bf16 a[96:111], a[200:203], v[216:219], a[96:111]
ds_read_b128 a[144:147], v3 offset:4096
ds_read_b128 a[148:151], v3 offset:5120
v_fma_f32 v178, v42, s20, v10
v_fma_f32 v179, v43, s20, v10
v_fma_f32 v180, v44, s20, v10
v_fma_f32 v181, v45, s20, v10
v_fma_f32 v182, v46, s20, v10
v_mfma_f32_32x32x16_bf16 a[112:127], a[204:207], v[216:219], a[112:127]
ds_read_b128 a[152:155], v3 offset:6144
ds_read_b128 a[156:159], v3 offset:7168
v_fma_f32 v183, v47, s20, v10
v_fma_f32 v184, v48, s20, v10
v_fma_f32 v185, v49, s20, v10
v_fma_f32 v186, v50, s20, v10
v_fma_f32 v187, v51, s20, v10
v_mfma_f32_32x32x16_bf16 a[64:79], a[208:211], v[220:223], a[64:79]
ds_read_b128 a[160:163], v3 offset:16384
s_add_u32 s43, s45, 16384
s_xor_b32 m0, s43, s69
s_add_u32 s59, s56, 0
s_lshl_b32 s59, s59, 14
buffer_load_dwordx4 v226, s[12:15], s59 offen offset:0 lds
v_mfma_f32_32x32x16_bf16 a[80:95], a[212:215], v[220:223], a[80:95]
ds_read_b128 a[164:167], v3 offset:17408
buffer_load_dwordx4 v227, s[12:15], s59 offen offset:1024 lds
buffer_load_dwordx4 v228, s[12:15], s59 offen offset:2048 lds
v_fma_f32 v188, v52, s20, v10
v_fma_f32 v189, v53, s20, v10
v_fma_f32 v190, v54, s20, v10
v_fma_f32 v191, v55, s20, v10
v_exp_f32 v12, v144
v_mfma_f32_32x32x16_bf16 a[96:111], a[216:219], v[220:223], a[96:111]
ds_read_b128 a[168:171], v3 offset:18432
buffer_load_dwordx4 v229, s[12:15], s59 offen offset:3072 lds
s_add_u32 s43, s45, 0
s_xor_b32 m0, s43, s69
s_add_u32 s58, s56, 256
s_lshl_b32 s58, s58, 10
s_add_u32 s58, s58, s55
v_mfma_f32_32x32x16_bf16 a[112:127], a[220:223], v[220:223], a[112:127]
ds_read_b128 a[172:175], v3 offset:19456
buffer_load_dwordx4 v224, s[4:7], s58 offen offset:0 lds
buffer_load_dwordx4 v224, s[4:7], s58 offen offset:1024 lds
v_exp_f32 v13, v145
v_exp_f32 v14, v146
v_add_f32 v7, v12, v13
v_cvt_pk_bf16_f32 v200, v12, v13
s_waitcnt lgkmcnt(8)
v_mfma_f32_32x32x16_bf16 v[176:191], a[128:131], v[96:99], v[176:191]
ds_read_b128 a[176:179], v3 offset:20480
buffer_load_dwordx4 v224, s[4:7], s58 offen offset:2048 lds
buffer_load_dwordx4 v224, s[4:7], s58 offen offset:3072 lds
v_exp_f32 v15, v147
v_add_f32 v7, v7, v14
v_exp_f32 v16, v148
v_add_f32 v7, v7, v15
v_mfma_f32_32x32x16_bf16 v[176:191], a[132:135], v[100:103], v[176:191]
ds_read_b128 a[180:183], v3 offset:21504
s_add_u32 s43, s45, 49152
s_xor_b32 m0, s43, s69
s_add_u32 s59, s56, 4
s_lshl_b32 s59, s59, 14
buffer_load_dwordx4 v226, s[12:15], s59 offen offset:0 lds
v_cvt_pk_bf16_f32 v201, v14, v15
v_mfma_f32_32x32x16_bf16 v[176:191], a[136:139], v[104:107], v[176:191]
ds_read_b128 a[184:187], v3 offset:22528
buffer_load_dwordx4 v227, s[12:15], s59 offen offset:1024 lds
buffer_load_dwordx4 v228, s[12:15], s59 offen offset:2048 lds
v_exp_f32 v17, v149
v_add_f32 v7, v7, v16
v_exp_f32 v12, v150
v_add_f32 v7, v7, v17
v_mfma_f32_32x32x16_bf16 v[176:191], a[140:143], v[108:111], v[176:191]
ds_read_b128 a[188:191], v3 offset:23552
buffer_load_dwordx4 v229, s[12:15], s59 offen offset:3072 lds
v_cvt_pk_bf16_f32 v202, v16, v17
v_exp_f32 v13, v151
v_add_f32 v7, v7, v12
v_exp_f32 v14, v152
v_add_f32 v7, v7, v13
v_cvt_pk_bf16_f32 v203, v12, v13
s_waitcnt lgkmcnt(8)
v_mfma_f32_32x32x16_bf16 v[176:191], a[144:147], v[112:115], v[176:191]
v_exp_f32 v15, v153
v_add_f32 v7, v7, v14
v_exp_f32 v16, v154
v_add_f32 v7, v7, v15
v_cvt_pk_bf16_f32 v204, v14, v15
v_exp_f32 v17, v155
v_add_f32 v7, v7, v16
v_exp_f32 v12, v156
v_add_f32 v7, v7, v17
v_mfma_f32_32x32x16_bf16 v[176:191], a[148:151], v[116:119], v[176:191]
v_cvt_pk_bf16_f32 v205, v16, v17
v_exp_f32 v13, v157
v_add_f32 v7, v7, v12
v_exp_f32 v14, v158
v_add_f32 v7, v7, v13
v_cvt_pk_bf16_f32 v206, v12, v13
v_exp_f32 v15, v159
v_add_f32 v7, v7, v14
v_add_f32 v7, v7, v15
v_cvt_pk_bf16_f32 v207, v14, v15
v_mfma_f32_32x32x16_bf16 v[176:191], a[152:155], v[120:123], v[176:191]
v_cmp_lt_f32 vcc, s70, v7
v_mfma_f32_32x32x16_bf16 v[176:191], a[156:159], v[124:127], v[176:191]
s_cbranch_vccnz L_rare_65
L_back_66:
v_add_f32 v5, v5, v7
s_waitcnt lgkmcnt(0)
v_mfma_f32_32x32x16_bf16 a[64:79], a[160:163], v[200:203], a[64:79]
ds_read_b128 a[192:195], v3 offset:24576
v_mfma_f32_32x32x16_bf16 a[80:95], a[164:167], v[200:203], a[80:95]
ds_read_b128 a[196:199], v3 offset:25600
s_add_u32 s43, s45, 32768
s_xor_b32 m0, s43, s69
s_add_u32 s58, s56, 260
s_lshl_b32 s58, s58, 10
s_add_u32 s58, s58, s55
buffer_load_dwordx4 v224, s[4:7], s58 offen offset:0 lds
buffer_load_dwordx4 v224, s[4:7], s58 offen offset:1024 lds
buffer_load_dwordx4 v224, s[4:7], s58 offen offset:2048 lds
buffer_load_dwordx4 v224, s[4:7], s58 offen offset:3072 lds
v_mfma_f32_32x32x16_bf16 a[96:111], a[168:171], v[200:203], a[96:111]
ds_read_b128 a[200:203], v3 offset:26624
s_add_u32 s43, s45, 81920
s_xor_b32 m0, s43, s69
s_add_u32 s59, s56, 8
s_lshl_b32 s59, s59, 14
buffer_load_dwordx4 v226, s[12:15], s59 offen offset:0 lds
buffer_load_dwordx4 v227, s[12:15], s59 offen offset:1024 lds
buffer_load_dwordx4 v228, s[12:15], s59 offen offset:2048 lds
buffer_load_dwordx4 v229, s[12:15], s59 offen offset:3072 lds
v_mfma_f32_32x32x16_bf16 a[112:127], a[172:175], v[200:203], a[112:127]
ds_read_b128 a[204:207], v3 offset:27648
s_add_u32 s43, s45, 65536
s_xor_b32 m0, s43, s69
s_add_u32 s58, s56, 264
s_lshl_b32 s58, s58, 10
s_add_u32 s58, s58, s55
buffer_load_dwordx4 v224, s[4:7], s58 offen offset:0 lds
buffer_load_dwordx4 v224, s[4:7], s58 offen offset:1024 lds
buffer_load_dwordx4 v224, s[4:7], s58 offen offset:2048 lds
buffer_load_dwordx4 v224, s[4:7], s58 offen offset:3072 lds
v_mfma_f32_32x32x16_bf16 a[64:79], a[176:179], v[204:207], a[64:79]
ds_read_b128 a[208:211], v3 offset:28672
v_exp_f32 v12, v176
v_exp_f32 v13, v177
v_exp_f32 v14, v178
v_add_f32 v7, v12, v13
v_cvt_pk_bf16_f32 v216, v12, v13
v_exp_f32 v15, v179
v_add_f32 v7, v7, v14
v_exp_f32 v16, v180
v_add_f32 v7, v7, v15
v_cvt_pk_bf16_f32 v217, v14, v15
v_exp_f32 v17, v181
v_add_f32 v7, v7, v16
v_exp_f32 v12, v182
v_add_f32 v7, v7, v17
v_cvt_pk_bf16_f32 v218, v16, v17
v_exp_f32 v13, v183
v_add_f32 v7, v7, v12
v_exp_f32 v14, v184
v_add_f32 v7, v7, v13
v_mfma_f32_32x32x16_bf16 a[80:95], a[180:183], v[204:207], a[80:95]
ds_read_b128 a[212:215], v3 offset:29696
v_cvt_pk_bf16_f32 v219, v12, v13
v_exp_f32 v15, v185
v_add_f32 v7, v7, v14
v_exp_f32 v16, v186
v_add_f32 v7, v7, v15
v_cvt_pk_bf16_f32 v220, v14, v15
v_exp_f32 v17, v187
v_add_f32 v7, v7, v16
v_exp_f32 v12, v188
v_add_f32 v7, v7, v17
v_cvt_pk_bf16_f32 v221, v16, v17
v_exp_f32 v13, v189
v_add_f32 v7, v7, v12
v_exp_f32 v14, v190
v_add_f32 v7, v7, v13
v_cvt_pk_bf16_f32 v222, v12, v13
v_exp_f32 v15, v191
v_add_f32 v7, v7, v14
v_add_f32 v7, v7, v15
v_cvt_pk_bf16_f32 v223, v14, v15
v_mfma_f32_32x32x16_bf16 a[96:111], a[184:187], v[204:207], a[96:111]
ds_read_b128 a[216:219], v3 offset:30720
v_cmp_lt_f32 vcc, s70, v7
v_mfma_f32_32x32x16_bf16 a[112:127], a[188:191], v[204:207], a[112:127]
ds_read_b128 a[220:223], v3 offset:31744
s_cbranch_vccnz L_rare_67
L_back_68:
v_add_f32 v5, v5, v7
s_add_u32 s68, s68, 64
s_waitcnt lgkmcnt(0)
v_mfma_f32_32x32x16_bf16 a[64:79], a[192:195], v[216:219], a[64:79]
v_mfma_f32_32x32x16_bf16 a[80:95], a[196:199], v[216:219], a[80:95]
v_mfma_f32_32x32x16_bf16 a[96:111], a[200:203], v[216:219], a[96:111]
v_mfma_f32_32x32x16_bf16 a[112:127], a[204:207], v[216:219], a[112:127]
v_mfma_f32_32x32x16_bf16 a[64:79], a[208:211], v[220:223], a[64:79]
v_mfma_f32_32x32x16_bf16 a[80:95], a[212:215], v[220:223], a[80:95]
v_mfma_f32_32x32x16_bf16 a[96:111], a[216:219], v[220:223], a[96:111]
v_mfma_f32_32x32x16_bf16 a[112:127], a[220:223], v[220:223], a[112:127]
s_nop 15
v_mov_b32 v18, v5
s_nop 1
v_permlane32_swap_b32 v18, v5
s_nop 1
v_add_f32 v18, v18, v5
v_rcp_f32 v18, v18
s_lshr_b32 s41, s49, 5
s_mul_i32 s41, s41, 350208
v_mul_f32 v18, v18, v38
s_lshl_b32 s42, s36, 13
s_add_u32 s41, s41, s42
s_add_u32 s41, s41, 0x2000000
s_add_u32 s42, s41, 4096
v_lshlrev_b32 v19, 4, v1
v_accvgpr_read_b32 v20, a64
v_accvgpr_read_b32 v21, a65
v_accvgpr_read_b32 v22, a66
v_accvgpr_read_b32 v23, a67
v_accvgpr_read_b32 v24, a68
v_accvgpr_read_b32 v25, a69
v_accvgpr_read_b32 v26, a70
v_accvgpr_read_b32 v27, a71
v_pk_mul_f32 v[20:21], v[20:21], v[18:19] op_sel:[0,0] op_sel_hi:[1,0]
v_pk_mul_f32 v[22:23], v[22:23], v[18:19] op_sel:[0,0] op_sel_hi:[1,0]
v_pk_mul_f32 v[24:25], v[24:25], v[18:19] op_sel:[0,0] op_sel_hi:[1,0]
v_pk_mul_f32 v[26:27], v[26:27], v[18:19] op_sel:[0,0] op_sel_hi:[1,0]
v_cvt_pk_bf16_f32 v48, v20, v21
v_cvt_pk_bf16_f32 v49, v22, v23
v_cvt_pk_bf16_f32 v50, v24, v25
v_cvt_pk_bf16_f32 v51, v26, v27
buffer_store_dwordx4 v[48:51], v19, s[16:19], s41 offen offset:0 sc1
v_accvgpr_read_b32 v40, a72
v_accvgpr_read_b32 v41, a73
v_accvgpr_read_b32 v42, a74
v_accvgpr_read_b32 v43, a75
v_accvgpr_read_b32 v44, a76
v_accvgpr_read_b32 v45, a77
v_accvgpr_read_b32 v46, a78
v_accvgpr_read_b32 v47, a79
v_pk_mul_f32 v[40:41], v[40:41], v[18:19] op_sel:[0,0] op_sel_hi:[1,0]
v_pk_mul_f32 v[42:43], v[42:43], v[18:19] op_sel:[0,0] op_sel_hi:[1,0]
v_pk_mul_f32 v[44:45], v[44:45], v[18:19] op_sel:[0,0] op_sel_hi:[1,0]
v_pk_mul_f32 v[46:47], v[46:47], v[18:19] op_sel:[0,0] op_sel_hi:[1,0]
v_cvt_pk_bf16_f32 v52, v40, v41
v_cvt_pk_bf16_f32 v53, v42, v43
v_cvt_pk_bf16_f32 v54, v44, v45
v_cvt_pk_bf16_f32 v55, v46, v47
buffer_store_dwordx4 v[52:55], v19, s[16:19], s41 offen offset:1024 sc1
v_accvgpr_read_b32 v20, a80
v_accvgpr_read_b32 v21, a81
v_accvgpr_read_b32 v22, a82
v_accvgpr_read_b32 v23, a83
v_accvgpr_read_b32 v24, a84
v_accvgpr_read_b32 v25, a85
v_accvgpr_read_b32 v26, a86
v_accvgpr_read_b32 v27, a87
v_pk_mul_f32 v[20:21], v[20:21], v[18:19] op_sel:[0,0] op_sel_hi:[1,0]
v_pk_mul_f32 v[22:23], v[22:23], v[18:19] op_sel:[0,0] op_sel_hi:[1,0]
v_pk_mul_f32 v[24:25], v[24:25], v[18:19] op_sel:[0,0] op_sel_hi:[1,0]
v_pk_mul_f32 v[26:27], v[26:27], v[18:19] op_sel:[0,0] op_sel_hi:[1,0]
v_cvt_pk_bf16_f32 v56, v20, v21
v_cvt_pk_bf16_f32 v57, v22, v23
v_cvt_pk_bf16_f32 v58, v24, v25
v_cvt_pk_bf16_f32 v59, v26, v27
buffer_store_dwordx4 v[56:59], v19, s[16:19], s41 offen offset:2048 sc1
v_accvgpr_read_b32 v40, a88
v_accvgpr_read_b32 v41, a89
v_accvgpr_read_b32 v42, a90
v_accvgpr_read_b32 v43, a91
v_accvgpr_read_b32 v44, a92
v_accvgpr_read_b32 v45, a93
v_accvgpr_read_b32 v46, a94
v_accvgpr_read_b32 v47, a95
v_pk_mul_f32 v[40:41], v[40:41], v[18:19] op_sel:[0,0] op_sel_hi:[1,0]
v_pk_mul_f32 v[42:43], v[42:43], v[18:19] op_sel:[0,0] op_sel_hi:[1,0]
v_pk_mul_f32 v[44:45], v[44:45], v[18:19] op_sel:[0,0] op_sel_hi:[1,0]
v_pk_mul_f32 v[46:47], v[46:47], v[18:19] op_sel:[0,0] op_sel_hi:[1,0]
v_cvt_pk_bf16_f32 v60, v40, v41
v_cvt_pk_bf16_f32 v61, v42, v43
v_cvt_pk_bf16_f32 v62, v44, v45
v_cvt_pk_bf16_f32 v63, v46, v47
buffer_store_dwordx4 v[60:63], v19, s[16:19], s41 offen offset:3072 sc1
v_accvgpr_read_b32 v20, a96
v_accvgpr_read_b32 v21, a97
v_accvgpr_read_b32 v22, a98
v_accvgpr_read_b32 v23, a99
v_accvgpr_read_b32 v24, a100
v_accvgpr_read_b32 v25, a101
v_accvgpr_read_b32 v26, a102
v_accvgpr_read_b32 v27, a103
v_pk_mul_f32 v[20:21], v[20:21], v[18:19] op_sel:[0,0] op_sel_hi:[1,0]
v_pk_mul_f32 v[22:23], v[22:23], v[18:19] op_sel:[0,0] op_sel_hi:[1,0]
v_pk_mul_f32 v[24:25], v[24:25], v[18:19] op_sel:[0,0] op_sel_hi:[1,0]
v_pk_mul_f32 v[26:27], v[26:27], v[18:19] op_sel:[0,0] op_sel_hi:[1,0]
v_cvt_pk_bf16_f32 v48, v20, v21
v_cvt_pk_bf16_f32 v49, v22, v23
v_cvt_pk_bf16_f32 v50, v24, v25
v_cvt_pk_bf16_f32 v51, v26, v27
buffer_store_dwordx4 v[48:51], v19, s[16:19], s42 offen offset:0 sc1
v_accvgpr_read_b32 v40, a104
v_accvgpr_read_b32 v41, a105
v_accvgpr_read_b32 v42, a106
v_accvgpr_read_b32 v43, a107
v_accvgpr_read_b32 v44, a108
v_accvgpr_read_b32 v45, a109
v_accvgpr_read_b32 v46, a110
v_accvgpr_read_b32 v47, a111
v_pk_mul_f32 v[40:41], v[40:41], v[18:19] op_sel:[0,0] op_sel_hi:[1,0]
v_pk_mul_f32 v[42:43], v[42:43], v[18:19] op_sel:[0,0] op_sel_hi:[1,0]
v_pk_mul_f32 v[44:45], v[44:45], v[18:19] op_sel:[0,0] op_sel_hi:[1,0]
v_pk_mul_f32 v[46:47], v[46:47], v[18:19] op_sel:[0,0] op_sel_hi:[1,0]
v_cvt_pk_bf16_f32 v52, v40, v41
v_cvt_pk_bf16_f32 v53, v42, v43
v_cvt_pk_bf16_f32 v54, v44, v45
v_cvt_pk_bf16_f32 v55, v46, v47
buffer_store_dwordx4 v[52:55], v19, s[16:19], s42 offen offset:1024 sc1
v_accvgpr_read_b32 v20, a112
v_accvgpr_read_b32 v21, a113
v_accvgpr_read_b32 v22, a114
v_accvgpr_read_b32 v23, a115
v_accvgpr_read_b32 v24, a116
v_accvgpr_read_b32 v25, a117
v_accvgpr_read_b32 v26, a118
v_accvgpr_read_b32 v27, a119
v_pk_mul_f32 v[20:21], v[20:21], v[18:19] op_sel:[0,0] op_sel_hi:[1,0]
v_pk_mul_f32 v[22:23], v[22:23], v[18:19] op_sel:[0,0] op_sel_hi:[1,0]
v_pk_mul_f32 v[24:25], v[24:25], v[18:19] op_sel:[0,0] op_sel_hi:[1,0]
v_pk_mul_f32 v[26:27], v[26:27], v[18:19] op_sel:[0,0] op_sel_hi:[1,0]
v_cvt_pk_bf16_f32 v56, v20, v21
v_cvt_pk_bf16_f32 v57, v22, v23
v_cvt_pk_bf16_f32 v58, v24, v25
v_cvt_pk_bf16_f32 v59, v26, v27
buffer_store_dwordx4 v[56:59], v19, s[16:19], s42 offen offset:2048 sc1
v_accvgpr_read_b32 v40, a120
v_accvgpr_read_b32 v41, a121
v_accvgpr_read_b32 v42, a122
v_accvgpr_read_b32 v43, a123
v_accvgpr_read_b32 v44, a124
v_accvgpr_read_b32 v45, a125
v_accvgpr_read_b32 v46, a126
v_accvgpr_read_b32 v47, a127
v_pk_mul_f32 v[40:41], v[40:41], v[18:19] op_sel:[0,0] op_sel_hi:[1,0]
v_pk_mul_f32 v[42:43], v[42:43], v[18:19] op_sel:[0,0] op_sel_hi:[1,0]
v_pk_mul_f32 v[44:45], v[44:45], v[18:19] op_sel:[0,0] op_sel_hi:[1,0]
v_pk_mul_f32 v[46:47], v[46:47], v[18:19] op_sel:[0,0] op_sel_hi:[1,0]
v_cvt_pk_bf16_f32 v60, v40, v41
v_cvt_pk_bf16_f32 v61, v42, v43
v_cvt_pk_bf16_f32 v62, v44, v45
v_cvt_pk_bf16_f32 v63, v46, v47
buffer_store_dwordx4 v[60:63], v19, s[16:19], s42 offen offset:3072 sc1
s_load_dwordx2 s[20:21], s[0:1], 96
s_load_dwordx2 s[24:25], s[0:1], 80
v_mov_b32 v234, 132096
ds_read_b32 v211, v234
s_lshl_b32 s40, s53, 7
s_lshr_b32 s41, s38, 1
s_lshl_b32 s41, s41, 6
s_add_u32 s40, s40, s41
s_lshr_b32 s41, s52, 1
s_lshl_b32 s41, s41, 5
s_add_u32 s40, s40, s41
v_and_b32 v234, 31, v1
v_add_u32 v234, s40, v234
v_lshlrev_b32 v210, 10, v234
v_lshlrev_b32 v234, 4, v234
v_add_u32 v234, 0x3800008, v234
s_waitcnt lgkmcnt(0)
s_mov_b32 s22, 0x200000
s_mov_b32 s23, 0x20000
s_mov_b32 s26, 0x400
s_mov_b32 s27, 0x20000
buffer_load_dword v212, v234, s[16:19], 0 offen sc1
s_and_b32 s40, s38, 1
s_lshl_b32 s40, s40, 1
s_and_b32 s41, s52, 1
s_add_u32 s40, s40, s41
s_lshl_b32 s40, s40, 6
s_lshl_b32 s41, s54, 8
s_add_u32 s51, s40, s41
v_lshrrev_b32 v235, 5, v1
v_lshlrev_b32 v235, 3, v235
buffer_load_dwordx2 v[214:215], v235, s[24:27], s51 offen offset:0
buffer_load_dwordx2 v[216:217], v235, s[24:27], s51 offen offset:16
buffer_load_dwordx2 v[218:219], v235, s[24:27], s51 offen offset:32
buffer_load_dwordx2 v[220:221], v235, s[24:27], s51 offen offset:48
v_add_u32 v210, v210, v235
s_lshl_b32 s40, s52, 3
v_add_u32 v208, s40, v1
v_lshlrev_b32 v208, 3, v208
v_add_u32 v208, s66, v208
v_lshlrev_b32 v208, 7, v208
v_add_u32 v208, 0x3910000, v208
s_waitcnt vmcnt(29)
s_barrier
ds_read_b128 v[128:131], v232 offset:0
ds_read_b128 v[132:135], v232 offset:4096
ds_read_b64_tr_b16 v[144:145], v192 offset:0
ds_read_b64_tr_b16 v[146:147], v192 offset:2048
ds_read_b64_tr_b16 v[148:149], v193 offset:0
ds_read_b64_tr_b16 v[150:151], v193 offset:2048
s_waitcnt lgkmcnt(2)
v_mfma_f32_32x32x16_bf16 v[64:79], v[144:147], v[128:131], 0
ds_read_b128 v[136:139], v232 offset:1024
s_add_u32 s43, s45, 147456
s_mov_b32 m0, s43
s_add_u32 s59, s56, 12
s_lshl_b32 s59, s59, 14
s_waitcnt lgkmcnt(1)
v_mfma_f32_32x32x16_bf16 v[80:95], v[148:151], v[128:131], 0
ds_read_b128 v[140:143], v232 offset:5120
buffer_load_dwordx4 v226, s[12:15], s59 offen offset:0 lds
v_mfma_f32_32x32x16_bf16 v[96:111], v[144:147], v[132:135], 0
ds_read_b64_tr_b16 v[152:153], v192 offset:4096
ds_read_b64_tr_b16 v[154:155], v192 offset:6144
buffer_load_dwordx4 v227, s[12:15], s59 offen offset:1024 lds
v_mfma_f32_32x32x16_bf16 v[112:127], v[148:151], v[132:135], 0
ds_read_b64_tr_b16 v[156:157], v193 offset:4096
ds_read_b64_tr_b16 v[158:159], v193 offset:6144
buffer_load_dwordx4 v228, s[12:15], s59 offen offset:2048 lds
s_waitcnt lgkmcnt(2)
v_mfma_f32_32x32x16_bf16 v[64:79], v[152:155], v[136:139], v[64:79]
ds_read_b128 v[128:131], v232 offset:2048
buffer_load_dwordx4 v229, s[12:15], s59 offen offset:3072 lds
s_waitcnt lgkmcnt(1)
v_mfma_f32_32x32x16_bf16 v[80:95], v[156:159], v[136:139], v[80:95]
ds_read_b128 v[132:135], v232 offset:6144
s_add_u32 m0, s45, 131072
s_add_u32 s58, s56, 268
s_lshl_b32 s58, s58, 10
s_add_u32 s58, s58, s55
v_mfma_f32_32x32x16_bf16 v[96:111], v[152:155], v[140:143], v[96:111]
ds_read_b64_tr_b16 v[144:145], v192 offset:8192
ds_read_b64_tr_b16 v[146:147], v192 offset:10240
buffer_load_dwordx4 v224, s[4:7], s58 offen offset:0 lds
v_mfma_f32_32x32x16_bf16 v[112:127], v[156:159], v[140:143], v[112:127]
ds_read_b64_tr_b16 v[148:149], v193 offset:8192
ds_read_b64_tr_b16 v[150:151], v193 offset:10240
buffer_load_dwordx4 v224, s[4:7], s58 offen offset:1024 lds
s_waitcnt lgkmcnt(2)
v_mfma_f32_32x32x16_bf16 v[64:79], v[144:147], v[128:131], v[64:79]
ds_read_b128 v[136:139], v232 offset:3072
buffer_load_dwordx4 v224, s[4:7], s58 offen offset:2048 lds
s_waitcnt lgkmcnt(1)
v_mfma_f32_32x32x16_bf16 v[80:95], v[148:151], v[128:131], v[80:95]
ds_read_b128 v[140:143], v232 offset:7168
buffer_load_dwordx4 v224, s[4:7], s58 offen offset:3072 lds
v_mfma_f32_32x32x16_bf16 v[96:111], v[144:147], v[132:135], v[96:111]
ds_read_b64_tr_b16 v[152:153], v192 offset:12288
ds_read_b64_tr_b16 v[154:155], v192 offset:14336
v_mfma_f32_32x32x16_bf16 v[112:127], v[148:151], v[132:135], v[112:127]
ds_read_b64_tr_b16 v[156:157], v193 offset:12288
ds_read_b64_tr_b16 v[158:159], v193 offset:14336
s_waitcnt lgkmcnt(2)
v_mfma_f32_32x32x16_bf16 v[64:79], v[152:155], v[136:139], v[64:79]
s_waitcnt vmcnt(29)
s_barrier
ds_read_b128 v[128:131], v232 offset:32768
s_waitcnt lgkmcnt(1)
v_mfma_f32_32x32x16_bf16 v[80:95], v[156:159], v[136:139], v[80:95]
ds_read_b128 v[132:135], v232 offset:36864
s_add_u32 s43, s45, 114688
s_xor_b32 m0, s43, s69
s_add_u32 s59, s56, 16
s_lshl_b32 s59, s59, 14
v_mfma_f32_32x32x16_bf16 v[96:111], v[152:155], v[140:143], v[96:111]
ds_read_b64_tr_b16 v[144:145], v192 offset:32768
ds_read_b64_tr_b16 v[146:147], v192 offset:34816
buffer_load_dwordx4 v226, s[12:15], s59 offen offset:0 lds
v_mfma_f32_32x32x16_bf16 v[112:127], v[156:159], v[140:143], v[112:127]
ds_read_b64_tr_b16 v[148:149], v193 offset:32768
ds_read_b64_tr_b16 v[150:151], v193 offset:34816
buffer_load_dwordx4 v227, s[12:15], s59 offen offset:1024 lds
s_waitcnt lgkmcnt(2)
v_mfma_f32_32x32x16_bf16 v[64:79], v[144:147], v[128:131], v[64:79]
ds_read_b128 v[136:139], v232 offset:33792
buffer_load_dwordx4 v228, s[12:15], s59 offen offset:2048 lds
s_waitcnt lgkmcnt(1)
v_mfma_f32_32x32x16_bf16 v[80:95], v[148:151], v[128:131], v[80:95]
ds_read_b128 v[140:143], v232 offset:37888
buffer_load_dwordx4 v229, s[12:15], s59 offen offset:3072 lds
v_mfma_f32_32x32x16_bf16 v[96:111], v[144:147], v[132:135], v[96:111]
ds_read_b64_tr_b16 v[152:153], v192 offset:36864
ds_read_b64_tr_b16 v[154:155], v192 offset:38912
s_add_u32 s43, s45, 98304
s_xor_b32 m0, s43, s69
s_add_u32 s58, s56, 272
s_lshl_b32 s58, s58, 10
s_add_u32 s58, s58, s55
v_mfma_f32_32x32x16_bf16 v[112:127], v[148:151], v[132:135], v[112:127]
ds_read_b64_tr_b16 v[156:157], v193 offset:36864
ds_read_b64_tr_b16 v[158:159], v193 offset:38912
buffer_load_dwordx4 v224, s[4:7], s58 offen offset:0 lds
s_waitcnt lgkmcnt(2)
v_mfma_f32_32x32x16_bf16 v[64:79], v[152:155], v[136:139], v[64:79]
ds_read_b128 v[128:131], v232 offset:34816
buffer_load_dwordx4 v224, s[4:7], s58 offen offset:1024 lds
s_waitcnt lgkmcnt(1)
v_mfma_f32_32x32x16_bf16 v[80:95], v[156:159], v[136:139], v[80:95]
ds_read_b128 v[132:135], v232 offset:38912
buffer_load_dwordx4 v224, s[4:7], s58 offen offset:2048 lds
v_mfma_f32_32x32x16_bf16 v[96:111], v[152:155], v[140:143], v[96:111]
ds_read_b64_tr_b16 v[144:145], v192 offset:40960
ds_read_b64_tr_b16 v[146:147], v192 offset:43008
buffer_load_dwordx4 v224, s[4:7], s58 offen offset:3072 lds
v_mfma_f32_32x32x16_bf16 v[112:127], v[156:159], v[140:143], v[112:127]
ds_read_b64_tr_b16 v[148:149], v193 offset:40960
ds_read_b64_tr_b16 v[150:151], v193 offset:43008
s_waitcnt lgkmcnt(2)
v_mfma_f32_32x32x16_bf16 v[64:79], v[144:147], v[128:131], v[64:79]
ds_read_b128 v[136:139], v232 offset:35840
s_waitcnt lgkmcnt(1)
v_mfma_f32_32x32x16_bf16 v[80:95], v[148:151], v[128:131], v[80:95]
ds_read_b128 v[140:143], v232 offset:39936
v_mfma_f32_32x32x16_bf16 v[96:111], v[144:147], v[132:135], v[96:111]
ds_read_b64_tr_b16 v[152:153], v192 offset:45056
ds_read_b64_tr_b16 v[154:155], v192 offset:47104
v_mfma_f32_32x32x16_bf16 v[112:127], v[148:151], v[132:135], v[112:127]
ds_read_b64_tr_b16 v[156:157], v193 offset:45056
ds_read_b64_tr_b16 v[158:159], v193 offset:47104
s_waitcnt lgkmcnt(2)
v_mfma_f32_32x32x16_bf16 v[64:79], v[152:155], v[136:139], v[64:79]
s_waitcnt vmcnt(29)
s_waitcnt vmcnt(21)
s_barrier
s_cmp_lg_u32 s38, 0
s_cbranch_scc1 L_w0_69
s_lshl_b32 s42, s67, 7
s_add_u32 s42, s42, 0x3910000
v_mov_b32 v61, s42
v_mov_b32 v62, s71
s_mov_b64 s[64:65], exec
s_mov_b64 exec, 1
buffer_store_dword v62, v61, s[16:19], 0 offen sc1
s_mov_b64 exec, s[64:65]
L_w0_69:
ds_read_b128 v[128:131], v233 offset:0
s_waitcnt lgkmcnt(1)
v_mfma_f32_32x32x16_bf16 v[80:95], v[156:159], v[136:139], v[80:95]
ds_read_b128 v[132:135], v233 offset:4096
s_lshr_b32 s43, s45, 1
s_add_u32 s43, s43, 16384
s_xor_b32 m0, s43, s69
s_add_u32 s59, s56, 20
s_lshl_b32 s59, s59, 14
s_cmp_eq_u32 s52, 3
s_cselect_b32 s59, s57, s59
v_mfma_f32_32x32x16_bf16 v[96:111], v[152:155], v[140:143], v[96:111]
ds_read_b64_tr_b16 v[144:145], v194 offset:0
ds_read_b64_tr_b16 v[146:147], v194 offset:2048
buffer_load_dwordx4 v230, s[12:15], s59 offen offset:0 lds
v_mfma_f32_32x32x16_bf16 v[112:127], v[156:159], v[140:143], v[112:127]
ds_read_b64_tr_b16 v[148:149], v195 offset:0
ds_read_b64_tr_b16 v[150:151], v195 offset:2048
buffer_load_dwordx4 v231, s[12:15], s59 offen offset:1024 lds
s_waitcnt lgkmcnt(2)
v_mfma_f32_32x32x16_bf16 v[64:79], v[144:147], v[128:131], v[64:79]
ds_read_b128 v[136:139], v233 offset:1024
s_add_u32 s43, s45, 0
s_xor_b32 m0, s43, s69
s_add_u32 s58, s56, 276
s_lshl_b32 s58, s58, 10
s_add_u32 s58, s58, s55
s_cmp_eq_u32 s52, 3
s_cselect_b32 s58, s57, s58
s_waitcnt lgkmcnt(1)
v_mfma_f32_32x32x16_bf16 v[80:95], v[148:151], v[128:131], v[80:95]
ds_read_b128 v[140:143], v233 offset:5120
buffer_load_dwordx4 v224, s[4:7], s58 offen offset:0 lds
v_mfma_f32_32x32x16_bf16 v[96:111], v[144:147], v[132:135], v[96:111]
ds_read_b64_tr_b16 v[152:153], v194 offset:4096
ds_read_b64_tr_b16 v[154:155], v194 offset:6144
buffer_load_dwordx4 v224, s[4:7], s58 offen offset:1024 lds
v_mfma_f32_32x32x16_bf16 v[112:127], v[148:151], v[132:135], v[112:127]
ds_read_b64_tr_b16 v[156:157], v195 offset:4096
ds_read_b64_tr_b16 v[158:159], v195 offset:6144
s_waitcnt lgkmcnt(2)
v_mfma_f32_32x32x16_bf16 v[64:79], v[152:155], v[136:139], v[64:79]
ds_read_b128 v[128:131], v233 offset:2048
s_waitcnt lgkmcnt(1)
v_mfma_f32_32x32x16_bf16 v[80:95], v[156:159], v[136:139], v[80:95]
ds_read_b128 v[132:135], v233 offset:6144
v_mfma_f32_32x32x16_bf16 v[96:111], v[152:155], v[140:143], v[96:111]
ds_read_b64_tr_b16 v[144:145], v194 offset:8192
ds_read_b64_tr_b16 v[146:147], v194 offset:10240
v_mfma_f32_32x32x16_bf16 v[112:127], v[156:159], v[140:143], v[112:127]
ds_read_b64_tr_b16 v[148:149], v195 offset:8192
ds_read_b64_tr_b16 v[150:151], v195 offset:10240
s_waitcnt lgkmcnt(2)
v_mfma_f32_32x32x16_bf16 v[64:79], v[144:147], v[128:131], v[64:79]
ds_read_b128 v[136:139], v233 offset:3072
s_waitcnt lgkmcnt(1)
v_mfma_f32_32x32x16_bf16 v[80:95], v[148:151], v[128:131], v[80:95]
ds_read_b128 v[140:143], v233 offset:7168
v_mfma_f32_32x32x16_bf16 v[96:111], v[144:147], v[132:135], v[96:111]
ds_read_b64_tr_b16 v[152:153], v194 offset:12288
ds_read_b64_tr_b16 v[154:155], v194 offset:14336
v_mfma_f32_32x32x16_bf16 v[112:127], v[148:151], v[132:135], v[112:127]
ds_read_b64_tr_b16 v[156:157], v195 offset:12288
ds_read_b64_tr_b16 v[158:159], v195 offset:14336
s_waitcnt lgkmcnt(2)
v_mfma_f32_32x32x16_bf16 v[64:79], v[152:155], v[136:139], v[64:79]
s_waitcnt vmcnt(12)
s_barrier
s_mov_b64 s[64:65], exec
s_mov_b64 exec, 0xff
buffer_load_dword v209, v208, s[16:19], 0 offen sc1
s_mov_b64 exec, s[64:65]
ds_read_b128 v[128:131], v239 offset:0
s_waitcnt lgkmcnt(1)
v_mfma_f32_32x32x16_bf16 v[80:95], v[156:159], v[136:139], v[80:95]
ds_read_b128 v[132:135], v239 offset:4096
s_add_u32 s43, s45, 49152
s_xor_b32 m0, s43, s69
s_lshl_b32 s59, s52, 20
s_add_u32 s59, s59, 0
v_mfma_f32_32x32x16_bf16 v[96:111], v[152:155], v[140:143], v[96:111]
ds_read_b64_tr_b16 v[144:145], v196 offset:0
ds_read_b64_tr_b16 v[146:147], v196 offset:2048
buffer_load_dwordx4 v226, s[8:11], s59 offen offset:0 lds
v_mfma_f32_32x32x16_bf16 v[112:127], v[156:159], v[140:143], v[112:127]
ds_read_b64_tr_b16 v[148:149], v197 offset:0
ds_read_b64_tr_b16 v[150:151], v197 offset:2048
buffer_load_dwordx4 v227, s[8:11], s59 offen offset:1024 lds
s_waitcnt lgkmcnt(2)
v_mfma_f32_32x32x16_bf16 v[64:79], v[144:147], v[128:131], v[64:79]
ds_read_b128 v[136:139], v239 offset:1024
buffer_load_dwordx4 v228, s[8:11], s59 offen offset:2048 lds
s_waitcnt lgkmcnt(1)
v_mfma_f32_32x32x16_bf16 v[80:95], v[148:151], v[128:131], v[80:95]
ds_read_b128 v[140:143], v239 offset:5120
buffer_load_dwordx4 v229, s[8:11], s59 offen offset:3072 lds
v_mfma_f32_32x32x16_bf16 v[96:111], v[144:147], v[132:135], v[96:111]
ds_read_b64_tr_b16 v[152:153], v196 offset:4096
ds_read_b64_tr_b16 v[154:155], v196 offset:6144
v_mfma_f32_32x32x16_bf16 v[112:127], v[148:151], v[132:135], v[112:127]
ds_read_b64_tr_b16 v[156:157], v197 offset:4096
ds_read_b64_tr_b16 v[158:159], v197 offset:6144
s_waitcnt lgkmcnt(2)
v_mfma_f32_32x32x16_bf16 v[64:79], v[152:155], v[136:139], v[64:79]
ds_read_b128 v[128:131], v239 offset:2048
s_waitcnt lgkmcnt(1)
v_mfma_f32_32x32x16_bf16 v[80:95], v[156:159], v[136:139], v[80:95]
ds_read_b128 v[132:135], v239 offset:6144
v_mfma_f32_32x32x16_bf16 v[96:111], v[152:155], v[140:143], v[96:111]
ds_read_b64_tr_b16 v[144:145], v196 offset:8192
ds_read_b64_tr_b16 v[146:147], v196 offset:10240
v_mfma_f32_32x32x16_bf16 v[112:127], v[156:159], v[140:143], v[112:127]
ds_read_b64_tr_b16 v[148:149], v197 offset:8192
ds_read_b64_tr_b16 v[150:151], v197 offset:10240
s_waitcnt lgkmcnt(2)
v_mfma_f32_32x32x16_bf16 v[64:79], v[144:147], v[128:131], v[64:79]
ds_read_b128 v[136:139], v239 offset:3072
s_waitcnt lgkmcnt(1)
v_mfma_f32_32x32x16_bf16 v[80:95], v[148:151], v[128:131], v[80:95]
ds_read_b128 v[140:143], v239 offset:7168
v_mfma_f32_32x32x16_bf16 v[96:111], v[144:147], v[132:135], v[96:111]
ds_read_b64_tr_b16 v[152:153], v196 offset:12288
ds_read_b64_tr_b16 v[154:155], v196 offset:14336
v_mfma_f32_32x32x16_bf16 v[112:127], v[148:151], v[132:135], v[112:127]
ds_read_b64_tr_b16 v[156:157], v197 offset:12288
ds_read_b64_tr_b16 v[158:159], v197 offset:14336
s_waitcnt lgkmcnt(2)
v_mfma_f32_32x32x16_bf16 v[64:79], v[152:155], v[136:139], v[64:79]
s_waitcnt vmcnt(9)
s_waitcnt vmcnt(4)
s_cmp_lg_u32 s38, 0
s_cbranch_scc1 L_w0_70
v_cmp_eq_u32 vcc, s71, v209
s_nop 1
s_and_b32 s42, vcc_lo, 0xff
s_cmp_eq_u32 s42, 0xff
s_cbranch_scc1 L_fok_71
s_mov_b64 s[64:65], exec
s_mov_b32 exec_lo, 0xff
s_mov_b32 exec_hi, 0x0
L_poll_72:
buffer_load_dword v62, v208, s[16:19], 0 offen sc1
s_waitcnt vmcnt(0)
v_cmp_eq_u32 vcc, s71, v62
s_nop 1
s_cmp_eq_u64 vcc, exec
s_cbranch_scc0 L_poll_72
s_mov_b64 exec, s[64:65]
L_fok_71:
L_w0_70:
s_barrier
ds_read_b128 v[128:131], v233 offset:32768
s_waitcnt lgkmcnt(1)
v_mfma_f32_32x32x16_bf16 v[80:95], v[156:159], v[136:139], v[80:95]
ds_read_b128 v[132:135], v233 offset:36864
s_add_u32 s43, s45, 32768
s_xor_b32 m0, s43, s69
s_lshl_b32 s58, s52, 16
s_add_u32 s58, s58, s55
s_add_u32 s58, s58, 0
v_mfma_f32_32x32x16_bf16 v[96:111], v[152:155], v[140:143], v[96:111]
ds_read_b64_tr_b16 v[144:145], v194 offset:32768
ds_read_b64_tr_b16 v[146:147], v194 offset:34816
buffer_load_dwordx4 v224, s[4:7], s58 offen offset:0 lds
v_mfma_f32_32x32x16_bf16 v[112:127], v[156:159], v[140:143], v[112:127]
ds_read_b64_tr_b16 v[148:149], v195 offset:32768
ds_read_b64_tr_b16 v[150:151], v195 offset:34816
buffer_load_dwordx4 v224, s[4:7], s58 offen offset:1024 lds
s_waitcnt lgkmcnt(2)
v_mfma_f32_32x32x16_bf16 v[64:79], v[144:147], v[128:131], v[64:79]
ds_read_b128 v[136:139], v233 offset:33792
buffer_load_dwordx4 v224, s[4:7], s58 offen offset:2048 lds
s_waitcnt lgkmcnt(1)
v_mfma_f32_32x32x16_bf16 v[80:95], v[148:151], v[128:131], v[80:95]
ds_read_b128 v[140:143], v233 offset:37888
buffer_load_dwordx4 v224, s[4:7], s58 offen offset:3072 lds
v_mfma_f32_32x32x16_bf16 v[96:111], v[144:147], v[132:135], v[96:111]
ds_read_b64_tr_b16 v[152:153], v194 offset:36864
ds_read_b64_tr_b16 v[154:155], v194 offset:38912
s_add_u32 s43, s45, 81920
s_xor_b32 m0, s43, s69
s_lshl_b32 s59, s52, 20
s_add_u32 s59, s59, 65536
v_mfma_f32_32x32x16_bf16 v[112:127], v[148:151], v[132:135], v[112:127]
ds_read_b64_tr_b16 v[156:157], v195 offset:36864
ds_read_b64_tr_b16 v[158:159], v195 offset:38912
buffer_load_dwordx4 v226, s[8:11], s59 offen offset:0 lds
s_waitcnt lgkmcnt(2)
v_mfma_f32_32x32x16_bf16 v[64:79], v[152:155], v[136:139], v[64:79]
ds_read_b128 v[128:131], v233 offset:34816
buffer_load_dwordx4 v227, s[8:11], s59 offen offset:1024 lds
s_waitcnt lgkmcnt(1)
v_mfma_f32_32x32x16_bf16 v[80:95], v[156:159], v[136:139], v[80:95]
ds_read_b128 v[132:135], v233 offset:38912
buffer_load_dwordx4 v228, s[8:11], s59 offen offset:2048 lds
v_mfma_f32_32x32x16_bf16 v[96:111], v[152:155], v[140:143], v[96:111]
ds_read_b64_tr_b16 v[144:145], v194 offset:40960
ds_read_b64_tr_b16 v[146:147], v194 offset:43008
buffer_load_dwordx4 v229, s[8:11], s59 offen offset:3072 lds
v_mfma_f32_32x32x16_bf16 v[112:127], v[156:159], v[140:143], v[112:127]
ds_read_b64_tr_b16 v[148:149], v195 offset:40960
ds_read_b64_tr_b16 v[150:151], v195 offset:43008
s_add_u32 s43, s45, 65536
s_xor_b32 m0, s43, s69
s_lshl_b32 s58, s52, 16
s_add_u32 s58, s58, s55
s_add_u32 s58, s58, 4096
s_waitcnt lgkmcnt(2)
v_mfma_f32_32x32x16_bf16 v[64:79], v[144:147], v[128:131], v[64:79]
ds_read_b128 v[136:139], v233 offset:35840
buffer_load_dwordx4 v224, s[4:7], s58 offen offset:0 lds
s_waitcnt lgkmcnt(1)
v_mfma_f32_32x32x16_bf16 v[80:95], v[148:151], v[128:131], v[80:95]
ds_read_b128 v[140:143], v233 offset:39936
buffer_load_dwordx4 v224, s[4:7], s58 offen offset:1024 lds
v_mfma_f32_32x32x16_bf16 v[96:111], v[144:147], v[132:135], v[96:111]
ds_read_b64_tr_b16 v[152:153], v194 offset:45056
ds_read_b64_tr_b16 v[154:155], v194 offset:47104
buffer_load_dwordx4 v224, s[4:7], s58 offen offset:2048 lds
v_mfma_f32_32x32x16_bf16 v[112:127], v[148:151], v[132:135], v[112:127]
ds_read_b64_tr_b16 v[156:157], v195 offset:45056
ds_read_b64_tr_b16 v[158:159], v195 offset:47104
buffer_load_dwordx4 v224, s[4:7], s58 offen offset:3072 lds
s_waitcnt lgkmcnt(2)
v_mfma_f32_32x32x16_bf16 v[64:79], v[152:155], v[136:139], v[64:79]
s_barrier
ds_read_b128 v[128:131], v232 offset:0
s_waitcnt lgkmcnt(1)
v_mfma_f32_32x32x16_bf16 v[80:95], v[156:159], v[136:139], v[80:95]
ds_read_b128 v[132:135], v232 offset:4096
s_add_u32 s43, s45, 147456
s_mov_b32 m0, s43
s_lshl_b32 s59, s52, 20
s_add_u32 s59, s59, 131072
v_mfma_f32_32x32x16_bf16 v[96:111], v[152:155], v[140:143], v[96:111]
ds_read_b64_tr_b16 v[144:145], v192 offset:0
ds_read_b64_tr_b16 v[146:147], v192 offset:2048
buffer_load_dwordx4 v226, s[8:11], s59 offen offset:0 lds
v_mfma_f32_32x32x16_bf16 v[112:127], v[156:159], v[140:143], v[112:127]
ds_read_b64_tr_b16 v[148:149], v193 offset:0
ds_read_b64_tr_b16 v[150:151], v193 offset:2048
buffer_load_dwordx4 v227, s[8:11], s59 offen offset:1024 lds
s_waitcnt lgkmcnt(2)
v_mfma_f32_32x32x16_bf16 v[64:79], v[144:147], v[128:131], v[64:79]
ds_read_b128 v[136:139], v232 offset:1024
buffer_load_dwordx4 v228, s[8:11], s59 offen offset:2048 lds
s_waitcnt lgkmcnt(1)
v_mfma_f32_32x32x16_bf16 v[80:95], v[148:151], v[128:131], v[80:95]
ds_read_b128 v[140:143], v232 offset:5120
buffer_load_dwordx4 v229, s[8:11], s59 offen offset:3072 lds
v_mfma_f32_32x32x16_bf16 v[96:111], v[144:147], v[132:135], v[96:111]
ds_read_b64_tr_b16 v[152:153], v192 offset:4096
ds_read_b64_tr_b16 v[154:155], v192 offset:6144
s_add_u32 m0, s45, 131072
s_lshl_b32 s58, s52, 16
s_add_u32 s58, s58, s55
s_add_u32 s58, s58, 8192
v_mfma_f32_32x32x16_bf16 v[112:127], v[148:151], v[132:135], v[112:127]
ds_read_b64_tr_b16 v[156:157], v193 offset:4096
ds_read_b64_tr_b16 v[158:159], v193 offset:6144
buffer_load_dwordx4 v224, s[4:7], s58 offen offset:0 lds
s_waitcnt lgkmcnt(2)
v_mfma_f32_32x32x16_bf16 v[64:79], v[152:155], v[136:139], v[64:79]
s_waitcnt vmcnt(13)
s_barrier
ds_read_b128 v[128:131], v232 offset:32768
buffer_load_dwordx4 v224, s[4:7], s58 offen offset:1024 lds
s_waitcnt lgkmcnt(1)
v_mfma_f32_32x32x16_bf16 v[80:95], v[156:159], v[136:139], v[80:95]
ds_read_b128 v[132:135], v232 offset:36864
buffer_load_dwordx4 v224, s[4:7], s58 offen offset:2048 lds
v_mfma_f32_32x32x16_bf16 v[96:111], v[152:155], v[140:143], v[96:111]
ds_read_b64_tr_b16 v[144:145], v192 offset:32768
ds_read_b64_tr_b16 v[146:147], v192 offset:34816
buffer_load_dwordx4 v224, s[4:7], s58 offen offset:3072 lds
v_mfma_f32_32x32x16_bf16 v[112:127], v[156:159], v[140:143], v[112:127]
ds_read_b64_tr_b16 v[148:149], v193 offset:32768
ds_read_b64_tr_b16 v[150:151], v193 offset:34816
s_add_u32 s43, s45, 114688
s_xor_b32 m0, s43, s69
s_lshl_b32 s59, s52, 20
s_add_u32 s59, s59, 196608
s_waitcnt lgkmcnt(2)
v_mfma_f32_32x32x16_bf16 v[64:79], v[144:147], v[128:131], v[64:79]
ds_read_b128 v[136:139], v232 offset:33792
buffer_load_dwordx4 v226, s[8:11], s59 offen offset:0 lds
s_waitcnt lgkmcnt(1)
v_mfma_f32_32x32x16_bf16 v[80:95], v[148:151], v[128:131], v[80:95]
ds_read_b128 v[140:143], v232 offset:37888
buffer_load_dwordx4 v227, s[8:11], s59 offen offset:1024 lds
v_mfma_f32_32x32x16_bf16 v[96:111], v[144:147], v[132:135], v[96:111]
ds_read_b64_tr_b16 v[152:153], v192 offset:36864
ds_read_b64_tr_b16 v[154:155], v192 offset:38912
buffer_load_dwordx4 v228, s[8:11], s59 offen offset:2048 lds
v_mfma_f32_32x32x16_bf16 v[112:127], v[148:151], v[132:135], v[112:127]
ds_read_b64_tr_b16 v[156:157], v193 offset:36864
ds_read_b64_tr_b16 v[158:159], v193 offset:38912
buffer_load_dwordx4 v229, s[8:11], s59 offen offset:3072 lds
s_waitcnt lgkmcnt(2)
v_mfma_f32_32x32x16_bf16 v[64:79], v[152:155], v[136:139], v[64:79]
ds_read_b128 v[128:131], v232 offset:34816
s_add_u32 s43, s45, 98304
s_xor_b32 m0, s43, s69
s_lshl_b32 s58, s52, 16
s_add_u32 s58, s58, s55
s_add_u32 s58, s58, 12288
s_waitcnt lgkmcnt(1)
v_mfma_f32_32x32x16_bf16 v[80:95], v[156:159], v[136:139], v[80:95]
ds_read_b128 v[132:135], v232 offset:38912
buffer_load_dwordx4 v224, s[4:7], s58 offen offset:0 lds
v_mfma_f32_32x32x16_bf16 v[96:111], v[152:155], v[140:143], v[96:111]
ds_read_b64_tr_b16 v[144:145], v192 offset:40960
ds_read_b64_tr_b16 v[146:147], v192 offset:43008
buffer_load_dwordx4 v224, s[4:7], s58 offen offset:1024 lds
v_mfma_f32_32x32x16_bf16 v[112:127], v[156:159], v[140:143], v[112:127]
ds_read_b64_tr_b16 v[148:149], v193 offset:40960
ds_read_b64_tr_b16 v[150:151], v193 offset:43008
buffer_load_dwordx4 v224, s[4:7], s58 offen offset:2048 lds
s_waitcnt lgkmcnt(2)
v_mfma_f32_32x32x16_bf16 v[64:79], v[144:147], v[128:131], v[64:79]
ds_read_b128 v[136:139], v232 offset:35840
buffer_load_dwordx4 v224, s[4:7], s58 offen offset:3072 lds
s_waitcnt lgkmcnt(1)
v_mfma_f32_32x32x16_bf16 v[80:95], v[148:151], v[128:131], v[80:95]
ds_read_b128 v[140:143], v232 offset:39936
v_mfma_f32_32x32x16_bf16 v[96:111], v[144:147], v[132:135], v[96:111]
ds_read_b64_tr_b16 v[152:153], v192 offset:45056
ds_read_b64_tr_b16 v[154:155], v192 offset:47104
v_mfma_f32_32x32x16_bf16 v[112:127], v[148:151], v[132:135], v[112:127]
ds_read_b64_tr_b16 v[156:157], v193 offset:45056
ds_read_b64_tr_b16 v[158:159], v193 offset:47104
s_waitcnt lgkmcnt(2)
v_mfma_f32_32x32x16_bf16 v[64:79], v[152:155], v[136:139], v[64:79]
s_waitcnt vmcnt(16)
s_barrier
ds_read_b128 v[128:131], v233 offset:0
s_waitcnt lgkmcnt(1)
v_mfma_f32_32x32x16_bf16 v[80:95], v[156:159], v[136:139], v[80:95]
ds_read_b128 v[132:135], v233 offset:4096
s_add_u32 s43, s45, 16384
s_xor_b32 m0, s43, s69
s_lshl_b32 s59, s52, 20
s_add_u32 s59, s59, 262144
v_mfma_f32_32x32x16_bf16 v[96:111], v[152:155], v[140:143], v[96:111]
ds_read_b64_tr_b16 v[144:145], v194 offset:0
ds_read_b64_tr_b16 v[146:147], v194 offset:2048
buffer_load_dwordx4 v226, s[8:11], s59 offen offset:0 lds
v_mfma_f32_32x32x16_bf16 v[112:127], v[156:159], v[140:143], v[112:127]
ds_read_b64_tr_b16 v[148:149], v195 offset:0
ds_read_b64_tr_b16 v[150:151], v195 offset:2048
buffer_load_dwordx4 v227, s[8:11], s59 offen offset:1024 lds
s_waitcnt lgkmcnt(2)
v_mfma_f32_32x32x16_bf16 v[64:79], v[144:147], v[128:131], v[64:79]
ds_read_b128 v[136:139], v233 offset:1024
buffer_load_dwordx4 v228, s[8:11], s59 offen offset:2048 lds
s_waitcnt lgkmcnt(1)
v_mfma_f32_32x32x16_bf16 v[80:95], v[148:151], v[128:131], v[80:95]
ds_read_b128 v[140:143], v233 offset:5120
buffer_load_dwordx4 v229, s[8:11], s59 offen offset:3072 lds
v_mfma_f32_32x32x16_bf16 v[96:111], v[144:147], v[132:135], v[96:111]
ds_read_b64_tr_b16 v[152:153], v194 offset:4096
ds_read_b64_tr_b16 v[154:155], v194 offset:6144
s_add_u32 s43, s45, 0
s_xor_b32 m0, s43, s69
s_lshl_b32 s58, s52, 16
s_add_u32 s58, s58, s55
s_add_u32 s58, s58, 16384
v_mfma_f32_32x32x16_bf16 v[112:127], v[148:151], v[132:135], v[112:127]
ds_read_b64_tr_b16 v[156:157], v195 offset:4096
ds_read_b64_tr_b16 v[158:159], v195 offset:6144
buffer_load_dwordx4 v224, s[4:7], s58 offen offset:0 lds
s_waitcnt lgkmcnt(2)
v_mfma_f32_32x32x16_bf16 v[64:79], v[152:155], v[136:139], v[64:79]
ds_read_b128 v[128:131], v233 offset:2048
buffer_load_dwordx4 v224, s[4:7], s58 offen offset:1024 lds
s_waitcnt lgkmcnt(1)
v_mfma_f32_32x32x16_bf16 v[80:95], v[156:159], v[136:139], v[80:95]
ds_read_b128 v[132:135], v233 offset:6144
buffer_load_dwordx4 v224, s[4:7], s58 offen offset:2048 lds
v_mfma_f32_32x32x16_bf16 v[96:111], v[152:155], v[140:143], v[96:111]
ds_read_b64_tr_b16 v[144:145], v194 offset:8192
ds_read_b64_tr_b16 v[146:147], v194 offset:10240
buffer_load_dwordx4 v224, s[4:7], s58 offen offset:3072 lds
v_mfma_f32_32x32x16_bf16 v[112:127], v[156:159], v[140:143], v[112:127]
ds_read_b64_tr_b16 v[148:149], v195 offset:8192
ds_read_b64_tr_b16 v[150:151], v195 offset:10240
s_waitcnt lgkmcnt(2)
v_mfma_f32_32x32x16_bf16 v[64:79], v[144:147], v[128:131], v[64:79]
ds_read_b128 v[136:139], v233 offset:3072
s_waitcnt lgkmcnt(1)
v_mfma_f32_32x32x16_bf16 v[80:95], v[148:151], v[128:131], v[80:95]
ds_read_b128 v[140:143], v233 offset:7168
v_mfma_f32_32x32x16_bf16 v[96:111], v[144:147], v[132:135], v[96:111]
ds_read_b64_tr_b16 v[152:153], v194 offset:12288
ds_read_b64_tr_b16 v[154:155], v194 offset:14336
v_mfma_f32_32x32x16_bf16 v[112:127], v[148:151], v[132:135], v[112:127]
ds_read_b64_tr_b16 v[156:157], v195 offset:12288
ds_read_b64_tr_b16 v[158:159], v195 offset:14336
s_waitcnt lgkmcnt(2)
v_mfma_f32_32x32x16_bf16 v[64:79], v[152:155], v[136:139], v[64:79]
s_waitcnt vmcnt(16)
s_barrier
ds_read_b128 v[128:131], v239 offset:0
s_waitcnt lgkmcnt(1)
v_mfma_f32_32x32x16_bf16 v[80:95], v[156:159], v[136:139], v[80:95]
ds_read_b128 v[132:135], v239 offset:4096
s_add_u32 s43, s45, 49152
s_xor_b32 m0, s43, s69
s_lshl_b32 s59, s52, 20
s_add_u32 s59, s59, 327680
v_mfma_f32_32x32x16_bf16 v[96:111], v[152:155], v[140:143], v[96:111]
ds_read_b64_tr_b16 v[144:145], v196 offset:0
ds_read_b64_tr_b16 v[146:147], v196 offset:2048
buffer_load_dwordx4 v226, s[8:11], s59 offen offset:0 lds
v_mfma_f32_32x32x16_bf16 v[112:127], v[156:159], v[140:143], v[112:127]
ds_read_b64_tr_b16 v[148:149], v197 offset:0
ds_read_b64_tr_b16 v[150:151], v197 offset:2048
buffer_load_dwordx4 v227, s[8:11], s59 offen offset:1024 lds
s_waitcnt lgkmcnt(2)
v_mfma_f32_32x32x16_bf16 v[64:79], v[144:147], v[128:131], v[64:79]
ds_read_b128 v[136:139], v239 offset:1024
buffer_load_dwordx4 v228, s[8:11], s59 offen offset:2048 lds
s_waitcnt lgkmcnt(1)
v_mfma_f32_32x32x16_bf16 v[80:95], v[148:151], v[128:131], v[80:95]
ds_read_b128 v[140:143], v239 offset:5120
buffer_load_dwordx4 v229, s[8:11], s59 offen offset:3072 lds
v_mfma_f32_32x32x16_bf16 v[96:111], v[144:147], v[132:135], v[96:111]
ds_read_b64_tr_b16 v[152:153], v196 offset:4096
ds_read_b64_tr_b16 v[154:155], v196 offset:6144
s_add_u32 s43, s45, 32768
s_xor_b32 m0, s43, s69
s_lshl_b32 s58, s52, 16
s_add_u32 s58, s58, s55
s_add_u32 s58, s58, 20480
v_mfma_f32_32x32x16_bf16 v[112:127], v[148:151], v[132:135], v[112:127]
ds_read_b64_tr_b16 v[156:157], v197 offset:4096
ds_read_b64_tr_b16 v[158:159], v197 offset:6144
buffer_load_dwordx4 v224, s[4:7], s58 offen offset:0 lds
s_waitcnt lgkmcnt(2)
v_mfma_f32_32x32x16_bf16 v[64:79], v[152:155], v[136:139], v[64:79]
ds_read_b128 v[128:131], v239 offset:2048
buffer_load_dwordx4 v224, s[4:7], s58 offen offset:1024 lds
s_waitcnt lgkmcnt(1)
v_mfma_f32_32x32x16_bf16 v[80:95], v[156:159], v[136:139], v[80:95]
ds_read_b128 v[132:135], v239 offset:6144
buffer_load_dwordx4 v224, s[4:7], s58 offen offset:2048 lds
v_mfma_f32_32x32x16_bf16 v[96:111], v[152:155], v[140:143], v[96:111]
ds_read_b64_tr_b16 v[144:145], v196 offset:8192
ds_read_b64_tr_b16 v[146:147], v196 offset:10240
buffer_load_dwordx4 v224, s[4:7], s58 offen offset:3072 lds
v_mfma_f32_32x32x16_bf16 v[112:127], v[156:159], v[140:143], v[112:127]
ds_read_b64_tr_b16 v[148:149], v197 offset:8192
ds_read_b64_tr_b16 v[150:151], v197 offset:10240
s_waitcnt lgkmcnt(2)
v_mfma_f32_32x32x16_bf16 v[64:79], v[144:147], v[128:131], v[64:79]
ds_read_b128 v[136:139], v239 offset:3072
s_waitcnt lgkmcnt(1)
v_mfma_f32_32x32x16_bf16 v[80:95], v[148:151], v[128:131], v[80:95]
ds_read_b128 v[140:143], v239 offset:7168
v_mfma_f32_32x32x16_bf16 v[96:111], v[144:147], v[132:135], v[96:111]
ds_read_b64_tr_b16 v[152:153], v196 offset:12288
ds_read_b64_tr_b16 v[154:155], v196 offset:14336
v_mfma_f32_32x32x16_bf16 v[112:127], v[148:151], v[132:135], v[112:127]
ds_read_b64_tr_b16 v[156:157], v197 offset:12288
ds_read_b64_tr_b16 v[158:159], v197 offset:14336
s_waitcnt lgkmcnt(2)
v_mfma_f32_32x32x16_bf16 v[64:79], v[152:155], v[136:139], v[64:79]
s_waitcnt vmcnt(16)
s_barrier
ds_read_b128 v[128:131], v233 offset:32768
s_waitcnt lgkmcnt(1)
v_mfma_f32_32x32x16_bf16 v[80:95], v[156:159], v[136:139], v[80:95]
ds_read_b128 v[132:135], v233 offset:36864
s_add_u32 s43, s45, 81920
s_xor_b32 m0, s43, s69
s_lshl_b32 s59, s52, 20
s_add_u32 s59, s59, 393216
v_mfma_f32_32x32x16_bf16 v[96:111], v[152:155], v[140:143], v[96:111]
ds_read_b64_tr_b16 v[144:145], v194 offset:32768
ds_read_b64_tr_b16 v[146:147], v194 offset:34816
buffer_load_dwordx4 v226, s[8:11], s59 offen offset:0 lds
v_mfma_f32_32x32x16_bf16 v[112:127], v[156:159], v[140:143], v[112:127]
ds_read_b64_tr_b16 v[148:149], v195 offset:32768
ds_read_b64_tr_b16 v[150:151], v195 offset:34816
buffer_load_dwordx4 v227, s[8:11], s59 offen offset:1024 lds
s_waitcnt lgkmcnt(2)
v_mfma_f32_32x32x16_bf16 v[64:79], v[144:147], v[128:131], v[64:79]
ds_read_b128 v[136:139], v233 offset:33792
buffer_load_dwordx4 v228, s[8:11], s59 offen offset:2048 lds
s_waitcnt lgkmcnt(1)
v_mfma_f32_32x32x16_bf16 v[80:95], v[148:151], v[128:131], v[80:95]
ds_read_b128 v[140:143], v233 offset:37888
buffer_load_dwordx4 v229, s[8:11], s59 offen offset:3072 lds
v_mfma_f32_32x32x16_bf16 v[96:111], v[144:147], v[132:135], v[96:111]
ds_read_b64_tr_b16 v[152:153], v194 offset:36864
ds_read_b64_tr_b16 v[154:155], v194 offset:38912
s_add_u32 s43, s45, 65536
s_xor_b32 m0, s43, s69
s_lshl_b32 s58, s52, 16
s_add_u32 s58, s58, s55
s_add_u32 s58, s58, 24576
v_mfma_f32_32x32x16_bf16 v[112:127], v[148:151], v[132:135], v[112:127]
ds_read_b64_tr_b16 v[156:157], v195 offset:36864
ds_read_b64_tr_b16 v[158:159], v195 offset:38912
buffer_load_dwordx4 v224, s[4:7], s58 offen offset:0 lds
s_waitcnt lgkmcnt(2)
v_mfma_f32_32x32x16_bf16 v[64:79], v[152:155], v[136:139], v[64:79]
ds_read_b128 v[128:131], v233 offset:34816
buffer_load_dwordx4 v224, s[4:7], s58 offen offset:1024 lds
s_waitcnt lgkmcnt(1)
v_mfma_f32_32x32x16_bf16 v[80:95], v[156:159], v[136:139], v[80:95]
ds_read_b128 v[132:135], v233 offset:38912
buffer_load_dwordx4 v224, s[4:7], s58 offen offset:2048 lds
v_mfma_f32_32x32x16_bf16 v[96:111], v[152:155], v[140:143], v[96:111]
ds_read_b64_tr_b16 v[144:145], v194 offset:40960
ds_read_b64_tr_b16 v[146:147], v194 offset:43008
buffer_load_dwordx4 v224, s[4:7], s58 offen offset:3072 lds
v_mfma_f32_32x32x16_bf16 v[112:127], v[156:159], v[140:143], v[112:127]
ds_read_b64_tr_b16 v[148:149], v195 offset:40960
ds_read_b64_tr_b16 v[150:151], v195 offset:43008
s_waitcnt lgkmcnt(2)
v_mfma_f32_32x32x16_bf16 v[64:79], v[144:147], v[128:131], v[64:79]
ds_read_b128 v[136:139], v233 offset:35840
s_waitcnt lgkmcnt(1)
v_mfma_f32_32x32x16_bf16 v[80:95], v[148:151], v[128:131], v[80:95]
ds_read_b128 v[140:143], v233 offset:39936
v_mfma_f32_32x32x16_bf16 v[96:111], v[144:147], v[132:135], v[96:111]
ds_read_b64_tr_b16 v[152:153], v194 offset:45056
ds_read_b64_tr_b16 v[154:155], v194 offset:47104
v_mfma_f32_32x32x16_bf16 v[112:127], v[148:151], v[132:135], v[112:127]
ds_read_b64_tr_b16 v[156:157], v195 offset:45056
ds_read_b64_tr_b16 v[158:159], v195 offset:47104
s_waitcnt lgkmcnt(2)
v_mfma_f32_32x32x16_bf16 v[64:79], v[152:155], v[136:139], v[64:79]
s_waitcnt vmcnt(16)
s_barrier
ds_read_b128 v[128:131], v232 offset:0
s_waitcnt lgkmcnt(1)
v_mfma_f32_32x32x16_bf16 v[80:95], v[156:159], v[136:139], v[80:95]
ds_read_b128 v[132:135], v232 offset:4096
s_add_u32 s43, s45, 147456
s_mov_b32 m0, s43
s_lshl_b32 s59, s52, 20
s_add_u32 s59, s59, 458752
v_mfma_f32_32x32x16_bf16 v[96:111], v[152:155], v[140:143], v[96:111]
ds_read_b64_tr_b16 v[144:145], v192 offset:0
ds_read_b64_tr_b16 v[146:147], v192 offset:2048
buffer_load_dwordx4 v226, s[8:11], s59 offen offset:0 lds
v_mfma_f32_32x32x16_bf16 v[112:127], v[156:159], v[140:143], v[112:127]
ds_read_b64_tr_b16 v[148:149], v193 offset:0
ds_read_b64_tr_b16 v[150:151], v193 offset:2048
buffer_load_dwordx4 v227, s[8:11], s59 offen offset:1024 lds
s_waitcnt lgkmcnt(2)
v_mfma_f32_32x32x16_bf16 v[64:79], v[144:147], v[128:131], v[64:79]
ds_read_b128 v[136:139], v232 offset:1024
buffer_load_dwordx4 v228, s[8:11], s59 offen offset:2048 lds
s_waitcnt lgkmcnt(1)
v_mfma_f32_32x32x16_bf16 v[80:95], v[148:151], v[128:131], v[80:95]
ds_read_b128 v[140:143], v232 offset:5120
buffer_load_dwordx4 v229, s[8:11], s59 offen offset:3072 lds
v_mfma_f32_32x32x16_bf16 v[96:111], v[144:147], v[132:135], v[96:111]
ds_read_b64_tr_b16 v[152:153], v192 offset:4096
ds_read_b64_tr_b16 v[154:155], v192 offset:6144
s_add_u32 m0, s45, 131072
s_lshl_b32 s58, s52, 16
s_add_u32 s58, s58, s55
s_add_u32 s58, s58, 28672
v_mfma_f32_32x32x16_bf16 v[112:127], v[148:151], v[132:135], v[112:127]
ds_read_b64_tr_b16 v[156:157], v193 offset:4096
ds_read_b64_tr_b16 v[158:159], v193 offset:6144
buffer_load_dwordx4 v224, s[4:7], s58 offen offset:0 lds
s_waitcnt lgkmcnt(2)
v_mfma_f32_32x32x16_bf16 v[64:79], v[152:155], v[136:139], v[64:79]
ds_read_b128 v[128:131], v232 offset:2048
buffer_load_dwordx4 v224, s[4:7], s58 offen offset:1024 lds
s_waitcnt lgkmcnt(1)
v_mfma_f32_32x32x16_bf16 v[80:95], v[156:159], v[136:139], v[80:95]
ds_read_b128 v[132:135], v232 offset:6144
buffer_load_dwordx4 v224, s[4:7], s58 offen offset:2048 lds
v_mfma_f32_32x32x16_bf16 v[96:111], v[152:155], v[140:143], v[96:111]
ds_read_b64_tr_b16 v[144:145], v192 offset:8192
ds_read_b64_tr_b16 v[146:147], v192 offset:10240
buffer_load_dwordx4 v224, s[4:7], s58 offen offset:3072 lds
v_mfma_f32_32x32x16_bf16 v[112:127], v[156:159], v[140:143], v[112:127]
ds_read_b64_tr_b16 v[148:149], v193 offset:8192
ds_read_b64_tr_b16 v[150:151], v193 offset:10240
s_waitcnt lgkmcnt(2)
v_mfma_f32_32x32x16_bf16 v[64:79], v[144:147], v[128:131], v[64:79]
ds_read_b128 v[136:139], v232 offset:3072
s_waitcnt lgkmcnt(1)
v_mfma_f32_32x32x16_bf16 v[80:95], v[148:151], v[128:131], v[80:95]
ds_read_b128 v[140:143], v232 offset:7168
v_mfma_f32_32x32x16_bf16 v[96:111], v[144:147], v[132:135], v[96:111]
ds_read_b64_tr_b16 v[152:153], v192 offset:12288
ds_read_b64_tr_b16 v[154:155], v192 offset:14336
v_mfma_f32_32x32x16_bf16 v[112:127], v[148:151], v[132:135], v[112:127]
ds_read_b64_tr_b16 v[156:157], v193 offset:12288
ds_read_b64_tr_b16 v[158:159], v193 offset:14336
s_waitcnt lgkmcnt(2)
v_mfma_f32_32x32x16_bf16 v[64:79], v[152:155], v[136:139], v[64:79]
s_waitcnt vmcnt(16)
s_barrier
ds_read_b128 v[128:131], v232 offset:32768
s_waitcnt lgkmcnt(1)
v_mfma_f32_32x32x16_bf16 v[80:95], v[156:159], v[136:139], v[80:95]
ds_read_b128 v[132:135], v232 offset:36864
s_add_u32 s43, s45, 114688
s_xor_b32 m0, s43, s69
s_lshl_b32 s59, s52, 20
s_add_u32 s59, s59, 524288
v_mfma_f32_32x32x16_bf16 v[96:111], v[152:155], v[140:143], v[96:111]
ds_read_b64_tr_b16 v[144:145], v192 offset:32768
ds_read_b64_tr_b16 v[146:147], v192 offset:34816
buffer_load_dwordx4 v226, s[8:11], s59 offen offset:0 lds
v_mfma_f32_32x32x16_bf16 v[112:127], v[156:159], v[140:143], v[112:127]
ds_read_b64_tr_b16 v[148:149], v193 offset:32768
ds_read_b64_tr_b16 v[150:151], v193 offset:34816
buffer_load_dwordx4 v227, s[8:11], s59 offen offset:1024 lds
s_waitcnt lgkmcnt(2)
v_mfma_f32_32x32x16_bf16 v[64:79], v[144:147], v[128:131], v[64:79]
ds_read_b128 v[136:139], v232 offset:33792
buffer_load_dwordx4 v228, s[8:11], s59 offen offset:2048 lds
s_waitcnt lgkmcnt(1)
v_mfma_f32_32x32x16_bf16 v[80:95], v[148:151], v[128:131], v[80:95]
ds_read_b128 v[140:143], v232 offset:37888
buffer_load_dwordx4 v229, s[8:11], s59 offen offset:3072 lds
v_mfma_f32_32x32x16_bf16 v[96:111], v[144:147], v[132:135], v[96:111]
ds_read_b64_tr_b16 v[152:153], v192 offset:36864
ds_read_b64_tr_b16 v[154:155], v192 offset:38912
s_add_u32 s43, s45, 98304
s_xor_b32 m0, s43, s69
s_lshl_b32 s58, s52, 16
s_add_u32 s58, s58, s55
s_add_u32 s58, s58, 32768
v_mfma_f32_32x32x16_bf16 v[112:127], v[148:151], v[132:135], v[112:127]
ds_read_b64_tr_b16 v[156:157], v193 offset:36864
ds_read_b64_tr_b16 v[158:159], v193 offset:38912
buffer_load_dwordx4 v224, s[4:7], s58 offen offset:0 lds
s_waitcnt lgkmcnt(2)
v_mfma_f32_32x32x16_bf16 v[64:79], v[152:155], v[136:139], v[64:79]
ds_read_b128 v[128:131], v232 offset:34816
buffer_load_dwordx4 v224, s[4:7], s58 offen offset:1024 lds
s_waitcnt lgkmcnt(1)
v_mfma_f32_32x32x16_bf16 v[80:95], v[156:159], v[136:139], v[80:95]
ds_read_b128 v[132:135], v232 offset:38912
buffer_load_dwordx4 v224, s[4:7], s58 offen offset:2048 lds
v_mfma_f32_32x32x16_bf16 v[96:111], v[152:155], v[140:143], v[96:111]
ds_read_b64_tr_b16 v[144:145], v192 offset:40960
ds_read_b64_tr_b16 v[146:147], v192 offset:43008
buffer_load_dwordx4 v224, s[4:7], s58 offen offset:3072 lds
v_mfma_f32_32x32x16_bf16 v[112:127], v[156:159], v[140:143], v[112:127]
ds_read_b64_tr_b16 v[148:149], v193 offset:40960
ds_read_b64_tr_b16 v[150:151], v193 offset:43008
s_waitcnt lgkmcnt(2)
v_mfma_f32_32x32x16_bf16 v[64:79], v[144:147], v[128:131], v[64:79]
ds_read_b128 v[136:139], v232 offset:35840
s_waitcnt lgkmcnt(1)
v_mfma_f32_32x32x16_bf16 v[80:95], v[148:151], v[128:131], v[80:95]
ds_read_b128 v[140:143], v232 offset:39936
v_mfma_f32_32x32x16_bf16 v[96:111], v[144:147], v[132:135], v[96:111]
ds_read_b64_tr_b16 v[152:153], v192 offset:45056
ds_read_b64_tr_b16 v[154:155], v192 offset:47104
v_mfma_f32_32x32x16_bf16 v[112:127], v[148:151], v[132:135], v[112:127]
ds_read_b64_tr_b16 v[156:157], v193 offset:45056
ds_read_b64_tr_b16 v[158:159], v193 offset:47104
s_waitcnt lgkmcnt(2)
v_mfma_f32_32x32x16_bf16 v[64:79], v[152:155], v[136:139], v[64:79]
s_waitcnt vmcnt(16)
s_barrier
ds_read_b128 v[128:131], v233 offset:0
s_waitcnt lgkmcnt(1)
v_mfma_f32_32x32x16_bf16 v[80:95], v[156:159], v[136:139], v[80:95]
ds_read_b128 v[132:135], v233 offset:4096
s_add_u32 s43, s45, 16384
s_xor_b32 m0, s43, s69
s_lshl_b32 s59, s52, 20
s_add_u32 s59, s59, 589824
v_mfma_f32_32x32x16_bf16 v[96:111], v[152:155], v[140:143], v[96:111]
ds_read_b64_tr_b16 v[144:145], v194 offset:0
ds_read_b64_tr_b16 v[146:147], v194 offset:2048
buffer_load_dwordx4 v226, s[8:11], s59 offen offset:0 lds
v_mfma_f32_32x32x16_bf16 v[112:127], v[156:159], v[140:143], v[112:127]
ds_read_b64_tr_b16 v[148:149], v195 offset:0
ds_read_b64_tr_b16 v[150:151], v195 offset:2048
buffer_load_dwordx4 v227, s[8:11], s59 offen offset:1024 lds
s_waitcnt lgkmcnt(2)
v_mfma_f32_32x32x16_bf16 v[64:79], v[144:147], v[128:131], v[64:79]
ds_read_b128 v[136:139], v233 offset:1024
buffer_load_dwordx4 v228, s[8:11], s59 offen offset:2048 lds
s_waitcnt lgkmcnt(1)
v_mfma_f32_32x32x16_bf16 v[80:95], v[148:151], v[128:131], v[80:95]
ds_read_b128 v[140:143], v233 offset:5120
buffer_load_dwordx4 v229, s[8:11], s59 offen offset:3072 lds
v_mfma_f32_32x32x16_bf16 v[96:111], v[144:147], v[132:135], v[96:111]
ds_read_b64_tr_b16 v[152:153], v194 offset:4096
ds_read_b64_tr_b16 v[154:155], v194 offset:6144
s_add_u32 s43, s45, 0
s_xor_b32 m0, s43, s69
s_lshl_b32 s58, s52, 16
s_add_u32 s58, s58, s55
s_add_u32 s58, s58, 36864
v_mfma_f32_32x32x16_bf16 v[112:127], v[148:151], v[132:135], v[112:127]
ds_read_b64_tr_b16 v[156:157], v195 offset:4096
ds_read_b64_tr_b16 v[158:159], v195 offset:6144
buffer_load_dwordx4 v224, s[4:7], s58 offen offset:0 lds
s_waitcnt lgkmcnt(2)
v_mfma_f32_32x32x16_bf16 v[64:79], v[152:155], v[136:139], v[64:79]
ds_read_b128 v[128:131], v233 offset:2048
buffer_load_dwordx4 v224, s[4:7], s58 offen offset:1024 lds
s_waitcnt lgkmcnt(1)
v_mfma_f32_32x32x16_bf16 v[80:95], v[156:159], v[136:139], v[80:95]
ds_read_b128 v[132:135], v233 offset:6144
buffer_load_dwordx4 v224, s[4:7], s58 offen offset:2048 lds
v_mfma_f32_32x32x16_bf16 v[96:111], v[152:155], v[140:143], v[96:111]
ds_read_b64_tr_b16 v[144:145], v194 offset:8192
ds_read_b64_tr_b16 v[146:147], v194 offset:10240
buffer_load_dwordx4 v224, s[4:7], s58 offen offset:3072 lds
v_mfma_f32_32x32x16_bf16 v[112:127], v[156:159], v[140:143], v[112:127]
ds_read_b64_tr_b16 v[148:149], v195 offset:8192
ds_read_b64_tr_b16 v[150:151], v195 offset:10240
s_waitcnt lgkmcnt(2)
v_mfma_f32_32x32x16_bf16 v[64:79], v[144:147], v[128:131], v[64:79]
ds_read_b128 v[136:139], v233 offset:3072
s_waitcnt lgkmcnt(1)
v_mfma_f32_32x32x16_bf16 v[80:95], v[148:151], v[128:131], v[80:95]
ds_read_b128 v[140:143], v233 offset:7168
v_mfma_f32_32x32x16_bf16 v[96:111], v[144:147], v[132:135], v[96:111]
ds_read_b64_tr_b16 v[152:153], v194 offset:12288
ds_read_b64_tr_b16 v[154:155], v194 offset:14336
v_mfma_f32_32x32x16_bf16 v[112:127], v[148:151], v[132:135], v[112:127]
ds_read_b64_tr_b16 v[156:157], v195 offset:12288
ds_read_b64_tr_b16 v[158:159], v195 offset:14336
s_waitcnt lgkmcnt(2)
v_mfma_f32_32x32x16_bf16 v[64:79], v[152:155], v[136:139], v[64:79]
s_waitcnt vmcnt(16)
s_barrier
ds_read_b128 v[128:131], v239 offset:0
s_waitcnt lgkmcnt(1)
v_mfma_f32_32x32x16_bf16 v[80:95], v[156:159], v[136:139], v[80:95]
ds_read_b128 v[132:135], v239 offset:4096
s_add_u32 s43, s45, 49152
s_xor_b32 m0, s43, s69
s_lshl_b32 s59, s52, 20
s_add_u32 s59, s59, 655360
v_mfma_f32_32x32x16_bf16 v[96:111], v[152:155], v[140:143], v[96:111]
ds_read_b64_tr_b16 v[144:145], v196 offset:0
ds_read_b64_tr_b16 v[146:147], v196 offset:2048
buffer_load_dwordx4 v226, s[8:11], s59 offen offset:0 lds
v_mfma_f32_32x32x16_bf16 v[112:127], v[156:159], v[140:143], v[112:127]
ds_read_b64_tr_b16 v[148:149], v197 offset:0
ds_read_b64_tr_b16 v[150:151], v197 offset:2048
buffer_load_dwordx4 v227, s[8:11], s59 offen offset:1024 lds
s_waitcnt lgkmcnt(2)
v_mfma_f32_32x32x16_bf16 v[64:79], v[144:147], v[128:131], v[64:79]
ds_read_b128 v[136:139], v239 offset:1024
buffer_load_dwordx4 v228, s[8:11], s59 offen offset:2048 lds
s_waitcnt lgkmcnt(1)
v_mfma_f32_32x32x16_bf16 v[80:95], v[148:151], v[128:131], v[80:95]
ds_read_b128 v[140:143], v239 offset:5120
buffer_load_dwordx4 v229, s[8:11], s59 offen offset:3072 lds
v_mov_b32 v3, v211
v_mfma_f32_32x32x16_bf16 v[96:111], v[144:147], v[132:135], v[96:111]
ds_read_b64_tr_b16 v[152:153], v196 offset:4096
ds_read_b64_tr_b16 v[154:155], v196 offset:6144
s_add_u32 s43, s45, 32768
s_xor_b32 m0, s43, s69
s_lshl_b32 s58, s52, 16
s_add_u32 s58, s58, s55
s_add_u32 s58, s58, 40960
v_mfma_f32_32x32x16_bf16 v[112:127], v[148:151], v[132:135], v[112:127]
ds_read_b64_tr_b16 v[156:157], v197 offset:4096
ds_read_b64_tr_b16 v[158:159], v197 offset:6144
buffer_load_dwordx4 v224, s[4:7], s58 offen offset:0 lds
s_waitcnt lgkmcnt(2)
v_mfma_f32_32x32x16_bf16 v[64:79], v[152:155], v[136:139], v[64:79]
ds_read_b128 v[128:131], v239 offset:2048
buffer_load_dwordx4 v224, s[4:7], s58 offen offset:1024 lds
s_waitcnt lgkmcnt(1)
v_mfma_f32_32x32x16_bf16 v[80:95], v[156:159], v[136:139], v[80:95]
ds_read_b128 v[132:135], v239 offset:6144
buffer_load_dwordx4 v224, s[4:7], s58 offen offset:2048 lds
v_mfma_f32_32x32x16_bf16 v[96:111], v[152:155], v[140:143], v[96:111]
ds_read_b64_tr_b16 v[144:145], v196 offset:8192
ds_read_b64_tr_b16 v[146:147], v196 offset:10240
buffer_load_dwordx4 v224, s[4:7], s58 offen offset:3072 lds
v_mfma_f32_32x32x16_bf16 v[112:127], v[156:159], v[140:143], v[112:127]
ds_read_b64_tr_b16 v[148:149], v197 offset:8192
ds_read_b64_tr_b16 v[150:151], v197 offset:10240
v_mov_b32 v5, v211
s_waitcnt lgkmcnt(2)
v_mfma_f32_32x32x16_bf16 v[64:79], v[144:147], v[128:131], v[64:79]
ds_read_b128 v[136:139], v239 offset:3072
s_waitcnt lgkmcnt(1)
v_mfma_f32_32x32x16_bf16 v[80:95], v[148:151], v[128:131], v[80:95]
ds_read_b128 v[140:143], v239 offset:7168
v_mfma_f32_32x32x16_bf16 v[96:111], v[144:147], v[132:135], v[96:111]
ds_read_b64_tr_b16 v[152:153], v196 offset:12288
ds_read_b64_tr_b16 v[154:155], v196 offset:14336
v_mov_b32 v7, v211
v_mfma_f32_32x32x16_bf16 v[112:127], v[148:151], v[132:135], v[112:127]
ds_read_b64_tr_b16 v[156:157], v197 offset:12288
ds_read_b64_tr_b16 v[158:159], v197 offset:14336
s_waitcnt lgkmcnt(2)
v_mfma_f32_32x32x16_bf16 v[64:79], v[152:155], v[136:139], v[64:79]
s_waitcnt vmcnt(16)
s_barrier
ds_read_b128 v[128:131], v233 offset:32768
s_waitcnt lgkmcnt(1)
v_mfma_f32_32x32x16_bf16 v[80:95], v[156:159], v[136:139], v[80:95]
ds_read_b128 v[132:135], v233 offset:36864
s_add_u32 s43, s45, 81920
s_xor_b32 m0, s43, s69
s_lshl_b32 s59, s52, 20
s_add_u32 s59, s59, 720896
v_mfma_f32_32x32x16_bf16 v[96:111], v[152:155], v[140:143], v[96:111]
ds_read_b64_tr_b16 v[144:145], v194 offset:32768
ds_read_b64_tr_b16 v[146:147], v194 offset:34816
buffer_load_dwordx4 v226, s[8:11], s59 offen offset:0 lds
v_mov_b32 v9, v211
v_mfma_f32_32x32x16_bf16 v[112:127], v[156:159], v[140:143], v[112:127]
ds_read_b64_tr_b16 v[148:149], v195 offset:32768
ds_read_b64_tr_b16 v[150:151], v195 offset:34816
buffer_load_dwordx4 v227, s[8:11], s59 offen offset:1024 lds
s_waitcnt lgkmcnt(2)
v_mfma_f32_32x32x16_bf16 v[64:79], v[144:147], v[128:131], v[64:79]
ds_read_b128 v[136:139], v233 offset:33792
buffer_load_dwordx4 v228, s[8:11], s59 offen offset:2048 lds
s_waitcnt lgkmcnt(1)
v_mfma_f32_32x32x16_bf16 v[80:95], v[148:151], v[128:131], v[80:95]
ds_read_b128 v[140:143], v233 offset:37888
buffer_load_dwordx4 v229, s[8:11], s59 offen offset:3072 lds
v_mfma_f32_32x32x16_bf16 v[96:111], v[144:147], v[132:135], v[96:111]
ds_read_b64_tr_b16 v[152:153], v194 offset:36864
ds_read_b64_tr_b16 v[154:155], v194 offset:38912
s_add_u32 s43, s45, 65536
s_xor_b32 m0, s43, s69
s_lshl_b32 s58, s52, 16
s_add_u32 s58, s58, s55
s_add_u32 s58, s58, 45056
v_mfma_f32_32x32x16_bf16 v[112:127], v[148:151], v[132:135], v[112:127]
ds_read_b64_tr_b16 v[156:157], v195 offset:36864
ds_read_b64_tr_b16 v[158:159], v195 offset:38912
buffer_load_dwordx4 v224, s[4:7], s58 offen offset:0 lds
s_waitcnt lgkmcnt(2)
v_mfma_f32_32x32x16_bf16 v[64:79], v[152:155], v[136:139], v[64:79]
ds_read_b128 v[128:131], v233 offset:34816
buffer_load_dwordx4 v224, s[4:7], s58 offen offset:1024 lds
v_mov_b32 v11, v211
s_waitcnt lgkmcnt(1)
v_mfma_f32_32x32x16_bf16 v[80:95], v[156:159], v[136:139], v[80:95]
ds_read_b128 v[132:135], v233 offset:38912
buffer_load_dwordx4 v224, s[4:7], s58 offen offset:2048 lds
v_mfma_f32_32x32x16_bf16 v[96:111], v[152:155], v[140:143], v[96:111]
ds_read_b64_tr_b16 v[144:145], v194 offset:40960
ds_read_b64_tr_b16 v[146:147], v194 offset:43008
buffer_load_dwordx4 v224, s[4:7], s58 offen offset:3072 lds
v_mfma_f32_32x32x16_bf16 v[112:127], v[156:159], v[140:143], v[112:127]
ds_read_b64_tr_b16 v[148:149], v195 offset:40960
ds_read_b64_tr_b16 v[150:151], v195 offset:43008
s_waitcnt lgkmcnt(2)
v_mfma_f32_32x32x16_bf16 v[64:79], v[144:147], v[128:131], v[64:79]
ds_read_b128 v[136:139], v233 offset:35840
v_mov_b32 v13, v211
s_waitcnt lgkmcnt(1)
v_mfma_f32_32x32x16_bf16 v[80:95], v[148:151], v[128:131], v[80:95]
ds_read_b128 v[140:143], v233 offset:39936
v_mfma_f32_32x32x16_bf16 v[96:111], v[144:147], v[132:135], v[96:111]
ds_read_b64_tr_b16 v[152:153], v194 offset:45056
ds_read_b64_tr_b16 v[154:155], v194 offset:47104
v_mfma_f32_32x32x16_bf16 v[112:127], v[148:151], v[132:135], v[112:127]
ds_read_b64_tr_b16 v[156:157], v195 offset:45056
ds_read_b64_tr_b16 v[158:159], v195 offset:47104
v_mov_b32 v15, v211
s_waitcnt lgkmcnt(2)
v_mfma_f32_32x32x16_bf16 v[64:79], v[152:155], v[136:139], v[64:79]
s_waitcnt vmcnt(16)
s_barrier
ds_read_b128 v[128:131], v232 offset:0
s_waitcnt lgkmcnt(1)
v_mfma_f32_32x32x16_bf16 v[80:95], v[156:159], v[136:139], v[80:95]
ds_read_b128 v[132:135], v232 offset:4096
s_add_u32 s43, s45, 147456
s_mov_b32 m0, s43
s_lshl_b32 s59, s52, 20
s_add_u32 s59, s59, 786432
v_mfma_f32_32x32x16_bf16 v[96:111], v[152:155], v[140:143], v[96:111]
ds_read_b64_tr_b16 v[144:145], v192 offset:0
ds_read_b64_tr_b16 v[146:147], v192 offset:2048
buffer_load_dwordx4 v226, s[8:11], s59 offen offset:0 lds
v_mfma_f32_32x32x16_bf16 v[112:127], v[156:159], v[140:143], v[112:127]
ds_read_b64_tr_b16 v[148:149], v193 offset:0
ds_read_b64_tr_b16 v[150:151], v193 offset:2048
buffer_load_dwordx4 v227, s[8:11], s59 offen offset:1024 lds
s_waitcnt lgkmcnt(2)
v_mfma_f32_32x32x16_bf16 v[64:79], v[144:147], v[128:131], v[64:79]
ds_read_b128 v[136:139], v232 offset:1024
buffer_load_dwordx4 v228, s[8:11], s59 offen offset:2048 lds
v_mov_b32 v17, v211
s_waitcnt lgkmcnt(1)
v_mfma_f32_32x32x16_bf16 v[80:95], v[148:151], v[128:131], v[80:95]
ds_read_b128 v[140:143], v232 offset:5120
buffer_load_dwordx4 v229, s[8:11], s59 offen offset:3072 lds
v_mfma_f32_32x32x16_bf16 v[96:111], v[144:147], v[132:135], v[96:111]
ds_read_b64_tr_b16 v[152:153], v192 offset:4096
ds_read_b64_tr_b16 v[154:155], v192 offset:6144
s_add_u32 m0, s45, 131072
s_lshl_b32 s58, s52, 16
s_add_u32 s58, s58, s55
s_add_u32 s58, s58, 49152
v_mfma_f32_32x32x16_bf16 v[112:127], v[148:151], v[132:135], v[112:127]
ds_read_b64_tr_b16 v[156:157], v193 offset:4096
ds_read_b64_tr_b16 v[158:159], v193 offset:6144
buffer_load_dwordx4 v224, s[4:7], s58 offen offset:0 lds
s_waitcnt lgkmcnt(2)
v_mfma_f32_32x32x16_bf16 v[64:79], v[152:155], v[136:139], v[64:79]
ds_read_b128 v[128:131], v232 offset:2048
buffer_load_dwordx4 v224, s[4:7], s58 offen offset:1024 lds
s_waitcnt lgkmcnt(1)
v_mfma_f32_32x32x16_bf16 v[80:95], v[156:159], v[136:139], v[80:95]
ds_read_b128 v[132:135], v232 offset:6144
buffer_load_dwordx4 v224, s[4:7], s58 offen offset:2048 lds
v_mov_b32 v19, v211
v_mfma_f32_32x32x16_bf16 v[96:111], v[152:155], v[140:143], v[96:111]
ds_read_b64_tr_b16 v[144:145], v192 offset:8192
ds_read_b64_tr_b16 v[146:147], v192 offset:10240
buffer_load_dwordx4 v224, s[4:7], s58 offen offset:3072 lds
v_mfma_f32_32x32x16_bf16 v[112:127], v[156:159], v[140:143], v[112:127]
ds_read_b64_tr_b16 v[148:149], v193 offset:8192
ds_read_b64_tr_b16 v[150:151], v193 offset:10240
s_waitcnt lgkmcnt(2)
v_mfma_f32_32x32x16_bf16 v[64:79], v[144:147], v[128:131], v[64:79]
ds_read_b128 v[136:139], v232 offset:3072
v_mov_b32 v21, v211
s_waitcnt lgkmcnt(1)
v_mfma_f32_32x32x16_bf16 v[80:95], v[148:151], v[128:131], v[80:95]
ds_read_b128 v[140:143], v232 offset:7168
v_mfma_f32_32x32x16_bf16 v[96:111], v[144:147], v[132:135], v[96:111]
ds_read_b64_tr_b16 v[152:153], v192 offset:12288
ds_read_b64_tr_b16 v[154:155], v192 offset:14336
v_mfma_f32_32x32x16_bf16 v[112:127], v[148:151], v[132:135], v[112:127]
ds_read_b64_tr_b16 v[156:157], v193 offset:12288
ds_read_b64_tr_b16 v[158:159], v193 offset:14336
s_waitcnt lgkmcnt(2)
v_mfma_f32_32x32x16_bf16 v[64:79], v[152:155], v[136:139], v[64:79]
s_waitcnt vmcnt(16)
s_barrier
ds_read_b128 v[128:131], v232 offset:32768
v_mov_b32 v23, v211
s_waitcnt lgkmcnt(1)
v_mfma_f32_32x32x16_bf16 v[80:95], v[156:159], v[136:139], v[80:95]
ds_read_b128 v[132:135], v232 offset:36864
s_add_u32 s43, s45, 114688
s_xor_b32 m0, s43, s69
s_lshl_b32 s59, s52, 20
s_add_u32 s59, s59, 851968
v_mfma_f32_32x32x16_bf16 v[96:111], v[152:155], v[140:143], v[96:111]
ds_read_b64_tr_b16 v[144:145], v192 offset:32768
ds_read_b64_tr_b16 v[146:147], v192 offset:34816
buffer_load_dwordx4 v226, s[8:11], s59 offen offset:0 lds
v_mfma_f32_32x32x16_bf16 v[112:127], v[156:159], v[140:143], v[112:127]
ds_read_b64_tr_b16 v[148:149], v193 offset:32768
ds_read_b64_tr_b16 v[150:151], v193 offset:34816
buffer_load_dwordx4 v227, s[8:11], s59 offen offset:1024 lds
s_waitcnt lgkmcnt(2)
v_mfma_f32_32x32x16_bf16 v[64:79], v[144:147], v[128:131], v[64:79]
ds_read_b128 v[136:139], v232 offset:33792
buffer_load_dwordx4 v228, s[8:11], s59 offen offset:2048 lds
s_waitcnt lgkmcnt(1)
v_mfma_f32_32x32x16_bf16 v[80:95], v[148:151], v[128:131], v[80:95]
ds_read_b128 v[140:143], v232 offset:37888
buffer_load_dwordx4 v229, s[8:11], s59 offen offset:3072 lds
v_mov_b32 v25, v211
v_mfma_f32_32x32x16_bf16 v[96:111], v[144:147], v[132:135], v[96:111]
ds_read_b64_tr_b16 v[152:153], v192 offset:36864
ds_read_b64_tr_b16 v[154:155], v192 offset:38912
s_add_u32 s43, s45, 98304
s_xor_b32 m0, s43, s69
s_lshl_b32 s58, s52, 16
s_add_u32 s58, s58, s55
s_add_u32 s58, s58, 53248
v_mfma_f32_32x32x16_bf16 v[112:127], v[148:151], v[132:135], v[112:127]
ds_read_b64_tr_b16 v[156:157], v193 offset:36864
ds_read_b64_tr_b16 v[158:159], v193 offset:38912
buffer_load_dwordx4 v224, s[4:7], s58 offen offset:0 lds
s_waitcnt lgkmcnt(2)
v_mfma_f32_32x32x16_bf16 v[64:79], v[152:155], v[136:139], v[64:79]
ds_read_b128 v[128:131], v232 offset:34816
buffer_load_dwordx4 v224, s[4:7], s58 offen offset:1024 lds
s_waitcnt lgkmcnt(1)
v_mfma_f32_32x32x16_bf16 v[80:95], v[156:159], v[136:139], v[80:95]
ds_read_b128 v[132:135], v232 offset:38912
buffer_load_dwordx4 v224, s[4:7], s58 offen offset:2048 lds
v_mfma_f32_32x32x16_bf16 v[96:111], v[152:155], v[140:143], v[96:111]
ds_read_b64_tr_b16 v[144:145], v192 offset:40960
ds_read_b64_tr_b16 v[146:147], v192 offset:43008
buffer_load_dwordx4 v224, s[4:7], s58 offen offset:3072 lds
v_mov_b32 v27, v211
v_mfma_f32_32x32x16_bf16 v[112:127], v[156:159], v[140:143], v[112:127]
ds_read_b64_tr_b16 v[148:149], v193 offset:40960
ds_read_b64_tr_b16 v[150:151], v193 offset:43008
s_waitcnt lgkmcnt(2)
v_mfma_f32_32x32x16_bf16 v[64:79], v[144:147], v[128:131], v[64:79]
ds_read_b128 v[136:139], v232 offset:35840
s_waitcnt lgkmcnt(1)
v_mfma_f32_32x32x16_bf16 v[80:95], v[148:151], v[128:131], v[80:95]
ds_read_b128 v[140:143], v232 offset:39936
v_mov_b32 v29, v211
v_mfma_f32_32x32x16_bf16 v[96:111], v[144:147], v[132:135], v[96:111]
ds_read_b64_tr_b16 v[152:153], v192 offset:45056
ds_read_b64_tr_b16 v[154:155], v192 offset:47104
v_mfma_f32_32x32x16_bf16 v[112:127], v[148:151], v[132:135], v[112:127]
ds_read_b64_tr_b16 v[156:157], v193 offset:45056
ds_read_b64_tr_b16 v[158:159], v193 offset:47104
s_waitcnt lgkmcnt(2)
v_mfma_f32_32x32x16_bf16 v[64:79], v[152:155], v[136:139], v[64:79]
s_waitcnt vmcnt(16)
s_barrier
ds_read_b128 v[128:131], v233 offset:0
s_waitcnt lgkmcnt(1)
v_mfma_f32_32x32x16_bf16 v[80:95], v[156:159], v[136:139], v[80:95]
ds_read_b128 v[132:135], v233 offset:4096
s_add_u32 s43, s45, 16384
s_xor_b32 m0, s43, s69
s_lshl_b32 s59, s52, 20
s_add_u32 s59, s59, 917504
v_mfma_f32_32x32x16_bf16 v[96:111], v[152:155], v[140:143], v[96:111]
ds_read_b64_tr_b16 v[144:145], v194 offset:0
ds_read_b64_tr_b16 v[146:147], v194 offset:2048
buffer_load_dwordx4 v226, s[8:11], s59 offen offset:0 lds
v_mov_b32 v31, v211
v_mfma_f32_32x32x16_bf16 v[112:127], v[156:159], v[140:143], v[112:127]
ds_read_b64_tr_b16 v[148:149], v195 offset:0
ds_read_b64_tr_b16 v[150:151], v195 offset:2048
buffer_load_dwordx4 v227, s[8:11], s59 offen offset:1024 lds
s_waitcnt lgkmcnt(2)
v_mfma_f32_32x32x16_bf16 v[64:79], v[144:147], v[128:131], v[64:79]
ds_read_b128 v[136:139], v233 offset:1024
buffer_load_dwordx4 v228, s[8:11], s59 offen offset:2048 lds
s_waitcnt lgkmcnt(1)
v_mfma_f32_32x32x16_bf16 v[80:95], v[148:151], v[128:131], v[80:95]
ds_read_b128 v[140:143], v233 offset:5120
buffer_load_dwordx4 v229, s[8:11], s59 offen offset:3072 lds
v_mfma_f32_32x32x16_bf16 v[96:111], v[144:147], v[132:135], v[96:111]
ds_read_b64_tr_b16 v[152:153], v194 offset:4096
ds_read_b64_tr_b16 v[154:155], v194 offset:6144
s_add_u32 s43, s45, 0
s_xor_b32 m0, s43, s69
s_lshl_b32 s58, s52, 16
s_add_u32 s58, s58, s55
s_add_u32 s58, s58, 57344
v_mfma_f32_32x32x16_bf16 v[112:127], v[148:151], v[132:135], v[112:127]
ds_read_b64_tr_b16 v[156:157], v195 offset:4096
ds_read_b64_tr_b16 v[158:159], v195 offset:6144
buffer_load_dwordx4 v224, s[4:7], s58 offen offset:0 lds
v_mov_b32 v33, v211
s_waitcnt lgkmcnt(2)
v_mfma_f32_32x32x16_bf16 v[64:79], v[152:155], v[136:139], v[64:79]
ds_read_b128 v[128:131], v233 offset:2048
buffer_load_dwordx4 v224, s[4:7], s58 offen offset:1024 lds
s_waitcnt lgkmcnt(1)
v_mfma_f32_32x32x16_bf16 v[80:95], v[156:159], v[136:139], v[80:95]
ds_read_b128 v[132:135], v233 offset:6144
buffer_load_dwordx4 v224, s[4:7], s58 offen offset:2048 lds
v_mfma_f32_32x32x16_bf16 v[96:111], v[152:155], v[140:143], v[96:111]
ds_read_b64_tr_b16 v[144:145], v194 offset:8192
ds_read_b64_tr_b16 v[146:147], v194 offset:10240
buffer_load_dwordx4 v224, s[4:7], s58 offen offset:3072 lds
v_mfma_f32_32x32x16_bf16 v[112:127], v[156:159], v[140:143], v[112:127]
ds_read_b64_tr_b16 v[148:149], v195 offset:8192
ds_read_b64_tr_b16 v[150:151], v195 offset:10240
v_mov_b32 v35, v211
s_waitcnt lgkmcnt(2)
v_mfma_f32_32x32x16_bf16 v[64:79], v[144:147], v[128:131], v[64:79]
ds_read_b128 v[136:139], v233 offset:3072
s_waitcnt lgkmcnt(1)
v_mfma_f32_32x32x16_bf16 v[80:95], v[148:151], v[128:131], v[80:95]
ds_read_b128 v[140:143], v233 offset:7168
v_mfma_f32_32x32x16_bf16 v[96:111], v[144:147], v[132:135], v[96:111]
ds_read_b64_tr_b16 v[152:153], v194 offset:12288
ds_read_b64_tr_b16 v[154:155], v194 offset:14336
v_mov_b32 v37, v211
v_mfma_f32_32x32x16_bf16 v[112:127], v[148:151], v[132:135], v[112:127]
ds_read_b64_tr_b16 v[156:157], v195 offset:12288
ds_read_b64_tr_b16 v[158:159], v195 offset:14336
s_waitcnt lgkmcnt(2)
v_mfma_f32_32x32x16_bf16 v[64:79], v[152:155], v[136:139], v[64:79]
s_waitcnt vmcnt(16)
s_barrier
ds_read_b128 v[128:131], v239 offset:0
s_waitcnt lgkmcnt(1)
v_mfma_f32_32x32x16_bf16 v[80:95], v[156:159], v[136:139], v[80:95]
ds_read_b128 v[132:135], v239 offset:4096
s_add_u32 s43, s45, 49152
s_xor_b32 m0, s43, s69
s_lshl_b32 s59, s52, 20
s_add_u32 s59, s59, 983040
v_mfma_f32_32x32x16_bf16 v[96:111], v[152:155], v[140:143], v[96:111]
ds_read_b64_tr_b16 v[144:145], v196 offset:0
ds_read_b64_tr_b16 v[146:147], v196 offset:2048
buffer_load_dwordx4 v226, s[8:11], s59 offen offset:0 lds
v_mfma_f32_32x32x16_bf16 v[112:127], v[156:159], v[140:143], v[112:127]
ds_read_b64_tr_b16 v[148:149], v197 offset:0
ds_read_b64_tr_b16 v[150:151], v197 offset:2048
buffer_load_dwordx4 v227, s[8:11], s59 offen offset:1024 lds
s_waitcnt lgkmcnt(2)
v_mfma_f32_32x32x16_bf16 v[64:79], v[144:147], v[128:131], v[64:79]
ds_read_b128 v[136:139], v239 offset:1024
buffer_load_dwordx4 v228, s[8:11], s59 offen offset:2048 lds
v_mov_b32 v39, v211
s_waitcnt lgkmcnt(1)
v_mfma_f32_32x32x16_bf16 v[80:95], v[148:151], v[128:131], v[80:95]
ds_read_b128 v[140:143], v239 offset:5120
buffer_load_dwordx4 v229, s[8:11], s59 offen offset:3072 lds
v_mfma_f32_32x32x16_bf16 v[96:111], v[144:147], v[132:135], v[96:111]
ds_read_b64_tr_b16 v[152:153], v196 offset:4096
ds_read_b64_tr_b16 v[154:155], v196 offset:6144
s_add_u32 s43, s45, 32768
s_xor_b32 m0, s43, s69
s_lshl_b32 s58, s52, 16
s_add_u32 s58, s58, s55
s_add_u32 s58, s58, 61440
v_mfma_f32_32x32x16_bf16 v[112:127], v[148:151], v[132:135], v[112:127]
ds_read_b64_tr_b16 v[156:157], v197 offset:4096
ds_read_b64_tr_b16 v[158:159], v197 offset:6144
buffer_load_dwordx4 v224, s[4:7], s58 offen offset:0 lds
s_waitcnt lgkmcnt(2)
v_mfma_f32_32x32x16_bf16 v[64:79], v[152:155], v[136:139], v[64:79]
ds_read_b128 v[128:131], v239 offset:2048
buffer_load_dwordx4 v224, s[4:7], s58 offen offset:1024 lds
v_mov_b32 v41, v211
s_waitcnt lgkmcnt(1)
v_mfma_f32_32x32x16_bf16 v[80:95], v[156:159], v[136:139], v[80:95]
ds_read_b128 v[132:135], v239 offset:6144
buffer_load_dwordx4 v224, s[4:7], s58 offen offset:2048 lds
v_mfma_f32_32x32x16_bf16 v[96:111], v[152:155], v[140:143], v[96:111]
ds_read_b64_tr_b16 v[144:145], v196 offset:8192
ds_read_b64_tr_b16 v[146:147], v196 offset:10240
buffer_load_dwordx4 v224, s[4:7], s58 offen offset:3072 lds
v_mfma_f32_32x32x16_bf16 v[112:127], v[156:159], v[140:143], v[112:127]
ds_read_b64_tr_b16 v[148:149], v197 offset:8192
ds_read_b64_tr_b16 v[150:151], v197 offset:10240
s_waitcnt lgkmcnt(2)
v_mfma_f32_32x32x16_bf16 v[64:79], v[144:147], v[128:131], v[64:79]
ds_read_b128 v[136:139], v239 offset:3072
v_mov_b32 v43, v211
s_waitcnt lgkmcnt(1)
v_mfma_f32_32x32x16_bf16 v[80:95], v[148:151], v[128:131], v[80:95]
ds_read_b128 v[140:143], v239 offset:7168
v_mfma_f32_32x32x16_bf16 v[96:111], v[144:147], v[132:135], v[96:111]
ds_read_b64_tr_b16 v[152:153], v196 offset:12288
ds_read_b64_tr_b16 v[154:155], v196 offset:14336
v_mfma_f32_32x32x16_bf16 v[112:127], v[148:151], v[132:135], v[112:127]
ds_read_b64_tr_b16 v[156:157], v197 offset:12288
ds_read_b64_tr_b16 v[158:159], v197 offset:14336
v_mov_b32 v45, v211
s_waitcnt lgkmcnt(2)
v_mfma_f32_32x32x16_bf16 v[64:79], v[152:155], v[136:139], v[64:79]
s_waitcnt vmcnt(16)
s_barrier
ds_read_b128 v[128:131], v233 offset:32768
s_waitcnt lgkmcnt(1)
v_mfma_f32_32x32x16_bf16 v[80:95], v[156:159], v[136:139], v[80:95]
ds_read_b128 v[132:135], v233 offset:36864
v_mfma_f32_32x32x16_bf16 v[96:111], v[152:155], v[140:143], v[96:111]
ds_read_b64_tr_b16 v[144:145], v194 offset:32768
ds_read_b64_tr_b16 v[146:147], v194 offset:34816
v_mfma_f32_32x32x16_bf16 v[112:127], v[156:159], v[140:143], v[112:127]
ds_read_b64_tr_b16 v[148:149], v195 offset:32768
ds_read_b64_tr_b16 v[150:151], v195 offset:34816
v_mov_b32 v47, v211
s_waitcnt lgkmcnt(2)
v_mfma_f32_32x32x16_bf16 v[64:79], v[144:147], v[128:131], v[64:79]
ds_read_b128 v[136:139], v233 offset:33792
s_waitcnt lgkmcnt(1)
v_mfma_f32_32x32x16_bf16 v[80:95], v[148:151], v[128:131], v[80:95]
ds_read_b128 v[140:143], v233 offset:37888
v_mfma_f32_32x32x16_bf16 v[96:111], v[144:147], v[132:135], v[96:111]
ds_read_b64_tr_b16 v[152:153], v194 offset:36864
ds_read_b64_tr_b16 v[154:155], v194 offset:38912
v_mov_b32 v49, v211
v_mfma_f32_32x32x16_bf16 v[112:127], v[148:151], v[132:135], v[112:127]
ds_read_b64_tr_b16 v[156:157], v195 offset:36864
ds_read_b64_tr_b16 v[158:159], v195 offset:38912
s_waitcnt lgkmcnt(2)
v_mfma_f32_32x32x16_bf16 v[64:79], v[152:155], v[136:139], v[64:79]
ds_read_b128 v[128:131], v233 offset:34816
s_waitcnt lgkmcnt(1)
v_mfma_f32_32x32x16_bf16 v[80:95], v[156:159], v[136:139], v[80:95]
ds_read_b128 v[132:135], v233 offset:38912
v_mfma_f32_32x32x16_bf16 v[96:111], v[152:155], v[140:143], v[96:111]
ds_read_b64_tr_b16 v[144:145], v194 offset:40960
ds_read_b64_tr_b16 v[146:147], v194 offset:43008
v_mfma_f32_32x32x16_bf16 v[112:127], v[156:159], v[140:143], v[112:127]
ds_read_b64_tr_b16 v[148:149], v195 offset:40960
ds_read_b64_tr_b16 v[150:151], v195 offset:43008
s_waitcnt lgkmcnt(2)
v_mfma_f32_32x32x16_bf16 v[64:79], v[144:147], v[128:131], v[64:79]
ds_read_b128 v[136:139], v233 offset:35840
s_waitcnt lgkmcnt(1)
v_mfma_f32_32x32x16_bf16 v[80:95], v[148:151], v[128:131], v[80:95]
ds_read_b128 v[140:143], v233 offset:39936
v_mfma_f32_32x32x16_bf16 v[96:111], v[144:147], v[132:135], v[96:111]
ds_read_b64_tr_b16 v[152:153], v194 offset:45056
ds_read_b64_tr_b16 v[154:155], v194 offset:47104
v_mfma_f32_32x32x16_bf16 v[112:127], v[148:151], v[132:135], v[112:127]
ds_read_b64_tr_b16 v[156:157], v195 offset:45056
ds_read_b64_tr_b16 v[158:159], v195 offset:47104
s_waitcnt lgkmcnt(2)
v_mfma_f32_32x32x16_bf16 v[64:79], v[152:155], v[136:139], v[64:79]
s_waitcnt vmcnt(8)
s_barrier
ds_read_b128 v[128:131], v232 offset:0
s_waitcnt lgkmcnt(1)
v_mfma_f32_32x32x16_bf16 v[80:95], v[156:159], v[136:139], v[80:95]
ds_read_b128 v[132:135], v232 offset:4096
v_mfma_f32_32x32x16_bf16 v[96:111], v[152:155], v[140:143], v[96:111]
ds_read_b64_tr_b16 v[144:145], v192 offset:0
ds_read_b64_tr_b16 v[146:147], v192 offset:2048
v_mfma_f32_32x32x16_bf16 v[112:127], v[156:159], v[140:143], v[112:127]
ds_read_b64_tr_b16 v[148:149], v193 offset:0
ds_read_b64_tr_b16 v[150:151], v193 offset:2048
s_waitcnt lgkmcnt(2)
v_mfma_f32_32x32x16_bf16 v[64:79], v[144:147], v[128:131], v[64:79]
ds_read_b128 v[136:139], v232 offset:1024
s_waitcnt lgkmcnt(1)
v_mfma_f32_32x32x16_bf16 v[80:95], v[148:151], v[128:131], v[80:95]
ds_read_b128 v[140:143], v232 offset:5120
v_mfma_f32_32x32x16_bf16 v[96:111], v[144:147], v[132:135], v[96:111]
ds_read_b64_tr_b16 v[152:153], v192 offset:4096
ds_read_b64_tr_b16 v[154:155], v192 offset:6144
v_mfma_f32_32x32x16_bf16 v[112:127], v[148:151], v[132:135], v[112:127]
ds_read_b64_tr_b16 v[156:157], v193 offset:4096
ds_read_b64_tr_b16 v[158:159], v193 offset:6144
s_waitcnt lgkmcnt(2)
v_mfma_f32_32x32x16_bf16 v[64:79], v[152:155], v[136:139], v[64:79]
ds_read_b128 v[128:131], v232 offset:2048
s_waitcnt lgkmcnt(1)
v_mfma_f32_32x32x16_bf16 v[80:95], v[156:159], v[136:139], v[80:95]
ds_read_b128 v[132:135], v232 offset:6144
v_mfma_f32_32x32x16_bf16 v[96:111], v[152:155], v[140:143], v[96:111]
ds_read_b64_tr_b16 v[144:145], v192 offset:8192
ds_read_b64_tr_b16 v[146:147], v192 offset:10240
v_mfma_f32_32x32x16_bf16 v[112:127], v[156:159], v[140:143], v[112:127]
ds_read_b64_tr_b16 v[148:149], v193 offset:8192
ds_read_b64_tr_b16 v[150:151], v193 offset:10240
s_waitcnt lgkmcnt(2)
v_mfma_f32_32x32x16_bf16 v[64:79], v[144:147], v[128:131], v[64:79]
ds_read_b128 v[136:139], v232 offset:3072
s_waitcnt lgkmcnt(1)
v_mfma_f32_32x32x16_bf16 v[80:95], v[148:151], v[128:131], v[80:95]
ds_read_b128 v[140:143], v232 offset:7168
v_mfma_f32_32x32x16_bf16 v[96:111], v[144:147], v[132:135], v[96:111]
ds_read_b64_tr_b16 v[152:153], v192 offset:12288
ds_read_b64_tr_b16 v[154:155], v192 offset:14336
v_mfma_f32_32x32x16_bf16 v[112:127], v[148:151], v[132:135], v[112:127]
ds_read_b64_tr_b16 v[156:157], v193 offset:12288
ds_read_b64_tr_b16 v[158:159], v193 offset:14336
s_waitcnt lgkmcnt(2)
v_mfma_f32_32x32x16_bf16 v[64:79], v[152:155], v[136:139], v[64:79]
s_waitcnt vmcnt(0)
s_barrier
ds_read_b128 v[128:131], v232 offset:32768
s_waitcnt lgkmcnt(1)
v_mfma_f32_32x32x16_bf16 v[80:95], v[156:159], v[136:139], v[80:95]
ds_read_b128 v[132:135], v232 offset:36864
v_mfma_f32_32x32x16_bf16 v[96:111], v[152:155], v[140:143], v[96:111]
ds_read_b64_tr_b16 v[144:145], v192 offset:32768
ds_read_b64_tr_b16 v[146:147], v192 offset:34816
v_mfma_f32_32x32x16_bf16 v[112:127], v[156:159], v[140:143], v[112:127]
ds_read_b64_tr_b16 v[148:149], v193 offset:32768
ds_read_b64_tr_b16 v[150:151], v193 offset:34816
s_waitcnt lgkmcnt(2)
v_mfma_f32_32x32x16_bf16 v[64:79], v[144:147], v[128:131], v[64:79]
ds_read_b128 v[136:139], v232 offset:33792
s_waitcnt lgkmcnt(1)
v_mfma_f32_32x32x16_bf16 v[80:95], v[148:151], v[128:131], v[80:95]
ds_read_b128 v[140:143], v232 offset:37888
v_mfma_f32_32x32x16_bf16 v[96:111], v[144:147], v[132:135], v[96:111]
ds_read_b64_tr_b16 v[152:153], v192 offset:36864
ds_read_b64_tr_b16 v[154:155], v192 offset:38912
v_mfma_f32_32x32x16_bf16 v[112:127], v[148:151], v[132:135], v[112:127]
ds_read_b64_tr_b16 v[156:157], v193 offset:36864
ds_read_b64_tr_b16 v[158:159], v193 offset:38912
s_waitcnt lgkmcnt(2)
v_mfma_f32_32x32x16_bf16 v[64:79], v[152:155], v[136:139], v[64:79]
ds_read_b128 v[128:131], v232 offset:34816
s_waitcnt lgkmcnt(1)
v_mfma_f32_32x32x16_bf16 v[80:95], v[156:159], v[136:139], v[80:95]
ds_read_b128 v[132:135], v232 offset:38912
v_mfma_f32_32x32x16_bf16 v[96:111], v[152:155], v[140:143], v[96:111]
ds_read_b64_tr_b16 v[144:145], v192 offset:40960
ds_read_b64_tr_b16 v[146:147], v192 offset:43008
v_mfma_f32_32x32x16_bf16 v[112:127], v[156:159], v[140:143], v[112:127]
ds_read_b64_tr_b16 v[148:149], v193 offset:40960
ds_read_b64_tr_b16 v[150:151], v193 offset:43008
s_waitcnt lgkmcnt(2)
v_mfma_f32_32x32x16_bf16 v[64:79], v[144:147], v[128:131], v[64:79]
ds_read_b128 v[136:139], v232 offset:35840
s_waitcnt lgkmcnt(1)
v_mfma_f32_32x32x16_bf16 v[80:95], v[148:151], v[128:131], v[80:95]
ds_read_b128 v[140:143], v232 offset:39936
v_mfma_f32_32x32x16_bf16 v[96:111], v[144:147], v[132:135], v[96:111]
ds_read_b64_tr_b16 v[152:153], v192 offset:45056
ds_read_b64_tr_b16 v[154:155], v192 offset:47104
v_mfma_f32_32x32x16_bf16 v[112:127], v[148:151], v[132:135], v[112:127]
ds_read_b64_tr_b16 v[156:157], v193 offset:45056
ds_read_b64_tr_b16 v[158:159], v193 offset:47104
s_waitcnt lgkmcnt(2)
v_mfma_f32_32x32x16_bf16 v[64:79], v[152:155], v[136:139], v[64:79]
s_waitcnt lgkmcnt(0)
v_mfma_f32_32x32x16_bf16 v[80:95], v[156:159], v[136:139], v[80:95]
v_mfma_f32_32x32x16_bf16 v[96:111], v[152:155], v[140:143], v[96:111]
v_mfma_f32_32x32x16_bf16 v[112:127], v[156:159], v[140:143], v[112:127]
s_nop 15
s_lshl_b32 s40, s53, 2
s_add_u32 s40, s40, s54
s_lshl_b32 s40, s40, 18
s_add_u32 s40, s40, 0x4000000
s_add_u32 s61, s40, s45
s_lshl_b32 s41, s52, 14
s_add_u32 s62, s61, s41
s_lshl_b32 s41, s52, 16
s_add_u32 s63, s61, s41
L_x_74:
s_cmp_lg_u32 s52, 0
s_cbranch_scc1 L_x_75
s_add_u32 s43, s62, 65536
v_cvt_pk_bf16_f32 v2, v80, v81
v_cvt_pk_bf16_f32 v4, v82, v83
v_cvt_pk_bf16_f32 v6, v84, v85
v_cvt_pk_bf16_f32 v8, v86, v87
v_cvt_pk_bf16_f32 v10, v88, v89
v_cvt_pk_bf16_f32 v12, v90, v91
v_cvt_pk_bf16_f32 v14, v92, v93
v_cvt_pk_bf16_f32 v16, v94, v95
buffer_store_dwordx4 v[2:5], v224, s[16:19], s43 offen offset:0 sc1
buffer_store_dwordx4 v[6:9], v224, s[16:19], s43 offen offset:1024 sc1
buffer_store_dwordx4 v[10:13], v224, s[16:19], s43 offen offset:2048 sc1
buffer_store_dwordx4 v[14:17], v224, s[16:19], s43 offen offset:3072 sc1
s_add_u32 s43, s62, 131072
v_cvt_pk_bf16_f32 v18, v96, v97
v_cvt_pk_bf16_f32 v20, v98, v99
v_cvt_pk_bf16_f32 v22, v100, v101
v_cvt_pk_bf16_f32 v24, v102, v103
v_cvt_pk_bf16_f32 v26, v104, v105
v_cvt_pk_bf16_f32 v28, v106, v107
v_cvt_pk_bf16_f32 v30, v108, v109
v_cvt_pk_bf16_f32 v32, v110, v111
buffer_store_dwordx4 v[18:21], v224, s[16:19], s43 offen offset:0 sc1
buffer_store_dwordx4 v[22:25], v224, s[16:19], s43 offen offset:1024 sc1
buffer_store_dwordx4 v[26:29], v224, s[16:19], s43 offen offset:2048 sc1
buffer_store_dwordx4 v[30:33], v224, s[16:19], s43 offen offset:3072 sc1
s_add_u32 s43, s62, 196608
v_cvt_pk_bf16_f32 v34, v112, v113
v_cvt_pk_bf16_f32 v36, v114, v115
v_cvt_pk_bf16_f32 v38, v116, v117
v_cvt_pk_bf16_f32 v40, v118, v119
v_cvt_pk_bf16_f32 v42, v120, v121
v_cvt_pk_bf16_f32 v44, v122, v123
v_cvt_pk_bf16_f32 v46, v124, v125
v_cvt_pk_bf16_f32 v48, v126, v127
buffer_store_dwordx4 v[34:37], v224, s[16:19], s43 offen offset:0 sc1
buffer_store_dwordx4 v[38:41], v224, s[16:19], s43 offen offset:1024 sc1
buffer_store_dwordx4 v[42:45], v224, s[16:19], s43 offen offset:2048 sc1
buffer_store_dwordx4 v[46:49], v224, s[16:19], s43 offen offset:3072 sc1
v_mov_b32 v176, v64
v_mov_b32 v177, v65
v_mov_b32 v178, v66
v_mov_b32 v179, v67
v_mov_b32 v180, v68
v_mov_b32 v181, v69
v_mov_b32 v182, v70
v_mov_b32 v183, v71
v_mov_b32 v184, v72
v_mov_b32 v185, v73
v_mov_b32 v186, v74
v_mov_b32 v187, v75
v_mov_b32 v188, v76
v_mov_b32 v189, v77
v_mov_b32 v190, v78
v_mov_b32 v191, v79
s_branch L_x_done_73
L_x_75:
s_cmp_lg_u32 s52, 1
s_cbranch_scc1 L_x_76
s_add_u32 s43, s62, 0
v_cvt_pk_bf16_f32 v2, v64, v65
v_cvt_pk_bf16_f32 v4, v66, v67
v_cvt_pk_bf16_f32 v6, v68, v69
v_cvt_pk_bf16_f32 v8, v70, v71
v_cvt_pk_bf16_f32 v10, v72, v73
v_cvt_pk_bf16_f32 v12, v74, v75
v_cvt_pk_bf16_f32 v14, v76, v77
v_cvt_pk_bf16_f32 v16, v78, v79
buffer_store_dwordx4 v[2:5], v224, s[16:19], s43 offen offset:0 sc1
buffer_store_dwordx4 v[6:9], v224, s[16:19], s43 offen offset:1024 sc1
buffer_store_dwordx4 v[10:13], v224, s[16:19], s43 offen offset:2048 sc1
buffer_store_dwordx4 v[14:17], v224, s[16:19], s43 offen offset:3072 sc1
s_add_u32 s43, s62, 131072
v_cvt_pk_bf16_f32 v18, v96, v97
v_cvt_pk_bf16_f32 v20, v98, v99
v_cvt_pk_bf16_f32 v22, v100, v101
v_cvt_pk_bf16_f32 v24, v102, v103
v_cvt_pk_bf16_f32 v26, v104, v105
v_cvt_pk_bf16_f32 v28, v106, v107
v_cvt_pk_bf16_f32 v30, v108, v109
v_cvt_pk_bf16_f32 v32, v110, v111
buffer_store_dwordx4 v[18:21], v224, s[16:19], s43 offen offset:0 sc1
buffer_store_dwordx4 v[22:25], v224, s[16:19], s43 offen offset:1024 sc1
buffer_store_dwordx4 v[26:29], v224, s[16:19], s43 offen offset:2048 sc1
buffer_store_dwordx4 v[30:33], v224, s[16:19], s43 offen offset:3072 sc1
s_add_u32 s43, s62, 196608
v_cvt_pk_bf16_f32 v34, v112, v113
v_cvt_pk_bf16_f32 v36, v114, v115
v_cvt_pk_bf16_f32 v38, v116, v117
v_cvt_pk_bf16_f32 v40, v118, v119
v_cvt_pk_bf16_f32 v42, v120, v121
v_cvt_pk_bf16_f32 v44, v122, v123
v_cvt_pk_bf16_f32 v46, v124, v125
v_cvt_pk_bf16_f32 v48, v126, v127
buffer_store_dwordx4 v[34:37], v224, s[16:19], s43 offen offset:0 sc1
buffer_store_dwordx4 v[38:41], v224, s[16:19], s43 offen offset:1024 sc1
buffer_store_dwordx4 v[42:45], v224, s[16:19], s43 offen offset:2048 sc1
buffer_store_dwordx4 v[46:49], v224, s[16:19], s43 offen offset:3072 sc1
v_mov_b32 v176, v80
v_mov_b32 v177, v81
v_mov_b32 v178, v82
v_mov_b32 v179, v83
v_mov_b32 v180, v84
v_mov_b32 v181, v85
v_mov_b32 v182, v86
v_mov_b32 v183, v87
v_mov_b32 v184, v88
v_mov_b32 v185, v89
v_mov_b32 v186, v90
v_mov_b32 v187, v91
v_mov_b32 v188, v92
v_mov_b32 v189, v93
v_mov_b32 v190, v94
v_mov_b32 v191, v95
s_branch L_x_done_73
L_x_76:
s_cmp_lg_u32 s52, 2
s_cbranch_scc1 L_x_77
s_add_u32 s43, s62, 0
v_cvt_pk_bf16_f32 v2, v64, v65
v_cvt_pk_bf16_f32 v4, v66, v67
v_cvt_pk_bf16_f32 v6, v68, v69
v_cvt_pk_bf16_f32 v8, v70, v71
v_cvt_pk_bf16_f32 v10, v72, v73
v_cvt_pk_bf16_f32 v12, v74, v75
v_cvt_pk_bf16_f32 v14, v76, v77
v_cvt_pk_bf16_f32 v16, v78, v79
buffer_store_dwordx4 v[2:5], v224, s[16:19], s43 offen offset:0 sc1
buffer_store_dwordx4 v[6:9], v224, s[16:19], s43 offen offset:1024 sc1
buffer_store_dwordx4 v[10:13], v224, s[16:19], s43 offen offset:2048 sc1
buffer_store_dwordx4 v[14:17], v224, s[16:19], s43 offen offset:3072 sc1
s_add_u32 s43, s62, 65536
v_cvt_pk_bf16_f32 v18, v80, v81
v_cvt_pk_bf16_f32 v20, v82, v83
v_cvt_pk_bf16_f32 v22, v84, v85
v_cvt_pk_bf16_f32 v24, v86, v87
v_cvt_pk_bf16_f32 v26, v88, v89
v_cvt_pk_bf16_f32 v28, v90, v91
v_cvt_pk_bf16_f32 v30, v92, v93
v_cvt_pk_bf16_f32 v32, v94, v95
buffer_store_dwordx4 v[18:21], v224, s[16:19], s43 offen offset:0 sc1
buffer_store_dwordx4 v[22:25], v224, s[16:19], s43 offen offset:1024 sc1
buffer_store_dwordx4 v[26:29], v224, s[16:19], s43 offen offset:2048 sc1
buffer_store_dwordx4 v[30:33], v224, s[16:19], s43 offen offset:3072 sc1
s_add_u32 s43, s62, 196608
v_cvt_pk_bf16_f32 v34, v112, v113
v_cvt_pk_bf16_f32 v36, v114, v115
v_cvt_pk_bf16_f32 v38, v116, v117
v_cvt_pk_bf16_f32 v40, v118, v119
v_cvt_pk_bf16_f32 v42, v120, v121
v_cvt_pk_bf16_f32 v44, v122, v123
v_cvt_pk_bf16_f32 v46, v124, v125
v_cvt_pk_bf16_f32 v48, v126, v127
buffer_store_dwordx4 v[34:37], v224, s[16:19], s43 offen offset:0 sc1
buffer_store_dwordx4 v[38:41], v224, s[16:19], s43 offen offset:1024 sc1
buffer_store_dwordx4 v[42:45], v224, s[16:19], s43 offen offset:2048 sc1
buffer_store_dwordx4 v[46:49], v224, s[16:19], s43 offen offset:3072 sc1
v_mov_b32 v176, v96
v_mov_b32 v177, v97
v_mov_b32 v178, v98
v_mov_b32 v179, v99
v_mov_b32 v180, v100
v_mov_b32 v181, v101
v_mov_b32 v182, v102
v_mov_b32 v183, v103
v_mov_b32 v184, v104
v_mov_b32 v185, v105
v_mov_b32 v186, v106
v_mov_b32 v187, v107
v_mov_b32 v188, v108
v_mov_b32 v189, v109
v_mov_b32 v190, v110
v_mov_b32 v191, v111
s_branch L_x_done_73
L_x_77:
s_add_u32 s43, s62, 0
v_cvt_pk_bf16_f32 v2, v64, v65
v_cvt_pk_bf16_f32 v4, v66, v67
v_cvt_pk_bf16_f32 v6, v68, v69
v_cvt_pk_bf16_f32 v8, v70, v71
v_cvt_pk_bf16_f32 v10, v72, v73
v_cvt_pk_bf16_f32 v12, v74, v75
v_cvt_pk_bf16_f32 v14, v76, v77
v_cvt_pk_bf16_f32 v16, v78, v79
buffer_store_dwordx4 v[2:5], v224, s[16:19], s43 offen offset:0 sc1
buffer_store_dwordx4 v[6:9], v224, s[16:19], s43 offen offset:1024 sc1
buffer_store_dwordx4 v[10:13], v224, s[16:19], s43 offen offset:2048 sc1
buffer_store_dwordx4 v[14:17], v224, s[16:19], s43 offen offset:3072 sc1
s_add_u32 s43, s62, 65536
v_cvt_pk_bf16_f32 v18, v80, v81
v_cvt_pk_bf16_f32 v20, v82, v83
v_cvt_pk_bf16_f32 v22, v84, v85
v_cvt_pk_bf16_f32 v24, v86, v87
v_cvt_pk_bf16_f32 v26, v88, v89
v_cvt_pk_bf16_f32 v28, v90, v91
v_cvt_pk_bf16_f32 v30, v92, v93
v_cvt_pk_bf16_f32 v32, v94, v95
buffer_store_dwordx4 v[18:21], v224, s[16:19], s43 offen offset:0 sc1
buffer_store_dwordx4 v[22:25], v224, s[16:19], s43 offen offset:1024 sc1
buffer_store_dwordx4 v[26:29], v224, s[16:19], s43 offen offset:2048 sc1
buffer_store_dwordx4 v[30:33], v224, s[16:19], s43 offen offset:3072 sc1
s_add_u32 s43, s62, 131072
v_cvt_pk_bf16_f32 v34, v96, v97
v_cvt_pk_bf16_f32 v36, v98, v99
v_cvt_pk_bf16_f32 v38, v100, v101
v_cvt_pk_bf16_f32 v40, v102, v103
v_cvt_pk_bf16_f32 v42, v104, v105
v_cvt_pk_bf16_f32 v44, v106, v107
v_cvt_pk_bf16_f32 v46, v108, v109
v_cvt_pk_bf16_f32 v48, v110, v111
buffer_store_dwordx4 v[34:37], v224, s[16:19], s43 offen offset:0 sc1
buffer_store_dwordx4 v[38:41], v224, s[16:19], s43 offen offset:1024 sc1
buffer_store_dwordx4 v[42:45], v224, s[16:19], s43 offen offset:2048 sc1
buffer_store_dwordx4 v[46:49], v224, s[16:19], s43 offen offset:3072 sc1
v_mov_b32 v176, v112
v_mov_b32 v177, v113
v_mov_b32 v178, v114
v_mov_b32 v179, v115
v_mov_b32 v180, v116
v_mov_b32 v181, v117
v_mov_b32 v182, v118
v_mov_b32 v183, v119
v_mov_b32 v184, v120
v_mov_b32 v185, v121
v_mov_b32 v186, v122
v_mov_b32 v187, v123
v_mov_b32 v188, v124
v_mov_b32 v189, v125
v_mov_b32 v190, v126
v_mov_b32 v191, v127
s_branch L_x_done_73
L_x_done_73:
v_sub_f32 v50, 1.0, v212
v_lshlrev_b32 v51, 16, v214
v_fmac_f32 v176, v50, v51
v_and_b32 v51, 0xffff0000, v214
v_fmac_f32 v177, v50, v51
v_lshlrev_b32 v51, 16, v215
v_fmac_f32 v178, v50, v51
v_and_b32 v51, 0xffff0000, v215
v_fmac_f32 v179, v50, v51
v_lshlrev_b32 v51, 16, v216
v_fmac_f32 v180, v50, v51
v_and_b32 v51, 0xffff0000, v216
v_fmac_f32 v181, v50, v51
v_lshlrev_b32 v51, 16, v217
v_fmac_f32 v182, v50, v51
v_and_b32 v51, 0xffff0000, v217
v_fmac_f32 v183, v50, v51
v_lshlrev_b32 v51, 16, v218
v_fmac_f32 v184, v50, v51
v_and_b32 v51, 0xffff0000, v218
v_fmac_f32 v185, v50, v51
v_lshlrev_b32 v51, 16, v219
v_fmac_f32 v186, v50, v51
v_and_b32 v51, 0xffff0000, v219
v_fmac_f32 v187, v50, v51
v_lshlrev_b32 v51, 16, v220
v_fmac_f32 v188, v50, v51
v_and_b32 v51, 0xffff0000, v220
v_fmac_f32 v189, v50, v51
v_lshlrev_b32 v51, 16, v221
v_fmac_f32 v190, v50, v51
v_and_b32 v51, 0xffff0000, v221
v_fmac_f32 v191, v50, v51
s_add_u32 s40, s52, 1
s_and_b32 s40, s40, 3
s_lshl_b32 s40, s40, 14
s_add_u32 s68, s63, s40
s_add_u32 s40, s52, 2
s_and_b32 s40, s40, 3
s_lshl_b32 s40, s40, 14
s_add_u32 s69, s63, s40
s_add_u32 s40, s52, 3
s_and_b32 s40, s40, 3
s_lshl_b32 s40, s40, 14
s_add_u32 s70, s63, s40
s_mov_b64 s[64:65], exec
s_mov_b32 exec_lo, 0
s_mov_b32 exec_hi, 0x80000000
L_px_79:
buffer_load_dwordx4 v[64:67], v224, s[16:19], s68 offen offset:3072 sc1
buffer_load_dwordx4 v[68:71], v224, s[16:19], s69 offen offset:3072 sc1
buffer_load_dwordx4 v[72:75], v224, s[16:19], s70 offen offset:3072 sc1
s_waitcnt vmcnt(0)
v_xor_b32 v52, v211, v67
v_xor_b32 v53, v211, v71
v_xor_b32 v54, v211, v75
v_or3_b32 v54, v52, v53, v54
v_cmp_ne_u32 vcc, 0, v54
s_nop 1
s_cbranch_vccnz L_px_79
s_mov_b64 exec, s[64:65]
L_rx_78:
buffer_load_dwordx4 v[64:67], v224, s[16:19], s68 offen offset:0 sc1
buffer_load_dwordx4 v[68:71], v224, s[16:19], s68 offen offset:1024 sc1
buffer_load_dwordx4 v[72:75], v224, s[16:19], s68 offen offset:2048 sc1
buffer_load_dwordx4 v[76:79], v224, s[16:19], s68 offen offset:3072 sc1
buffer_load_dwordx4 v[80:83], v224, s[16:19], s69 offen offset:0 sc1
buffer_load_dwordx4 v[84:87], v224, s[16:19], s69 offen offset:1024 sc1
buffer_load_dwordx4 v[88:91], v224, s[16:19], s69 offen offset:2048 sc1
buffer_load_dwordx4 v[92:95], v224, s[16:19], s69 offen offset:3072 sc1
buffer_load_dwordx4 v[96:99], v224, s[16:19], s70 offen offset:0 sc1
buffer_load_dwordx4 v[100:103], v224, s[16:19], s70 offen offset:1024 sc1
buffer_load_dwordx4 v[104:107], v224, s[16:19], s70 offen offset:2048 sc1
buffer_load_dwordx4 v[108:111], v224, s[16:19], s70 offen offset:3072 sc1
s_waitcnt vmcnt(0)
v_xor_b32 v52, v211, v65
v_xor_b32 v53, v211, v67
v_or_b32 v54, v52, v53
v_xor_b32 v52, v211, v69
v_xor_b32 v53, v211, v71
v_or3_b32 v54, v52, v53, v54
v_xor_b32 v52, v211, v73
v_xor_b32 v53, v211, v75
v_or3_b32 v54, v52, v53, v54
v_xor_b32 v52, v211, v77
v_xor_b32 v53, v211, v79
v_or3_b32 v54, v52, v53, v54
v_xor_b32 v52, v211, v81
v_xor_b32 v53, v211, v83
v_or3_b32 v54, v52, v53, v54
v_xor_b32 v52, v211, v85
v_xor_b32 v53, v211, v87
v_or3_b32 v54, v52, v53, v54
v_xor_b32 v52, v211, v89
v_xor_b32 v53, v211, v91
v_or3_b32 v54, v52, v53, v54
v_xor_b32 v52, v211, v93
v_xor_b32 v53, v211, v95
v_or3_b32 v54, v52, v53, v54
v_xor_b32 v52, v211, v97
v_xor_b32 v53, v211, v99
v_or3_b32 v54, v52, v53, v54
v_xor_b32 v52, v211, v101
v_xor_b32 v53, v211, v103
v_or3_b32 v54, v52, v53, v54
v_xor_b32 v52, v211, v105
v_xor_b32 v53, v211, v107
v_or3_b32 v54, v52, v53, v54
v_xor_b32 v52, v211, v109
v_xor_b32 v53, v211, v111
v_or3_b32 v54, v52, v53, v54
v_cmp_ne_u32 vcc, 0, v54
s_nop 1
s_cbranch_vccnz L_rx_78
v_lshlrev_b32 v52, 16, v64
v_and_b32 v53, 0xffff0000, v64
v_pk_add_f32 v[176:177], v[176:177], v[52:53] op_sel:[0,0] op_sel_hi:[1,1]
v_lshlrev_b32 v54, 16, v66
v_and_b32 v55, 0xffff0000, v66
v_pk_add_f32 v[178:179], v[178:179], v[54:55] op_sel:[0,0] op_sel_hi:[1,1]
v_lshlrev_b32 v52, 16, v68
v_and_b32 v53, 0xffff0000, v68
v_pk_add_f32 v[180:181], v[180:181], v[52:53] op_sel:[0,0] op_sel_hi:[1,1]
v_lshlrev_b32 v54, 16, v70
v_and_b32 v55, 0xffff0000, v70
v_pk_add_f32 v[182:183], v[182:183], v[54:55] op_sel:[0,0] op_sel_hi:[1,1]
v_lshlrev_b32 v52, 16, v72
v_and_b32 v53, 0xffff0000, v72
v_pk_add_f32 v[184:185], v[184:185], v[52:53] op_sel:[0,0] op_sel_hi:[1,1]
v_lshlrev_b32 v54, 16, v74
v_and_b32 v55, 0xffff0000, v74
v_pk_add_f32 v[186:187], v[186:187], v[54:55] op_sel:[0,0] op_sel_hi:[1,1]
v_lshlrev_b32 v52, 16, v76
v_and_b32 v53, 0xffff0000, v76
v_pk_add_f32 v[188:189], v[188:189], v[52:53] op_sel:[0,0] op_sel_hi:[1,1]
v_lshlrev_b32 v54, 16, v78
v_and_b32 v55, 0xffff0000, v78
v_pk_add_f32 v[190:191], v[190:191], v[54:55] op_sel:[0,0] op_sel_hi:[1,1]
v_lshlrev_b32 v52, 16, v80
v_and_b32 v53, 0xffff0000, v80
v_pk_add_f32 v[176:177], v[176:177], v[52:53] op_sel:[0,0] op_sel_hi:[1,1]
v_lshlrev_b32 v54, 16, v82
v_and_b32 v55, 0xffff0000, v82
v_pk_add_f32 v[178:179], v[178:179], v[54:55] op_sel:[0,0] op_sel_hi:[1,1]
v_lshlrev_b32 v52, 16, v84
v_and_b32 v53, 0xffff0000, v84
v_pk_add_f32 v[180:181], v[180:181], v[52:53] op_sel:[0,0] op_sel_hi:[1,1]
v_lshlrev_b32 v54, 16, v86
v_and_b32 v55, 0xffff0000, v86
v_pk_add_f32 v[182:183], v[182:183], v[54:55] op_sel:[0,0] op_sel_hi:[1,1]
v_lshlrev_b32 v52, 16, v88
v_and_b32 v53, 0xffff0000, v88
v_pk_add_f32 v[184:185], v[184:185], v[52:53] op_sel:[0,0] op_sel_hi:[1,1]
v_lshlrev_b32 v54, 16, v90
v_and_b32 v55, 0xffff0000, v90
v_pk_add_f32 v[186:187], v[186:187], v[54:55] op_sel:[0,0] op_sel_hi:[1,1]
v_lshlrev_b32 v52, 16, v92
v_and_b32 v53, 0xffff0000, v92
v_pk_add_f32 v[188:189], v[188:189], v[52:53] op_sel:[0,0] op_sel_hi:[1,1]
v_lshlrev_b32 v54, 16, v94
v_and_b32 v55, 0xffff0000, v94
v_pk_add_f32 v[190:191], v[190:191], v[54:55] op_sel:[0,0] op_sel_hi:[1,1]
v_lshlrev_b32 v52, 16, v96
v_and_b32 v53, 0xffff0000, v96
v_pk_add_f32 v[176:177], v[176:177], v[52:53] op_sel:[0,0] op_sel_hi:[1,1]
v_lshlrev_b32 v54, 16, v98
v_and_b32 v55, 0xffff0000, v98
v_pk_add_f32 v[178:179], v[178:179], v[54:55] op_sel:[0,0] op_sel_hi:[1,1]
v_lshlrev_b32 v52, 16, v100
v_and_b32 v53, 0xffff0000, v100
v_pk_add_f32 v[180:181], v[180:181], v[52:53] op_sel:[0,0] op_sel_hi:[1,1]
v_lshlrev_b32 v54, 16, v102
v_and_b32 v55, 0xffff0000, v102
v_pk_add_f32 v[182:183], v[182:183], v[54:55] op_sel:[0,0] op_sel_hi:[1,1]
v_lshlrev_b32 v52, 16, v104
v_and_b32 v53, 0xffff0000, v104
v_pk_add_f32 v[184:185], v[184:185], v[52:53] op_sel:[0,0] op_sel_hi:[1,1]
v_lshlrev_b32 v54, 16, v106
v_and_b32 v55, 0xffff0000, v106
v_pk_add_f32 v[186:187], v[186:187], v[54:55] op_sel:[0,0] op_sel_hi:[1,1]
v_lshlrev_b32 v52, 16, v108
v_and_b32 v53, 0xffff0000, v108
v_pk_add_f32 v[188:189], v[188:189], v[52:53] op_sel:[0,0] op_sel_hi:[1,1]
v_lshlrev_b32 v54, 16, v110
v_and_b32 v55, 0xffff0000, v110
v_pk_add_f32 v[190:191], v[190:191], v[54:55] op_sel:[0,0] op_sel_hi:[1,1]
v_cvt_pk_bf16_f32 v40, v176, v177
v_cvt_pk_bf16_f32 v41, v178, v179
v_cvt_pk_bf16_f32 v42, v180, v181
v_cvt_pk_bf16_f32 v43, v182, v183
v_cvt_pk_bf16_f32 v44, v184, v185
v_cvt_pk_bf16_f32 v45, v186, v187
v_cvt_pk_bf16_f32 v46, v188, v189
v_cvt_pk_bf16_f32 v47, v190, v191
buffer_store_dwordx2 v[40:41], v210, s[20:23], s51 offen offset:0
buffer_store_dwordx2 v[42:43], v210, s[20:23], s51 offen offset:16
buffer_store_dwordx2 v[44:45], v210, s[20:23], s51 offen offset:32
buffer_store_dwordx2 v[46:47], v210, s[20:23], s51 offen offset:48
s_branch L_p3end_80
L_rare_17:
s_swappc_b64 s[72:73], s[28:29]
s_branch L_back_18
L_rare_19:
s_swappc_b64 s[72:73], s[30:31]
s_branch L_back_20
L_rare_24:
s_swappc_b64 s[72:73], s[28:29]
s_branch L_back_25
L_rare_26:
s_swappc_b64 s[72:73], s[30:31]
s_branch L_back_27
L_rare_28:
s_swappc_b64 s[72:73], s[28:29]
s_branch L_back_29
L_rare_30:
s_swappc_b64 s[72:73], s[30:31]
s_branch L_back_31
L_rare_34:
s_swappc_b64 s[72:73], s[28:29]
s_branch L_back_35
L_rare_36:
s_swappc_b64 s[72:73], s[30:31]
s_branch L_back_37
L_rare_38:
s_swappc_b64 s[72:73], s[28:29]
s_branch L_back_39
L_rare_40:
s_swappc_b64 s[72:73], s[30:31]
s_branch L_back_41
L_rare_42:
s_swappc_b64 s[72:73], s[74:75]
s_branch L_back_43
L_rare_44:
s_swappc_b64 s[72:73], s[76:77]
s_branch L_back_45
L_rare_49:
s_swappc_b64 s[72:73], s[74:75]
s_branch L_back_50
L_rare_51:
s_swappc_b64 s[72:73], s[76:77]
s_branch L_back_52
L_rare_55:
s_swappc_b64 s[72:73], s[74:75]
s_branch L_back_56
L_rare_57:
s_swappc_b64 s[72:73], s[76:77]
s_branch L_back_58
L_rare_65:
s_swappc_b64 s[72:73], s[74:75]
s_branch L_back_66
L_rare_67:
s_swappc_b64 s[72:73], s[76:77]
s_branch L_back_68
L_sub_0_2:
s_nop 15
s_nop 15
v_max3_f32 v18, v128, v129, v130
v_max3_f32 v18, v18, v131, v132
v_max3_f32 v18, v18, v133, v134
v_max3_f32 v18, v18, v135, v136
v_max3_f32 v18, v18, v137, v138
v_max3_f32 v18, v18, v139, v140
v_max3_f32 v18, v18, v141, v142
v_max_f32 v18, v18, v143
v_mov_b32 v19, v18
s_nop 1
v_permlane32_swap_b32 v19, v18
s_nop 1
v_max3_f32 v18, v18, v19, 0
v_sub_f32 v20, 0, v18
v_exp_f32 v20, v20
v_sub_f32 v224, v224, v18
v_sub_f32 v128, v128, v18
v_sub_f32 v160, v160, v18
v_sub_f32 v225, v225, v18
v_sub_f32 v129, v129, v18
v_sub_f32 v161, v161, v18
v_sub_f32 v226, v226, v18
v_sub_f32 v130, v130, v18
v_sub_f32 v162, v162, v18
v_sub_f32 v227, v227, v18
v_sub_f32 v131, v131, v18
v_sub_f32 v163, v163, v18
v_sub_f32 v228, v228, v18
v_sub_f32 v132, v132, v18
v_sub_f32 v164, v164, v18
v_sub_f32 v229, v229, v18
v_sub_f32 v133, v133, v18
v_sub_f32 v165, v165, v18
v_sub_f32 v230, v230, v18
v_sub_f32 v134, v134, v18
v_sub_f32 v166, v166, v18
v_sub_f32 v231, v231, v18
v_sub_f32 v135, v135, v18
v_sub_f32 v167, v167, v18
v_sub_f32 v232, v232, v18
v_sub_f32 v136, v136, v18
v_sub_f32 v168, v168, v18
v_sub_f32 v233, v233, v18
v_sub_f32 v137, v137, v18
v_sub_f32 v169, v169, v18
v_sub_f32 v234, v234, v18
v_sub_f32 v138, v138, v18
v_sub_f32 v170, v170, v18
v_sub_f32 v235, v235, v18
v_sub_f32 v139, v139, v18
v_sub_f32 v171, v171, v18
v_sub_f32 v236, v236, v18
v_sub_f32 v140, v140, v18
v_sub_f32 v172, v172, v18
v_sub_f32 v237, v237, v18
v_sub_f32 v141, v141, v18
v_sub_f32 v173, v173, v18
v_sub_f32 v238, v238, v18
v_sub_f32 v142, v142, v18
v_sub_f32 v174, v174, v18
v_sub_f32 v239, v239, v18
v_sub_f32 v143, v143, v18
v_sub_f32 v175, v175, v18
v_mul_f32 v4, v4, v20
v_exp_f32 v12, v128
v_exp_f32 v13, v129
v_exp_f32 v14, v130
v_add_f32 v6, v12, v13
v_cvt_pk_bf16_f32 v192, v12, v13
v_exp_f32 v15, v131
v_add_f32 v6, v6, v14
v_exp_f32 v16, v132
v_add_f32 v6, v6, v15
v_cvt_pk_bf16_f32 v193, v14, v15
v_exp_f32 v17, v133
v_add_f32 v6, v6, v16
v_exp_f32 v12, v134
v_add_f32 v6, v6, v17
v_cvt_pk_bf16_f32 v194, v16, v17
v_exp_f32 v13, v135
v_add_f32 v6, v6, v12
v_exp_f32 v14, v136
v_add_f32 v6, v6, v13
v_cvt_pk_bf16_f32 v195, v12, v13
v_exp_f32 v15, v137
v_add_f32 v6, v6, v14
v_exp_f32 v16, v138
v_add_f32 v6, v6, v15
v_cvt_pk_bf16_f32 v196, v14, v15
v_exp_f32 v17, v139
v_add_f32 v6, v6, v16
v_exp_f32 v12, v140
v_add_f32 v6, v6, v17
v_cvt_pk_bf16_f32 v197, v16, v17
v_exp_f32 v13, v141
v_add_f32 v6, v6, v12
v_exp_f32 v14, v142
v_add_f32 v6, v6, v13
v_cvt_pk_bf16_f32 v198, v12, v13
v_exp_f32 v15, v143
v_add_f32 v6, v6, v14
v_add_f32 v6, v6, v15
v_cvt_pk_bf16_f32 v199, v14, v15
v_accvgpr_read_b32 v21, a0
v_mul_f32 v21, v21, v20
v_accvgpr_write_b32 a0, v21
v_accvgpr_read_b32 v21, a1
v_mul_f32 v21, v21, v20
v_accvgpr_write_b32 a1, v21
v_accvgpr_read_b32 v21, a2
v_mul_f32 v21, v21, v20
v_accvgpr_write_b32 a2, v21
v_accvgpr_read_b32 v21, a3
v_mul_f32 v21, v21, v20
v_accvgpr_write_b32 a3, v21
v_accvgpr_read_b32 v21, a4
v_mul_f32 v21, v21, v20
v_accvgpr_write_b32 a4, v21
v_accvgpr_read_b32 v21, a5
v_mul_f32 v21, v21, v20
v_accvgpr_write_b32 a5, v21
v_accvgpr_read_b32 v21, a6
v_mul_f32 v21, v21, v20
v_accvgpr_write_b32 a6, v21
v_accvgpr_read_b32 v21, a7
v_mul_f32 v21, v21, v20
v_accvgpr_write_b32 a7, v21
v_accvgpr_read_b32 v21, a8
v_mul_f32 v21, v21, v20
v_accvgpr_write_b32 a8, v21
v_accvgpr_read_b32 v21, a9
v_mul_f32 v21, v21, v20
v_accvgpr_write_b32 a9, v21
v_accvgpr_read_b32 v21, a10
v_mul_f32 v21, v21, v20
v_accvgpr_write_b32 a10, v21
v_accvgpr_read_b32 v21, a11
v_mul_f32 v21, v21, v20
v_accvgpr_write_b32 a11, v21
v_accvgpr_read_b32 v21, a12
v_mul_f32 v21, v21, v20
v_accvgpr_write_b32 a12, v21
v_accvgpr_read_b32 v21, a13
v_mul_f32 v21, v21, v20
v_accvgpr_write_b32 a13, v21
v_accvgpr_read_b32 v21, a14
v_mul_f32 v21, v21, v20
v_accvgpr_write_b32 a14, v21
v_accvgpr_read_b32 v21, a15
v_mul_f32 v21, v21, v20
v_accvgpr_write_b32 a15, v21
v_accvgpr_read_b32 v21, a16
v_mul_f32 v21, v21, v20
v_accvgpr_write_b32 a16, v21
v_accvgpr_read_b32 v21, a17
v_mul_f32 v21, v21, v20
v_accvgpr_write_b32 a17, v21
v_accvgpr_read_b32 v21, a18
v_mul_f32 v21, v21, v20
v_accvgpr_write_b32 a18, v21
v_accvgpr_read_b32 v21, a19
v_mul_f32 v21, v21, v20
v_accvgpr_write_b32 a19, v21
v_accvgpr_read_b32 v21, a20
v_mul_f32 v21, v21, v20
v_accvgpr_write_b32 a20, v21
v_accvgpr_read_b32 v21, a21
v_mul_f32 v21, v21, v20
v_accvgpr_write_b32 a21, v21
v_accvgpr_read_b32 v21, a22
v_mul_f32 v21, v21, v20
v_accvgpr_write_b32 a22, v21
v_accvgpr_read_b32 v21, a23
v_mul_f32 v21, v21, v20
v_accvgpr_write_b32 a23, v21
v_accvgpr_read_b32 v21, a24
v_mul_f32 v21, v21, v20
v_accvgpr_write_b32 a24, v21
v_accvgpr_read_b32 v21, a25
v_mul_f32 v21, v21, v20
v_accvgpr_write_b32 a25, v21
v_accvgpr_read_b32 v21, a26
v_mul_f32 v21, v21, v20
v_accvgpr_write_b32 a26, v21
v_accvgpr_read_b32 v21, a27
v_mul_f32 v21, v21, v20
v_accvgpr_write_b32 a27, v21
v_accvgpr_read_b32 v21, a28
v_mul_f32 v21, v21, v20
v_accvgpr_write_b32 a28, v21
v_accvgpr_read_b32 v21, a29
v_mul_f32 v21, v21, v20
v_accvgpr_write_b32 a29, v21
v_accvgpr_read_b32 v21, a30
v_mul_f32 v21, v21, v20
v_accvgpr_write_b32 a30, v21
v_accvgpr_read_b32 v21, a31
v_mul_f32 v21, v21, v20
v_accvgpr_write_b32 a31, v21
v_accvgpr_read_b32 v21, a32
v_mul_f32 v21, v21, v20
v_accvgpr_write_b32 a32, v21
v_accvgpr_read_b32 v21, a33
v_mul_f32 v21, v21, v20
v_accvgpr_write_b32 a33, v21
v_accvgpr_read_b32 v21, a34
v_mul_f32 v21, v21, v20
v_accvgpr_write_b32 a34, v21
v_accvgpr_read_b32 v21, a35
v_mul_f32 v21, v21, v20
v_accvgpr_write_b32 a35, v21
v_accvgpr_read_b32 v21, a36
v_mul_f32 v21, v21, v20
v_accvgpr_write_b32 a36, v21
v_accvgpr_read_b32 v21, a37
v_mul_f32 v21, v21, v20
v_accvgpr_write_b32 a37, v21
v_accvgpr_read_b32 v21, a38
v_mul_f32 v21, v21, v20
v_accvgpr_write_b32 a38, v21
v_accvgpr_read_b32 v21, a39
v_mul_f32 v21, v21, v20
v_accvgpr_write_b32 a39, v21
v_accvgpr_read_b32 v21, a40
v_mul_f32 v21, v21, v20
v_accvgpr_write_b32 a40, v21
v_accvgpr_read_b32 v21, a41
v_mul_f32 v21, v21, v20
v_accvgpr_write_b32 a41, v21
v_accvgpr_read_b32 v21, a42
v_mul_f32 v21, v21, v20
v_accvgpr_write_b32 a42, v21
v_accvgpr_read_b32 v21, a43
v_mul_f32 v21, v21, v20
v_accvgpr_write_b32 a43, v21
v_accvgpr_read_b32 v21, a44
v_mul_f32 v21, v21, v20
v_accvgpr_write_b32 a44, v21
v_accvgpr_read_b32 v21, a45
v_mul_f32 v21, v21, v20
v_accvgpr_write_b32 a45, v21
v_accvgpr_read_b32 v21, a46
v_mul_f32 v21, v21, v20
v_accvgpr_write_b32 a46, v21
v_accvgpr_read_b32 v21, a47
v_mul_f32 v21, v21, v20
v_accvgpr_write_b32 a47, v21
v_accvgpr_read_b32 v21, a48
v_mul_f32 v21, v21, v20
v_accvgpr_write_b32 a48, v21
v_accvgpr_read_b32 v21, a49
v_mul_f32 v21, v21, v20
v_accvgpr_write_b32 a49, v21
v_accvgpr_read_b32 v21, a50
v_mul_f32 v21, v21, v20
v_accvgpr_write_b32 a50, v21
v_accvgpr_read_b32 v21, a51
v_mul_f32 v21, v21, v20
v_accvgpr_write_b32 a51, v21
v_accvgpr_read_b32 v21, a52
v_mul_f32 v21, v21, v20
v_accvgpr_write_b32 a52, v21
v_accvgpr_read_b32 v21, a53
v_mul_f32 v21, v21, v20
v_accvgpr_write_b32 a53, v21
v_accvgpr_read_b32 v21, a54
v_mul_f32 v21, v21, v20
v_accvgpr_write_b32 a54, v21
v_accvgpr_read_b32 v21, a55
v_mul_f32 v21, v21, v20
v_accvgpr_write_b32 a55, v21
v_accvgpr_read_b32 v21, a56
v_mul_f32 v21, v21, v20
v_accvgpr_write_b32 a56, v21
v_accvgpr_read_b32 v21, a57
v_mul_f32 v21, v21, v20
v_accvgpr_write_b32 a57, v21
v_accvgpr_read_b32 v21, a58
v_mul_f32 v21, v21, v20
v_accvgpr_write_b32 a58, v21
v_accvgpr_read_b32 v21, a59
v_mul_f32 v21, v21, v20
v_accvgpr_write_b32 a59, v21
v_accvgpr_read_b32 v21, a60
v_mul_f32 v21, v21, v20
v_accvgpr_write_b32 a60, v21
v_accvgpr_read_b32 v21, a61
v_mul_f32 v21, v21, v20
v_accvgpr_write_b32 a61, v21
v_accvgpr_read_b32 v21, a62
v_mul_f32 v21, v21, v20
v_accvgpr_write_b32 a62, v21
v_accvgpr_read_b32 v21, a63
v_mul_f32 v21, v21, v20
v_accvgpr_write_b32 a63, v21
v_max3_f32 v18, v144, v145, v146
v_max3_f32 v18, v18, v147, v148
v_max3_f32 v18, v18, v149, v150
v_max3_f32 v18, v18, v151, v152
v_max3_f32 v18, v18, v153, v154
v_max3_f32 v18, v18, v155, v156
v_max3_f32 v18, v18, v157, v158
v_max_f32 v18, v18, v159
v_mov_b32 v19, v18
s_nop 1
v_permlane32_swap_b32 v19, v18
s_nop 1
v_max3_f32 v18, v18, v19, 0
v_sub_f32 v20, 0, v18
v_exp_f32 v20, v20
v_sub_f32 v240, v240, v18
v_sub_f32 v144, v144, v18
v_sub_f32 v176, v176, v18
v_sub_f32 v241, v241, v18
v_sub_f32 v145, v145, v18
v_sub_f32 v177, v177, v18
v_sub_f32 v242, v242, v18
v_sub_f32 v146, v146, v18
v_sub_f32 v178, v178, v18
v_sub_f32 v243, v243, v18
v_sub_f32 v147, v147, v18
v_sub_f32 v179, v179, v18
v_sub_f32 v244, v244, v18
v_sub_f32 v148, v148, v18
v_sub_f32 v180, v180, v18
v_sub_f32 v245, v245, v18
v_sub_f32 v149, v149, v18
v_sub_f32 v181, v181, v18
v_sub_f32 v246, v246, v18
v_sub_f32 v150, v150, v18
v_sub_f32 v182, v182, v18
v_sub_f32 v247, v247, v18
v_sub_f32 v151, v151, v18
v_sub_f32 v183, v183, v18
v_sub_f32 v248, v248, v18
v_sub_f32 v152, v152, v18
v_sub_f32 v184, v184, v18
v_sub_f32 v249, v249, v18
v_sub_f32 v153, v153, v18
v_sub_f32 v185, v185, v18
v_sub_f32 v250, v250, v18
v_sub_f32 v154, v154, v18
v_sub_f32 v186, v186, v18
v_sub_f32 v251, v251, v18
v_sub_f32 v155, v155, v18
v_sub_f32 v187, v187, v18
v_sub_f32 v252, v252, v18
v_sub_f32 v156, v156, v18
v_sub_f32 v188, v188, v18
v_sub_f32 v253, v253, v18
v_sub_f32 v157, v157, v18
v_sub_f32 v189, v189, v18
v_sub_f32 v254, v254, v18
v_sub_f32 v158, v158, v18
v_sub_f32 v190, v190, v18
v_sub_f32 v255, v255, v18
v_sub_f32 v159, v159, v18
v_sub_f32 v191, v191, v18
v_mul_f32 v5, v5, v20
v_exp_f32 v12, v144
v_exp_f32 v13, v145
v_exp_f32 v14, v146
v_add_f32 v7, v12, v13
v_cvt_pk_bf16_f32 v200, v12, v13
v_exp_f32 v15, v147
v_add_f32 v7, v7, v14
v_exp_f32 v16, v148
v_add_f32 v7, v7, v15
v_cvt_pk_bf16_f32 v201, v14, v15
v_exp_f32 v17, v149
v_add_f32 v7, v7, v16
v_exp_f32 v12, v150
v_add_f32 v7, v7, v17
v_cvt_pk_bf16_f32 v202, v16, v17
v_exp_f32 v13, v151
v_add_f32 v7, v7, v12
v_exp_f32 v14, v152
v_add_f32 v7, v7, v13
v_cvt_pk_bf16_f32 v203, v12, v13
v_exp_f32 v15, v153
v_add_f32 v7, v7, v14
v_exp_f32 v16, v154
v_add_f32 v7, v7, v15
v_cvt_pk_bf16_f32 v204, v14, v15
v_exp_f32 v17, v155
v_add_f32 v7, v7, v16
v_exp_f32 v12, v156
v_add_f32 v7, v7, v17
v_cvt_pk_bf16_f32 v205, v16, v17
v_exp_f32 v13, v157
v_add_f32 v7, v7, v12
v_exp_f32 v14, v158
v_add_f32 v7, v7, v13
v_cvt_pk_bf16_f32 v206, v12, v13
v_exp_f32 v15, v159
v_add_f32 v7, v7, v14
v_add_f32 v7, v7, v15
v_cvt_pk_bf16_f32 v207, v14, v15
v_accvgpr_read_b32 v21, a64
v_mul_f32 v21, v21, v20
v_accvgpr_write_b32 a64, v21
v_accvgpr_read_b32 v21, a65
v_mul_f32 v21, v21, v20
v_accvgpr_write_b32 a65, v21
v_accvgpr_read_b32 v21, a66
v_mul_f32 v21, v21, v20
v_accvgpr_write_b32 a66, v21
v_accvgpr_read_b32 v21, a67
v_mul_f32 v21, v21, v20
v_accvgpr_write_b32 a67, v21
v_accvgpr_read_b32 v21, a68
v_mul_f32 v21, v21, v20
v_accvgpr_write_b32 a68, v21
v_accvgpr_read_b32 v21, a69
v_mul_f32 v21, v21, v20
v_accvgpr_write_b32 a69, v21
v_accvgpr_read_b32 v21, a70
v_mul_f32 v21, v21, v20
v_accvgpr_write_b32 a70, v21
v_accvgpr_read_b32 v21, a71
v_mul_f32 v21, v21, v20
v_accvgpr_write_b32 a71, v21
v_accvgpr_read_b32 v21, a72
v_mul_f32 v21, v21, v20
v_accvgpr_write_b32 a72, v21
v_accvgpr_read_b32 v21, a73
v_mul_f32 v21, v21, v20
v_accvgpr_write_b32 a73, v21
v_accvgpr_read_b32 v21, a74
v_mul_f32 v21, v21, v20
v_accvgpr_write_b32 a74, v21
v_accvgpr_read_b32 v21, a75
v_mul_f32 v21, v21, v20
v_accvgpr_write_b32 a75, v21
v_accvgpr_read_b32 v21, a76
v_mul_f32 v21, v21, v20
v_accvgpr_write_b32 a76, v21
v_accvgpr_read_b32 v21, a77
v_mul_f32 v21, v21, v20
v_accvgpr_write_b32 a77, v21
v_accvgpr_read_b32 v21, a78
v_mul_f32 v21, v21, v20
v_accvgpr_write_b32 a78, v21
v_accvgpr_read_b32 v21, a79
v_mul_f32 v21, v21, v20
v_accvgpr_write_b32 a79, v21
v_accvgpr_read_b32 v21, a80
v_mul_f32 v21, v21, v20
v_accvgpr_write_b32 a80, v21
v_accvgpr_read_b32 v21, a81
v_mul_f32 v21, v21, v20
v_accvgpr_write_b32 a81, v21
v_accvgpr_read_b32 v21, a82
v_mul_f32 v21, v21, v20
v_accvgpr_write_b32 a82, v21
v_accvgpr_read_b32 v21, a83
v_mul_f32 v21, v21, v20
v_accvgpr_write_b32 a83, v21
v_accvgpr_read_b32 v21, a84
v_mul_f32 v21, v21, v20
v_accvgpr_write_b32 a84, v21
v_accvgpr_read_b32 v21, a85
v_mul_f32 v21, v21, v20
v_accvgpr_write_b32 a85, v21
v_accvgpr_read_b32 v21, a86
v_mul_f32 v21, v21, v20
v_accvgpr_write_b32 a86, v21
v_accvgpr_read_b32 v21, a87
v_mul_f32 v21, v21, v20
v_accvgpr_write_b32 a87, v21
v_accvgpr_read_b32 v21, a88
v_mul_f32 v21, v21, v20
v_accvgpr_write_b32 a88, v21
v_accvgpr_read_b32 v21, a89
v_mul_f32 v21, v21, v20
v_accvgpr_write_b32 a89, v21
v_accvgpr_read_b32 v21, a90
v_mul_f32 v21, v21, v20
v_accvgpr_write_b32 a90, v21
v_accvgpr_read_b32 v21, a91
v_mul_f32 v21, v21, v20
v_accvgpr_write_b32 a91, v21
v_accvgpr_read_b32 v21, a92
v_mul_f32 v21, v21, v20
v_accvgpr_write_b32 a92, v21
v_accvgpr_read_b32 v21, a93
v_mul_f32 v21, v21, v20
v_accvgpr_write_b32 a93, v21
v_accvgpr_read_b32 v21, a94
v_mul_f32 v21, v21, v20
v_accvgpr_write_b32 a94, v21
v_accvgpr_read_b32 v21, a95
v_mul_f32 v21, v21, v20
v_accvgpr_write_b32 a95, v21
v_accvgpr_read_b32 v21, a96
v_mul_f32 v21, v21, v20
v_accvgpr_write_b32 a96, v21
v_accvgpr_read_b32 v21, a97
v_mul_f32 v21, v21, v20
v_accvgpr_write_b32 a97, v21
v_accvgpr_read_b32 v21, a98
v_mul_f32 v21, v21, v20
v_accvgpr_write_b32 a98, v21
v_accvgpr_read_b32 v21, a99
v_mul_f32 v21, v21, v20
v_accvgpr_write_b32 a99, v21
v_accvgpr_read_b32 v21, a100
v_mul_f32 v21, v21, v20
v_accvgpr_write_b32 a100, v21
v_accvgpr_read_b32 v21, a101
v_mul_f32 v21, v21, v20
v_accvgpr_write_b32 a101, v21
v_accvgpr_read_b32 v21, a102
v_mul_f32 v21, v21, v20
v_accvgpr_write_b32 a102, v21
v_accvgpr_read_b32 v21, a103
v_mul_f32 v21, v21, v20
v_accvgpr_write_b32 a103, v21
v_accvgpr_read_b32 v21, a104
v_mul_f32 v21, v21, v20
v_accvgpr_write_b32 a104, v21
v_accvgpr_read_b32 v21, a105
v_mul_f32 v21, v21, v20
v_accvgpr_write_b32 a105, v21
v_accvgpr_read_b32 v21, a106
v_mul_f32 v21, v21, v20
v_accvgpr_write_b32 a106, v21
v_accvgpr_read_b32 v21, a107
v_mul_f32 v21, v21, v20
v_accvgpr_write_b32 a107, v21
v_accvgpr_read_b32 v21, a108
v_mul_f32 v21, v21, v20
v_accvgpr_write_b32 a108, v21
v_accvgpr_read_b32 v21, a109
v_mul_f32 v21, v21, v20
v_accvgpr_write_b32 a109, v21
v_accvgpr_read_b32 v21, a110
v_mul_f32 v21, v21, v20
v_accvgpr_write_b32 a110, v21
v_accvgpr_read_b32 v21, a111
v_mul_f32 v21, v21, v20
v_accvgpr_write_b32 a111, v21
v_accvgpr_read_b32 v21, a112
v_mul_f32 v21, v21, v20
v_accvgpr_write_b32 a112, v21
v_accvgpr_read_b32 v21, a113
v_mul_f32 v21, v21, v20
v_accvgpr_write_b32 a113, v21
v_accvgpr_read_b32 v21, a114
v_mul_f32 v21, v21, v20
v_accvgpr_write_b32 a114, v21
v_accvgpr_read_b32 v21, a115
v_mul_f32 v21, v21, v20
v_accvgpr_write_b32 a115, v21
v_accvgpr_read_b32 v21, a116
v_mul_f32 v21, v21, v20
v_accvgpr_write_b32 a116, v21
v_accvgpr_read_b32 v21, a117
v_mul_f32 v21, v21, v20
v_accvgpr_write_b32 a117, v21
v_accvgpr_read_b32 v21, a118
v_mul_f32 v21, v21, v20
v_accvgpr_write_b32 a118, v21
v_accvgpr_read_b32 v21, a119
v_mul_f32 v21, v21, v20
v_accvgpr_write_b32 a119, v21
v_accvgpr_read_b32 v21, a120
v_mul_f32 v21, v21, v20
v_accvgpr_write_b32 a120, v21
v_accvgpr_read_b32 v21, a121
v_mul_f32 v21, v21, v20
v_accvgpr_write_b32 a121, v21
v_accvgpr_read_b32 v21, a122
v_mul_f32 v21, v21, v20
v_accvgpr_write_b32 a122, v21
v_accvgpr_read_b32 v21, a123
v_mul_f32 v21, v21, v20
v_accvgpr_write_b32 a123, v21
v_accvgpr_read_b32 v21, a124
v_mul_f32 v21, v21, v20
v_accvgpr_write_b32 a124, v21
v_accvgpr_read_b32 v21, a125
v_mul_f32 v21, v21, v20
v_accvgpr_write_b32 a125, v21
v_accvgpr_read_b32 v21, a126
v_mul_f32 v21, v21, v20
v_accvgpr_write_b32 a126, v21
v_accvgpr_read_b32 v21, a127
v_mul_f32 v21, v21, v20
v_accvgpr_write_b32 a127, v21
s_nop 2
s_setpc_b64 s[72:73]
L_sub_1_2:
s_nop 15
s_nop 15
v_max3_f32 v18, v160, v161, v162
v_max3_f32 v18, v18, v163, v164
v_max3_f32 v18, v18, v165, v166
v_max3_f32 v18, v18, v167, v168
v_max3_f32 v18, v18, v169, v170
v_max3_f32 v18, v18, v171, v172
v_max3_f32 v18, v18, v173, v174
v_max_f32 v18, v18, v175
v_mov_b32 v19, v18
s_nop 1
v_permlane32_swap_b32 v19, v18
s_nop 1
v_max3_f32 v18, v18, v19, 0
v_sub_f32 v20, 0, v18
v_exp_f32 v20, v20
v_sub_f32 v224, v224, v18
v_sub_f32 v160, v160, v18
v_sub_f32 v128, v128, v18
v_sub_f32 v225, v225, v18
v_sub_f32 v161, v161, v18
v_sub_f32 v129, v129, v18
v_sub_f32 v226, v226, v18
v_sub_f32 v162, v162, v18
v_sub_f32 v130, v130, v18
v_sub_f32 v227, v227, v18
v_sub_f32 v163, v163, v18
v_sub_f32 v131, v131, v18
v_sub_f32 v228, v228, v18
v_sub_f32 v164, v164, v18
v_sub_f32 v132, v132, v18
v_sub_f32 v229, v229, v18
v_sub_f32 v165, v165, v18
v_sub_f32 v133, v133, v18
v_sub_f32 v230, v230, v18
v_sub_f32 v166, v166, v18
v_sub_f32 v134, v134, v18
v_sub_f32 v231, v231, v18
v_sub_f32 v167, v167, v18
v_sub_f32 v135, v135, v18
v_sub_f32 v232, v232, v18
v_sub_f32 v168, v168, v18
v_sub_f32 v136, v136, v18
v_sub_f32 v233, v233, v18
v_sub_f32 v169, v169, v18
v_sub_f32 v137, v137, v18
v_sub_f32 v234, v234, v18
v_sub_f32 v170, v170, v18
v_sub_f32 v138, v138, v18
v_sub_f32 v235, v235, v18
v_sub_f32 v171, v171, v18
v_sub_f32 v139, v139, v18
v_sub_f32 v236, v236, v18
v_sub_f32 v172, v172, v18
v_sub_f32 v140, v140, v18
v_sub_f32 v237, v237, v18
v_sub_f32 v173, v173, v18
v_sub_f32 v141, v141, v18
v_sub_f32 v238, v238, v18
v_sub_f32 v174, v174, v18
v_sub_f32 v142, v142, v18
v_sub_f32 v239, v239, v18
v_sub_f32 v175, v175, v18
v_sub_f32 v143, v143, v18
v_mul_f32 v4, v4, v20
v_exp_f32 v12, v160
v_exp_f32 v13, v161
v_exp_f32 v14, v162
v_add_f32 v6, v12, v13
v_cvt_pk_bf16_f32 v208, v12, v13
v_exp_f32 v15, v163
v_add_f32 v6, v6, v14
v_exp_f32 v16, v164
v_add_f32 v6, v6, v15
v_cvt_pk_bf16_f32 v209, v14, v15
v_exp_f32 v17, v165
v_add_f32 v6, v6, v16
v_exp_f32 v12, v166
v_add_f32 v6, v6, v17
v_cvt_pk_bf16_f32 v210, v16, v17
v_exp_f32 v13, v167
v_add_f32 v6, v6, v12
v_exp_f32 v14, v168
v_add_f32 v6, v6, v13
v_cvt_pk_bf16_f32 v211, v12, v13
v_exp_f32 v15, v169
v_add_f32 v6, v6, v14
v_exp_f32 v16, v170
v_add_f32 v6, v6, v15
v_cvt_pk_bf16_f32 v212, v14, v15
v_exp_f32 v17, v171
v_add_f32 v6, v6, v16
v_exp_f32 v12, v172
v_add_f32 v6, v6, v17
v_cvt_pk_bf16_f32 v213, v16, v17
v_exp_f32 v13, v173
v_add_f32 v6, v6, v12
v_exp_f32 v14, v174
v_add_f32 v6, v6, v13
v_cvt_pk_bf16_f32 v214, v12, v13
v_exp_f32 v15, v175
v_add_f32 v6, v6, v14
v_add_f32 v6, v6, v15
v_cvt_pk_bf16_f32 v215, v14, v15
v_accvgpr_read_b32 v21, a0
v_mul_f32 v21, v21, v20
v_accvgpr_write_b32 a0, v21
v_accvgpr_read_b32 v21, a1
v_mul_f32 v21, v21, v20
v_accvgpr_write_b32 a1, v21
v_accvgpr_read_b32 v21, a2
v_mul_f32 v21, v21, v20
v_accvgpr_write_b32 a2, v21
v_accvgpr_read_b32 v21, a3
v_mul_f32 v21, v21, v20
v_accvgpr_write_b32 a3, v21
v_accvgpr_read_b32 v21, a4
v_mul_f32 v21, v21, v20
v_accvgpr_write_b32 a4, v21
v_accvgpr_read_b32 v21, a5
v_mul_f32 v21, v21, v20
v_accvgpr_write_b32 a5, v21
v_accvgpr_read_b32 v21, a6
v_mul_f32 v21, v21, v20
v_accvgpr_write_b32 a6, v21
v_accvgpr_read_b32 v21, a7
v_mul_f32 v21, v21, v20
v_accvgpr_write_b32 a7, v21
v_accvgpr_read_b32 v21, a8
v_mul_f32 v21, v21, v20
v_accvgpr_write_b32 a8, v21
v_accvgpr_read_b32 v21, a9
v_mul_f32 v21, v21, v20
v_accvgpr_write_b32 a9, v21
v_accvgpr_read_b32 v21, a10
v_mul_f32 v21, v21, v20
v_accvgpr_write_b32 a10, v21
v_accvgpr_read_b32 v21, a11
v_mul_f32 v21, v21, v20
v_accvgpr_write_b32 a11, v21
v_accvgpr_read_b32 v21, a12
v_mul_f32 v21, v21, v20
v_accvgpr_write_b32 a12, v21
v_accvgpr_read_b32 v21, a13
v_mul_f32 v21, v21, v20
v_accvgpr_write_b32 a13, v21
v_accvgpr_read_b32 v21, a14
v_mul_f32 v21, v21, v20
v_accvgpr_write_b32 a14, v21
v_accvgpr_read_b32 v21, a15
v_mul_f32 v21, v21, v20
v_accvgpr_write_b32 a15, v21
v_accvgpr_read_b32 v21, a16
v_mul_f32 v21, v21, v20
v_accvgpr_write_b32 a16, v21
v_accvgpr_read_b32 v21, a17
v_mul_f32 v21, v21, v20
v_accvgpr_write_b32 a17, v21
v_accvgpr_read_b32 v21, a18
v_mul_f32 v21, v21, v20
v_accvgpr_write_b32 a18, v21
v_accvgpr_read_b32 v21, a19
v_mul_f32 v21, v21, v20
v_accvgpr_write_b32 a19, v21
v_accvgpr_read_b32 v21, a20
v_mul_f32 v21, v21, v20
v_accvgpr_write_b32 a20, v21
v_accvgpr_read_b32 v21, a21
v_mul_f32 v21, v21, v20
v_accvgpr_write_b32 a21, v21
v_accvgpr_read_b32 v21, a22
v_mul_f32 v21, v21, v20
v_accvgpr_write_b32 a22, v21
v_accvgpr_read_b32 v21, a23
v_mul_f32 v21, v21, v20
v_accvgpr_write_b32 a23, v21
v_accvgpr_read_b32 v21, a24
v_mul_f32 v21, v21, v20
v_accvgpr_write_b32 a24, v21
v_accvgpr_read_b32 v21, a25
v_mul_f32 v21, v21, v20
v_accvgpr_write_b32 a25, v21
v_accvgpr_read_b32 v21, a26
v_mul_f32 v21, v21, v20
v_accvgpr_write_b32 a26, v21
v_accvgpr_read_b32 v21, a27
v_mul_f32 v21, v21, v20
v_accvgpr_write_b32 a27, v21
v_accvgpr_read_b32 v21, a28
v_mul_f32 v21, v21, v20
v_accvgpr_write_b32 a28, v21
v_accvgpr_read_b32 v21, a29
v_mul_f32 v21, v21, v20
v_accvgpr_write_b32 a29, v21
v_accvgpr_read_b32 v21, a30
v_mul_f32 v21, v21, v20
v_accvgpr_write_b32 a30, v21
v_accvgpr_read_b32 v21, a31
v_mul_f32 v21, v21, v20
v_accvgpr_write_b32 a31, v21
v_accvgpr_read_b32 v21, a32
v_mul_f32 v21, v21, v20
v_accvgpr_write_b32 a32, v21
v_accvgpr_read_b32 v21, a33
v_mul_f32 v21, v21, v20
v_accvgpr_write_b32 a33, v21
v_accvgpr_read_b32 v21, a34
v_mul_f32 v21, v21, v20
v_accvgpr_write_b32 a34, v21
v_accvgpr_read_b32 v21, a35
v_mul_f32 v21, v21, v20
v_accvgpr_write_b32 a35, v21
v_accvgpr_read_b32 v21, a36
v_mul_f32 v21, v21, v20
v_accvgpr_write_b32 a36, v21
v_accvgpr_read_b32 v21, a37
v_mul_f32 v21, v21, v20
v_accvgpr_write_b32 a37, v21
v_accvgpr_read_b32 v21, a38
v_mul_f32 v21, v21, v20
v_accvgpr_write_b32 a38, v21
v_accvgpr_read_b32 v21, a39
v_mul_f32 v21, v21, v20
v_accvgpr_write_b32 a39, v21
v_accvgpr_read_b32 v21, a40
v_mul_f32 v21, v21, v20
v_accvgpr_write_b32 a40, v21
v_accvgpr_read_b32 v21, a41
v_mul_f32 v21, v21, v20
v_accvgpr_write_b32 a41, v21
v_accvgpr_read_b32 v21, a42
v_mul_f32 v21, v21, v20
v_accvgpr_write_b32 a42, v21
v_accvgpr_read_b32 v21, a43
v_mul_f32 v21, v21, v20
v_accvgpr_write_b32 a43, v21
v_accvgpr_read_b32 v21, a44
v_mul_f32 v21, v21, v20
v_accvgpr_write_b32 a44, v21
v_accvgpr_read_b32 v21, a45
v_mul_f32 v21, v21, v20
v_accvgpr_write_b32 a45, v21
v_accvgpr_read_b32 v21, a46
v_mul_f32 v21, v21, v20
v_accvgpr_write_b32 a46, v21
v_accvgpr_read_b32 v21, a47
v_mul_f32 v21, v21, v20
v_accvgpr_write_b32 a47, v21
v_accvgpr_read_b32 v21, a48
v_mul_f32 v21, v21, v20
v_accvgpr_write_b32 a48, v21
v_accvgpr_read_b32 v21, a49
v_mul_f32 v21, v21, v20
v_accvgpr_write_b32 a49, v21
v_accvgpr_read_b32 v21, a50
v_mul_f32 v21, v21, v20
v_accvgpr_write_b32 a50, v21
v_accvgpr_read_b32 v21, a51
v_mul_f32 v21, v21, v20
v_accvgpr_write_b32 a51, v21
v_accvgpr_read_b32 v21, a52
v_mul_f32 v21, v21, v20
v_accvgpr_write_b32 a52, v21
v_accvgpr_read_b32 v21, a53
v_mul_f32 v21, v21, v20
v_accvgpr_write_b32 a53, v21
v_accvgpr_read_b32 v21, a54
v_mul_f32 v21, v21, v20
v_accvgpr_write_b32 a54, v21
v_accvgpr_read_b32 v21, a55
v_mul_f32 v21, v21, v20
v_accvgpr_write_b32 a55, v21
v_accvgpr_read_b32 v21, a56
v_mul_f32 v21, v21, v20
v_accvgpr_write_b32 a56, v21
v_accvgpr_read_b32 v21, a57
v_mul_f32 v21, v21, v20
v_accvgpr_write_b32 a57, v21
v_accvgpr_read_b32 v21, a58
v_mul_f32 v21, v21, v20
v_accvgpr_write_b32 a58, v21
v_accvgpr_read_b32 v21, a59
v_mul_f32 v21, v21, v20
v_accvgpr_write_b32 a59, v21
v_accvgpr_read_b32 v21, a60
v_mul_f32 v21, v21, v20
v_accvgpr_write_b32 a60, v21
v_accvgpr_read_b32 v21, a61
v_mul_f32 v21, v21, v20
v_accvgpr_write_b32 a61, v21
v_accvgpr_read_b32 v21, a62
v_mul_f32 v21, v21, v20
v_accvgpr_write_b32 a62, v21
v_accvgpr_read_b32 v21, a63
v_mul_f32 v21, v21, v20
v_accvgpr_write_b32 a63, v21
v_max3_f32 v18, v176, v177, v178
v_max3_f32 v18, v18, v179, v180
v_max3_f32 v18, v18, v181, v182
v_max3_f32 v18, v18, v183, v184
v_max3_f32 v18, v18, v185, v186
v_max3_f32 v18, v18, v187, v188
v_max3_f32 v18, v18, v189, v190
v_max_f32 v18, v18, v191
v_mov_b32 v19, v18
s_nop 1
v_permlane32_swap_b32 v19, v18
s_nop 1
v_max3_f32 v18, v18, v19, 0
v_sub_f32 v20, 0, v18
v_exp_f32 v20, v20
v_sub_f32 v240, v240, v18
v_sub_f32 v176, v176, v18
v_sub_f32 v144, v144, v18
v_sub_f32 v241, v241, v18
v_sub_f32 v177, v177, v18
v_sub_f32 v145, v145, v18
v_sub_f32 v242, v242, v18
v_sub_f32 v178, v178, v18
v_sub_f32 v146, v146, v18
v_sub_f32 v243, v243, v18
v_sub_f32 v179, v179, v18
v_sub_f32 v147, v147, v18
v_sub_f32 v244, v244, v18
v_sub_f32 v180, v180, v18
v_sub_f32 v148, v148, v18
v_sub_f32 v245, v245, v18
v_sub_f32 v181, v181, v18
v_sub_f32 v149, v149, v18
v_sub_f32 v246, v246, v18
v_sub_f32 v182, v182, v18
v_sub_f32 v150, v150, v18
v_sub_f32 v247, v247, v18
v_sub_f32 v183, v183, v18
v_sub_f32 v151, v151, v18
v_sub_f32 v248, v248, v18
v_sub_f32 v184, v184, v18
v_sub_f32 v152, v152, v18
v_sub_f32 v249, v249, v18
v_sub_f32 v185, v185, v18
v_sub_f32 v153, v153, v18
v_sub_f32 v250, v250, v18
v_sub_f32 v186, v186, v18
v_sub_f32 v154, v154, v18
v_sub_f32 v251, v251, v18
v_sub_f32 v187, v187, v18
v_sub_f32 v155, v155, v18
v_sub_f32 v252, v252, v18
v_sub_f32 v188, v188, v18
v_sub_f32 v156, v156, v18
v_sub_f32 v253, v253, v18
v_sub_f32 v189, v189, v18
v_sub_f32 v157, v157, v18
v_sub_f32 v254, v254, v18
v_sub_f32 v190, v190, v18
v_sub_f32 v158, v158, v18
v_sub_f32 v255, v255, v18
v_sub_f32 v191, v191, v18
v_sub_f32 v159, v159, v18
v_mul_f32 v5, v5, v20
v_exp_f32 v12, v176
v_exp_f32 v13, v177
v_exp_f32 v14, v178
v_add_f32 v7, v12, v13
v_cvt_pk_bf16_f32 v216, v12, v13
v_exp_f32 v15, v179
v_add_f32 v7, v7, v14
v_exp_f32 v16, v180
v_add_f32 v7, v7, v15
v_cvt_pk_bf16_f32 v217, v14, v15
v_exp_f32 v17, v181
v_add_f32 v7, v7, v16
v_exp_f32 v12, v182
v_add_f32 v7, v7, v17
v_cvt_pk_bf16_f32 v218, v16, v17
v_exp_f32 v13, v183
v_add_f32 v7, v7, v12
v_exp_f32 v14, v184
v_add_f32 v7, v7, v13
v_cvt_pk_bf16_f32 v219, v12, v13
v_exp_f32 v15, v185
v_add_f32 v7, v7, v14
v_exp_f32 v16, v186
v_add_f32 v7, v7, v15
v_cvt_pk_bf16_f32 v220, v14, v15
v_exp_f32 v17, v187
v_add_f32 v7, v7, v16
v_exp_f32 v12, v188
v_add_f32 v7, v7, v17
v_cvt_pk_bf16_f32 v221, v16, v17
v_exp_f32 v13, v189
v_add_f32 v7, v7, v12
v_exp_f32 v14, v190
v_add_f32 v7, v7, v13
v_cvt_pk_bf16_f32 v222, v12, v13
v_exp_f32 v15, v191
v_add_f32 v7, v7, v14
v_add_f32 v7, v7, v15
v_cvt_pk_bf16_f32 v223, v14, v15
v_accvgpr_read_b32 v21, a64
v_mul_f32 v21, v21, v20
v_accvgpr_write_b32 a64, v21
v_accvgpr_read_b32 v21, a65
v_mul_f32 v21, v21, v20
v_accvgpr_write_b32 a65, v21
v_accvgpr_read_b32 v21, a66
v_mul_f32 v21, v21, v20
v_accvgpr_write_b32 a66, v21
v_accvgpr_read_b32 v21, a67
v_mul_f32 v21, v21, v20
v_accvgpr_write_b32 a67, v21
v_accvgpr_read_b32 v21, a68
v_mul_f32 v21, v21, v20
v_accvgpr_write_b32 a68, v21
v_accvgpr_read_b32 v21, a69
v_mul_f32 v21, v21, v20
v_accvgpr_write_b32 a69, v21
v_accvgpr_read_b32 v21, a70
v_mul_f32 v21, v21, v20
v_accvgpr_write_b32 a70, v21
v_accvgpr_read_b32 v21, a71
v_mul_f32 v21, v21, v20
v_accvgpr_write_b32 a71, v21
v_accvgpr_read_b32 v21, a72
v_mul_f32 v21, v21, v20
v_accvgpr_write_b32 a72, v21
v_accvgpr_read_b32 v21, a73
v_mul_f32 v21, v21, v20
v_accvgpr_write_b32 a73, v21
v_accvgpr_read_b32 v21, a74
v_mul_f32 v21, v21, v20
v_accvgpr_write_b32 a74, v21
v_accvgpr_read_b32 v21, a75
v_mul_f32 v21, v21, v20
v_accvgpr_write_b32 a75, v21
v_accvgpr_read_b32 v21, a76
v_mul_f32 v21, v21, v20
v_accvgpr_write_b32 a76, v21
v_accvgpr_read_b32 v21, a77
v_mul_f32 v21, v21, v20
v_accvgpr_write_b32 a77, v21
v_accvgpr_read_b32 v21, a78
v_mul_f32 v21, v21, v20
v_accvgpr_write_b32 a78, v21
v_accvgpr_read_b32 v21, a79
v_mul_f32 v21, v21, v20
v_accvgpr_write_b32 a79, v21
v_accvgpr_read_b32 v21, a80
v_mul_f32 v21, v21, v20
v_accvgpr_write_b32 a80, v21
v_accvgpr_read_b32 v21, a81
v_mul_f32 v21, v21, v20
v_accvgpr_write_b32 a81, v21
v_accvgpr_read_b32 v21, a82
v_mul_f32 v21, v21, v20
v_accvgpr_write_b32 a82, v21
v_accvgpr_read_b32 v21, a83
v_mul_f32 v21, v21, v20
v_accvgpr_write_b32 a83, v21
v_accvgpr_read_b32 v21, a84
v_mul_f32 v21, v21, v20
v_accvgpr_write_b32 a84, v21
v_accvgpr_read_b32 v21, a85
v_mul_f32 v21, v21, v20
v_accvgpr_write_b32 a85, v21
v_accvgpr_read_b32 v21, a86
v_mul_f32 v21, v21, v20
v_accvgpr_write_b32 a86, v21
v_accvgpr_read_b32 v21, a87
v_mul_f32 v21, v21, v20
v_accvgpr_write_b32 a87, v21
v_accvgpr_read_b32 v21, a88
v_mul_f32 v21, v21, v20
v_accvgpr_write_b32 a88, v21
v_accvgpr_read_b32 v21, a89
v_mul_f32 v21, v21, v20
v_accvgpr_write_b32 a89, v21
v_accvgpr_read_b32 v21, a90
v_mul_f32 v21, v21, v20
v_accvgpr_write_b32 a90, v21
v_accvgpr_read_b32 v21, a91
v_mul_f32 v21, v21, v20
v_accvgpr_write_b32 a91, v21
v_accvgpr_read_b32 v21, a92
v_mul_f32 v21, v21, v20
v_accvgpr_write_b32 a92, v21
v_accvgpr_read_b32 v21, a93
v_mul_f32 v21, v21, v20
v_accvgpr_write_b32 a93, v21
v_accvgpr_read_b32 v21, a94
v_mul_f32 v21, v21, v20
v_accvgpr_write_b32 a94, v21
v_accvgpr_read_b32 v21, a95
v_mul_f32 v21, v21, v20
v_accvgpr_write_b32 a95, v21
v_accvgpr_read_b32 v21, a96
v_mul_f32 v21, v21, v20
v_accvgpr_write_b32 a96, v21
v_accvgpr_read_b32 v21, a97
v_mul_f32 v21, v21, v20
v_accvgpr_write_b32 a97, v21
v_accvgpr_read_b32 v21, a98
v_mul_f32 v21, v21, v20
v_accvgpr_write_b32 a98, v21
v_accvgpr_read_b32 v21, a99
v_mul_f32 v21, v21, v20
v_accvgpr_write_b32 a99, v21
v_accvgpr_read_b32 v21, a100
v_mul_f32 v21, v21, v20
v_accvgpr_write_b32 a100, v21
v_accvgpr_read_b32 v21, a101
v_mul_f32 v21, v21, v20
v_accvgpr_write_b32 a101, v21
v_accvgpr_read_b32 v21, a102
v_mul_f32 v21, v21, v20
v_accvgpr_write_b32 a102, v21
v_accvgpr_read_b32 v21, a103
v_mul_f32 v21, v21, v20
v_accvgpr_write_b32 a103, v21
v_accvgpr_read_b32 v21, a104
v_mul_f32 v21, v21, v20
v_accvgpr_write_b32 a104, v21
v_accvgpr_read_b32 v21, a105
v_mul_f32 v21, v21, v20
v_accvgpr_write_b32 a105, v21
v_accvgpr_read_b32 v21, a106
v_mul_f32 v21, v21, v20
v_accvgpr_write_b32 a106, v21
v_accvgpr_read_b32 v21, a107
v_mul_f32 v21, v21, v20
v_accvgpr_write_b32 a107, v21
v_accvgpr_read_b32 v21, a108
v_mul_f32 v21, v21, v20
v_accvgpr_write_b32 a108, v21
v_accvgpr_read_b32 v21, a109
v_mul_f32 v21, v21, v20
v_accvgpr_write_b32 a109, v21
v_accvgpr_read_b32 v21, a110
v_mul_f32 v21, v21, v20
v_accvgpr_write_b32 a110, v21
v_accvgpr_read_b32 v21, a111
v_mul_f32 v21, v21, v20
v_accvgpr_write_b32 a111, v21
v_accvgpr_read_b32 v21, a112
v_mul_f32 v21, v21, v20
v_accvgpr_write_b32 a112, v21
v_accvgpr_read_b32 v21, a113
v_mul_f32 v21, v21, v20
v_accvgpr_write_b32 a113, v21
v_accvgpr_read_b32 v21, a114
v_mul_f32 v21, v21, v20
v_accvgpr_write_b32 a114, v21
v_accvgpr_read_b32 v21, a115
v_mul_f32 v21, v21, v20
v_accvgpr_write_b32 a115, v21
v_accvgpr_read_b32 v21, a116
v_mul_f32 v21, v21, v20
v_accvgpr_write_b32 a116, v21
v_accvgpr_read_b32 v21, a117
v_mul_f32 v21, v21, v20
v_accvgpr_write_b32 a117, v21
v_accvgpr_read_b32 v21, a118
v_mul_f32 v21, v21, v20
v_accvgpr_write_b32 a118, v21
v_accvgpr_read_b32 v21, a119
v_mul_f32 v21, v21, v20
v_accvgpr_write_b32 a119, v21
v_accvgpr_read_b32 v21, a120
v_mul_f32 v21, v21, v20
v_accvgpr_write_b32 a120, v21
v_accvgpr_read_b32 v21, a121
v_mul_f32 v21, v21, v20
v_accvgpr_write_b32 a121, v21
v_accvgpr_read_b32 v21, a122
v_mul_f32 v21, v21, v20
v_accvgpr_write_b32 a122, v21
v_accvgpr_read_b32 v21, a123
v_mul_f32 v21, v21, v20
v_accvgpr_write_b32 a123, v21
v_accvgpr_read_b32 v21, a124
v_mul_f32 v21, v21, v20
v_accvgpr_write_b32 a124, v21
v_accvgpr_read_b32 v21, a125
v_mul_f32 v21, v21, v20
v_accvgpr_write_b32 a125, v21
v_accvgpr_read_b32 v21, a126
v_mul_f32 v21, v21, v20
v_accvgpr_write_b32 a126, v21
v_accvgpr_read_b32 v21, a127
v_mul_f32 v21, v21, v20
v_accvgpr_write_b32 a127, v21
s_nop 2
s_setpc_b64 s[72:73]
L_sub_0_1:
s_nop 15
s_nop 15
v_max3_f32 v18, v144, v145, v146
v_max3_f32 v18, v18, v147, v148
v_max3_f32 v18, v18, v149, v150
v_max3_f32 v18, v18, v151, v152
v_max3_f32 v18, v18, v153, v154
v_max3_f32 v18, v18, v155, v156
v_max3_f32 v18, v18, v157, v158
v_max_f32 v18, v18, v159
v_mov_b32 v19, v18
s_nop 1
v_permlane32_swap_b32 v19, v18
s_nop 1
v_max3_f32 v18, v18, v19, 0
v_sub_f32 v20, 0, v18
v_exp_f32 v20, v20
v_sub_f32 v240, v240, v18
v_sub_f32 v144, v144, v18
v_sub_f32 v176, v176, v18
v_sub_f32 v241, v241, v18
v_sub_f32 v145, v145, v18
v_sub_f32 v177, v177, v18
v_sub_f32 v242, v242, v18
v_sub_f32 v146, v146, v18
v_sub_f32 v178, v178, v18
v_sub_f32 v243, v243, v18
v_sub_f32 v147, v147, v18
v_sub_f32 v179, v179, v18
v_sub_f32 v244, v244, v18
v_sub_f32 v148, v148, v18
v_sub_f32 v180, v180, v18
v_sub_f32 v245, v245, v18
v_sub_f32 v149, v149, v18
v_sub_f32 v181, v181, v18
v_sub_f32 v246, v246, v18
v_sub_f32 v150, v150, v18
v_sub_f32 v182, v182, v18
v_sub_f32 v247, v247, v18
v_sub_f32 v151, v151, v18
v_sub_f32 v183, v183, v18
v_sub_f32 v248, v248, v18
v_sub_f32 v152, v152, v18
v_sub_f32 v184, v184, v18
v_sub_f32 v249, v249, v18
v_sub_f32 v153, v153, v18
v_sub_f32 v185, v185, v18
v_sub_f32 v250, v250, v18
v_sub_f32 v154, v154, v18
v_sub_f32 v186, v186, v18
v_sub_f32 v251, v251, v18
v_sub_f32 v155, v155, v18
v_sub_f32 v187, v187, v18
v_sub_f32 v252, v252, v18
v_sub_f32 v156, v156, v18
v_sub_f32 v188, v188, v18
v_sub_f32 v253, v253, v18
v_sub_f32 v157, v157, v18
v_sub_f32 v189, v189, v18
v_sub_f32 v254, v254, v18
v_sub_f32 v158, v158, v18
v_sub_f32 v190, v190, v18
v_sub_f32 v255, v255, v18
v_sub_f32 v159, v159, v18
v_sub_f32 v191, v191, v18
v_mul_f32 v5, v5, v20
v_exp_f32 v12, v144
v_exp_f32 v13, v145
v_exp_f32 v14, v146
v_add_f32 v7, v12, v13
v_cvt_pk_bf16_f32 v200, v12, v13
v_exp_f32 v15, v147
v_add_f32 v7, v7, v14
v_exp_f32 v16, v148
v_add_f32 v7, v7, v15
v_cvt_pk_bf16_f32 v201, v14, v15
v_exp_f32 v17, v149
v_add_f32 v7, v7, v16
v_exp_f32 v12, v150
v_add_f32 v7, v7, v17
v_cvt_pk_bf16_f32 v202, v16, v17
v_exp_f32 v13, v151
v_add_f32 v7, v7, v12
v_exp_f32 v14, v152
v_add_f32 v7, v7, v13
v_cvt_pk_bf16_f32 v203, v12, v13
v_exp_f32 v15, v153
v_add_f32 v7, v7, v14
v_exp_f32 v16, v154
v_add_f32 v7, v7, v15
v_cvt_pk_bf16_f32 v204, v14, v15
v_exp_f32 v17, v155
v_add_f32 v7, v7, v16
v_exp_f32 v12, v156
v_add_f32 v7, v7, v17
v_cvt_pk_bf16_f32 v205, v16, v17
v_exp_f32 v13, v157
v_add_f32 v7, v7, v12
v_exp_f32 v14, v158
v_add_f32 v7, v7, v13
v_cvt_pk_bf16_f32 v206, v12, v13
v_exp_f32 v15, v159
v_add_f32 v7, v7, v14
v_add_f32 v7, v7, v15
v_cvt_pk_bf16_f32 v207, v14, v15
v_accvgpr_read_b32 v21, a64
v_mul_f32 v21, v21, v20
v_accvgpr_write_b32 a64, v21
v_accvgpr_read_b32 v21, a65
v_mul_f32 v21, v21, v20
v_accvgpr_write_b32 a65, v21
v_accvgpr_read_b32 v21, a66
v_mul_f32 v21, v21, v20
v_accvgpr_write_b32 a66, v21
v_accvgpr_read_b32 v21, a67
v_mul_f32 v21, v21, v20
v_accvgpr_write_b32 a67, v21
v_accvgpr_read_b32 v21, a68
v_mul_f32 v21, v21, v20
v_accvgpr_write_b32 a68, v21
v_accvgpr_read_b32 v21, a69
v_mul_f32 v21, v21, v20
v_accvgpr_write_b32 a69, v21
v_accvgpr_read_b32 v21, a70
v_mul_f32 v21, v21, v20
v_accvgpr_write_b32 a70, v21
v_accvgpr_read_b32 v21, a71
v_mul_f32 v21, v21, v20
v_accvgpr_write_b32 a71, v21
v_accvgpr_read_b32 v21, a72
v_mul_f32 v21, v21, v20
v_accvgpr_write_b32 a72, v21
v_accvgpr_read_b32 v21, a73
v_mul_f32 v21, v21, v20
v_accvgpr_write_b32 a73, v21
v_accvgpr_read_b32 v21, a74
v_mul_f32 v21, v21, v20
v_accvgpr_write_b32 a74, v21
v_accvgpr_read_b32 v21, a75
v_mul_f32 v21, v21, v20
v_accvgpr_write_b32 a75, v21
v_accvgpr_read_b32 v21, a76
v_mul_f32 v21, v21, v20
v_accvgpr_write_b32 a76, v21
v_accvgpr_read_b32 v21, a77
v_mul_f32 v21, v21, v20
v_accvgpr_write_b32 a77, v21
v_accvgpr_read_b32 v21, a78
v_mul_f32 v21, v21, v20
v_accvgpr_write_b32 a78, v21
v_accvgpr_read_b32 v21, a79
v_mul_f32 v21, v21, v20
v_accvgpr_write_b32 a79, v21
v_accvgpr_read_b32 v21, a80
v_mul_f32 v21, v21, v20
v_accvgpr_write_b32 a80, v21
v_accvgpr_read_b32 v21, a81
v_mul_f32 v21, v21, v20
v_accvgpr_write_b32 a81, v21
v_accvgpr_read_b32 v21, a82
v_mul_f32 v21, v21, v20
v_accvgpr_write_b32 a82, v21
v_accvgpr_read_b32 v21, a83
v_mul_f32 v21, v21, v20
v_accvgpr_write_b32 a83, v21
v_accvgpr_read_b32 v21, a84
v_mul_f32 v21, v21, v20
v_accvgpr_write_b32 a84, v21
v_accvgpr_read_b32 v21, a85
v_mul_f32 v21, v21, v20
v_accvgpr_write_b32 a85, v21
v_accvgpr_read_b32 v21, a86
v_mul_f32 v21, v21, v20
v_accvgpr_write_b32 a86, v21
v_accvgpr_read_b32 v21, a87
v_mul_f32 v21, v21, v20
v_accvgpr_write_b32 a87, v21
v_accvgpr_read_b32 v21, a88
v_mul_f32 v21, v21, v20
v_accvgpr_write_b32 a88, v21
v_accvgpr_read_b32 v21, a89
v_mul_f32 v21, v21, v20
v_accvgpr_write_b32 a89, v21
v_accvgpr_read_b32 v21, a90
v_mul_f32 v21, v21, v20
v_accvgpr_write_b32 a90, v21
v_accvgpr_read_b32 v21, a91
v_mul_f32 v21, v21, v20
v_accvgpr_write_b32 a91, v21
v_accvgpr_read_b32 v21, a92
v_mul_f32 v21, v21, v20
v_accvgpr_write_b32 a92, v21
v_accvgpr_read_b32 v21, a93
v_mul_f32 v21, v21, v20
v_accvgpr_write_b32 a93, v21
v_accvgpr_read_b32 v21, a94
v_mul_f32 v21, v21, v20
v_accvgpr_write_b32 a94, v21
v_accvgpr_read_b32 v21, a95
v_mul_f32 v21, v21, v20
v_accvgpr_write_b32 a95, v21
v_accvgpr_read_b32 v21, a96
v_mul_f32 v21, v21, v20
v_accvgpr_write_b32 a96, v21
v_accvgpr_read_b32 v21, a97
v_mul_f32 v21, v21, v20
v_accvgpr_write_b32 a97, v21
v_accvgpr_read_b32 v21, a98
v_mul_f32 v21, v21, v20
v_accvgpr_write_b32 a98, v21
v_accvgpr_read_b32 v21, a99
v_mul_f32 v21, v21, v20
v_accvgpr_write_b32 a99, v21
v_accvgpr_read_b32 v21, a100
v_mul_f32 v21, v21, v20
v_accvgpr_write_b32 a100, v21
v_accvgpr_read_b32 v21, a101
v_mul_f32 v21, v21, v20
v_accvgpr_write_b32 a101, v21
v_accvgpr_read_b32 v21, a102
v_mul_f32 v21, v21, v20
v_accvgpr_write_b32 a102, v21
v_accvgpr_read_b32 v21, a103
v_mul_f32 v21, v21, v20
v_accvgpr_write_b32 a103, v21
v_accvgpr_read_b32 v21, a104
v_mul_f32 v21, v21, v20
v_accvgpr_write_b32 a104, v21
v_accvgpr_read_b32 v21, a105
v_mul_f32 v21, v21, v20
v_accvgpr_write_b32 a105, v21
v_accvgpr_read_b32 v21, a106
v_mul_f32 v21, v21, v20
v_accvgpr_write_b32 a106, v21
v_accvgpr_read_b32 v21, a107
v_mul_f32 v21, v21, v20
v_accvgpr_write_b32 a107, v21
v_accvgpr_read_b32 v21, a108
v_mul_f32 v21, v21, v20
v_accvgpr_write_b32 a108, v21
v_accvgpr_read_b32 v21, a109
v_mul_f32 v21, v21, v20
v_accvgpr_write_b32 a109, v21
v_accvgpr_read_b32 v21, a110
v_mul_f32 v21, v21, v20
v_accvgpr_write_b32 a110, v21
v_accvgpr_read_b32 v21, a111
v_mul_f32 v21, v21, v20
v_accvgpr_write_b32 a111, v21
v_accvgpr_read_b32 v21, a112
v_mul_f32 v21, v21, v20
v_accvgpr_write_b32 a112, v21
v_accvgpr_read_b32 v21, a113
v_mul_f32 v21, v21, v20
v_accvgpr_write_b32 a113, v21
v_accvgpr_read_b32 v21, a114
v_mul_f32 v21, v21, v20
v_accvgpr_write_b32 a114, v21
v_accvgpr_read_b32 v21, a115
v_mul_f32 v21, v21, v20
v_accvgpr_write_b32 a115, v21
v_accvgpr_read_b32 v21, a116
v_mul_f32 v21, v21, v20
v_accvgpr_write_b32 a116, v21
v_accvgpr_read_b32 v21, a117
v_mul_f32 v21, v21, v20
v_accvgpr_write_b32 a117, v21
v_accvgpr_read_b32 v21, a118
v_mul_f32 v21, v21, v20
v_accvgpr_write_b32 a118, v21
v_accvgpr_read_b32 v21, a119
v_mul_f32 v21, v21, v20
v_accvgpr_write_b32 a119, v21
v_accvgpr_read_b32 v21, a120
v_mul_f32 v21, v21, v20
v_accvgpr_write_b32 a120, v21
v_accvgpr_read_b32 v21, a121
v_mul_f32 v21, v21, v20
v_accvgpr_write_b32 a121, v21
v_accvgpr_read_b32 v21, a122
v_mul_f32 v21, v21, v20
v_accvgpr_write_b32 a122, v21
v_accvgpr_read_b32 v21, a123
v_mul_f32 v21, v21, v20
v_accvgpr_write_b32 a123, v21
v_accvgpr_read_b32 v21, a124
v_mul_f32 v21, v21, v20
v_accvgpr_write_b32 a124, v21
v_accvgpr_read_b32 v21, a125
v_mul_f32 v21, v21, v20
v_accvgpr_write_b32 a125, v21
v_accvgpr_read_b32 v21, a126
v_mul_f32 v21, v21, v20
v_accvgpr_write_b32 a126, v21
v_accvgpr_read_b32 v21, a127
v_mul_f32 v21, v21, v20
v_accvgpr_write_b32 a127, v21
s_nop 2
s_setpc_b64 s[72:73]
L_sub_1_1:
s_nop 15
s_nop 15
v_max3_f32 v18, v176, v177, v178
v_max3_f32 v18, v18, v179, v180
v_max3_f32 v18, v18, v181, v182
v_max3_f32 v18, v18, v183, v184
v_max3_f32 v18, v18, v185, v186
v_max3_f32 v18, v18, v187, v188
v_max3_f32 v18, v18, v189, v190
v_max_f32 v18, v18, v191
v_mov_b32 v19, v18
s_nop 1
v_permlane32_swap_b32 v19, v18
s_nop 1
v_max3_f32 v18, v18, v19, 0
v_sub_f32 v20, 0, v18
v_exp_f32 v20, v20
v_sub_f32 v240, v240, v18
v_sub_f32 v176, v176, v18
v_sub_f32 v144, v144, v18
v_sub_f32 v241, v241, v18
v_sub_f32 v177, v177, v18
v_sub_f32 v145, v145, v18
v_sub_f32 v242, v242, v18
v_sub_f32 v178, v178, v18
v_sub_f32 v146, v146, v18
v_sub_f32 v243, v243, v18
v_sub_f32 v179, v179, v18
v_sub_f32 v147, v147, v18
v_sub_f32 v244, v244, v18
v_sub_f32 v180, v180, v18
v_sub_f32 v148, v148, v18
v_sub_f32 v245, v245, v18
v_sub_f32 v181, v181, v18
v_sub_f32 v149, v149, v18
v_sub_f32 v246, v246, v18
v_sub_f32 v182, v182, v18
v_sub_f32 v150, v150, v18
v_sub_f32 v247, v247, v18
v_sub_f32 v183, v183, v18
v_sub_f32 v151, v151, v18
v_sub_f32 v248, v248, v18
v_sub_f32 v184, v184, v18
v_sub_f32 v152, v152, v18
v_sub_f32 v249, v249, v18
v_sub_f32 v185, v185, v18
v_sub_f32 v153, v153, v18
v_sub_f32 v250, v250, v18
v_sub_f32 v186, v186, v18
v_sub_f32 v154, v154, v18
v_sub_f32 v251, v251, v18
v_sub_f32 v187, v187, v18
v_sub_f32 v155, v155, v18
v_sub_f32 v252, v252, v18
v_sub_f32 v188, v188, v18
v_sub_f32 v156, v156, v18
v_sub_f32 v253, v253, v18
v_sub_f32 v189, v189, v18
v_sub_f32 v157, v157, v18
v_sub_f32 v254, v254, v18
v_sub_f32 v190, v190, v18
v_sub_f32 v158, v158, v18
v_sub_f32 v255, v255, v18
v_sub_f32 v191, v191, v18
v_sub_f32 v159, v159, v18
v_mul_f32 v5, v5, v20
v_exp_f32 v12, v176
v_exp_f32 v13, v177
v_exp_f32 v14, v178
v_add_f32 v7, v12, v13
v_cvt_pk_bf16_f32 v216, v12, v13
v_exp_f32 v15, v179
v_add_f32 v7, v7, v14
v_exp_f32 v16, v180
v_add_f32 v7, v7, v15
v_cvt_pk_bf16_f32 v217, v14, v15
v_exp_f32 v17, v181
v_add_f32 v7, v7, v16
v_exp_f32 v12, v182
v_add_f32 v7, v7, v17
v_cvt_pk_bf16_f32 v218, v16, v17
v_exp_f32 v13, v183
v_add_f32 v7, v7, v12
v_exp_f32 v14, v184
v_add_f32 v7, v7, v13
v_cvt_pk_bf16_f32 v219, v12, v13
v_exp_f32 v15, v185
v_add_f32 v7, v7, v14
v_exp_f32 v16, v186
v_add_f32 v7, v7, v15
v_cvt_pk_bf16_f32 v220, v14, v15
v_exp_f32 v17, v187
v_add_f32 v7, v7, v16
v_exp_f32 v12, v188
v_add_f32 v7, v7, v17
v_cvt_pk_bf16_f32 v221, v16, v17
v_exp_f32 v13, v189
v_add_f32 v7, v7, v12
v_exp_f32 v14, v190
v_add_f32 v7, v7, v13
v_cvt_pk_bf16_f32 v222, v12, v13
v_exp_f32 v15, v191
v_add_f32 v7, v7, v14
v_add_f32 v7, v7, v15
v_cvt_pk_bf16_f32 v223, v14, v15
v_accvgpr_read_b32 v21, a64
v_mul_f32 v21, v21, v20
v_accvgpr_write_b32 a64, v21
v_accvgpr_read_b32 v21, a65
v_mul_f32 v21, v21, v20
v_accvgpr_write_b32 a65, v21
v_accvgpr_read_b32 v21, a66
v_mul_f32 v21, v21, v20
v_accvgpr_write_b32 a66, v21
v_accvgpr_read_b32 v21, a67
v_mul_f32 v21, v21, v20
v_accvgpr_write_b32 a67, v21
v_accvgpr_read_b32 v21, a68
v_mul_f32 v21, v21, v20
v_accvgpr_write_b32 a68, v21
v_accvgpr_read_b32 v21, a69
v_mul_f32 v21, v21, v20
v_accvgpr_write_b32 a69, v21
v_accvgpr_read_b32 v21, a70
v_mul_f32 v21, v21, v20
v_accvgpr_write_b32 a70, v21
v_accvgpr_read_b32 v21, a71
v_mul_f32 v21, v21, v20
v_accvgpr_write_b32 a71, v21
v_accvgpr_read_b32 v21, a72
v_mul_f32 v21, v21, v20
v_accvgpr_write_b32 a72, v21
v_accvgpr_read_b32 v21, a73
v_mul_f32 v21, v21, v20
v_accvgpr_write_b32 a73, v21
v_accvgpr_read_b32 v21, a74
v_mul_f32 v21, v21, v20
v_accvgpr_write_b32 a74, v21
v_accvgpr_read_b32 v21, a75
v_mul_f32 v21, v21, v20
v_accvgpr_write_b32 a75, v21
v_accvgpr_read_b32 v21, a76
v_mul_f32 v21, v21, v20
v_accvgpr_write_b32 a76, v21
v_accvgpr_read_b32 v21, a77
v_mul_f32 v21, v21, v20
v_accvgpr_write_b32 a77, v21
v_accvgpr_read_b32 v21, a78
v_mul_f32 v21, v21, v20
v_accvgpr_write_b32 a78, v21
v_accvgpr_read_b32 v21, a79
v_mul_f32 v21, v21, v20
v_accvgpr_write_b32 a79, v21
v_accvgpr_read_b32 v21, a80
v_mul_f32 v21, v21, v20
v_accvgpr_write_b32 a80, v21
v_accvgpr_read_b32 v21, a81
v_mul_f32 v21, v21, v20
v_accvgpr_write_b32 a81, v21
v_accvgpr_read_b32 v21, a82
v_mul_f32 v21, v21, v20
v_accvgpr_write_b32 a82, v21
v_accvgpr_read_b32 v21, a83
v_mul_f32 v21, v21, v20
v_accvgpr_write_b32 a83, v21
v_accvgpr_read_b32 v21, a84
v_mul_f32 v21, v21, v20
v_accvgpr_write_b32 a84, v21
v_accvgpr_read_b32 v21, a85
v_mul_f32 v21, v21, v20
v_accvgpr_write_b32 a85, v21
v_accvgpr_read_b32 v21, a86
v_mul_f32 v21, v21, v20
v_accvgpr_write_b32 a86, v21
v_accvgpr_read_b32 v21, a87
v_mul_f32 v21, v21, v20
v_accvgpr_write_b32 a87, v21
v_accvgpr_read_b32 v21, a88
v_mul_f32 v21, v21, v20
v_accvgpr_write_b32 a88, v21
v_accvgpr_read_b32 v21, a89
v_mul_f32 v21, v21, v20
v_accvgpr_write_b32 a89, v21
v_accvgpr_read_b32 v21, a90
v_mul_f32 v21, v21, v20
v_accvgpr_write_b32 a90, v21
v_accvgpr_read_b32 v21, a91
v_mul_f32 v21, v21, v20
v_accvgpr_write_b32 a91, v21
v_accvgpr_read_b32 v21, a92
v_mul_f32 v21, v21, v20
v_accvgpr_write_b32 a92, v21
v_accvgpr_read_b32 v21, a93
v_mul_f32 v21, v21, v20
v_accvgpr_write_b32 a93, v21
v_accvgpr_read_b32 v21, a94
v_mul_f32 v21, v21, v20
v_accvgpr_write_b32 a94, v21
v_accvgpr_read_b32 v21, a95
v_mul_f32 v21, v21, v20
v_accvgpr_write_b32 a95, v21
v_accvgpr_read_b32 v21, a96
v_mul_f32 v21, v21, v20
v_accvgpr_write_b32 a96, v21
v_accvgpr_read_b32 v21, a97
v_mul_f32 v21, v21, v20
v_accvgpr_write_b32 a97, v21
v_accvgpr_read_b32 v21, a98
v_mul_f32 v21, v21, v20
v_accvgpr_write_b32 a98, v21
v_accvgpr_read_b32 v21, a99
v_mul_f32 v21, v21, v20
v_accvgpr_write_b32 a99, v21
v_accvgpr_read_b32 v21, a100
v_mul_f32 v21, v21, v20
v_accvgpr_write_b32 a100, v21
v_accvgpr_read_b32 v21, a101
v_mul_f32 v21, v21, v20
v_accvgpr_write_b32 a101, v21
v_accvgpr_read_b32 v21, a102
v_mul_f32 v21, v21, v20
v_accvgpr_write_b32 a102, v21
v_accvgpr_read_b32 v21, a103
v_mul_f32 v21, v21, v20
v_accvgpr_write_b32 a103, v21
v_accvgpr_read_b32 v21, a104
v_mul_f32 v21, v21, v20
v_accvgpr_write_b32 a104, v21
v_accvgpr_read_b32 v21, a105
v_mul_f32 v21, v21, v20
v_accvgpr_write_b32 a105, v21
v_accvgpr_read_b32 v21, a106
v_mul_f32 v21, v21, v20
v_accvgpr_write_b32 a106, v21
v_accvgpr_read_b32 v21, a107
v_mul_f32 v21, v21, v20
v_accvgpr_write_b32 a107, v21
v_accvgpr_read_b32 v21, a108
v_mul_f32 v21, v21, v20
v_accvgpr_write_b32 a108, v21
v_accvgpr_read_b32 v21, a109
v_mul_f32 v21, v21, v20
v_accvgpr_write_b32 a109, v21
v_accvgpr_read_b32 v21, a110
v_mul_f32 v21, v21, v20
v_accvgpr_write_b32 a110, v21
v_accvgpr_read_b32 v21, a111
v_mul_f32 v21, v21, v20
v_accvgpr_write_b32 a111, v21
v_accvgpr_read_b32 v21, a112
v_mul_f32 v21, v21, v20
v_accvgpr_write_b32 a112, v21
v_accvgpr_read_b32 v21, a113
v_mul_f32 v21, v21, v20
v_accvgpr_write_b32 a113, v21
v_accvgpr_read_b32 v21, a114
v_mul_f32 v21, v21, v20
v_accvgpr_write_b32 a114, v21
v_accvgpr_read_b32 v21, a115
v_mul_f32 v21, v21, v20
v_accvgpr_write_b32 a115, v21
v_accvgpr_read_b32 v21, a116
v_mul_f32 v21, v21, v20
v_accvgpr_write_b32 a116, v21
v_accvgpr_read_b32 v21, a117
v_mul_f32 v21, v21, v20
v_accvgpr_write_b32 a117, v21
v_accvgpr_read_b32 v21, a118
v_mul_f32 v21, v21, v20
v_accvgpr_write_b32 a118, v21
v_accvgpr_read_b32 v21, a119
v_mul_f32 v21, v21, v20
v_accvgpr_write_b32 a119, v21
v_accvgpr_read_b32 v21, a120
v_mul_f32 v21, v21, v20
v_accvgpr_write_b32 a120, v21
v_accvgpr_read_b32 v21, a121
v_mul_f32 v21, v21, v20
v_accvgpr_write_b32 a121, v21
v_accvgpr_read_b32 v21, a122
v_mul_f32 v21, v21, v20
v_accvgpr_write_b32 a122, v21
v_accvgpr_read_b32 v21, a123
v_mul_f32 v21, v21, v20
v_accvgpr_write_b32 a123, v21
v_accvgpr_read_b32 v21, a124
v_mul_f32 v21, v21, v20
v_accvgpr_write_b32 a124, v21
v_accvgpr_read_b32 v21, a125
v_mul_f32 v21, v21, v20
v_accvgpr_write_b32 a125, v21
v_accvgpr_read_b32 v21, a126
v_mul_f32 v21, v21, v20
v_accvgpr_write_b32 a126, v21
v_accvgpr_read_b32 v21, a127
v_mul_f32 v21, v21, v20
v_accvgpr_write_b32 a127, v21
s_nop 2
s_setpc_b64 s[72:73]
L_p3end_80:
L_k12_end:
s_endpgm
.section .rodata,"a"
.p2align 6
.amdhsa_kernel gated_mix__compressed_kv_cla__mixer_channel_mlp__prompt_kernel
  .amdhsa_next_free_vgpr 512
  .amdhsa_next_free_sgpr 102
  .amdhsa_accum_offset 256
  .amdhsa_group_segment_fixed_size 0
  .amdhsa_kernarg_size 120
  .amdhsa_user_sgpr_count 2
  .amdhsa_user_sgpr_kernarg_segment_ptr 1
  .amdhsa_system_sgpr_workgroup_id_x 1
  .amdhsa_float_denorm_mode_32 3
.end_amdhsa_kernel
```
